```python
import torch

def _softmax(x, axis=-1):
    return torch.softmax(x, dim=axis)

def _gelu(x):
    return torch.nn.functional.gelu(x, approximate='tanh')

def _silu(x):
    return torch.nn.functional.silu(x)

def _sigmoid(x):
    return torch.sigmoid(x)

def _layernorm(x, axis=-1, eps=1e-05):
    m = x.mean(dim=axis, keepdim=True)
    v = x.var(dim=axis, keepdim=True, unbiased=False)
    return (x - m) / torch.sqrt(v + eps)

def _scatter_add(tgt, idx, src, axis=0):
    return tgt.clone().index_add_(axis, idx, src)

def _segment_sum(src, seg, n):
    out = torch.zeros((n,) + src.shape[1:], dtype=src.dtype)
    return out.index_add_(0, seg, src)

def _pad(x, pw):
    flat = tuple((v for pair in reversed(pw) for v in pair))
    return torch.nn.functional.pad(x, flat)
kernel_name = 'sequential_preLN__memory_aug_recurrent_mem_tr__mixer_channel_mlp__prompt'

def setup_inputs():

    _w = lambda a: (lambda t: t.to(torch.bfloat16) if t.is_floating_point() else t)(torch.as_tensor(a))

    def _A_setup():
        B, S, Dm = (1, 2048, 448)
        H, Dh = (16, 256)
        M, seg = (8, 32)
        seg = min(seg, S)
        S = S // seg * seg
        return {'x': _w((lambda *s: torch.randn(*s, dtype=torch.bfloat16) * 0.05)(B, S, Dm)), 'mem0': _w((lambda *s: torch.randn(*s, dtype=torch.bfloat16) * 0.2)(B, M, Dm)), 'Wq': _w((lambda *s: torch.randn(*s, dtype=torch.bfloat16) * 1.6)(Dm, H, Dh) * Dm ** (-0.5)), 'Wk': _w((lambda *s: torch.randn(*s, dtype=torch.bfloat16) * 1.6)(Dm, H, Dh) * Dm ** (-0.5)), 'Wv': _w((lambda *s: torch.randn(*s, dtype=torch.bfloat16) * 0.2)(Dm, H, Dh) * Dm ** (-0.5)), 'Wo': _w((lambda *s: torch.randn(*s, dtype=torch.bfloat16) * 0.2)(H, Dh, Dm) * (H * Dh) ** (-0.5)), 'seg_len': seg}
    _A_in = _A_setup()

    def _B_setup():
        B, S, D, F = (1, 2048, 448, 1792)
        return {'x': _w((lambda *s: torch.randn(*s, dtype=torch.bfloat16) * 0.05)(B, S, D)), 'w1': _w((lambda *s: torch.randn(*s, dtype=torch.bfloat16) * 0.8)(D, F) * D ** (-0.5)), 'b1': _w((lambda *s: torch.randn(*s, dtype=torch.bfloat16) * 0.4)(F)), 'w2': _w((lambda *s: torch.randn(*s, dtype=torch.bfloat16) * 0.05)(F, D) * F ** (-0.5)), 'b2': _w((lambda *s: torch.randn(*s, dtype=torch.bfloat16) * 0.05)(D))}
    _B_in = _B_setup()
    return {'A_x': _A_in['x'], 'A_mem0': _A_in['mem0'], 'A_Wq': _A_in['Wq'], 'A_Wk': _A_in['Wk'], 'A_Wv': _A_in['Wv'], 'A_Wo': _A_in['Wo'], 'A_seg_len': _A_in['seg_len'], 'B_x': _B_in['x'], 'B_w1': _B_in['w1'], 'B_b1': _B_in['b1'], 'B_w2': _B_in['w2'], 'B_b2': _B_in['b2']}

def reference(A_x, A_mem0, A_Wq, A_Wk, A_Wv, A_Wo, A_seg_len, B_x, B_w1, B_b1, B_w2, B_b2):

    def _A_ref(x, mem0, Wq, Wk, Wv, Wo, seg_len):
        B, S, Dm = x.shape
        H, Dh = (Wq.shape[1], Wq.shape[2])
        M = mem0.shape[1]
        scale = Dh ** (-0.5)
        n_seg = S // seg_len
        L = M + seg_len
        idx = torch.arange(L)
        mask = (idx[:, None] < M) | (idx[:, None] >= idx[None, :])
        mem = mem0
        outs = []
        for s in range(n_seg):
            xs = x[:, s * seg_len:(s + 1) * seg_len, :].clone()
            h = torch.concatenate([mem, xs], axis=1)
            q = torch.einsum('btd,dhe->bhte', h, Wq)
            k = torch.einsum('btd,dhe->bhte', h, Wk)
            v = torch.einsum('btd,dhe->bhte', h, Wv)
            scores = torch.einsum('bhqe,bhke->bhqk', q, k) * scale
            scores = torch.where(mask[None, None], scores, -1000000000.0)
            p = _softmax(scores, axis=-1)
            o = torch.einsum('bhqk,bhke->bhqe', p, v)
            o = torch.einsum('bhte,hed->btd', o, Wo)
            mem = o[:, :M, :].clone()
            outs.append(o[:, M:, :])
        return torch.concatenate(outs, axis=1)

    def _B_ref(x, w1, b1, w2, b2):
        y = _layernorm(x, axis=-1)
        h = _gelu(torch.einsum('bsd,df->bsf', y, w1) + b1)
        return torch.einsum('bsf,fd->bsd', h, w2) + b2
    x = A_x
    h = x + _A_ref(_layernorm(x, axis=-1), A_mem0, A_Wq, A_Wk, A_Wv, A_Wo, A_seg_len)
    h2 = h + _B_ref(_layernorm(h, axis=-1), B_w1, B_b1, B_w2, B_b2)
    return h2
```

```asm
; @launch kernel=sequential_preLN__memory_aug_recurrent_mem_tr__mixer_channel_mlp__prompt_kernel grid=(256,1,1) block=(256,1,1) lds=162048
.amdgcn_target "amdgcn-amd-amdhsa--gfx950"
.text
.globl sequential_preLN__memory_aug_recurrent_mem_tr__mixer_channel_mlp__prompt_kernel
.p2align 8
.type sequential_preLN__memory_aug_recurrent_mem_tr__mixer_channel_mlp__prompt_kernel,@function
sequential_preLN__memory_aug_recurrent_mem_tr__mixer_channel_mlp__prompt_kernel:
 s_cmp_lt_u32 s2, 256
 s_cbranch_scc1 MAIN_go
 s_endpgm
MAIN_go:
 s_getpc_b64 s[4:5]
EN_pc:
 s_lshr_b32 s3, s2, 3
 s_sub_u32 s3, s3, 28
 s_cmp_ge_u32 s3, 3
 s_cbranch_scc1 EN_npf
 s_lshl_b32 s3, s3, 15
 v_lshlrev_b32 v244, 7, v0
 v_add_u32 v244, s3, v244
 v_min_u32 v244, CODE_END-EN_pc-4, v244
 global_load_dword v245, v244, s[4:5]
EN_npf:
 s_load_dwordx2 s[28:29], s[0:1], 104
 s_mov_b32 s30, 256
 s_mov_b32 s31, 0x20000
 v_readfirstlane_b32 s40, v0
 s_getreg_b32 s41, hwreg(HW_REG_XCC_ID)
 s_and_b32 s41, s41, 15
 s_mov_b32 s35, 0
 s_lshr_b32 s40, s40, 6
 s_load_dwordx2 s[16:17], s[0:1], 112
 s_mov_b32 s18, 268435456
 s_mov_b32 s19, 0x20000
 s_load_dwordx2 s[24:25], s[0:1], 0
 s_mov_b32 s26, 1835008
 s_mov_b32 s27, 0x20000
 s_load_dwordx8 s[84:91], s[0:1], 16
 v_and_b32 v0, 63, v0
 v_lshlrev_b32 v1, 4, v0
 s_mov_b32 s68, 524288
 s_memrealtime s[56:57]
 s_mov_b32 s46, s2
 s_mov_b32 s34, 0
 v_mov_b32 v250, 1073741824
 v_cmp_eq_u32 vcc, 0, v0
 s_nop 1
 v_cndmask_b32 v250, v250, 0, vcc
 v_mov_b32 v251, 1
 v_mov_b32 v253, 0
 v_mov_b32 v240, 1
 s_waitcnt lgkmcnt(0)
 s_cmp_lg_u32 s40, 0
 s_cbranch_scc1 EN_k
 s_and_b32 s55, s41, 7
 s_lshl_b32 s55, s55, 5
 s_mov_b32 s35, 1
 s_atomic_add s35, s[28:29], s55 glc
EN_k:
 s_cmp_ge_u32 s40, 0
 s_cbranch_scc1 EN_0
 s_cmp_eq_u32 s40, 0
 s_cselect_b64 s[60:61], s[88:89], s[90:91]
 s_cmp_eq_u32 s40, 2
 s_cselect_b64 s[60:61], s[84:85], s[60:61]
 s_cmp_eq_u32 s40, 3
 s_cselect_b64 s[60:61], s[86:87], s[60:61]
 s_mov_b32 s62, 3670016
 s_mov_b32 s63, 0x20000
 s_mul_i32 s64, s2, 14336
 s_add_u32 s65, s64, 6144
 v_lshlrev_b32 v116, 7, v0
 buffer_load_dword v115, v116, s[60:63], s64 offen
 buffer_load_dword v115, v116, s[60:63], s65 offen
EN_0:
 s_cmp_lg_u32 s40, 2
 s_cbranch_scc1 EN_1
 s_cmp_lg_u32 s2, 0
 s_cbranch_scc1 EN_1
 s_or_b32 s34, s56, 1
 s_lshl_b32 s34, s34, 4
 v_mov_b32 v2, s34
 buffer_store_dword v2, v250, s[28:31], 0 offen offset:248 sc1
EN_1:
 s_cmp_lg_u32 s40, 3
 s_cbranch_scc1 EN_2
 v_lshrrev_b32 v5, 3, v0
 v_mul_u32_u24 v5, 896, v5
 v_and_b32 v6, 7, v0
 v_lshl_add_u32 v5, v6, 4, v5
 s_mul_i32 s58, s2, 7168
 buffer_load_dwordx4 v[120:123], v5, s[24:27], s58 offen offset:0
 buffer_load_dwordx4 v[124:127], v5, s[24:27], s58 offen offset:128
 buffer_load_dwordx4 v[128:131], v5, s[24:27], s58 offen offset:256
 buffer_load_dwordx4 v[132:135], v5, s[24:27], s58 offen offset:384
 buffer_load_dwordx4 v[136:139], v5, s[24:27], s58 offen offset:512
 buffer_load_dwordx4 v[140:143], v5, s[24:27], s58 offen offset:640
 buffer_load_dwordx4 v[144:147], v5, s[24:27], s58 offen offset:768
EN_2:
 v_lshrrev_b32 v100, 2, v0
 v_bfe_u32 v102, v0, 5, 1
 v_bfe_u32 v103, v0, 4, 1
 v_xor_b32 v103, v103, v102
 v_lshl_add_u32 v102, v103, 1, v102
 v_and_b32 v101, 3, v0
 v_xor_b32 v101, v101, v102
 v_lshrrev_b32 v104, 2, v100
 v_lshlrev_b32 v104, 3, v104
 v_and_b32 v105, 3, v100
 v_add_u32 v104, v104, v105
 v_lshlrev_b32 v104, 13, v104
 v_lshl_add_u32 v104, v101, 4, v104
 v_lshrrev_b32 v106, 3, v100
 v_lshlrev_b32 v106, 4, v106
 v_bfe_u32 v105, v100, 1, 2
 v_lshl_add_u32 v106, v105, 2, v106
 v_and_b32 v105, 1, v100
 v_add_u32 v106, v106, v105
 v_lshlrev_b32 v106, 13, v106
 v_lshl_add_u32 v106, v101, 4, v106
 v_lshrrev_b32 v107, 3, v0
 v_mul_u32_u24 v107, 896, v107
 v_and_b32 v105, 7, v0
 v_lshl_add_u32 v107, v105, 4, v107
 v_lshrrev_b32 v110, 4, v0
 v_and_b32 v111, 15, v0
 v_bfe_u32 v102, v0, 3, 1
 v_bfe_u32 v103, v0, 2, 1
 v_xor_b32 v103, v103, v102
 v_lshl_add_u32 v102, v103, 1, v102
 v_xor_b32 v102, v102, v110
 v_lshlrev_b32 v108, 6, v111
 v_lshl_add_u32 v108, v102, 4, v108
 s_lshl_b32 s47, s40, 13
 s_add_u32 s47, s47, 114688
 v_add_u32 v109, s47, v108
 v_lshlrev_b32 v112, 10, v110
 v_lshrrev_b32 v105, 2, v111
 v_lshl_add_u32 v112, v105, 7, v112
 v_and_b32 v105, 3, v0
 v_lshl_add_u32 v112, v105, 3, v112
 s_lshl_b32 s54, s40, 5
 s_add_u32 s54, s54, 114688
 v_add_u32 v112, s54, v112
 s_mov_b32 s22, 3670016
 s_mov_b32 s23, 0x20000
 s_mov_b32 s26, 3670016
 s_mov_b32 s27, 0x20000
 s_mov_b32 s42, 0
 s_mov_b32 s43, 0
 s_mov_b64 s[20:21], s[88:89]
 s_mov_b64 s[24:25], s[90:91]
 s_mov_b64 s[8:9], s[84:85]
 s_mov_b64 s[12:13], s[86:87]
 s_mov_b32 s10, 3670016
 s_mov_b32 s11, 0x20000
 s_mov_b32 s14, 3670016
 s_mov_b32 s15, 0x20000
 s_mov_b32 s49, 1
 v_add_u32 v232, 0, v1
 v_add_u32 v233, 4096, v1
 v_add_u32 v234, 8192, v1
 v_add_u32 v235, 12288, v1
 v_add_u32 v236, 16384, v1
 v_add_u32 v237, 20480, v1
 v_add_u32 v238, 24576, v1
 s_cmp_lg_u32 s40, 0
 s_cbranch_scc1 SL_w
 s_waitcnt lgkmcnt(0)
 s_mov_b32 s56, s35
 s_and_b32 s57, s41, 7
 s_lshl_b32 s46, s57, 5
 s_add_u32 s46, s46, s56
 s_cmp_lt_u32 s56, 32
 s_cbranch_scc1 SL_ok
SL_eg:
 s_cmp_lg_u32 s34, 0
 s_cbranch_scc1 SL_eh
 buffer_load_dword v114, v253, s[28:31], 0 offen offset:248 sc1
 s_waitcnt vmcnt(0)
 v_readfirstlane_b32 s34, v114
 s_max_u32 s68, s68, 1
 s_sub_u32 s68, s68, 1
 s_cmp_lg_u32 s68, 0
 s_cbranch_scc1 SL_eg
SL_eh:
 v_mov_b32 v240, 1
 buffer_atomic_add v240, v250, s[28:31], 0 offen offset:16 sc0
 s_waitcnt vmcnt(0)
 v_readfirstlane_b32 s56, v240
 v_lshlrev_b32 v241, 2, v0
 s_mov_b32 s58, 2092032
SL_sp:
 buffer_load_dword v240, v253, s[28:31], 0 offen offset:16 sc1
 buffer_load_dword v242, v241, s[16:19], s58 offen offset:0 sc1
 buffer_load_dword v243, v241, s[16:19], s58 offen offset:256 sc1
 buffer_load_dword v244, v241, s[16:19], s58 offen offset:512 sc1
 buffer_load_dword v245, v241, s[16:19], s58 offen offset:768 sc1
 s_waitcnt vmcnt(0)
 v_readfirstlane_b32 s57, v240
 v_and_b32 v242, -16, v242
 v_cmp_eq_u32 vcc, s34, v242
 s_nop 0
 s_bcnt1_i32_b32 s80, vcc_lo
 s_bcnt1_i32_b32 s81, vcc_hi
 s_add_u32 s57, s57, s80
 s_add_u32 s57, s57, s81
 v_and_b32 v243, -16, v243
 v_cmp_eq_u32 vcc, s34, v243
 s_nop 0
 s_bcnt1_i32_b32 s82, vcc_lo
 s_bcnt1_i32_b32 s83, vcc_hi
 s_add_u32 s57, s57, s82
 s_add_u32 s57, s57, s83
 v_and_b32 v244, -16, v244
 v_cmp_eq_u32 vcc, s34, v244
 s_nop 0
 s_bcnt1_i32_b32 s84, vcc_lo
 s_bcnt1_i32_b32 s85, vcc_hi
 s_add_u32 s57, s57, s84
 s_add_u32 s57, s57, s85
 v_and_b32 v245, -16, v245
 v_cmp_eq_u32 vcc, s34, v245
 s_nop 0
 s_bcnt1_i32_b32 s86, vcc_lo
 s_bcnt1_i32_b32 s87, vcc_hi
 s_add_u32 s57, s57, s86
 s_add_u32 s57, s57, s87
 s_cmp_ge_u32 s57, 256
 s_cbranch_scc1 SL_sc
 s_max_u32 s68, s68, 1
 s_sub_u32 s68, s68, 1
 s_cmp_lg_u32 s68, 0
 s_cbranch_scc1 SL_sp
SL_sc:
 s_min_u32 s57, s80, 32
 s_sub_u32 s58, 32, s57
 s_add_u32 s46, s57, s56
 s_add_u32 s46, s46, 0
 s_cmp_lt_u32 s56, s58
 s_cbranch_scc1 SL_ok
 s_sub_u32 s56, s56, s58
 s_min_u32 s57, s81, 32
 s_sub_u32 s58, 32, s57
 s_add_u32 s46, s57, s56
 s_add_u32 s46, s46, 32
 s_cmp_lt_u32 s56, s58
 s_cbranch_scc1 SL_ok
 s_sub_u32 s56, s56, s58
 s_min_u32 s57, s82, 32
 s_sub_u32 s58, 32, s57
 s_add_u32 s46, s57, s56
 s_add_u32 s46, s46, 64
 s_cmp_lt_u32 s56, s58
 s_cbranch_scc1 SL_ok
 s_sub_u32 s56, s56, s58
 s_min_u32 s57, s83, 32
 s_sub_u32 s58, 32, s57
 s_add_u32 s46, s57, s56
 s_add_u32 s46, s46, 96
 s_cmp_lt_u32 s56, s58
 s_cbranch_scc1 SL_ok
 s_sub_u32 s56, s56, s58
 s_min_u32 s57, s84, 32
 s_sub_u32 s58, 32, s57
 s_add_u32 s46, s57, s56
 s_add_u32 s46, s46, 128
 s_cmp_lt_u32 s56, s58
 s_cbranch_scc1 SL_ok
 s_sub_u32 s56, s56, s58
 s_min_u32 s57, s85, 32
 s_sub_u32 s58, 32, s57
 s_add_u32 s46, s57, s56
 s_add_u32 s46, s46, 160
 s_cmp_lt_u32 s56, s58
 s_cbranch_scc1 SL_ok
 s_sub_u32 s56, s56, s58
 s_min_u32 s57, s86, 32
 s_sub_u32 s58, 32, s57
 s_add_u32 s46, s57, s56
 s_add_u32 s46, s46, 192
 s_cmp_lt_u32 s56, s58
 s_cbranch_scc1 SL_ok
 s_sub_u32 s56, s56, s58
 s_min_u32 s57, s87, 32
 s_sub_u32 s58, 32, s57
 s_add_u32 s46, s57, s56
 s_add_u32 s46, s46, 224
 s_cmp_lt_u32 s56, s58
 s_cbranch_scc1 SL_ok
 s_sub_u32 s56, s56, s58
 s_mov_b32 s46, 255
SL_ok:
 v_mov_b32 v242, s46
 v_mov_b32 v241, 147456
 ds_write_b32 v241, v242
 s_waitcnt lgkmcnt(0)
SL_w:
 s_barrier
 v_mov_b32 v241, 147456
 ds_read_b32 v242, v241
 s_waitcnt lgkmcnt(0)
 v_readfirstlane_b32 s46, v242
 v_mov_b32 v116, 1073741824
 v_mov_b32 v117, 1073741824
 s_cmp_lg_u32 s40, 3
 s_cbranch_scc1 LNC_done
 s_waitcnt vmcnt(0)
 v_lshlrev_b32 v148, 16, v120
 v_and_b32 v149, 0xffff0000, v120
 v_lshlrev_b32 v150, 16, v121
 v_and_b32 v151, 0xffff0000, v121
 v_lshlrev_b32 v152, 16, v122
 v_and_b32 v153, 0xffff0000, v122
 v_lshlrev_b32 v154, 16, v123
 v_and_b32 v155, 0xffff0000, v123
 v_lshlrev_b32 v156, 16, v124
 v_and_b32 v157, 0xffff0000, v124
 v_lshlrev_b32 v158, 16, v125
 v_and_b32 v159, 0xffff0000, v125
 v_lshlrev_b32 v160, 16, v126
 v_and_b32 v161, 0xffff0000, v126
 v_lshlrev_b32 v162, 16, v127
 v_and_b32 v163, 0xffff0000, v127
 v_lshlrev_b32 v164, 16, v128
 v_and_b32 v165, 0xffff0000, v128
 v_lshlrev_b32 v166, 16, v129
 v_and_b32 v167, 0xffff0000, v129
 v_lshlrev_b32 v168, 16, v130
 v_and_b32 v169, 0xffff0000, v130
 v_lshlrev_b32 v170, 16, v131
 v_and_b32 v171, 0xffff0000, v131
 v_lshlrev_b32 v172, 16, v132
 v_and_b32 v173, 0xffff0000, v132
 v_lshlrev_b32 v174, 16, v133
 v_and_b32 v175, 0xffff0000, v133
 v_lshlrev_b32 v176, 16, v134
 v_and_b32 v177, 0xffff0000, v134
 v_lshlrev_b32 v178, 16, v135
 v_and_b32 v179, 0xffff0000, v135
 v_lshlrev_b32 v180, 16, v136
 v_and_b32 v181, 0xffff0000, v136
 v_lshlrev_b32 v182, 16, v137
 v_and_b32 v183, 0xffff0000, v137
 v_lshlrev_b32 v184, 16, v138
 v_and_b32 v185, 0xffff0000, v138
 v_lshlrev_b32 v186, 16, v139
 v_and_b32 v187, 0xffff0000, v139
 v_lshlrev_b32 v188, 16, v140
 v_and_b32 v189, 0xffff0000, v140
 v_lshlrev_b32 v190, 16, v141
 v_and_b32 v191, 0xffff0000, v141
 v_lshlrev_b32 v192, 16, v142
 v_and_b32 v193, 0xffff0000, v142
 v_lshlrev_b32 v194, 16, v143
 v_and_b32 v195, 0xffff0000, v143
 v_lshlrev_b32 v196, 16, v144
 v_and_b32 v197, 0xffff0000, v144
 v_lshlrev_b32 v198, 16, v145
 v_and_b32 v199, 0xffff0000, v145
 v_lshlrev_b32 v200, 16, v146
 v_and_b32 v201, 0xffff0000, v146
 v_lshlrev_b32 v202, 16, v147
 v_and_b32 v203, 0xffff0000, v147
 v_add_f32 v116, v148, v149
 v_add_f32 v117, v150, v151
 v_add_f32 v116, v116, v152
 v_add_f32 v117, v117, v153
 v_add_f32 v116, v116, v154
 v_add_f32 v117, v117, v155
 v_add_f32 v116, v116, v156
 v_add_f32 v117, v117, v157
 v_add_f32 v116, v116, v158
 v_add_f32 v117, v117, v159
 v_add_f32 v116, v116, v160
 v_add_f32 v117, v117, v161
 v_add_f32 v116, v116, v162
 v_add_f32 v117, v117, v163
 v_add_f32 v116, v116, v164
 v_add_f32 v117, v117, v165
 v_add_f32 v116, v116, v166
 v_add_f32 v117, v117, v167
 v_add_f32 v116, v116, v168
 v_add_f32 v117, v117, v169
 v_add_f32 v116, v116, v170
 v_add_f32 v117, v117, v171
 v_add_f32 v116, v116, v172
 v_add_f32 v117, v117, v173
 v_add_f32 v116, v116, v174
 v_add_f32 v117, v117, v175
 v_add_f32 v116, v116, v176
 v_add_f32 v117, v117, v177
 v_add_f32 v116, v116, v178
 v_add_f32 v117, v117, v179
 v_add_f32 v116, v116, v180
 v_add_f32 v117, v117, v181
 v_add_f32 v116, v116, v182
 v_add_f32 v117, v117, v183
 v_add_f32 v116, v116, v184
 v_add_f32 v117, v117, v185
 v_add_f32 v116, v116, v186
 v_add_f32 v117, v117, v187
 v_add_f32 v116, v116, v188
 v_add_f32 v117, v117, v189
 v_add_f32 v116, v116, v190
 v_add_f32 v117, v117, v191
 v_add_f32 v116, v116, v192
 v_add_f32 v117, v117, v193
 v_add_f32 v116, v116, v194
 v_add_f32 v117, v117, v195
 v_add_f32 v116, v116, v196
 v_add_f32 v117, v117, v197
 v_add_f32 v116, v116, v198
 v_add_f32 v117, v117, v199
 v_add_f32 v116, v116, v200
 v_add_f32 v117, v117, v201
 v_add_f32 v116, v116, v202
 v_add_f32 v117, v117, v203
 v_add_f32 v116, v116, v117
 s_nop 1
 v_add_f32_dpp v116, v116, v116 quad_perm:[1,0,3,2] row_mask:0xf bank_mask:0xf
 s_nop 1
 v_add_f32_dpp v116, v116, v116 quad_perm:[2,3,0,1] row_mask:0xf bank_mask:0xf
 s_nop 1
 v_add_f32_dpp v116, v116, v116 row_half_mirror row_mask:0xf bank_mask:0xf
 v_mul_f32 v116, 991054117, v116
 v_sub_f32 v148, v148, v116
 v_sub_f32 v149, v149, v116
 v_sub_f32 v150, v150, v116
 v_sub_f32 v151, v151, v116
 v_sub_f32 v152, v152, v116
 v_sub_f32 v153, v153, v116
 v_sub_f32 v154, v154, v116
 v_sub_f32 v155, v155, v116
 v_sub_f32 v156, v156, v116
 v_sub_f32 v157, v157, v116
 v_sub_f32 v158, v158, v116
 v_sub_f32 v159, v159, v116
 v_sub_f32 v160, v160, v116
 v_sub_f32 v161, v161, v116
 v_sub_f32 v162, v162, v116
 v_sub_f32 v163, v163, v116
 v_sub_f32 v164, v164, v116
 v_sub_f32 v165, v165, v116
 v_sub_f32 v166, v166, v116
 v_sub_f32 v167, v167, v116
 v_sub_f32 v168, v168, v116
 v_sub_f32 v169, v169, v116
 v_sub_f32 v170, v170, v116
 v_sub_f32 v171, v171, v116
 v_sub_f32 v172, v172, v116
 v_sub_f32 v173, v173, v116
 v_sub_f32 v174, v174, v116
 v_sub_f32 v175, v175, v116
 v_sub_f32 v176, v176, v116
 v_sub_f32 v177, v177, v116
 v_sub_f32 v178, v178, v116
 v_sub_f32 v179, v179, v116
 v_sub_f32 v180, v180, v116
 v_sub_f32 v181, v181, v116
 v_sub_f32 v182, v182, v116
 v_sub_f32 v183, v183, v116
 v_sub_f32 v184, v184, v116
 v_sub_f32 v185, v185, v116
 v_sub_f32 v186, v186, v116
 v_sub_f32 v187, v187, v116
 v_sub_f32 v188, v188, v116
 v_sub_f32 v189, v189, v116
 v_sub_f32 v190, v190, v116
 v_sub_f32 v191, v191, v116
 v_sub_f32 v192, v192, v116
 v_sub_f32 v193, v193, v116
 v_sub_f32 v194, v194, v116
 v_sub_f32 v195, v195, v116
 v_sub_f32 v196, v196, v116
 v_sub_f32 v197, v197, v116
 v_sub_f32 v198, v198, v116
 v_sub_f32 v199, v199, v116
 v_sub_f32 v200, v200, v116
 v_sub_f32 v201, v201, v116
 v_sub_f32 v202, v202, v116
 v_sub_f32 v203, v203, v116
 v_mul_f32 v116, v148, v148
 v_mul_f32 v117, v149, v149
 v_fmac_f32 v116, v150, v150
 v_fmac_f32 v117, v151, v151
 v_fmac_f32 v116, v152, v152
 v_fmac_f32 v117, v153, v153
 v_fmac_f32 v116, v154, v154
 v_fmac_f32 v117, v155, v155
 v_fmac_f32 v116, v156, v156
 v_fmac_f32 v117, v157, v157
 v_fmac_f32 v116, v158, v158
 v_fmac_f32 v117, v159, v159
 v_fmac_f32 v116, v160, v160
 v_fmac_f32 v117, v161, v161
 v_fmac_f32 v116, v162, v162
 v_fmac_f32 v117, v163, v163
 v_fmac_f32 v116, v164, v164
 v_fmac_f32 v117, v165, v165
 v_fmac_f32 v116, v166, v166
 v_fmac_f32 v117, v167, v167
 v_fmac_f32 v116, v168, v168
 v_fmac_f32 v117, v169, v169
 v_fmac_f32 v116, v170, v170
 v_fmac_f32 v117, v171, v171
 v_fmac_f32 v116, v172, v172
 v_fmac_f32 v117, v173, v173
 v_fmac_f32 v116, v174, v174
 v_fmac_f32 v117, v175, v175
 v_fmac_f32 v116, v176, v176
 v_fmac_f32 v117, v177, v177
 v_fmac_f32 v116, v178, v178
 v_fmac_f32 v117, v179, v179
 v_fmac_f32 v116, v180, v180
 v_fmac_f32 v117, v181, v181
 v_fmac_f32 v116, v182, v182
 v_fmac_f32 v117, v183, v183
 v_fmac_f32 v116, v184, v184
 v_fmac_f32 v117, v185, v185
 v_fmac_f32 v116, v186, v186
 v_fmac_f32 v117, v187, v187
 v_fmac_f32 v116, v188, v188
 v_fmac_f32 v117, v189, v189
 v_fmac_f32 v116, v190, v190
 v_fmac_f32 v117, v191, v191
 v_fmac_f32 v116, v192, v192
 v_fmac_f32 v117, v193, v193
 v_fmac_f32 v116, v194, v194
 v_fmac_f32 v117, v195, v195
 v_fmac_f32 v116, v196, v196
 v_fmac_f32 v117, v197, v197
 v_fmac_f32 v116, v198, v198
 v_fmac_f32 v117, v199, v199
 v_fmac_f32 v116, v200, v200
 v_fmac_f32 v117, v201, v201
 v_fmac_f32 v116, v202, v202
 v_fmac_f32 v117, v203, v203
 v_add_f32 v116, v116, v117
 s_nop 1
 v_add_f32_dpp v116, v116, v116 quad_perm:[1,0,3,2] row_mask:0xf bank_mask:0xf
 s_nop 1
 v_add_f32_dpp v116, v116, v116 quad_perm:[2,3,0,1] row_mask:0xf bank_mask:0xf
 s_nop 1
 v_add_f32_dpp v116, v116, v116 row_half_mirror row_mask:0xf bank_mask:0xf
 v_mov_b32 v117, 925353388
 v_fmac_f32 v117, 991054117, v116
 v_rsq_f32 v116, v117
 s_nop 0
 v_mul_f32 v148, v148, v116
 v_mul_f32 v149, v149, v116
 v_mul_f32 v150, v150, v116
 v_mul_f32 v151, v151, v116
 v_mul_f32 v152, v152, v116
 v_mul_f32 v153, v153, v116
 v_mul_f32 v154, v154, v116
 v_mul_f32 v155, v155, v116
 v_mul_f32 v156, v156, v116
 v_mul_f32 v157, v157, v116
 v_mul_f32 v158, v158, v116
 v_mul_f32 v159, v159, v116
 v_mul_f32 v160, v160, v116
 v_mul_f32 v161, v161, v116
 v_mul_f32 v162, v162, v116
 v_mul_f32 v163, v163, v116
 v_mul_f32 v164, v164, v116
 v_mul_f32 v165, v165, v116
 v_mul_f32 v166, v166, v116
 v_mul_f32 v167, v167, v116
 v_mul_f32 v168, v168, v116
 v_mul_f32 v169, v169, v116
 v_mul_f32 v170, v170, v116
 v_mul_f32 v171, v171, v116
 v_mul_f32 v172, v172, v116
 v_mul_f32 v173, v173, v116
 v_mul_f32 v174, v174, v116
 v_mul_f32 v175, v175, v116
 v_mul_f32 v176, v176, v116
 v_mul_f32 v177, v177, v116
 v_mul_f32 v178, v178, v116
 v_mul_f32 v179, v179, v116
 v_mul_f32 v180, v180, v116
 v_mul_f32 v181, v181, v116
 v_mul_f32 v182, v182, v116
 v_mul_f32 v183, v183, v116
 v_mul_f32 v184, v184, v116
 v_mul_f32 v185, v185, v116
 v_mul_f32 v186, v186, v116
 v_mul_f32 v187, v187, v116
 v_mul_f32 v188, v188, v116
 v_mul_f32 v189, v189, v116
 v_mul_f32 v190, v190, v116
 v_mul_f32 v191, v191, v116
 v_mul_f32 v192, v192, v116
 v_mul_f32 v193, v193, v116
 v_mul_f32 v194, v194, v116
 v_mul_f32 v195, v195, v116
 v_mul_f32 v196, v196, v116
 v_mul_f32 v197, v197, v116
 v_mul_f32 v198, v198, v116
 v_mul_f32 v199, v199, v116
 v_mul_f32 v200, v200, v116
 v_mul_f32 v201, v201, v116
 v_mul_f32 v202, v202, v116
 v_mul_f32 v203, v203, v116
 v_cvt_pk_bf16_f32 v120, v148, v149
 v_cvt_pk_bf16_f32 v121, v150, v151
 v_cvt_pk_bf16_f32 v122, v152, v153
 v_cvt_pk_bf16_f32 v123, v154, v155
 v_cvt_pk_bf16_f32 v124, v156, v157
 v_cvt_pk_bf16_f32 v125, v158, v159
 v_cvt_pk_bf16_f32 v126, v160, v161
 v_cvt_pk_bf16_f32 v127, v162, v163
 v_cvt_pk_bf16_f32 v128, v164, v165
 v_cvt_pk_bf16_f32 v129, v166, v167
 v_cvt_pk_bf16_f32 v130, v168, v169
 v_cvt_pk_bf16_f32 v131, v170, v171
 v_cvt_pk_bf16_f32 v132, v172, v173
 v_cvt_pk_bf16_f32 v133, v174, v175
 v_cvt_pk_bf16_f32 v134, v176, v177
 v_cvt_pk_bf16_f32 v135, v178, v179
 v_cvt_pk_bf16_f32 v136, v180, v181
 v_cvt_pk_bf16_f32 v137, v182, v183
 v_cvt_pk_bf16_f32 v138, v184, v185
 v_cvt_pk_bf16_f32 v139, v186, v187
 v_cvt_pk_bf16_f32 v140, v188, v189
 v_cvt_pk_bf16_f32 v141, v190, v191
 v_cvt_pk_bf16_f32 v142, v192, v193
 v_cvt_pk_bf16_f32 v143, v194, v195
 v_cvt_pk_bf16_f32 v144, v196, v197
 v_cvt_pk_bf16_f32 v145, v198, v199
 v_cvt_pk_bf16_f32 v146, v200, v201
 v_cvt_pk_bf16_f32 v147, v202, v203
 v_mov_b32 v116, 147712
 v_bfe_u32 v119, v0, 0, 3
 v_lshl_add_u32 v116, v119, 7, v116
 v_bfe_u32 v119, v0, 3, 3
 v_lshl_add_u32 v116, v119, 4, v116
 v_mov_b32 v117, 154880
 v_bfe_u32 v119, v0, 3, 1
 v_lshl_add_u32 v117, v119, 8, v117
 v_bfe_u32 v119, v0, 1, 2
 v_lshl_add_u32 v117, v119, 6, v117
 v_bfe_u32 v119, v0, 4, 2
 v_lshl_add_u32 v117, v119, 4, v117
 v_bfe_u32 v119, v0, 0, 1
 v_lshl_add_u32 v117, v119, 3, v117
 v_mov_b32 v118, 147712
 v_bfe_u32 v119, v0, 0, 6
 v_lshl_add_u32 v118, v119, 4, v118
 ds_write_b128 v116, v[120:123] offset:0
 ds_write_b128 v116, v[124:127] offset:1024
 ds_write_b128 v116, v[128:131] offset:2048
 ds_write_b128 v116, v[132:135] offset:3072
 ds_write_b128 v116, v[136:139] offset:4096
 ds_write_b128 v116, v[140:143] offset:5120
 ds_write_b128 v116, v[144:147] offset:6144
 v_swap_b32 v121, v122
 v_swap_b32 v125, v126
 v_swap_b32 v129, v130
 v_swap_b32 v133, v134
 v_swap_b32 v137, v138
 v_swap_b32 v141, v142
 v_swap_b32 v145, v146
 ds_write_b64 v117, v[120:121] offset:0
 ds_write_b64 v117, v[122:123] offset:1024
 ds_write_b64 v117, v[124:125] offset:512
 ds_write_b64 v117, v[126:127] offset:1536
 ds_write_b64 v117, v[128:129] offset:2048
 ds_write_b64 v117, v[130:131] offset:3072
 ds_write_b64 v117, v[132:133] offset:2560
 ds_write_b64 v117, v[134:135] offset:3584
 ds_write_b64 v117, v[136:137] offset:4096
 ds_write_b64 v117, v[138:139] offset:5120
 ds_write_b64 v117, v[140:141] offset:4608
 ds_write_b64 v117, v[142:143] offset:5632
 ds_write_b64 v117, v[144:145] offset:6144
 ds_write_b64 v117, v[146:147] offset:6656
 ds_read_b128 v[148:151], v118 offset:0
 ds_read_b128 v[152:155], v118 offset:1024
 ds_read_b128 v[156:159], v118 offset:2048
 ds_read_b128 v[160:163], v118 offset:3072
 ds_read_b128 v[164:167], v118 offset:4096
 ds_read_b128 v[168:171], v118 offset:5120
 ds_read_b128 v[172:175], v118 offset:6144
 ds_read_b128 v[176:179], v118 offset:7168
 ds_read_b128 v[180:183], v118 offset:8192
 ds_read_b128 v[184:187], v118 offset:9216
 ds_read_b128 v[188:191], v118 offset:10240
 ds_read_b128 v[192:195], v118 offset:11264
 ds_read_b128 v[196:199], v118 offset:12288
 ds_read_b128 v[200:203], v118 offset:13312
 v_mov_b32 v116, 0
 v_bfe_u32 v119, v0, 3, 3
 v_lshl_add_u32 v116, v119, 8, v116
 v_bfe_u32 v119, v0, 0, 3
 v_lshl_add_u32 v116, v119, 4, v116
 v_mov_b32 v117, 0
 v_bfe_u32 v119, v0, 5, 1
 v_lshl_add_u32 v117, v119, 10, v117
 v_bfe_u32 v119, v0, 4, 1
 v_lshl_add_u32 v117, v119, 11, v117
 v_bfe_u32 v119, v0, 2, 2
 v_lshl_add_u32 v117, v119, 8, v117
 v_bfe_u32 v119, v0, 0, 2
 v_lshl_add_u32 v117, v119, 4, v117
 s_lshr_b32 s60, s2, 1
 s_mul_i32 s60, s60, 14336
 s_and_b32 s61, s2, 1
 s_lshl_b32 s61, s61, 7
 s_add_u32 s60, s60, s61
 s_add_u32 s60, s60, 15728640
 s_lshr_b32 s61, s2, 2
 s_mul_i32 s61, s61, 28672
 s_and_b32 s62, s2, 3
 s_lshl_b32 s62, s62, 6
 s_add_u32 s61, s61, s62
 s_add_u32 s61, s61, 17825792
LNC_done:
 s_cmp_ge_u32 s46, 16
 s_cbranch_scc1 AL_skip
 s_lshl_b32 s56, s46, 9
 s_mul_i32 s58, s40, 24576
 s_add_u32 s58, s58, 49152
 v_add_u32 v109, s58, v108
 s_lshr_b32 s55, s40, 1
 s_and_b32 s59, s40, 1
 s_lshl_b32 s70, s40, 5
 s_add_u32 s70, s70, 256
 s_add_u32 s71, s70, 2
 s_lshl_b32 s72, s59, 5
 s_lshl_b32 s55, s55, 1
 s_add_u32 s72, s72, s55
 s_add_u32 s72, s72, 384
 s_lshl_b32 s70, s70, 13
 s_add_u32 s70, s70, s56
 s_lshl_b32 s71, s71, 13
 s_add_u32 s71, s71, s56
 s_lshl_b32 s72, s72, 13
 s_add_u32 s72, s72, s56
 s_lshl_b32 s57, s40, 7
 s_add_u32 s66, s56, s57
 s_lshl_b32 s59, s40, 11
 s_add_u32 m0, s58, 0
 s_nop 0
 buffer_load_dwordx4 v106, s[12:15], s70 offen offset:0 lds
 s_add_u32 m0, s58, 960
 s_nop 0
 buffer_load_dwordx4 v106, s[12:15], s70 offen offset:64 lds
 s_add_u32 m0, s58, 1920
 s_nop 0
 buffer_load_dwordx4 v106, s[12:15], s70 offen offset:128 lds
 s_add_u32 m0, s58, 2880
 s_nop 0
 buffer_load_dwordx4 v106, s[12:15], s70 offen offset:192 lds
 s_add_u32 m0, s58, 3840
 s_nop 0
 buffer_load_dwordx4 v106, s[12:15], s70 offen offset:256 lds
 s_add_u32 m0, s58, 4800
 s_nop 0
 buffer_load_dwordx4 v106, s[12:15], s70 offen offset:320 lds
 s_add_u32 m0, s58, 5760
 s_nop 0
 buffer_load_dwordx4 v106, s[12:15], s70 offen offset:384 lds
 s_add_u32 m0, s58, 6720
 s_nop 0
 buffer_load_dwordx4 v106, s[12:15], s70 offen offset:448 lds
 s_add_u32 m0, s58, 8192
 s_nop 0
 buffer_load_dwordx4 v106, s[12:15], s71 offen offset:0 lds
 s_add_u32 m0, s58, 9152
 s_nop 0
 buffer_load_dwordx4 v106, s[12:15], s71 offen offset:64 lds
 s_add_u32 m0, s58, 10112
 s_nop 0
 buffer_load_dwordx4 v106, s[12:15], s71 offen offset:128 lds
 s_add_u32 m0, s58, 11072
 s_nop 0
 buffer_load_dwordx4 v106, s[12:15], s71 offen offset:192 lds
 s_add_u32 m0, s58, 12032
 s_nop 0
 buffer_load_dwordx4 v106, s[12:15], s71 offen offset:256 lds
 s_add_u32 m0, s58, 12992
 s_nop 0
 buffer_load_dwordx4 v106, s[12:15], s71 offen offset:320 lds
 s_add_u32 m0, s58, 13952
 s_nop 0
 buffer_load_dwordx4 v106, s[12:15], s71 offen offset:384 lds
 s_add_u32 m0, s58, 14912
 s_nop 0
 buffer_load_dwordx4 v106, s[12:15], s71 offen offset:448 lds
 s_add_u32 m0, s58, 16384
 s_nop 0
 buffer_load_dwordx4 v106, s[12:15], s72 offen offset:0 lds
 s_add_u32 m0, s58, 17344
 s_nop 0
 buffer_load_dwordx4 v106, s[12:15], s72 offen offset:64 lds
 s_add_u32 m0, s58, 18304
 s_nop 0
 buffer_load_dwordx4 v106, s[12:15], s72 offen offset:128 lds
 s_add_u32 m0, s58, 19264
 s_nop 0
 buffer_load_dwordx4 v106, s[12:15], s72 offen offset:192 lds
 s_add_u32 m0, s58, 20224
 s_nop 0
 buffer_load_dwordx4 v106, s[12:15], s72 offen offset:256 lds
 s_add_u32 m0, s58, 21184
 s_nop 0
 buffer_load_dwordx4 v106, s[12:15], s72 offen offset:320 lds
 s_add_u32 m0, s58, 22144
 s_nop 0
 buffer_load_dwordx4 v106, s[12:15], s72 offen offset:384 lds
 s_add_u32 m0, s58, 23104
 s_nop 0
 buffer_load_dwordx4 v106, s[12:15], s72 offen offset:448 lds
 s_add_u32 m0, s59, 0
 s_nop 0
 buffer_load_dwordx4 v104, s[8:11], s66 offen lds
 s_add_u32 m0, s59, 960
 s_nop 0
 buffer_load_dwordx4 v104, s[8:11], s66 offen offset:64 lds
 s_add_u32 s66, s66, 32768
 s_add_u32 m0, s59, 8192
 s_nop 0
 buffer_load_dwordx4 v104, s[8:11], s66 offen lds
 s_add_u32 m0, s59, 9152
 s_nop 0
 buffer_load_dwordx4 v104, s[8:11], s66 offen offset:64 lds
 s_add_u32 s66, s66, 229376
 s_add_u32 m0, s59, 16384
 s_nop 0
 buffer_load_dwordx4 v104, s[8:11], s66 offen lds
 s_add_u32 m0, s59, 17344
 s_nop 0
 buffer_load_dwordx4 v104, s[8:11], s66 offen offset:64 lds
 s_add_u32 s66, s66, 32768
 s_add_u32 m0, s59, 24576
 s_nop 0
 buffer_load_dwordx4 v104, s[8:11], s66 offen lds
 s_add_u32 m0, s59, 25536
 s_nop 0
 buffer_load_dwordx4 v104, s[8:11], s66 offen offset:64 lds
 s_add_u32 s66, s66, 229376
 s_add_u32 m0, s59, 32768
 s_nop 0
 buffer_load_dwordx4 v104, s[8:11], s66 offen lds
 s_add_u32 m0, s59, 33728
 s_nop 0
 buffer_load_dwordx4 v104, s[8:11], s66 offen offset:64 lds
 s_add_u32 s66, s66, 32768
 s_add_u32 m0, s59, 40960
 s_nop 0
 buffer_load_dwordx4 v104, s[8:11], s66 offen lds
 s_add_u32 m0, s59, 41920
 s_nop 0
 buffer_load_dwordx4 v104, s[8:11], s66 offen offset:64 lds
 s_add_u32 s66, s66, 229376
 s_branch AL_skip2
AL_skip:
 s_cmp_ge_u32 s46, 32
 s_cbranch_scc1 AL_skip2
 s_sub_u32 s55, s46, 16
 s_lshl_b32 s55, s55, 2
 s_add_u32 s55, s55, s40
 s_lshl_b32 s55, s55, 13
 s_add_u32 s55, s55, 786432
 v_lshlrev_b32 v113, 7, v0
 buffer_load_dword v115, v113, s[8:11], s55 offen
 s_add_u32 s55, s55, 524288
 buffer_load_dword v115, v113, s[8:11], s55 offen
 s_add_u32 s55, s55, 524288
 buffer_load_dword v115, v113, s[8:11], s55 offen
 s_add_u32 s55, s55, 524288
 buffer_load_dword v115, v113, s[8:11], s55 offen
 s_add_u32 s55, s55, 524288
 buffer_load_dword v115, v113, s[8:11], s55 offen
 s_add_u32 s55, s55, 524288
 buffer_load_dword v115, v113, s[8:11], s55 offen
 s_add_u32 s55, s55, 524288
AL_skip2:
 s_sub_u32 s36, s46, 32
 s_cmp_ge_u32 s46, 32
 s_cbranch_scc1 PU_go
 s_mov_b32 s49, 0
 s_cmp_ge_u32 s40, 2
 s_cbranch_scc1 PU_ln
 s_branch PU_t
PU_go:
 s_mul_i32 s42, s36, 4682
 s_lshr_b32 s42, s42, 16
 s_mul_i32 s54, s42, 14
 s_sub_u32 s43, s36, s54
 s_lshr_b32 s44, s43, 1
 s_lshl_b32 s44, s44, 2
 s_add_u32 s44, s44, s40
 s_and_b32 s45, s43, 1
 s_mul_i32 s66, s45, 1835008
 s_lshl_b32 s56, s42, 9
 s_add_u32 s66, s66, s56
 s_lshl_b32 s57, s40, 7
 s_add_u32 s66, s66, s57
 s_lshl_b32 s58, s40, 11
 s_mov_b32 s55, s66
 s_mul_i32 s57, s42, 229376
 s_lshr_b32 s59, s43, 1
 s_lshl_b32 s59, s59, 7
 s_add_u32 s57, s57, s59
 s_mul_i32 s59, s40, 57344
 s_add_u32 s57, s57, s59
 s_add_u32 m0, s58, 0
 s_nop 0
 buffer_load_dwordx4 v104, s[20:23], s55 offen lds
 s_add_u32 m0, s58, 960
 s_nop 0
 buffer_load_dwordx4 v104, s[20:23], s55 offen offset:64 lds
 s_add_u32 s55, s55, 32768
 s_add_u32 m0, s47, 0
 s_nop 0
 buffer_load_dwordx4 v107, s[24:27], s57 offen lds
 s_add_u32 s57, s57, 7168
 s_add_u32 m0, s58, 8192
 s_nop 0
 buffer_load_dwordx4 v104, s[20:23], s55 offen lds
 s_add_u32 m0, s58, 9152
 s_nop 0
 buffer_load_dwordx4 v104, s[20:23], s55 offen offset:64 lds
 s_add_u32 s55, s55, 229376
 s_add_u32 m0, s47, 1024
 s_nop 0
 buffer_load_dwordx4 v107, s[24:27], s57 offen lds
 s_add_u32 s57, s57, 7168
 s_add_u32 m0, s58, 16384
 s_nop 0
 buffer_load_dwordx4 v104, s[20:23], s55 offen lds
 s_add_u32 m0, s58, 17344
 s_nop 0
 buffer_load_dwordx4 v104, s[20:23], s55 offen offset:64 lds
 s_add_u32 s55, s55, 32768
 s_add_u32 m0, s47, 2048
 s_nop 0
 buffer_load_dwordx4 v107, s[24:27], s57 offen lds
 s_add_u32 s57, s57, 7168
 s_add_u32 m0, s58, 24576
 s_nop 0
 buffer_load_dwordx4 v104, s[20:23], s55 offen lds
 s_add_u32 m0, s58, 25536
 s_nop 0
 buffer_load_dwordx4 v104, s[20:23], s55 offen offset:64 lds
 s_add_u32 s55, s55, 229376
 s_add_u32 m0, s47, 3072
 s_nop 0
 buffer_load_dwordx4 v107, s[24:27], s57 offen lds
 s_add_u32 s57, s57, 7168
 s_add_u32 m0, s58, 32768
 s_nop 0
 buffer_load_dwordx4 v104, s[20:23], s55 offen lds
 s_add_u32 m0, s58, 33728
 s_nop 0
 buffer_load_dwordx4 v104, s[20:23], s55 offen offset:64 lds
 s_add_u32 s55, s55, 32768
 s_add_u32 m0, s47, 4096
 s_nop 0
 buffer_load_dwordx4 v107, s[24:27], s57 offen lds
 s_add_u32 s57, s57, 7168
 s_add_u32 m0, s58, 40960
 s_nop 0
 buffer_load_dwordx4 v104, s[20:23], s55 offen lds
 s_add_u32 m0, s58, 41920
 s_nop 0
 buffer_load_dwordx4 v104, s[20:23], s55 offen offset:64 lds
 s_add_u32 s55, s55, 229376
 s_add_u32 m0, s47, 5120
 s_nop 0
 buffer_load_dwordx4 v107, s[24:27], s57 offen lds
 s_add_u32 s57, s57, 7168
 s_add_u32 m0, s58, 49152
 s_nop 0
 buffer_load_dwordx4 v104, s[20:23], s55 offen lds
 s_add_u32 m0, s58, 50112
 s_nop 0
 buffer_load_dwordx4 v104, s[20:23], s55 offen offset:64 lds
 s_add_u32 s55, s55, 32768
 s_add_u32 m0, s47, 6144
 s_nop 0
 buffer_load_dwordx4 v107, s[24:27], s57 offen lds
 s_add_u32 s57, s57, 7168
 s_add_u32 m0, s58, 57344
 s_nop 0
 buffer_load_dwordx4 v104, s[20:23], s55 offen lds
 s_add_u32 m0, s58, 58304
 s_nop 0
 buffer_load_dwordx4 v104, s[20:23], s55 offen offset:64 lds
 s_add_u32 s55, s55, 229376
 s_add_u32 m0, s47, 7168
 s_nop 0
 buffer_load_dwordx4 v107, s[24:27], s57 offen lds
 s_add_u32 s57, s57, 7168
 s_add_u32 m0, s58, 65536
 s_nop 0
 buffer_load_dwordx4 v104, s[20:23], s55 offen lds
 s_add_u32 m0, s58, 66496
 s_nop 0
 buffer_load_dwordx4 v104, s[20:23], s55 offen offset:64 lds
 s_add_u32 s55, s55, 32768
 s_add_u32 m0, s58, 73728
 s_nop 0
 buffer_load_dwordx4 v104, s[20:23], s55 offen lds
 s_add_u32 m0, s58, 74688
 s_nop 0
 buffer_load_dwordx4 v104, s[20:23], s55 offen offset:64 lds
 s_add_u32 s55, s55, 229376
 s_add_u32 m0, s58, 81920
 s_nop 0
 buffer_load_dwordx4 v104, s[20:23], s55 offen lds
 s_add_u32 m0, s58, 82880
 s_nop 0
 buffer_load_dwordx4 v104, s[20:23], s55 offen offset:64 lds
 s_add_u32 s55, s55, 32768
 s_add_u32 m0, s58, 90112
 s_nop 0
 buffer_load_dwordx4 v104, s[20:23], s55 offen lds
 s_add_u32 m0, s58, 91072
 s_nop 0
 buffer_load_dwordx4 v104, s[20:23], s55 offen offset:64 lds
 s_add_u32 s55, s55, 229376
 s_add_u32 m0, s58, 98304
 s_nop 0
 buffer_load_dwordx4 v104, s[20:23], s55 offen lds
 s_add_u32 m0, s58, 99264
 s_nop 0
 buffer_load_dwordx4 v104, s[20:23], s55 offen offset:64 lds
 s_add_u32 s55, s55, 32768
 s_add_u32 m0, s58, 106496
 s_nop 0
 buffer_load_dwordx4 v104, s[20:23], s55 offen lds
 s_add_u32 m0, s58, 107456
 s_nop 0
 buffer_load_dwordx4 v104, s[20:23], s55 offen offset:64 lds
 s_add_u32 s55, s55, 229376
 s_mov_b32 s37, 1.0
 s_mul_i32 s67, s42, 401408
 s_mul_i32 s55, s44, 14336
 s_add_u32 s67, s67, s55
 s_mul_i32 s55, s45, 7168
 s_add_u32 s67, s67, s55
 s_add_u32 s54, s67, 8519680
 buffer_load_dword v114, v253, s[28:31], 0 offen offset:248 sc1
 s_cmp_ge_u32 s40, 2
 s_cbranch_scc1 PU_ln
 s_waitcnt vmcnt(0)
PU_t:
 s_cmp_eq_u32 s40, 0
 s_cselect_b64 s[60:61], s[8:9], s[12:13]
 s_mov_b32 s62, 3670016
 s_mov_b32 s63, 0x20000
 s_mul_i32 s64, s2, 14336
 s_add_u32 s65, s64, 6144
 v_lshlrev_b32 v116, 7, v0
 buffer_load_dword v115, v116, s[60:63], s64 offen
 buffer_load_dword v115, v116, s[60:63], s65 offen
 s_waitcnt vmcnt(2)
PU_ln:
 s_cmp_eq_u32 s40, 3
 s_cbranch_scc1 LH_ln
 s_cmp_lg_u32 s40, 2
 s_cbranch_scc1 LH_done
 v_mov_b32 v120, 0
 v_mov_b32 v124, -1
 v_mov_b32 v121, 0
 v_mov_b32 v125, -1
 v_mov_b32 v122, 0
 v_mov_b32 v126, -1
 v_mov_b32 v123, 0
 v_mov_b32 v127, -1
 v_lshlrev_b32 v116, 4, v0
 v_lshlrev_b32 v117, 3, v0
 s_lshl_b32 s60, s2, 9
 buffer_store_dwordx2 v[120:121], v117, s[16:19], s60 offen sc1
 s_lshl_b32 s60, s2, 12
 s_add_u32 s60, s60, 138240
 buffer_store_dwordx4 v[124:127], v116, s[16:19], s60 offen offset:0 sc1
 buffer_store_dwordx4 v[124:127], v116, s[16:19], s60 offen offset:1024 sc1
 buffer_store_dwordx4 v[124:127], v116, s[16:19], s60 offen offset:2048 sc1
 buffer_store_dwordx4 v[124:127], v116, s[16:19], s60 offen offset:3072 sc1
 s_cmp_lg_u32 s46, 31
 s_cbranch_scc1 LH_done
 s_load_dwordx2 s[60:61], s[0:1], 8
 s_mov_b32 s62, 7168
 s_mov_b32 s63, 0x20000
 v_lshrrev_b32 v116, 3, v0
 v_and_b32 v117, 7, v0
 v_mul_u32_u24 v118, 896, v116
 v_lshl_add_u32 v118, v117, 4, v118
 s_waitcnt lgkmcnt(0)
 buffer_load_dwordx4 v[130:133], v118, s[60:63], 0 offen offset:0
 buffer_load_dwordx4 v[134:137], v118, s[60:63], 0 offen offset:128
 buffer_load_dwordx4 v[138:141], v118, s[60:63], 0 offen offset:256
 buffer_load_dwordx4 v[142:145], v118, s[60:63], 0 offen offset:384
 buffer_load_dwordx4 v[146:149], v118, s[60:63], 0 offen offset:512
 buffer_load_dwordx4 v[150:153], v118, s[60:63], 0 offen offset:640
 buffer_load_dwordx4 v[154:157], v118, s[60:63], 0 offen offset:768
 v_lshrrev_b32 v118, 1, v117
 v_lshlrev_b32 v118, 8, v118
 v_lshrrev_b32 v119, 1, v116
 v_lshl_add_u32 v118, v119, 6, v118
 v_and_b32 v119, 1, v116
 v_lshl_add_u32 v118, v119, 4, v118
 v_and_b32 v119, 1, v117
 v_lshl_add_u32 v118, v119, 3, v118
 s_mov_b32 s72, 0x7f817f81
 s_mov_b32 s74, 0x7fff7fff
 s_waitcnt vmcnt(0)
 v_and_b32 v119, s74, v130
 v_pk_min_u16 v119, v119, s72
 v_bfi_b32 v130, s74, v119, v130
 v_and_b32 v119, s74, v131
 v_pk_min_u16 v119, v119, s72
 v_bfi_b32 v131, s74, v119, v131
 v_and_b32 v119, s74, v132
 v_pk_min_u16 v119, v119, s72
 v_bfi_b32 v132, s74, v119, v132
 v_and_b32 v119, s74, v133
 v_pk_min_u16 v119, v119, s72
 v_bfi_b32 v133, s74, v119, v133
 v_and_b32 v119, s74, v134
 v_pk_min_u16 v119, v119, s72
 v_bfi_b32 v134, s74, v119, v134
 v_and_b32 v119, s74, v135
 v_pk_min_u16 v119, v119, s72
 v_bfi_b32 v135, s74, v119, v135
 v_and_b32 v119, s74, v136
 v_pk_min_u16 v119, v119, s72
 v_bfi_b32 v136, s74, v119, v136
 v_and_b32 v119, s74, v137
 v_pk_min_u16 v119, v119, s72
 v_bfi_b32 v137, s74, v119, v137
 v_and_b32 v119, s74, v138
 v_pk_min_u16 v119, v119, s72
 v_bfi_b32 v138, s74, v119, v138
 v_and_b32 v119, s74, v139
 v_pk_min_u16 v119, v119, s72
 v_bfi_b32 v139, s74, v119, v139
 v_and_b32 v119, s74, v140
 v_pk_min_u16 v119, v119, s72
 v_bfi_b32 v140, s74, v119, v140
 v_and_b32 v119, s74, v141
 v_pk_min_u16 v119, v119, s72
 v_bfi_b32 v141, s74, v119, v141
 v_and_b32 v119, s74, v142
 v_pk_min_u16 v119, v119, s72
 v_bfi_b32 v142, s74, v119, v142
 v_and_b32 v119, s74, v143
 v_pk_min_u16 v119, v119, s72
 v_bfi_b32 v143, s74, v119, v143
 v_and_b32 v119, s74, v144
 v_pk_min_u16 v119, v119, s72
 v_bfi_b32 v144, s74, v119, v144
 v_and_b32 v119, s74, v145
 v_pk_min_u16 v119, v119, s72
 v_bfi_b32 v145, s74, v119, v145
 v_and_b32 v119, s74, v146
 v_pk_min_u16 v119, v119, s72
 v_bfi_b32 v146, s74, v119, v146
 v_and_b32 v119, s74, v147
 v_pk_min_u16 v119, v119, s72
 v_bfi_b32 v147, s74, v119, v147
 v_and_b32 v119, s74, v148
 v_pk_min_u16 v119, v119, s72
 v_bfi_b32 v148, s74, v119, v148
 v_and_b32 v119, s74, v149
 v_pk_min_u16 v119, v119, s72
 v_bfi_b32 v149, s74, v119, v149
 v_and_b32 v119, s74, v150
 v_pk_min_u16 v119, v119, s72
 v_bfi_b32 v150, s74, v119, v150
 v_and_b32 v119, s74, v151
 v_pk_min_u16 v119, v119, s72
 v_bfi_b32 v151, s74, v119, v151
 v_and_b32 v119, s74, v152
 v_pk_min_u16 v119, v119, s72
 v_bfi_b32 v152, s74, v119, v152
 v_and_b32 v119, s74, v153
 v_pk_min_u16 v119, v119, s72
 v_bfi_b32 v153, s74, v119, v153
 v_and_b32 v119, s74, v154
 v_pk_min_u16 v119, v119, s72
 v_bfi_b32 v154, s74, v119, v154
 v_and_b32 v119, s74, v155
 v_pk_min_u16 v119, v119, s72
 v_bfi_b32 v155, s74, v119, v155
 v_and_b32 v119, s74, v156
 v_pk_min_u16 v119, v119, s72
 v_bfi_b32 v156, s74, v119, v156
 v_and_b32 v119, s74, v157
 v_pk_min_u16 v119, v119, s72
 v_bfi_b32 v157, s74, v119, v157
 v_swap_b32 v131, v132
 v_swap_b32 v135, v136
 v_swap_b32 v139, v140
 v_swap_b32 v143, v144
 v_swap_b32 v147, v148
 v_swap_b32 v151, v152
 v_swap_b32 v155, v156
 s_mov_b32 s64, 131072
 buffer_store_dwordx2 v[130:131], v118, s[16:19], s64 offen offset:0 sc1
 buffer_store_dwordx2 v[132:133], v118, s[16:19], s64 offen offset:32 sc1
 s_mov_b32 s64, 132096
 buffer_store_dwordx2 v[134:135], v118, s[16:19], s64 offen offset:0 sc1
 buffer_store_dwordx2 v[136:137], v118, s[16:19], s64 offen offset:32 sc1
 s_mov_b32 s64, 133120
 buffer_store_dwordx2 v[138:139], v118, s[16:19], s64 offen offset:0 sc1
 buffer_store_dwordx2 v[140:141], v118, s[16:19], s64 offen offset:32 sc1
 s_mov_b32 s64, 134144
 buffer_store_dwordx2 v[142:143], v118, s[16:19], s64 offen offset:0 sc1
 buffer_store_dwordx2 v[144:145], v118, s[16:19], s64 offen offset:32 sc1
 s_mov_b32 s64, 135168
 buffer_store_dwordx2 v[146:147], v118, s[16:19], s64 offen offset:0 sc1
 buffer_store_dwordx2 v[148:149], v118, s[16:19], s64 offen offset:32 sc1
 s_mov_b32 s64, 136192
 buffer_store_dwordx2 v[150:151], v118, s[16:19], s64 offen offset:0 sc1
 buffer_store_dwordx2 v[152:153], v118, s[16:19], s64 offen offset:32 sc1
 s_mov_b32 s64, 137216
 buffer_store_dwordx2 v[154:155], v118, s[16:19], s64 offen offset:0 sc1
 buffer_store_dwordx2 v[156:157], v118, s[16:19], s64 offen offset:32 sc1
 s_branch LH_done
LH_ln:
 s_waitcnt lgkmcnt(0)
 buffer_store_dwordx4 v[148:151], v116, s[16:19], s60 offen sc1
 s_add_u32 s60, s60, 2048
 buffer_store_dwordx4 v[152:155], v116, s[16:19], s60 offen sc1
 s_add_u32 s60, s60, 2048
 buffer_store_dwordx4 v[156:159], v116, s[16:19], s60 offen sc1
 s_add_u32 s60, s60, 2048
 buffer_store_dwordx4 v[160:163], v116, s[16:19], s60 offen sc1
 s_add_u32 s60, s60, 2048
 buffer_store_dwordx4 v[164:167], v116, s[16:19], s60 offen sc1
 s_add_u32 s60, s60, 2048
 buffer_store_dwordx4 v[168:171], v116, s[16:19], s60 offen sc1
 s_add_u32 s60, s60, 2048
 buffer_store_dwordx4 v[172:175], v116, s[16:19], s60 offen sc1
 s_add_u32 s60, s60, 2048
 buffer_store_dwordx4 v[176:179], v117, s[16:19], s61 offen sc1
 s_add_u32 s61, s61, 4096
 buffer_store_dwordx4 v[180:183], v117, s[16:19], s61 offen sc1
 s_add_u32 s61, s61, 4096
 buffer_store_dwordx4 v[184:187], v117, s[16:19], s61 offen sc1
 s_add_u32 s61, s61, 4096
 buffer_store_dwordx4 v[188:191], v117, s[16:19], s61 offen sc1
 s_add_u32 s61, s61, 4096
 buffer_store_dwordx4 v[192:195], v117, s[16:19], s61 offen sc1
 s_add_u32 s61, s61, 4096
 buffer_store_dwordx4 v[196:199], v117, s[16:19], s61 offen sc1
 s_add_u32 s61, s61, 4096
 buffer_store_dwordx4 v[200:203], v117, s[16:19], s61 offen sc1
 s_add_u32 s61, s61, 4096
LH_done:
 s_cmp_lt_u32 s46, 32
 s_cbranch_scc1 PU_end
 s_waitcnt vmcnt(14)
 s_cmp_lg_u32 s40, 2
 s_cbranch_scc1 PU_w
 s_waitcnt vmcnt(5)
PU_w:
 v_readfirstlane_b32 s34, v114
 s_barrier
 ds_read_b64_tr_b16 v[8:9], v112 offset:0
 ds_read_b64_tr_b16 v[10:11], v112 offset:512
 ds_read_b64_tr_b16 v[12:13], v112 offset:4096
 ds_read_b64_tr_b16 v[14:15], v112 offset:4608
 ds_read_b64_tr_b16 v[16:17], v112 offset:8192
 ds_read_b64_tr_b16 v[18:19], v112 offset:8704
 ds_read_b64_tr_b16 v[20:21], v112 offset:12288
 ds_read_b64_tr_b16 v[22:23], v112 offset:12800
 ds_read_b64_tr_b16 v[24:25], v112 offset:16384
 ds_read_b64_tr_b16 v[26:27], v112 offset:16896
 ds_read_b64_tr_b16 v[28:29], v112 offset:20480
 ds_read_b64_tr_b16 v[30:31], v112 offset:20992
 ds_read_b64_tr_b16 v[32:33], v112 offset:24576
 ds_read_b64_tr_b16 v[34:35], v112 offset:25088
 ds_read_b64_tr_b16 v[36:37], v112 offset:28672
 ds_read_b64_tr_b16 v[38:39], v112 offset:29184
 s_mov_b32 s3, 1073741824
 s_branch PU_rd
PU_a:
 s_lshl_b32 s56, s42, 9
 s_lshr_b32 s57, s44, 1
 s_lshl_b32 s57, s57, 5
 s_and_b32 s59, s44, 1
 s_lshl_b32 s59, s59, 1
 s_add_u32 s57, s57, s59
 s_lshl_b32 s57, s57, 13
 s_add_u32 s57, s57, s56
 s_lshl_b32 s58, s40, 11
 s_add_u32 m0, s58, 0
 s_nop 0
 buffer_load_dwordx4 v104, s[8:11], s66 offen lds
 s_add_u32 m0, s58, 960
 s_nop 0
 buffer_load_dwordx4 v104, s[8:11], s66 offen offset:64 lds
 s_add_u32 s66, s66, 32768
 s_add_u32 m0, s47, 0
 s_nop 0
 buffer_load_dwordx4 v106, s[12:15], s57 offen offset:0 lds
 s_add_u32 m0, s58, 8192
 s_nop 0
 buffer_load_dwordx4 v104, s[8:11], s66 offen lds
 s_add_u32 m0, s58, 9152
 s_nop 0
 buffer_load_dwordx4 v104, s[8:11], s66 offen offset:64 lds
 s_add_u32 s66, s66, 229376
 s_add_u32 m0, s47, 960
 s_nop 0
 buffer_load_dwordx4 v106, s[12:15], s57 offen offset:64 lds
 s_add_u32 m0, s58, 16384
 s_nop 0
 buffer_load_dwordx4 v104, s[8:11], s66 offen lds
 s_add_u32 m0, s58, 17344
 s_nop 0
 buffer_load_dwordx4 v104, s[8:11], s66 offen offset:64 lds
 s_add_u32 s66, s66, 32768
 s_add_u32 m0, s47, 1920
 s_nop 0
 buffer_load_dwordx4 v106, s[12:15], s57 offen offset:128 lds
 s_add_u32 m0, s58, 24576
 s_nop 0
 buffer_load_dwordx4 v104, s[8:11], s66 offen lds
 s_add_u32 m0, s58, 25536
 s_nop 0
 buffer_load_dwordx4 v104, s[8:11], s66 offen offset:64 lds
 s_add_u32 s66, s66, 229376
 s_add_u32 m0, s47, 2880
 s_nop 0
 buffer_load_dwordx4 v106, s[12:15], s57 offen offset:192 lds
 s_add_u32 m0, s58, 32768
 s_nop 0
 buffer_load_dwordx4 v104, s[8:11], s66 offen lds
 s_add_u32 m0, s58, 33728
 s_nop 0
 buffer_load_dwordx4 v104, s[8:11], s66 offen offset:64 lds
 s_add_u32 s66, s66, 32768
 s_add_u32 m0, s47, 3840
 s_nop 0
 buffer_load_dwordx4 v106, s[12:15], s57 offen offset:256 lds
 s_add_u32 m0, s58, 40960
 s_nop 0
 buffer_load_dwordx4 v104, s[8:11], s66 offen lds
 s_add_u32 m0, s58, 41920
 s_nop 0
 buffer_load_dwordx4 v104, s[8:11], s66 offen offset:64 lds
 s_add_u32 s66, s66, 229376
 s_add_u32 m0, s47, 4800
 s_nop 0
 buffer_load_dwordx4 v106, s[12:15], s57 offen offset:320 lds
 s_add_u32 m0, s58, 49152
 s_nop 0
 buffer_load_dwordx4 v104, s[8:11], s66 offen lds
 s_add_u32 m0, s58, 50112
 s_nop 0
 buffer_load_dwordx4 v104, s[8:11], s66 offen offset:64 lds
 s_add_u32 s66, s66, 32768
 s_add_u32 m0, s47, 5760
 s_nop 0
 buffer_load_dwordx4 v106, s[12:15], s57 offen offset:384 lds
 s_add_u32 m0, s58, 57344
 s_nop 0
 buffer_load_dwordx4 v104, s[8:11], s66 offen lds
 s_add_u32 m0, s58, 58304
 s_nop 0
 buffer_load_dwordx4 v104, s[8:11], s66 offen offset:64 lds
 s_add_u32 s66, s66, 229376
 s_add_u32 m0, s47, 6720
 s_nop 0
 buffer_load_dwordx4 v106, s[12:15], s57 offen offset:448 lds
 s_add_u32 m0, s58, 65536
 s_nop 0
 buffer_load_dwordx4 v104, s[8:11], s66 offen lds
 s_add_u32 m0, s58, 66496
 s_nop 0
 buffer_load_dwordx4 v104, s[8:11], s66 offen offset:64 lds
 s_add_u32 s66, s66, 32768
 s_add_u32 m0, s58, 73728
 s_nop 0
 buffer_load_dwordx4 v104, s[8:11], s66 offen lds
 s_add_u32 m0, s58, 74688
 s_nop 0
 buffer_load_dwordx4 v104, s[8:11], s66 offen offset:64 lds
 s_add_u32 s66, s66, 229376
 s_add_u32 m0, s58, 81920
 s_nop 0
 buffer_load_dwordx4 v104, s[8:11], s66 offen lds
 s_add_u32 m0, s58, 82880
 s_nop 0
 buffer_load_dwordx4 v104, s[8:11], s66 offen offset:64 lds
 s_add_u32 s66, s66, 32768
 s_add_u32 m0, s58, 90112
 s_nop 0
 buffer_load_dwordx4 v104, s[8:11], s66 offen lds
 s_add_u32 m0, s58, 91072
 s_nop 0
 buffer_load_dwordx4 v104, s[8:11], s66 offen offset:64 lds
 s_add_u32 s66, s66, 229376
 s_add_u32 m0, s58, 98304
 s_nop 0
 buffer_load_dwordx4 v104, s[8:11], s66 offen lds
 s_add_u32 m0, s58, 99264
 s_nop 0
 buffer_load_dwordx4 v104, s[8:11], s66 offen offset:64 lds
 s_add_u32 s66, s66, 32768
 s_add_u32 m0, s58, 106496
 s_nop 0
 buffer_load_dwordx4 v104, s[8:11], s66 offen lds
 s_add_u32 m0, s58, 107456
 s_nop 0
 buffer_load_dwordx4 v104, s[8:11], s66 offen offset:64 lds
 s_add_u32 s66, s66, 229376
 s_mov_b32 s37, 1035512379
 s_add_u32 s54, s67, 2097152
 s_lshl_b32 s3, s45, 2
 s_add_u32 s3, s3, s40
 s_mul_i32 s3, s3, 28672
 s_add_u32 s3, s3, 15728640
 s_waitcnt vmcnt(0)
 s_barrier
 ds_read_b128 v[8:11], v109 offset:0
 ds_read_b128 v[12:15], v109 offset:1024
 ds_read_b128 v[16:19], v109 offset:2048
 ds_read_b128 v[20:23], v109 offset:3072
 ds_read_b128 v[24:27], v109 offset:4096
 ds_read_b128 v[28:31], v109 offset:5120
 ds_read_b128 v[32:35], v109 offset:6144
 ds_read_b128 v[36:39], v109 offset:7168
PU_rd:
 v_add_u32 v113, 0xe000, v108
 s_add_u32 s55, s54, 4096
 ds_read_b128 v[40:43], v108 offset:0
 ds_read_b128 v[44:47], v108 offset:1024
 ds_read_b128 v[48:51], v108 offset:2048
 ds_read_b128 v[52:55], v108 offset:3072
 ds_read_b128 v[56:59], v108 offset:4096
 ds_read_b128 v[60:63], v108 offset:5120
 ds_read_b128 v[64:67], v108 offset:6144
 ds_read_b128 v[68:71], v108 offset:7168
 s_waitcnt lgkmcnt(7)
 v_mfma_f32_16x16x32_bf16 v[72:75], v[40:43], v[8:11], 0
 ds_read_b128 v[40:43], v108 offset:8192
 s_waitcnt lgkmcnt(7)
 v_mfma_f32_16x16x32_bf16 v[72:75], v[44:47], v[12:15], v[72:75]
 ds_read_b128 v[44:47], v108 offset:9216
 s_waitcnt lgkmcnt(7)
 v_mfma_f32_16x16x32_bf16 v[72:75], v[48:51], v[16:19], v[72:75]
 ds_read_b128 v[48:51], v108 offset:10240
 s_waitcnt lgkmcnt(7)
 v_mfma_f32_16x16x32_bf16 v[72:75], v[52:55], v[20:23], v[72:75]
 ds_read_b128 v[52:55], v108 offset:11264
 s_waitcnt lgkmcnt(7)
 v_mfma_f32_16x16x32_bf16 v[72:75], v[56:59], v[24:27], v[72:75]
 ds_read_b128 v[56:59], v108 offset:12288
 s_waitcnt lgkmcnt(7)
 v_mfma_f32_16x16x32_bf16 v[72:75], v[60:63], v[28:31], v[72:75]
 ds_read_b128 v[60:63], v108 offset:13312
 s_waitcnt lgkmcnt(7)
 v_mfma_f32_16x16x32_bf16 v[72:75], v[64:67], v[32:35], v[72:75]
 ds_read_b128 v[64:67], v108 offset:14336
 s_waitcnt lgkmcnt(7)
 v_mfma_f32_16x16x32_bf16 v[72:75], v[68:71], v[36:39], v[72:75]
 ds_read_b128 v[68:71], v108 offset:15360
 s_waitcnt lgkmcnt(7)
 v_mfma_f32_16x16x32_bf16 v[76:79], v[40:43], v[8:11], 0
 ds_read_b128 v[40:43], v108 offset:16384
 s_waitcnt lgkmcnt(7)
 v_mfma_f32_16x16x32_bf16 v[76:79], v[44:47], v[12:15], v[76:79]
 ds_read_b128 v[44:47], v108 offset:17408
 s_waitcnt lgkmcnt(7)
 v_mfma_f32_16x16x32_bf16 v[76:79], v[48:51], v[16:19], v[76:79]
 ds_read_b128 v[48:51], v108 offset:18432
 s_waitcnt lgkmcnt(7)
 v_mfma_f32_16x16x32_bf16 v[76:79], v[52:55], v[20:23], v[76:79]
 ds_read_b128 v[52:55], v108 offset:19456
 s_waitcnt lgkmcnt(7)
 v_mfma_f32_16x16x32_bf16 v[76:79], v[56:59], v[24:27], v[76:79]
 ds_read_b128 v[56:59], v108 offset:20480
 s_waitcnt lgkmcnt(7)
 v_mfma_f32_16x16x32_bf16 v[76:79], v[60:63], v[28:31], v[76:79]
 ds_read_b128 v[60:63], v108 offset:21504
 s_waitcnt lgkmcnt(7)
 v_mfma_f32_16x16x32_bf16 v[76:79], v[64:67], v[32:35], v[76:79]
 ds_read_b128 v[64:67], v108 offset:22528
 s_waitcnt lgkmcnt(7)
 v_mfma_f32_16x16x32_bf16 v[76:79], v[68:71], v[36:39], v[76:79]
 ds_read_b128 v[68:71], v108 offset:23552
 s_waitcnt lgkmcnt(7)
 v_mfma_f32_16x16x32_bf16 v[80:83], v[40:43], v[8:11], 0
 ds_read_b128 v[40:43], v108 offset:24576
 s_waitcnt lgkmcnt(7)
 v_mfma_f32_16x16x32_bf16 v[80:83], v[44:47], v[12:15], v[80:83]
 ds_read_b128 v[44:47], v108 offset:25600
 s_waitcnt lgkmcnt(7)
 v_mfma_f32_16x16x32_bf16 v[80:83], v[48:51], v[16:19], v[80:83]
 ds_read_b128 v[48:51], v108 offset:26624
 v_mul_f32 v72, s37, v72
 s_waitcnt lgkmcnt(7)
 v_mfma_f32_16x16x32_bf16 v[80:83], v[52:55], v[20:23], v[80:83]
 ds_read_b128 v[52:55], v108 offset:27648
 v_mul_f32 v73, s37, v73
 s_waitcnt lgkmcnt(7)
 v_mfma_f32_16x16x32_bf16 v[80:83], v[56:59], v[24:27], v[80:83]
 ds_read_b128 v[56:59], v108 offset:28672
 v_mul_f32 v74, s37, v74
 s_waitcnt lgkmcnt(7)
 v_mfma_f32_16x16x32_bf16 v[80:83], v[60:63], v[28:31], v[80:83]
 ds_read_b128 v[60:63], v108 offset:29696
 v_mul_f32 v75, s37, v75
 s_waitcnt lgkmcnt(7)
 v_mfma_f32_16x16x32_bf16 v[80:83], v[64:67], v[32:35], v[80:83]
 ds_read_b128 v[64:67], v108 offset:30720
 v_mul_f32 v76, s37, v76
 s_waitcnt lgkmcnt(7)
 v_mfma_f32_16x16x32_bf16 v[80:83], v[68:71], v[36:39], v[80:83]
 ds_read_b128 v[68:71], v108 offset:31744
 v_mul_f32 v77, s37, v77
 s_waitcnt lgkmcnt(7)
 v_mfma_f32_16x16x32_bf16 v[84:87], v[40:43], v[8:11], 0
 ds_read_b128 v[40:43], v108 offset:32768
 v_mul_f32 v78, s37, v78
 s_waitcnt lgkmcnt(7)
 v_mfma_f32_16x16x32_bf16 v[84:87], v[44:47], v[12:15], v[84:87]
 ds_read_b128 v[44:47], v108 offset:33792
 v_mul_f32 v79, s37, v79
 s_waitcnt lgkmcnt(7)
 v_mfma_f32_16x16x32_bf16 v[84:87], v[48:51], v[16:19], v[84:87]
 ds_read_b128 v[48:51], v108 offset:34816
 v_cvt_pk_bf16_f32 v88, v72, v73
 s_waitcnt lgkmcnt(7)
 v_mfma_f32_16x16x32_bf16 v[84:87], v[52:55], v[20:23], v[84:87]
 ds_read_b128 v[52:55], v108 offset:35840
 v_cvt_pk_bf16_f32 v89, v74, v75
 s_waitcnt lgkmcnt(7)
 v_mfma_f32_16x16x32_bf16 v[84:87], v[56:59], v[24:27], v[84:87]
 ds_read_b128 v[56:59], v108 offset:36864
 v_cvt_pk_bf16_f32 v90, v76, v77
 s_waitcnt lgkmcnt(7)
 v_mfma_f32_16x16x32_bf16 v[84:87], v[60:63], v[28:31], v[84:87]
 ds_read_b128 v[60:63], v108 offset:37888
 v_cvt_pk_bf16_f32 v91, v78, v79
 s_waitcnt lgkmcnt(7)
 v_mfma_f32_16x16x32_bf16 v[84:87], v[64:67], v[32:35], v[84:87]
 ds_read_b128 v[64:67], v108 offset:38912
 buffer_store_dwordx4 v[88:91], v1, s[16:19], s54 offen offset:0 sc1
 s_waitcnt lgkmcnt(7)
 v_mfma_f32_16x16x32_bf16 v[84:87], v[68:71], v[36:39], v[84:87]
 ds_read_b128 v[68:71], v108 offset:39936
 s_waitcnt lgkmcnt(7)
 v_mfma_f32_16x16x32_bf16 v[72:75], v[40:43], v[8:11], 0
 ds_read_b128 v[40:43], v108 offset:40960
 s_waitcnt lgkmcnt(7)
 v_mfma_f32_16x16x32_bf16 v[72:75], v[44:47], v[12:15], v[72:75]
 ds_read_b128 v[44:47], v108 offset:41984
 s_waitcnt lgkmcnt(7)
 v_mfma_f32_16x16x32_bf16 v[72:75], v[48:51], v[16:19], v[72:75]
 ds_read_b128 v[48:51], v108 offset:43008
 v_mul_f32 v80, s37, v80
 s_waitcnt lgkmcnt(7)
 v_mfma_f32_16x16x32_bf16 v[72:75], v[52:55], v[20:23], v[72:75]
 ds_read_b128 v[52:55], v108 offset:44032
 v_mul_f32 v81, s37, v81
 s_waitcnt lgkmcnt(7)
 v_mfma_f32_16x16x32_bf16 v[72:75], v[56:59], v[24:27], v[72:75]
 ds_read_b128 v[56:59], v108 offset:45056
 v_mul_f32 v82, s37, v82
 s_waitcnt lgkmcnt(7)
 v_mfma_f32_16x16x32_bf16 v[72:75], v[60:63], v[28:31], v[72:75]
 ds_read_b128 v[60:63], v108 offset:46080
 v_mul_f32 v83, s37, v83
 s_waitcnt lgkmcnt(7)
 v_mfma_f32_16x16x32_bf16 v[72:75], v[64:67], v[32:35], v[72:75]
 ds_read_b128 v[64:67], v108 offset:47104
 v_mul_f32 v84, s37, v84
 s_waitcnt lgkmcnt(7)
 v_mfma_f32_16x16x32_bf16 v[72:75], v[68:71], v[36:39], v[72:75]
 ds_read_b128 v[68:71], v108 offset:48128
 v_mul_f32 v85, s37, v85
 s_waitcnt lgkmcnt(7)
 v_mfma_f32_16x16x32_bf16 v[76:79], v[40:43], v[8:11], 0
 ds_read_b128 v[40:43], v108 offset:49152
 v_mul_f32 v86, s37, v86
 s_waitcnt lgkmcnt(7)
 v_mfma_f32_16x16x32_bf16 v[76:79], v[44:47], v[12:15], v[76:79]
 ds_read_b128 v[44:47], v108 offset:50176
 v_mul_f32 v87, s37, v87
 s_waitcnt lgkmcnt(7)
 v_mfma_f32_16x16x32_bf16 v[76:79], v[48:51], v[16:19], v[76:79]
 ds_read_b128 v[48:51], v108 offset:51200
 v_cvt_pk_bf16_f32 v92, v80, v81
 s_waitcnt lgkmcnt(7)
 v_mfma_f32_16x16x32_bf16 v[76:79], v[52:55], v[20:23], v[76:79]
 ds_read_b128 v[52:55], v108 offset:52224
 v_cvt_pk_bf16_f32 v93, v82, v83
 s_waitcnt lgkmcnt(7)
 v_mfma_f32_16x16x32_bf16 v[76:79], v[56:59], v[24:27], v[76:79]
 ds_read_b128 v[56:59], v108 offset:53248
 v_cvt_pk_bf16_f32 v94, v84, v85
 s_waitcnt lgkmcnt(7)
 v_mfma_f32_16x16x32_bf16 v[76:79], v[60:63], v[28:31], v[76:79]
 ds_read_b128 v[60:63], v108 offset:54272
 v_cvt_pk_bf16_f32 v95, v86, v87
 s_waitcnt lgkmcnt(7)
 v_mfma_f32_16x16x32_bf16 v[76:79], v[64:67], v[32:35], v[76:79]
 ds_read_b128 v[64:67], v108 offset:55296
 buffer_store_dwordx4 v[92:95], v1, s[16:19], s54 offen offset:1024 sc1
 s_waitcnt lgkmcnt(7)
 v_mfma_f32_16x16x32_bf16 v[76:79], v[68:71], v[36:39], v[76:79]
 ds_read_b128 v[68:71], v108 offset:56320
 s_waitcnt lgkmcnt(7)
 v_mfma_f32_16x16x32_bf16 v[80:83], v[40:43], v[8:11], 0
 ds_read_b128 v[40:43], v113 offset:0
 s_waitcnt lgkmcnt(7)
 v_mfma_f32_16x16x32_bf16 v[80:83], v[44:47], v[12:15], v[80:83]
 ds_read_b128 v[44:47], v113 offset:1024
 s_waitcnt lgkmcnt(7)
 v_mfma_f32_16x16x32_bf16 v[80:83], v[48:51], v[16:19], v[80:83]
 ds_read_b128 v[48:51], v113 offset:2048
 v_mul_f32 v72, s37, v72
 s_waitcnt lgkmcnt(7)
 v_mfma_f32_16x16x32_bf16 v[80:83], v[52:55], v[20:23], v[80:83]
 ds_read_b128 v[52:55], v113 offset:3072
 v_mul_f32 v73, s37, v73
 s_waitcnt lgkmcnt(7)
 v_mfma_f32_16x16x32_bf16 v[80:83], v[56:59], v[24:27], v[80:83]
 ds_read_b128 v[56:59], v113 offset:4096
 v_mul_f32 v74, s37, v74
 s_waitcnt lgkmcnt(7)
 v_mfma_f32_16x16x32_bf16 v[80:83], v[60:63], v[28:31], v[80:83]
 ds_read_b128 v[60:63], v113 offset:5120
 v_mul_f32 v75, s37, v75
 s_waitcnt lgkmcnt(7)
 v_mfma_f32_16x16x32_bf16 v[80:83], v[64:67], v[32:35], v[80:83]
 ds_read_b128 v[64:67], v113 offset:6144
 v_mul_f32 v76, s37, v76
 s_waitcnt lgkmcnt(7)
 v_mfma_f32_16x16x32_bf16 v[80:83], v[68:71], v[36:39], v[80:83]
 ds_read_b128 v[68:71], v113 offset:7168
 v_mul_f32 v77, s37, v77
 s_waitcnt lgkmcnt(7)
 v_mfma_f32_16x16x32_bf16 v[84:87], v[40:43], v[8:11], 0
 ds_read_b128 v[40:43], v113 offset:8192
 v_mul_f32 v78, s37, v78
 s_waitcnt lgkmcnt(7)
 v_mfma_f32_16x16x32_bf16 v[84:87], v[44:47], v[12:15], v[84:87]
 ds_read_b128 v[44:47], v113 offset:9216
 v_mul_f32 v79, s37, v79
 s_waitcnt lgkmcnt(7)
 v_mfma_f32_16x16x32_bf16 v[84:87], v[48:51], v[16:19], v[84:87]
 ds_read_b128 v[48:51], v113 offset:10240
 v_cvt_pk_bf16_f32 v88, v72, v73
 s_waitcnt lgkmcnt(7)
 v_mfma_f32_16x16x32_bf16 v[84:87], v[52:55], v[20:23], v[84:87]
 ds_read_b128 v[52:55], v113 offset:11264
 v_cvt_pk_bf16_f32 v89, v74, v75
 s_waitcnt lgkmcnt(7)
 v_mfma_f32_16x16x32_bf16 v[84:87], v[56:59], v[24:27], v[84:87]
 ds_read_b128 v[56:59], v113 offset:12288
 v_cvt_pk_bf16_f32 v90, v76, v77
 s_waitcnt lgkmcnt(7)
 v_mfma_f32_16x16x32_bf16 v[84:87], v[60:63], v[28:31], v[84:87]
 ds_read_b128 v[60:63], v113 offset:13312
 v_cvt_pk_bf16_f32 v91, v78, v79
 s_waitcnt lgkmcnt(7)
 v_mfma_f32_16x16x32_bf16 v[84:87], v[64:67], v[32:35], v[84:87]
 ds_read_b128 v[64:67], v113 offset:14336
 buffer_store_dwordx4 v[88:91], v1, s[16:19], s54 offen offset:2048 sc1
 s_waitcnt lgkmcnt(7)
 v_mfma_f32_16x16x32_bf16 v[84:87], v[68:71], v[36:39], v[84:87]
 ds_read_b128 v[68:71], v113 offset:15360
 s_waitcnt lgkmcnt(7)
 v_mfma_f32_16x16x32_bf16 v[72:75], v[40:43], v[8:11], 0
 ds_read_b128 v[40:43], v113 offset:16384
 s_waitcnt lgkmcnt(7)
 v_mfma_f32_16x16x32_bf16 v[72:75], v[44:47], v[12:15], v[72:75]
 ds_read_b128 v[44:47], v113 offset:17408
 s_waitcnt lgkmcnt(7)
 v_mfma_f32_16x16x32_bf16 v[72:75], v[48:51], v[16:19], v[72:75]
 ds_read_b128 v[48:51], v113 offset:18432
 v_mul_f32 v80, s37, v80
 s_waitcnt lgkmcnt(7)
 v_mfma_f32_16x16x32_bf16 v[72:75], v[52:55], v[20:23], v[72:75]
 ds_read_b128 v[52:55], v113 offset:19456
 v_mul_f32 v81, s37, v81
 s_waitcnt lgkmcnt(7)
 v_mfma_f32_16x16x32_bf16 v[72:75], v[56:59], v[24:27], v[72:75]
 ds_read_b128 v[56:59], v113 offset:20480
 v_mul_f32 v82, s37, v82
 s_waitcnt lgkmcnt(7)
 v_mfma_f32_16x16x32_bf16 v[72:75], v[60:63], v[28:31], v[72:75]
 ds_read_b128 v[60:63], v113 offset:21504
 v_mul_f32 v83, s37, v83
 s_waitcnt lgkmcnt(7)
 v_mfma_f32_16x16x32_bf16 v[72:75], v[64:67], v[32:35], v[72:75]
 ds_read_b128 v[64:67], v113 offset:22528
 v_mul_f32 v84, s37, v84
 s_waitcnt lgkmcnt(7)
 v_mfma_f32_16x16x32_bf16 v[72:75], v[68:71], v[36:39], v[72:75]
 ds_read_b128 v[68:71], v113 offset:23552
 v_mul_f32 v85, s37, v85
 s_waitcnt lgkmcnt(7)
 v_mfma_f32_16x16x32_bf16 v[76:79], v[40:43], v[8:11], 0
 ds_read_b128 v[40:43], v113 offset:24576
 v_mul_f32 v86, s37, v86
 s_waitcnt lgkmcnt(7)
 v_mfma_f32_16x16x32_bf16 v[76:79], v[44:47], v[12:15], v[76:79]
 ds_read_b128 v[44:47], v113 offset:25600
 v_mul_f32 v87, s37, v87
 s_waitcnt lgkmcnt(7)
 v_mfma_f32_16x16x32_bf16 v[76:79], v[48:51], v[16:19], v[76:79]
 ds_read_b128 v[48:51], v113 offset:26624
 v_cvt_pk_bf16_f32 v92, v80, v81
 s_waitcnt lgkmcnt(7)
 v_mfma_f32_16x16x32_bf16 v[76:79], v[52:55], v[20:23], v[76:79]
 ds_read_b128 v[52:55], v113 offset:27648
 v_cvt_pk_bf16_f32 v93, v82, v83
 s_waitcnt lgkmcnt(7)
 v_mfma_f32_16x16x32_bf16 v[76:79], v[56:59], v[24:27], v[76:79]
 ds_read_b128 v[56:59], v113 offset:28672
 v_cvt_pk_bf16_f32 v94, v84, v85
 s_waitcnt lgkmcnt(7)
 v_mfma_f32_16x16x32_bf16 v[76:79], v[60:63], v[28:31], v[76:79]
 ds_read_b128 v[60:63], v113 offset:29696
 v_cvt_pk_bf16_f32 v95, v86, v87
 s_waitcnt lgkmcnt(7)
 v_mfma_f32_16x16x32_bf16 v[76:79], v[64:67], v[32:35], v[76:79]
 ds_read_b128 v[64:67], v113 offset:30720
 buffer_store_dwordx4 v[92:95], v1, s[16:19], s54 offen offset:3072 sc1
 s_waitcnt lgkmcnt(7)
 v_mfma_f32_16x16x32_bf16 v[76:79], v[68:71], v[36:39], v[76:79]
 ds_read_b128 v[68:71], v113 offset:31744
 s_waitcnt lgkmcnt(7)
 v_mfma_f32_16x16x32_bf16 v[80:83], v[40:43], v[8:11], 0
 ds_read_b128 v[40:43], v113 offset:32768
 s_waitcnt lgkmcnt(7)
 v_mfma_f32_16x16x32_bf16 v[80:83], v[44:47], v[12:15], v[80:83]
 ds_read_b128 v[44:47], v113 offset:33792
 s_waitcnt lgkmcnt(7)
 v_mfma_f32_16x16x32_bf16 v[80:83], v[48:51], v[16:19], v[80:83]
 ds_read_b128 v[48:51], v113 offset:34816
 v_mul_f32 v72, s37, v72
 s_waitcnt lgkmcnt(7)
 v_mfma_f32_16x16x32_bf16 v[80:83], v[52:55], v[20:23], v[80:83]
 ds_read_b128 v[52:55], v113 offset:35840
 v_mul_f32 v73, s37, v73
 s_waitcnt lgkmcnt(7)
 v_mfma_f32_16x16x32_bf16 v[80:83], v[56:59], v[24:27], v[80:83]
 ds_read_b128 v[56:59], v113 offset:36864
 v_mul_f32 v74, s37, v74
 s_waitcnt lgkmcnt(7)
 v_mfma_f32_16x16x32_bf16 v[80:83], v[60:63], v[28:31], v[80:83]
 ds_read_b128 v[60:63], v113 offset:37888
 v_mul_f32 v75, s37, v75
 s_waitcnt lgkmcnt(7)
 v_mfma_f32_16x16x32_bf16 v[80:83], v[64:67], v[32:35], v[80:83]
 ds_read_b128 v[64:67], v113 offset:38912
 v_mul_f32 v76, s37, v76
 s_waitcnt lgkmcnt(7)
 v_mfma_f32_16x16x32_bf16 v[80:83], v[68:71], v[36:39], v[80:83]
 ds_read_b128 v[68:71], v113 offset:39936
 v_mul_f32 v77, s37, v77
 s_waitcnt lgkmcnt(7)
 v_mfma_f32_16x16x32_bf16 v[84:87], v[40:43], v[8:11], 0
 ds_read_b128 v[40:43], v113 offset:40960
 v_mul_f32 v78, s37, v78
 s_waitcnt lgkmcnt(7)
 v_mfma_f32_16x16x32_bf16 v[84:87], v[44:47], v[12:15], v[84:87]
 ds_read_b128 v[44:47], v113 offset:41984
 v_mul_f32 v79, s37, v79
 s_waitcnt lgkmcnt(7)
 v_mfma_f32_16x16x32_bf16 v[84:87], v[48:51], v[16:19], v[84:87]
 ds_read_b128 v[48:51], v113 offset:43008
 v_cvt_pk_bf16_f32 v88, v72, v73
 s_waitcnt lgkmcnt(7)
 v_mfma_f32_16x16x32_bf16 v[84:87], v[52:55], v[20:23], v[84:87]
 ds_read_b128 v[52:55], v113 offset:44032
 v_cvt_pk_bf16_f32 v89, v74, v75
 s_waitcnt lgkmcnt(7)
 v_mfma_f32_16x16x32_bf16 v[84:87], v[56:59], v[24:27], v[84:87]
 ds_read_b128 v[56:59], v113 offset:45056
 v_cvt_pk_bf16_f32 v90, v76, v77
 s_waitcnt lgkmcnt(7)
 v_mfma_f32_16x16x32_bf16 v[84:87], v[60:63], v[28:31], v[84:87]
 ds_read_b128 v[60:63], v113 offset:46080
 v_cvt_pk_bf16_f32 v91, v78, v79
 s_waitcnt lgkmcnt(7)
 v_mfma_f32_16x16x32_bf16 v[84:87], v[64:67], v[32:35], v[84:87]
 ds_read_b128 v[64:67], v113 offset:47104
 buffer_store_dwordx4 v[88:91], v1, s[16:19], s55 offen offset:0 sc1
 s_waitcnt lgkmcnt(7)
 v_mfma_f32_16x16x32_bf16 v[84:87], v[68:71], v[36:39], v[84:87]
 ds_read_b128 v[68:71], v113 offset:48128
 s_waitcnt lgkmcnt(7)
 v_mfma_f32_16x16x32_bf16 v[72:75], v[40:43], v[8:11], 0
 ds_read_b128 v[40:43], v113 offset:49152
 s_waitcnt lgkmcnt(7)
 v_mfma_f32_16x16x32_bf16 v[72:75], v[44:47], v[12:15], v[72:75]
 ds_read_b128 v[44:47], v113 offset:50176
 s_waitcnt lgkmcnt(7)
 v_mfma_f32_16x16x32_bf16 v[72:75], v[48:51], v[16:19], v[72:75]
 ds_read_b128 v[48:51], v113 offset:51200
 v_mul_f32 v80, s37, v80
 s_waitcnt lgkmcnt(7)
 v_mfma_f32_16x16x32_bf16 v[72:75], v[52:55], v[20:23], v[72:75]
 ds_read_b128 v[52:55], v113 offset:52224
 v_mul_f32 v81, s37, v81
 s_waitcnt lgkmcnt(7)
 v_mfma_f32_16x16x32_bf16 v[72:75], v[56:59], v[24:27], v[72:75]
 ds_read_b128 v[56:59], v113 offset:53248
 v_mul_f32 v82, s37, v82
 s_waitcnt lgkmcnt(7)
 v_mfma_f32_16x16x32_bf16 v[72:75], v[60:63], v[28:31], v[72:75]
 ds_read_b128 v[60:63], v113 offset:54272
 v_mul_f32 v83, s37, v83
 s_waitcnt lgkmcnt(7)
 v_mfma_f32_16x16x32_bf16 v[72:75], v[64:67], v[32:35], v[72:75]
 ds_read_b128 v[64:67], v113 offset:55296
 v_mul_f32 v84, s37, v84
 s_waitcnt lgkmcnt(7)
 v_mfma_f32_16x16x32_bf16 v[72:75], v[68:71], v[36:39], v[72:75]
 ds_read_b128 v[68:71], v113 offset:56320
 v_mul_f32 v85, s37, v85
 s_waitcnt lgkmcnt(7)
 v_mfma_f32_16x16x32_bf16 v[76:79], v[40:43], v[8:11], 0
 v_mul_f32 v86, s37, v86
 s_waitcnt lgkmcnt(6)
 v_mfma_f32_16x16x32_bf16 v[76:79], v[44:47], v[12:15], v[76:79]
 v_mul_f32 v87, s37, v87
 s_waitcnt lgkmcnt(5)
 v_mfma_f32_16x16x32_bf16 v[76:79], v[48:51], v[16:19], v[76:79]
 v_cvt_pk_bf16_f32 v92, v80, v81
 s_waitcnt lgkmcnt(4)
 v_mfma_f32_16x16x32_bf16 v[76:79], v[52:55], v[20:23], v[76:79]
 v_cvt_pk_bf16_f32 v93, v82, v83
 s_waitcnt lgkmcnt(3)
 v_mfma_f32_16x16x32_bf16 v[76:79], v[56:59], v[24:27], v[76:79]
 v_cvt_pk_bf16_f32 v94, v84, v85
 s_waitcnt lgkmcnt(2)
 v_mfma_f32_16x16x32_bf16 v[76:79], v[60:63], v[28:31], v[76:79]
 v_cvt_pk_bf16_f32 v95, v86, v87
 s_waitcnt lgkmcnt(1)
 v_mfma_f32_16x16x32_bf16 v[76:79], v[64:67], v[32:35], v[76:79]
 buffer_store_dwordx4 v[92:95], v1, s[16:19], s55 offen offset:1024 sc1
 s_waitcnt lgkmcnt(0)
 v_mfma_f32_16x16x32_bf16 v[76:79], v[68:71], v[36:39], v[76:79]
 v_mul_f32 v72, s37, v72
 v_mul_f32 v73, s37, v73
 v_mul_f32 v74, s37, v74
 v_mul_f32 v75, s37, v75
 s_nop 3
 v_mul_f32 v76, s37, v76
 v_mul_f32 v77, s37, v77
 v_mul_f32 v78, s37, v78
 v_mul_f32 v79, s37, v79
 v_cvt_pk_bf16_f32 v88, v72, v73
 v_cvt_pk_bf16_f32 v89, v74, v75
 v_cvt_pk_bf16_f32 v90, v76, v77
 v_cvt_pk_bf16_f32 v91, v78, v79
 buffer_store_dwordx4 v[88:91], v1, s[16:19], s55 offen offset:2048 sc1
PU_end:
PU_eg:
 s_cmp_lg_u32 s34, 0
 s_cbranch_scc1 PU_eh
 buffer_load_dword v114, v253, s[28:31], 0 offen offset:248 sc1
 s_waitcnt vmcnt(0)
 v_readfirstlane_b32 s34, v114
 s_max_u32 s68, s68, 1
 s_sub_u32 s68, s68, 1
 s_cmp_lg_u32 s68, 0
 s_cbranch_scc1 PU_eg
PU_eh:
 s_lshl_b32 s54, s42, 6
 s_lshl_b32 s55, s43, 2
 s_add_u32 s54, s54, s55
 s_lshl_b32 s55, s49, 10
 s_sub_u32 s54, s54, s55
 s_add_u32 s54, s54, 2089984
 s_cmp_lt_u32 s46, 32
 s_cselect_b32 s54, 1073741824, s54
 s_cselect_b32 s59, 1, s49
 s_lshl_b32 s55, s2, 2
 s_add_u32 s55, s55, 2093056
 s_cmp_eq_u32 s59, 1
 s_cselect_b32 s55, s55, 1073741824
 s_lshl_b32 s57, s46, 2
 s_add_u32 s57, s57, 2091008
 s_cmp_eq_u32 s59, 1
 s_cselect_b32 s57, s57, 1073741824
 s_add_u32 s58, s57, 1024
 s_cmp_lt_u32 s35, 32
 s_cselect_b32 s58, s58, 1073741824
 v_mov_b32 v114, 1073741824
 v_writelane_b32 v114, s54, 0
 v_writelane_b32 v114, s55, 1
 v_writelane_b32 v114, s57, 2
 v_writelane_b32 v114, s58, 3
 s_add_u32 s55, s34, s41
 v_mov_b32 v252, s55
 s_waitcnt vmcnt(0) lgkmcnt(0)
 s_barrier
 s_cmp_lg_u32 s40, 0
 s_cbranch_scc1 PU_nf
 buffer_store_dword v252, v114, s[16:19], 0 offen sc1
PU_nf:
 s_cmp_lt_u32 s46, 32
 s_cbranch_scc0 PU_h
 s_branch CH_start
PU_h:
 s_cmp_eq_u32 s49, 0
 s_cbranch_scc1 PU_out
 s_mov_b32 s49, 0
 s_branch PU_a
PU_out:
 v_add_u32 v2, 57344, v1
 s_mov_b32 s32, 1
 s_mov_b32 s67, 0x20000
 s_mov_b32 s69, 2093056
Hx_w:
 buffer_load_dwordx4 v[8:11], v1, s[16:19], s69 offen sc1
 s_waitcnt vmcnt(0)
 v_xor_b32 v8, s34, v8
 v_xor_b32 v9, s34, v9
 v_xor_b32 v10, s34, v10
 v_xor_b32 v11, s34, v11
 v_or3_b32 v8, v8, v9, v10
 v_or_b32 v8, v8, v11
 v_cmp_lt_u32 vcc, 15, v8
 s_cbranch_vccz Hx_d
 s_sleep 1
 s_max_u32 s68, s68, 1
 s_sub_u32 s68, s68, 1
 s_cmp_lg_u32 s68, 0
 s_cbranch_scc1 Hx_w
Hx_d:
 s_mul_i32 s42, s36, 4682
 s_lshr_b32 s42, s42, 16
 s_mul_i32 s54, s42, 14
 s_sub_u32 s54, s36, s54
 s_lshr_b32 s43, s54, 1
 s_and_b32 s41, s54, 1
 s_lshl_b32 s44, s41, 2
 s_add_u32 s44, s44, s40
 s_mul_i32 s45, s44, 28672
 s_add_u32 s45, s45, 15728640
 s_mul_i32 s47, s44, 458752
 s_lshl_b32 s54, s43, 16
 s_add_u32 s47, s47, s54
 s_lshl_b32 s54, s42, 10
 s_add_u32 s47, s47, s54
 s_add_u32 s47, s47, 44040192
 s_lshr_b32 s54, s36, 1
 s_lshl_b32 s54, s54, 2
 s_lshl_b32 s48, s41, 9
 s_add_u32 s48, s48, s54
 s_add_u32 s48, s48, 8192
 v_add_u32 v232, 0, v1
 v_add_u32 v233, 4096, v1
 v_add_u32 v234, 8192, v1
 v_add_u32 v235, 12288, v1
 v_add_u32 v236, 16384, v1
 v_add_u32 v237, 20480, v1
 v_add_u32 v238, 24576, v1
 s_mul_i32 s59, s42, 401408
 s_mul_i32 s54, s43, 57344
 s_add_u32 s59, s59, s54
 s_add_u32 s59, s59, 8519680
 s_mul_i32 s58, s40, 14336
 s_add_u32 s59, s59, s58
 s_add_u32 m0, s58, 0
 s_add_u32 s54, s59, 0
 buffer_load_dwordx4 v1, s[16:19], s54 offen offset:0 sc1 lds
 buffer_load_dwordx4 v1, s[16:19], s54 offen offset:1024 sc1 lds
 buffer_load_dwordx4 v1, s[16:19], s54 offen offset:2048 sc1 lds
 buffer_load_dwordx4 v1, s[16:19], s54 offen offset:3072 sc1 lds
 s_add_u32 m0, s58, 4096
 s_add_u32 s54, s59, 4096
 buffer_load_dwordx4 v1, s[16:19], s54 offen offset:0 sc1 lds
 buffer_load_dwordx4 v1, s[16:19], s54 offen offset:1024 sc1 lds
 buffer_load_dwordx4 v1, s[16:19], s54 offen offset:2048 sc1 lds
 buffer_load_dwordx4 v1, s[16:19], s54 offen offset:3072 sc1 lds
 s_add_u32 m0, s58, 8192
 s_add_u32 s54, s59, 8192
 buffer_load_dwordx4 v1, s[16:19], s54 offen offset:0 sc1 lds
 buffer_load_dwordx4 v1, s[16:19], s54 offen offset:1024 sc1 lds
 buffer_load_dwordx4 v1, s[16:19], s54 offen offset:2048 sc1 lds
 buffer_load_dwordx4 v1, s[16:19], s54 offen offset:3072 sc1 lds
 s_add_u32 m0, s58, 12288
 s_add_u32 s54, s59, 12288
 buffer_load_dwordx4 v1, s[16:19], s54 offen offset:0 sc1 lds
 buffer_load_dwordx4 v1, s[16:19], s54 offen offset:1024 sc1 lds
 buffer_load_dwordx4 v[120:123], v232, s[16:19], s45 offen offset:0 sc1
 buffer_load_dwordx4 v[176:179], v235, s[16:19], s45 offen offset:2048 sc1
 buffer_load_dwordx4 v[124:127], v232, s[16:19], s45 offen offset:1024 sc1
 buffer_load_dwordx4 v[180:183], v235, s[16:19], s45 offen offset:3072 sc1
 buffer_load_dwordx4 v[128:131], v232, s[16:19], s45 offen offset:2048 sc1
 buffer_load_dwordx4 v[184:187], v236, s[16:19], s45 offen offset:0 sc1
 buffer_load_dwordx4 v[132:135], v232, s[16:19], s45 offen offset:3072 sc1
 buffer_load_dwordx4 v[188:191], v236, s[16:19], s45 offen offset:1024 sc1
 buffer_load_dwordx4 v[136:139], v233, s[16:19], s45 offen offset:0 sc1
 buffer_load_dwordx4 v[192:195], v236, s[16:19], s45 offen offset:2048 sc1
 buffer_load_dwordx4 v[140:143], v233, s[16:19], s45 offen offset:1024 sc1
 buffer_load_dwordx4 v[196:199], v236, s[16:19], s45 offen offset:3072 sc1
 buffer_load_dwordx4 v[144:147], v233, s[16:19], s45 offen offset:2048 sc1
 buffer_load_dwordx4 v[200:203], v237, s[16:19], s45 offen offset:0 sc1
 buffer_load_dwordx4 v[148:151], v233, s[16:19], s45 offen offset:3072 sc1
 buffer_load_dwordx4 v[204:207], v237, s[16:19], s45 offen offset:1024 sc1
 buffer_load_dwordx4 v[152:155], v234, s[16:19], s45 offen offset:0 sc1
 buffer_load_dwordx4 v[208:211], v237, s[16:19], s45 offen offset:2048 sc1
 buffer_load_dwordx4 v[156:159], v234, s[16:19], s45 offen offset:1024 sc1
 buffer_load_dwordx4 v[212:215], v237, s[16:19], s45 offen offset:3072 sc1
 buffer_load_dwordx4 v[160:163], v234, s[16:19], s45 offen offset:2048 sc1
 buffer_load_dwordx4 v[216:219], v238, s[16:19], s45 offen offset:0 sc1
 buffer_load_dwordx4 v[164:167], v234, s[16:19], s45 offen offset:3072 sc1
 buffer_load_dwordx4 v[220:223], v238, s[16:19], s45 offen offset:1024 sc1
 buffer_load_dwordx4 v[168:171], v235, s[16:19], s45 offen offset:0 sc1
 buffer_load_dwordx4 v[224:227], v238, s[16:19], s45 offen offset:2048 sc1
 buffer_load_dwordx4 v[172:175], v235, s[16:19], s45 offen offset:1024 sc1
 buffer_load_dwordx4 v[228:231], v238, s[16:19], s45 offen offset:3072 sc1
 s_waitcnt vmcnt(28)
 s_barrier
 ds_read_b128 a[0:3], v1 offset:0
 ds_read_b128 a[4:7], v1 offset:1024
 ds_read_b128 a[8:11], v1 offset:2048
 ds_read_b128 a[12:15], v1 offset:3072
 ds_read_b128 a[16:19], v1 offset:4096
 ds_read_b128 a[20:23], v1 offset:5120
 ds_read_b128 a[24:27], v1 offset:6144
 ds_read_b128 a[28:31], v1 offset:7168
 ds_read_b128 a[32:35], v1 offset:8192
 ds_read_b128 a[36:39], v1 offset:9216
 ds_read_b128 a[40:43], v1 offset:10240
 ds_read_b128 a[44:47], v1 offset:11264
 ds_read_b128 a[48:51], v1 offset:12288
 ds_read_b128 a[52:55], v1 offset:13312
 ds_read_b128 a[56:59], v1 offset:14336
 ds_read_b128 a[60:63], v1 offset:15360
 ds_read_b128 a[64:67], v1 offset:16384
 ds_read_b128 a[68:71], v1 offset:17408
 ds_read_b128 a[72:75], v1 offset:18432
 ds_read_b128 a[76:79], v1 offset:19456
 ds_read_b128 a[80:83], v1 offset:20480
 ds_read_b128 a[84:87], v1 offset:21504
 ds_read_b128 a[88:91], v1 offset:22528
 ds_read_b128 a[92:95], v1 offset:23552
 ds_read_b128 a[96:99], v1 offset:24576
 ds_read_b128 a[100:103], v1 offset:25600
 ds_read_b128 a[104:107], v1 offset:26624
 ds_read_b128 a[108:111], v1 offset:27648
 ds_read_b128 a[112:115], v1 offset:28672
 ds_read_b128 a[116:119], v1 offset:29696
 ds_read_b128 a[120:123], v1 offset:30720
 ds_read_b128 a[124:127], v1 offset:31744
 ds_read_b128 a[128:131], v1 offset:32768
 ds_read_b128 a[132:135], v1 offset:33792
 ds_read_b128 a[136:139], v1 offset:34816
 ds_read_b128 a[140:143], v1 offset:35840
 ds_read_b128 a[144:147], v1 offset:36864
 ds_read_b128 a[148:151], v1 offset:37888
 ds_read_b128 a[152:155], v1 offset:38912
 ds_read_b128 a[156:159], v1 offset:39936
 ds_read_b128 a[160:163], v1 offset:40960
 ds_read_b128 a[164:167], v1 offset:41984
 ds_read_b128 a[168:171], v1 offset:43008
 ds_read_b128 a[172:175], v1 offset:44032
 ds_read_b128 a[176:179], v1 offset:45056
 ds_read_b128 a[180:183], v1 offset:46080
 ds_read_b128 a[184:187], v1 offset:47104
 ds_read_b128 a[188:191], v1 offset:48128
 ds_read_b128 a[192:195], v1 offset:49152
 ds_read_b128 a[196:199], v1 offset:50176
 ds_read_b128 a[200:203], v1 offset:51200
 ds_read_b128 a[204:207], v1 offset:52224
 ds_read_b128 a[208:211], v1 offset:53248
 ds_read_b128 a[212:215], v1 offset:54272
 ds_read_b128 a[216:219], v1 offset:55296
 ds_read_b128 a[220:223], v1 offset:56320
 s_waitcnt lgkmcnt(0)
 s_mov_b32 s49, 0
 s_waitcnt vmcnt(0)
UE_loop:
 s_add_u32 s45, s45, 229376
 s_waitcnt vmcnt(2)
 v_mfma_f32_16x16x32_bf16 a[224:227], v[120:123], a[0:3], 0
 buffer_load_dwordx4 v[8:11], v232, s[16:19], s45 offen offset:0 sc1
 v_mfma_f32_16x16x32_bf16 a[228:231], v[176:179], a[0:3], 0
 v_mfma_f32_16x16x32_bf16 a[232:235], v[120:123], a[56:59], 0
 v_mfma_f32_16x16x32_bf16 a[236:239], v[176:179], a[56:59], 0
 v_mfma_f32_16x16x32_bf16 a[224:227], v[124:127], a[4:7], a[224:227]
 buffer_load_dwordx4 v[64:67], v235, s[16:19], s45 offen offset:2048 sc1
 v_mfma_f32_16x16x32_bf16 a[228:231], v[180:183], a[4:7], a[228:231]
 v_mfma_f32_16x16x32_bf16 a[232:235], v[124:127], a[60:63], a[232:235]
 v_mfma_f32_16x16x32_bf16 a[236:239], v[180:183], a[60:63], a[236:239]
 v_mfma_f32_16x16x32_bf16 a[224:227], v[128:131], a[8:11], a[224:227]
 buffer_load_dwordx4 v[12:15], v232, s[16:19], s45 offen offset:1024 sc1
 v_mfma_f32_16x16x32_bf16 a[228:231], v[184:187], a[8:11], a[228:231]
 v_mfma_f32_16x16x32_bf16 a[232:235], v[128:131], a[64:67], a[232:235]
 v_mfma_f32_16x16x32_bf16 a[236:239], v[184:187], a[64:67], a[236:239]
 v_mfma_f32_16x16x32_bf16 a[224:227], v[132:135], a[12:15], a[224:227]
 buffer_load_dwordx4 v[68:71], v235, s[16:19], s45 offen offset:3072 sc1
 v_mfma_f32_16x16x32_bf16 a[228:231], v[188:191], a[12:15], a[228:231]
 v_mfma_f32_16x16x32_bf16 a[232:235], v[132:135], a[68:71], a[232:235]
 v_mfma_f32_16x16x32_bf16 a[236:239], v[188:191], a[68:71], a[236:239]
 v_mfma_f32_16x16x32_bf16 a[224:227], v[136:139], a[16:19], a[224:227]
 buffer_load_dwordx4 v[16:19], v232, s[16:19], s45 offen offset:2048 sc1
 v_mfma_f32_16x16x32_bf16 a[228:231], v[192:195], a[16:19], a[228:231]
 v_mfma_f32_16x16x32_bf16 a[232:235], v[136:139], a[72:75], a[232:235]
 v_mfma_f32_16x16x32_bf16 a[236:239], v[192:195], a[72:75], a[236:239]
 v_mfma_f32_16x16x32_bf16 a[224:227], v[140:143], a[20:23], a[224:227]
 buffer_load_dwordx4 v[72:75], v236, s[16:19], s45 offen offset:0 sc1
 v_mfma_f32_16x16x32_bf16 a[228:231], v[196:199], a[20:23], a[228:231]
 v_mfma_f32_16x16x32_bf16 a[232:235], v[140:143], a[76:79], a[232:235]
 v_mfma_f32_16x16x32_bf16 a[236:239], v[196:199], a[76:79], a[236:239]
 v_mfma_f32_16x16x32_bf16 a[224:227], v[144:147], a[24:27], a[224:227]
 buffer_load_dwordx4 v[20:23], v232, s[16:19], s45 offen offset:3072 sc1
 v_mfma_f32_16x16x32_bf16 a[228:231], v[200:203], a[24:27], a[228:231]
 v_mfma_f32_16x16x32_bf16 a[232:235], v[144:147], a[80:83], a[232:235]
 v_mfma_f32_16x16x32_bf16 a[236:239], v[200:203], a[80:83], a[236:239]
 v_mfma_f32_16x16x32_bf16 a[224:227], v[148:151], a[28:31], a[224:227]
 buffer_load_dwordx4 v[76:79], v236, s[16:19], s45 offen offset:1024 sc1
 v_mfma_f32_16x16x32_bf16 a[228:231], v[204:207], a[28:31], a[228:231]
 v_mfma_f32_16x16x32_bf16 a[232:235], v[148:151], a[84:87], a[232:235]
 v_mfma_f32_16x16x32_bf16 a[236:239], v[204:207], a[84:87], a[236:239]
 v_mfma_f32_16x16x32_bf16 a[224:227], v[152:155], a[32:35], a[224:227]
 buffer_load_dwordx4 v[24:27], v233, s[16:19], s45 offen offset:0 sc1
 v_mfma_f32_16x16x32_bf16 a[228:231], v[208:211], a[32:35], a[228:231]
 v_mfma_f32_16x16x32_bf16 a[232:235], v[152:155], a[88:91], a[232:235]
 v_mfma_f32_16x16x32_bf16 a[236:239], v[208:211], a[88:91], a[236:239]
 v_mfma_f32_16x16x32_bf16 a[224:227], v[156:159], a[36:39], a[224:227]
 buffer_load_dwordx4 v[80:83], v236, s[16:19], s45 offen offset:2048 sc1
 v_mfma_f32_16x16x32_bf16 a[228:231], v[212:215], a[36:39], a[228:231]
 v_mfma_f32_16x16x32_bf16 a[232:235], v[156:159], a[92:95], a[232:235]
 v_mfma_f32_16x16x32_bf16 a[236:239], v[212:215], a[92:95], a[236:239]
 v_mfma_f32_16x16x32_bf16 a[224:227], v[160:163], a[40:43], a[224:227]
 buffer_load_dwordx4 v[28:31], v233, s[16:19], s45 offen offset:1024 sc1
 v_mfma_f32_16x16x32_bf16 a[228:231], v[216:219], a[40:43], a[228:231]
 v_mfma_f32_16x16x32_bf16 a[232:235], v[160:163], a[96:99], a[232:235]
 v_mfma_f32_16x16x32_bf16 a[236:239], v[216:219], a[96:99], a[236:239]
 v_mfma_f32_16x16x32_bf16 a[224:227], v[164:167], a[44:47], a[224:227]
 buffer_load_dwordx4 v[84:87], v236, s[16:19], s45 offen offset:3072 sc1
 v_mfma_f32_16x16x32_bf16 a[228:231], v[220:223], a[44:47], a[228:231]
 v_mfma_f32_16x16x32_bf16 a[232:235], v[164:167], a[100:103], a[232:235]
 v_mfma_f32_16x16x32_bf16 a[236:239], v[220:223], a[100:103], a[236:239]
 v_mfma_f32_16x16x32_bf16 a[224:227], v[168:171], a[48:51], a[224:227]
 buffer_load_dwordx4 v[32:35], v233, s[16:19], s45 offen offset:2048 sc1
 v_mfma_f32_16x16x32_bf16 a[228:231], v[224:227], a[48:51], a[228:231]
 v_mfma_f32_16x16x32_bf16 a[232:235], v[168:171], a[104:107], a[232:235]
 v_mfma_f32_16x16x32_bf16 a[236:239], v[224:227], a[104:107], a[236:239]
 v_mfma_f32_16x16x32_bf16 a[224:227], v[172:175], a[52:55], a[224:227]
 buffer_load_dwordx4 v[88:91], v237, s[16:19], s45 offen offset:0 sc1
 v_mfma_f32_16x16x32_bf16 a[228:231], v[228:231], a[52:55], a[228:231]
 v_mfma_f32_16x16x32_bf16 a[232:235], v[172:175], a[108:111], a[232:235]
 v_mfma_f32_16x16x32_bf16 a[236:239], v[228:231], a[108:111], a[236:239]
 s_waitcnt vmcnt(14)
 s_barrier
 s_cmp_lg_u32 s40, 0
 s_cbranch_scc1 UE_n0
 s_cmp_eq_u32 s49, 0
 s_cbranch_scc1 UE_n0
 s_atomic_or s32, s[16:17], s48
 s_add_u32 s48, s48, 1024
UE_n0:
 v_mfma_f32_16x16x32_bf16 a[240:243], v[120:123], a[112:115], 0
 buffer_load_dwordx4 v[36:39], v233, s[16:19], s45 offen offset:3072 sc1
 v_mfma_f32_16x16x32_bf16 a[244:247], v[176:179], a[112:115], 0
 v_mfma_f32_16x16x32_bf16 a[248:251], v[120:123], a[168:171], 0
 v_mfma_f32_16x16x32_bf16 a[252:255], v[176:179], a[168:171], 0
 v_mfma_f32_16x16x32_bf16 a[240:243], v[124:127], a[116:119], a[240:243]
 buffer_load_dwordx4 v[92:95], v237, s[16:19], s45 offen offset:1024 sc1
 v_mfma_f32_16x16x32_bf16 a[244:247], v[180:183], a[116:119], a[244:247]
 v_accvgpr_read_b32 v240, a224
 v_mfma_f32_16x16x32_bf16 a[248:251], v[124:127], a[172:175], a[248:251]
 v_accvgpr_read_b32 v241, a225
 v_mfma_f32_16x16x32_bf16 a[252:255], v[180:183], a[172:175], a[252:255]
 v_accvgpr_read_b32 v242, a226
 v_mfma_f32_16x16x32_bf16 a[240:243], v[128:131], a[120:123], a[240:243]
 buffer_load_dwordx4 v[40:43], v234, s[16:19], s45 offen offset:0 sc1
 v_mfma_f32_16x16x32_bf16 a[244:247], v[184:187], a[120:123], a[244:247]
 v_accvgpr_read_b32 v243, a227
 v_mfma_f32_16x16x32_bf16 a[248:251], v[128:131], a[176:179], a[248:251]
 v_accvgpr_read_b32 v244, a228
 v_mfma_f32_16x16x32_bf16 a[252:255], v[184:187], a[176:179], a[252:255]
 v_accvgpr_read_b32 v245, a229
 v_mfma_f32_16x16x32_bf16 a[240:243], v[132:135], a[124:127], a[240:243]
 buffer_load_dwordx4 v[96:99], v237, s[16:19], s45 offen offset:2048 sc1
 v_mfma_f32_16x16x32_bf16 a[244:247], v[188:191], a[124:127], a[244:247]
 v_accvgpr_read_b32 v246, a230
 v_mfma_f32_16x16x32_bf16 a[248:251], v[132:135], a[180:183], a[248:251]
 v_accvgpr_read_b32 v247, a231
 v_mfma_f32_16x16x32_bf16 a[252:255], v[188:191], a[180:183], a[252:255]
 v_cvt_pk_bf16_f32 v4, v240, v241
 v_mfma_f32_16x16x32_bf16 a[240:243], v[136:139], a[128:131], a[240:243]
 buffer_load_dwordx4 v[44:47], v234, s[16:19], s45 offen offset:1024 sc1
 v_mfma_f32_16x16x32_bf16 a[244:247], v[192:195], a[128:131], a[244:247]
 v_cvt_pk_bf16_f32 v5, v242, v243
 v_mfma_f32_16x16x32_bf16 a[248:251], v[136:139], a[184:187], a[248:251]
 v_cvt_pk_bf16_f32 v6, v244, v245
 v_mfma_f32_16x16x32_bf16 a[252:255], v[192:195], a[184:187], a[252:255]
 v_cvt_pk_bf16_f32 v7, v246, v247
 v_mfma_f32_16x16x32_bf16 a[240:243], v[140:143], a[132:135], a[240:243]
 buffer_load_dwordx4 v[100:103], v237, s[16:19], s45 offen offset:3072 sc1
 v_mfma_f32_16x16x32_bf16 a[244:247], v[196:199], a[132:135], a[244:247]
 buffer_store_dwordx4 v[4:7], v1, s[16:19], s47 offen sc1
 s_add_u32 s47, s47, 16384
 v_mfma_f32_16x16x32_bf16 a[248:251], v[140:143], a[188:191], a[248:251]
 v_accvgpr_read_b32 v240, a232
 v_mfma_f32_16x16x32_bf16 a[252:255], v[196:199], a[188:191], a[252:255]
 v_accvgpr_read_b32 v241, a233
 v_mfma_f32_16x16x32_bf16 a[240:243], v[144:147], a[136:139], a[240:243]
 buffer_load_dwordx4 v[48:51], v234, s[16:19], s45 offen offset:2048 sc1
 v_mfma_f32_16x16x32_bf16 a[244:247], v[200:203], a[136:139], a[244:247]
 v_accvgpr_read_b32 v242, a234
 v_mfma_f32_16x16x32_bf16 a[248:251], v[144:147], a[192:195], a[248:251]
 v_accvgpr_read_b32 v243, a235
 v_mfma_f32_16x16x32_bf16 a[252:255], v[200:203], a[192:195], a[252:255]
 v_accvgpr_read_b32 v244, a236
 v_mfma_f32_16x16x32_bf16 a[240:243], v[148:151], a[140:143], a[240:243]
 buffer_load_dwordx4 v[104:107], v238, s[16:19], s45 offen offset:0 sc1
 v_mfma_f32_16x16x32_bf16 a[244:247], v[204:207], a[140:143], a[244:247]
 v_accvgpr_read_b32 v245, a237
 v_mfma_f32_16x16x32_bf16 a[248:251], v[148:151], a[196:199], a[248:251]
 v_accvgpr_read_b32 v246, a238
 v_mfma_f32_16x16x32_bf16 a[252:255], v[204:207], a[196:199], a[252:255]
 v_accvgpr_read_b32 v247, a239
 v_mfma_f32_16x16x32_bf16 a[240:243], v[152:155], a[144:147], a[240:243]
 buffer_load_dwordx4 v[52:55], v234, s[16:19], s45 offen offset:3072 sc1
 v_mfma_f32_16x16x32_bf16 a[244:247], v[208:211], a[144:147], a[244:247]
 v_cvt_pk_bf16_f32 v4, v240, v241
 v_mfma_f32_16x16x32_bf16 a[248:251], v[152:155], a[200:203], a[248:251]
 v_cvt_pk_bf16_f32 v5, v242, v243
 v_mfma_f32_16x16x32_bf16 a[252:255], v[208:211], a[200:203], a[252:255]
 v_cvt_pk_bf16_f32 v6, v244, v245
 v_mfma_f32_16x16x32_bf16 a[240:243], v[156:159], a[148:151], a[240:243]
 buffer_load_dwordx4 v[108:111], v238, s[16:19], s45 offen offset:1024 sc1
 v_mfma_f32_16x16x32_bf16 a[244:247], v[212:215], a[148:151], a[244:247]
 v_cvt_pk_bf16_f32 v7, v246, v247
 v_mfma_f32_16x16x32_bf16 a[248:251], v[156:159], a[204:207], a[248:251]
 buffer_store_dwordx4 v[4:7], v1, s[16:19], s47 offen sc1
 s_add_u32 s47, s47, 16384
 v_mfma_f32_16x16x32_bf16 a[252:255], v[212:215], a[204:207], a[252:255]
 v_mfma_f32_16x16x32_bf16 a[240:243], v[160:163], a[152:155], a[240:243]
 buffer_load_dwordx4 v[56:59], v235, s[16:19], s45 offen offset:0 sc1
 v_mfma_f32_16x16x32_bf16 a[244:247], v[216:219], a[152:155], a[244:247]
 v_mfma_f32_16x16x32_bf16 a[248:251], v[160:163], a[208:211], a[248:251]
 v_mfma_f32_16x16x32_bf16 a[252:255], v[216:219], a[208:211], a[252:255]
 v_mfma_f32_16x16x32_bf16 a[240:243], v[164:167], a[156:159], a[240:243]
 buffer_load_dwordx4 v[112:115], v238, s[16:19], s45 offen offset:2048 sc1
 v_mfma_f32_16x16x32_bf16 a[244:247], v[220:223], a[156:159], a[244:247]
 v_mfma_f32_16x16x32_bf16 a[248:251], v[164:167], a[212:215], a[248:251]
 v_mfma_f32_16x16x32_bf16 a[252:255], v[220:223], a[212:215], a[252:255]
 v_mfma_f32_16x16x32_bf16 a[240:243], v[168:171], a[160:163], a[240:243]
 buffer_load_dwordx4 v[60:63], v235, s[16:19], s45 offen offset:1024 sc1
 v_mfma_f32_16x16x32_bf16 a[244:247], v[224:227], a[160:163], a[244:247]
 v_mfma_f32_16x16x32_bf16 a[248:251], v[168:171], a[216:219], a[248:251]
 v_mfma_f32_16x16x32_bf16 a[252:255], v[224:227], a[216:219], a[252:255]
 v_mfma_f32_16x16x32_bf16 a[240:243], v[172:175], a[164:167], a[240:243]
 buffer_load_dwordx4 v[116:119], v238, s[16:19], s45 offen offset:3072 sc1
 v_mfma_f32_16x16x32_bf16 a[244:247], v[228:231], a[164:167], a[244:247]
 v_mfma_f32_16x16x32_bf16 a[248:251], v[172:175], a[220:223], a[248:251]
 v_mfma_f32_16x16x32_bf16 a[252:255], v[228:231], a[220:223], a[252:255]
 v_accvgpr_read_b32 v240, a240
 v_accvgpr_read_b32 v241, a241
 v_accvgpr_read_b32 v242, a242
 v_accvgpr_read_b32 v243, a243
 v_accvgpr_read_b32 v244, a244
 v_accvgpr_read_b32 v245, a245
 v_accvgpr_read_b32 v246, a246
 v_accvgpr_read_b32 v247, a247
 v_cvt_pk_bf16_f32 v4, v240, v241
 v_cvt_pk_bf16_f32 v5, v242, v243
 v_cvt_pk_bf16_f32 v6, v244, v245
 v_cvt_pk_bf16_f32 v7, v246, v247
 buffer_store_dwordx4 v[4:7], v1, s[16:19], s47 offen sc1
 s_add_u32 s47, s47, 16384
 v_accvgpr_read_b32 v240, a248
 v_accvgpr_read_b32 v241, a249
 v_accvgpr_read_b32 v242, a250
 v_accvgpr_read_b32 v243, a251
 v_accvgpr_read_b32 v244, a252
 v_accvgpr_read_b32 v245, a253
 v_accvgpr_read_b32 v246, a254
 v_accvgpr_read_b32 v247, a255
 v_cvt_pk_bf16_f32 v4, v240, v241
 v_cvt_pk_bf16_f32 v5, v242, v243
 v_cvt_pk_bf16_f32 v6, v244, v245
 v_cvt_pk_bf16_f32 v7, v246, v247
 buffer_store_dwordx4 v[4:7], v1, s[16:19], s47 offen sc1
 s_add_u32 s47, s47, 16384
 s_cmp_lg_u32 s49, 0
 s_cbranch_scc1 UE_f
 s_waitcnt vmcnt(0)
 s_barrier
 s_cmp_lg_u32 s40, 0
 s_cbranch_scc1 UE_f
 s_atomic_or s32, s[16:17], s48
UE_f:
 s_add_u32 s47, s47, 3604480
 s_add_u32 s45, s45, 229376
 s_cmp_eq_u32 s49, 3
 s_cselect_b32 s45, 1073741824, s45
 s_waitcnt vmcnt(2)
 v_mfma_f32_16x16x32_bf16 a[224:227], v[8:11], a[0:3], 0
 buffer_load_dwordx4 v[120:123], v232, s[16:19], s45 offen offset:0 sc1
 v_mfma_f32_16x16x32_bf16 a[228:231], v[64:67], a[0:3], 0
 v_mfma_f32_16x16x32_bf16 a[232:235], v[8:11], a[56:59], 0
 v_mfma_f32_16x16x32_bf16 a[236:239], v[64:67], a[56:59], 0
 v_mfma_f32_16x16x32_bf16 a[224:227], v[12:15], a[4:7], a[224:227]
 buffer_load_dwordx4 v[176:179], v235, s[16:19], s45 offen offset:2048 sc1
 v_mfma_f32_16x16x32_bf16 a[228:231], v[68:71], a[4:7], a[228:231]
 v_mfma_f32_16x16x32_bf16 a[232:235], v[12:15], a[60:63], a[232:235]
 v_mfma_f32_16x16x32_bf16 a[236:239], v[68:71], a[60:63], a[236:239]
 v_mfma_f32_16x16x32_bf16 a[224:227], v[16:19], a[8:11], a[224:227]
 buffer_load_dwordx4 v[124:127], v232, s[16:19], s45 offen offset:1024 sc1
 v_mfma_f32_16x16x32_bf16 a[228:231], v[72:75], a[8:11], a[228:231]
 v_mfma_f32_16x16x32_bf16 a[232:235], v[16:19], a[64:67], a[232:235]
 v_mfma_f32_16x16x32_bf16 a[236:239], v[72:75], a[64:67], a[236:239]
 v_mfma_f32_16x16x32_bf16 a[224:227], v[20:23], a[12:15], a[224:227]
 buffer_load_dwordx4 v[180:183], v235, s[16:19], s45 offen offset:3072 sc1
 v_mfma_f32_16x16x32_bf16 a[228:231], v[76:79], a[12:15], a[228:231]
 v_mfma_f32_16x16x32_bf16 a[232:235], v[20:23], a[68:71], a[232:235]
 v_mfma_f32_16x16x32_bf16 a[236:239], v[76:79], a[68:71], a[236:239]
 v_mfma_f32_16x16x32_bf16 a[224:227], v[24:27], a[16:19], a[224:227]
 buffer_load_dwordx4 v[128:131], v232, s[16:19], s45 offen offset:2048 sc1
 v_mfma_f32_16x16x32_bf16 a[228:231], v[80:83], a[16:19], a[228:231]
 v_mfma_f32_16x16x32_bf16 a[232:235], v[24:27], a[72:75], a[232:235]
 v_mfma_f32_16x16x32_bf16 a[236:239], v[80:83], a[72:75], a[236:239]
 v_mfma_f32_16x16x32_bf16 a[224:227], v[28:31], a[20:23], a[224:227]
 buffer_load_dwordx4 v[184:187], v236, s[16:19], s45 offen offset:0 sc1
 v_mfma_f32_16x16x32_bf16 a[228:231], v[84:87], a[20:23], a[228:231]
 v_mfma_f32_16x16x32_bf16 a[232:235], v[28:31], a[76:79], a[232:235]
 v_mfma_f32_16x16x32_bf16 a[236:239], v[84:87], a[76:79], a[236:239]
 v_mfma_f32_16x16x32_bf16 a[224:227], v[32:35], a[24:27], a[224:227]
 buffer_load_dwordx4 v[132:135], v232, s[16:19], s45 offen offset:3072 sc1
 v_mfma_f32_16x16x32_bf16 a[228:231], v[88:91], a[24:27], a[228:231]
 v_mfma_f32_16x16x32_bf16 a[232:235], v[32:35], a[80:83], a[232:235]
 v_mfma_f32_16x16x32_bf16 a[236:239], v[88:91], a[80:83], a[236:239]
 v_mfma_f32_16x16x32_bf16 a[224:227], v[36:39], a[28:31], a[224:227]
 buffer_load_dwordx4 v[188:191], v236, s[16:19], s45 offen offset:1024 sc1
 v_mfma_f32_16x16x32_bf16 a[228:231], v[92:95], a[28:31], a[228:231]
 v_mfma_f32_16x16x32_bf16 a[232:235], v[36:39], a[84:87], a[232:235]
 v_mfma_f32_16x16x32_bf16 a[236:239], v[92:95], a[84:87], a[236:239]
 v_mfma_f32_16x16x32_bf16 a[224:227], v[40:43], a[32:35], a[224:227]
 buffer_load_dwordx4 v[136:139], v233, s[16:19], s45 offen offset:0 sc1
 v_mfma_f32_16x16x32_bf16 a[228:231], v[96:99], a[32:35], a[228:231]
 v_mfma_f32_16x16x32_bf16 a[232:235], v[40:43], a[88:91], a[232:235]
 v_mfma_f32_16x16x32_bf16 a[236:239], v[96:99], a[88:91], a[236:239]
 v_mfma_f32_16x16x32_bf16 a[224:227], v[44:47], a[36:39], a[224:227]
 buffer_load_dwordx4 v[192:195], v236, s[16:19], s45 offen offset:2048 sc1
 v_mfma_f32_16x16x32_bf16 a[228:231], v[100:103], a[36:39], a[228:231]
 v_mfma_f32_16x16x32_bf16 a[232:235], v[44:47], a[92:95], a[232:235]
 v_mfma_f32_16x16x32_bf16 a[236:239], v[100:103], a[92:95], a[236:239]
 v_mfma_f32_16x16x32_bf16 a[224:227], v[48:51], a[40:43], a[224:227]
 buffer_load_dwordx4 v[140:143], v233, s[16:19], s45 offen offset:1024 sc1
 v_mfma_f32_16x16x32_bf16 a[228:231], v[104:107], a[40:43], a[228:231]
 v_mfma_f32_16x16x32_bf16 a[232:235], v[48:51], a[96:99], a[232:235]
 v_mfma_f32_16x16x32_bf16 a[236:239], v[104:107], a[96:99], a[236:239]
 v_mfma_f32_16x16x32_bf16 a[224:227], v[52:55], a[44:47], a[224:227]
 buffer_load_dwordx4 v[196:199], v236, s[16:19], s45 offen offset:3072 sc1
 v_mfma_f32_16x16x32_bf16 a[228:231], v[108:111], a[44:47], a[228:231]
 v_mfma_f32_16x16x32_bf16 a[232:235], v[52:55], a[100:103], a[232:235]
 v_mfma_f32_16x16x32_bf16 a[236:239], v[108:111], a[100:103], a[236:239]
 v_mfma_f32_16x16x32_bf16 a[224:227], v[56:59], a[48:51], a[224:227]
 buffer_load_dwordx4 v[144:147], v233, s[16:19], s45 offen offset:2048 sc1
 v_mfma_f32_16x16x32_bf16 a[228:231], v[112:115], a[48:51], a[228:231]
 v_mfma_f32_16x16x32_bf16 a[232:235], v[56:59], a[104:107], a[232:235]
 v_mfma_f32_16x16x32_bf16 a[236:239], v[112:115], a[104:107], a[236:239]
 v_mfma_f32_16x16x32_bf16 a[224:227], v[60:63], a[52:55], a[224:227]
 buffer_load_dwordx4 v[200:203], v237, s[16:19], s45 offen offset:0 sc1
 v_mfma_f32_16x16x32_bf16 a[228:231], v[116:119], a[52:55], a[228:231]
 v_mfma_f32_16x16x32_bf16 a[232:235], v[60:63], a[108:111], a[232:235]
 v_mfma_f32_16x16x32_bf16 a[236:239], v[116:119], a[108:111], a[236:239]
 s_waitcnt vmcnt(14)
 s_barrier
 s_cmp_lg_u32 s40, 0
 s_cbranch_scc1 UE_n1
 s_atomic_or s32, s[16:17], s48
 s_add_u32 s48, s48, 1024
UE_n1:
 v_mfma_f32_16x16x32_bf16 a[240:243], v[8:11], a[112:115], 0
 buffer_load_dwordx4 v[148:151], v233, s[16:19], s45 offen offset:3072 sc1
 v_mfma_f32_16x16x32_bf16 a[244:247], v[64:67], a[112:115], 0
 v_mfma_f32_16x16x32_bf16 a[248:251], v[8:11], a[168:171], 0
 v_mfma_f32_16x16x32_bf16 a[252:255], v[64:67], a[168:171], 0
 v_mfma_f32_16x16x32_bf16 a[240:243], v[12:15], a[116:119], a[240:243]
 buffer_load_dwordx4 v[204:207], v237, s[16:19], s45 offen offset:1024 sc1
 v_mfma_f32_16x16x32_bf16 a[244:247], v[68:71], a[116:119], a[244:247]
 v_accvgpr_read_b32 v240, a224
 v_mfma_f32_16x16x32_bf16 a[248:251], v[12:15], a[172:175], a[248:251]
 v_accvgpr_read_b32 v241, a225
 v_mfma_f32_16x16x32_bf16 a[252:255], v[68:71], a[172:175], a[252:255]
 v_accvgpr_read_b32 v242, a226
 v_mfma_f32_16x16x32_bf16 a[240:243], v[16:19], a[120:123], a[240:243]
 buffer_load_dwordx4 v[152:155], v234, s[16:19], s45 offen offset:0 sc1
 v_mfma_f32_16x16x32_bf16 a[244:247], v[72:75], a[120:123], a[244:247]
 v_accvgpr_read_b32 v243, a227
 v_mfma_f32_16x16x32_bf16 a[248:251], v[16:19], a[176:179], a[248:251]
 v_accvgpr_read_b32 v244, a228
 v_mfma_f32_16x16x32_bf16 a[252:255], v[72:75], a[176:179], a[252:255]
 v_accvgpr_read_b32 v245, a229
 v_mfma_f32_16x16x32_bf16 a[240:243], v[20:23], a[124:127], a[240:243]
 buffer_load_dwordx4 v[208:211], v237, s[16:19], s45 offen offset:2048 sc1
 v_mfma_f32_16x16x32_bf16 a[244:247], v[76:79], a[124:127], a[244:247]
 v_accvgpr_read_b32 v246, a230
 v_mfma_f32_16x16x32_bf16 a[248:251], v[20:23], a[180:183], a[248:251]
 v_accvgpr_read_b32 v247, a231
 v_mfma_f32_16x16x32_bf16 a[252:255], v[76:79], a[180:183], a[252:255]
 v_cvt_pk_bf16_f32 v4, v240, v241
 v_mfma_f32_16x16x32_bf16 a[240:243], v[24:27], a[128:131], a[240:243]
 buffer_load_dwordx4 v[156:159], v234, s[16:19], s45 offen offset:1024 sc1
 v_mfma_f32_16x16x32_bf16 a[244:247], v[80:83], a[128:131], a[244:247]
 v_cvt_pk_bf16_f32 v5, v242, v243
 v_mfma_f32_16x16x32_bf16 a[248:251], v[24:27], a[184:187], a[248:251]
 v_cvt_pk_bf16_f32 v6, v244, v245
 v_mfma_f32_16x16x32_bf16 a[252:255], v[80:83], a[184:187], a[252:255]
 v_cvt_pk_bf16_f32 v7, v246, v247
 v_mfma_f32_16x16x32_bf16 a[240:243], v[28:31], a[132:135], a[240:243]
 buffer_load_dwordx4 v[212:215], v237, s[16:19], s45 offen offset:3072 sc1
 v_mfma_f32_16x16x32_bf16 a[244:247], v[84:87], a[132:135], a[244:247]
 buffer_store_dwordx4 v[4:7], v1, s[16:19], s47 offen sc1
 s_add_u32 s47, s47, 16384
 v_mfma_f32_16x16x32_bf16 a[248:251], v[28:31], a[188:191], a[248:251]
 v_accvgpr_read_b32 v240, a232
 v_mfma_f32_16x16x32_bf16 a[252:255], v[84:87], a[188:191], a[252:255]
 v_accvgpr_read_b32 v241, a233
 v_mfma_f32_16x16x32_bf16 a[240:243], v[32:35], a[136:139], a[240:243]
 buffer_load_dwordx4 v[160:163], v234, s[16:19], s45 offen offset:2048 sc1
 v_mfma_f32_16x16x32_bf16 a[244:247], v[88:91], a[136:139], a[244:247]
 v_accvgpr_read_b32 v242, a234
 v_mfma_f32_16x16x32_bf16 a[248:251], v[32:35], a[192:195], a[248:251]
 v_accvgpr_read_b32 v243, a235
 v_mfma_f32_16x16x32_bf16 a[252:255], v[88:91], a[192:195], a[252:255]
 v_accvgpr_read_b32 v244, a236
 v_mfma_f32_16x16x32_bf16 a[240:243], v[36:39], a[140:143], a[240:243]
 buffer_load_dwordx4 v[216:219], v238, s[16:19], s45 offen offset:0 sc1
 v_mfma_f32_16x16x32_bf16 a[244:247], v[92:95], a[140:143], a[244:247]
 v_accvgpr_read_b32 v245, a237
 v_mfma_f32_16x16x32_bf16 a[248:251], v[36:39], a[196:199], a[248:251]
 v_accvgpr_read_b32 v246, a238
 v_mfma_f32_16x16x32_bf16 a[252:255], v[92:95], a[196:199], a[252:255]
 v_accvgpr_read_b32 v247, a239
 v_mfma_f32_16x16x32_bf16 a[240:243], v[40:43], a[144:147], a[240:243]
 buffer_load_dwordx4 v[164:167], v234, s[16:19], s45 offen offset:3072 sc1
 v_mfma_f32_16x16x32_bf16 a[244:247], v[96:99], a[144:147], a[244:247]
 v_cvt_pk_bf16_f32 v4, v240, v241
 v_mfma_f32_16x16x32_bf16 a[248:251], v[40:43], a[200:203], a[248:251]
 v_cvt_pk_bf16_f32 v5, v242, v243
 v_mfma_f32_16x16x32_bf16 a[252:255], v[96:99], a[200:203], a[252:255]
 v_cvt_pk_bf16_f32 v6, v244, v245
 v_mfma_f32_16x16x32_bf16 a[240:243], v[44:47], a[148:151], a[240:243]
 buffer_load_dwordx4 v[220:223], v238, s[16:19], s45 offen offset:1024 sc1
 v_mfma_f32_16x16x32_bf16 a[244:247], v[100:103], a[148:151], a[244:247]
 v_cvt_pk_bf16_f32 v7, v246, v247
 v_mfma_f32_16x16x32_bf16 a[248:251], v[44:47], a[204:207], a[248:251]
 buffer_store_dwordx4 v[4:7], v1, s[16:19], s47 offen sc1
 s_add_u32 s47, s47, 16384
 v_mfma_f32_16x16x32_bf16 a[252:255], v[100:103], a[204:207], a[252:255]
 v_mfma_f32_16x16x32_bf16 a[240:243], v[48:51], a[152:155], a[240:243]
 buffer_load_dwordx4 v[168:171], v235, s[16:19], s45 offen offset:0 sc1
 v_mfma_f32_16x16x32_bf16 a[244:247], v[104:107], a[152:155], a[244:247]
 v_mfma_f32_16x16x32_bf16 a[248:251], v[48:51], a[208:211], a[248:251]
 v_mfma_f32_16x16x32_bf16 a[252:255], v[104:107], a[208:211], a[252:255]
 v_mfma_f32_16x16x32_bf16 a[240:243], v[52:55], a[156:159], a[240:243]
 buffer_load_dwordx4 v[224:227], v238, s[16:19], s45 offen offset:2048 sc1
 v_mfma_f32_16x16x32_bf16 a[244:247], v[108:111], a[156:159], a[244:247]
 v_mfma_f32_16x16x32_bf16 a[248:251], v[52:55], a[212:215], a[248:251]
 v_mfma_f32_16x16x32_bf16 a[252:255], v[108:111], a[212:215], a[252:255]
 v_mfma_f32_16x16x32_bf16 a[240:243], v[56:59], a[160:163], a[240:243]
 buffer_load_dwordx4 v[172:175], v235, s[16:19], s45 offen offset:1024 sc1
 v_mfma_f32_16x16x32_bf16 a[244:247], v[112:115], a[160:163], a[244:247]
 v_mfma_f32_16x16x32_bf16 a[248:251], v[56:59], a[216:219], a[248:251]
 v_mfma_f32_16x16x32_bf16 a[252:255], v[112:115], a[216:219], a[252:255]
 v_mfma_f32_16x16x32_bf16 a[240:243], v[60:63], a[164:167], a[240:243]
 buffer_load_dwordx4 v[228:231], v238, s[16:19], s45 offen offset:3072 sc1
 v_mfma_f32_16x16x32_bf16 a[244:247], v[116:119], a[164:167], a[244:247]
 v_mfma_f32_16x16x32_bf16 a[248:251], v[60:63], a[220:223], a[248:251]
 v_mfma_f32_16x16x32_bf16 a[252:255], v[116:119], a[220:223], a[252:255]
 v_accvgpr_read_b32 v240, a240
 v_accvgpr_read_b32 v241, a241
 v_accvgpr_read_b32 v242, a242
 v_accvgpr_read_b32 v243, a243
 v_accvgpr_read_b32 v244, a244
 v_accvgpr_read_b32 v245, a245
 v_accvgpr_read_b32 v246, a246
 v_accvgpr_read_b32 v247, a247
 v_cvt_pk_bf16_f32 v4, v240, v241
 v_cvt_pk_bf16_f32 v5, v242, v243
 v_cvt_pk_bf16_f32 v6, v244, v245
 v_cvt_pk_bf16_f32 v7, v246, v247
 buffer_store_dwordx4 v[4:7], v1, s[16:19], s47 offen sc1
 s_add_u32 s47, s47, 16384
 v_accvgpr_read_b32 v240, a248
 v_accvgpr_read_b32 v241, a249
 v_accvgpr_read_b32 v242, a250
 v_accvgpr_read_b32 v243, a251
 v_accvgpr_read_b32 v244, a252
 v_accvgpr_read_b32 v245, a253
 v_accvgpr_read_b32 v246, a254
 v_accvgpr_read_b32 v247, a255
 v_cvt_pk_bf16_f32 v4, v240, v241
 v_cvt_pk_bf16_f32 v5, v242, v243
 v_cvt_pk_bf16_f32 v6, v244, v245
 v_cvt_pk_bf16_f32 v7, v246, v247
 buffer_store_dwordx4 v[4:7], v1, s[16:19], s47 offen sc1
 s_add_u32 s47, s47, 16384
 s_add_u32 s47, s47, 3604480
 s_add_u32 s49, s49, 1
 s_cmp_lt_u32 s49, 4
 s_cbranch_scc1 UE_loop
 s_waitcnt vmcnt(0)
 s_barrier
 s_cmp_lg_u32 s40, 0
 s_cbranch_scc1 UE_e
 s_atomic_or s32, s[16:17], s48
UE_e:
 s_sub_u32 s54, s36, 80
H_r2:
 s_cmp_lt_u32 s36, 80
 s_cbranch_scc1 H_t0
 s_cmp_ge_u32 s54, 112
 s_cbranch_scc1 H_w
 s_cmp_ge_u32 s54, 84
 s_cbranch_scc1 H_py
 s_cmp_ge_u32 s54, 28
 s_cselect_b32 s55, 28, 0
 s_sub_u32 s56, s54, s55
 s_mul_i32 s41, s56, 4682
 s_lshr_b32 s41, s41, 16
 s_mul_i32 s57, s41, 14
 s_sub_u32 s42, s56, s57
 s_cmp_lg_u32 s55, 0
 s_cbranch_scc1 H_m1
H_m2:
 s_load_dwordx2 s[20:21], s[0:1], 80
 s_mov_b32 s22, 1605632
 s_mov_b32 s23, 0x20000
 s_load_dwordx2 s[24:25], s[0:1], 88
 s_mov_b32 s26, 896
 s_mov_b32 s27, 0x20000
 s_load_dwordx2 s[28:29], s[0:1], 96
 s_mov_b32 s30, 1835008
 s_mov_b32 s31, 0x20000
 s_lshr_b32 s44, s42, 1
 s_and_b32 s45, s42, 1
 s_lshl_b32 s55, s44, 7
 s_mul_i32 s54, s40, 401408
 s_add_u32 s55, s55, s54
 s_mov_b32 s57, 28672
 s_mov_b32 s59, 4294594592
 s_waitcnt lgkmcnt(0)
 s_lshl_b32 s47, s44, 2
 s_add_u32 s47, s47, s40
 s_lshl_b32 s48, s47, 5
 v_lshrrev_b32 v8, 4, v0
 v_lshlrev_b32 v8, 3, v8
 buffer_load_dwordx2 v[100:101], v8, s[24:27], s48 offen
 s_barrier
 v_lshrrev_b32 v3, 1, v0
 v_mul_u32_u24 v3, 896, v3
 v_and_b32 v4, 1, v0
 v_lshl_add_u32 v3, v4, 4, v3
 v_lshrrev_b32 v5, 4, v0
 v_and_b32 v6, 15, v0
 s_mul_i32 s58, s40, 28672
 v_lshlrev_b32 v7, 7, v5
 v_lshl_add_u32 v7, v6, 3, v7
 v_add_u32 v7, s58, v7
 s_add_u32 m0, s58, 0
 s_nop 0
 buffer_load_dwordx4 v3, s[20:23], s55 offen lds
 s_add_u32 s55, s55, s57
 s_add_u32 m0, s58, 1024
 s_nop 0
 buffer_load_dwordx4 v3, s[20:23], s55 offen lds
 s_add_u32 s55, s55, s57
 s_add_u32 m0, s58, 2048
 s_nop 0
 buffer_load_dwordx4 v3, s[20:23], s55 offen lds
 s_add_u32 s55, s55, s57
 s_add_u32 m0, s58, 3072
 s_nop 0
 buffer_load_dwordx4 v3, s[20:23], s55 offen lds
 s_add_u32 s55, s55, s57
 s_add_u32 m0, s58, 4096
 s_nop 0
 buffer_load_dwordx4 v3, s[20:23], s55 offen lds
 s_add_u32 s55, s55, s57
 s_add_u32 m0, s58, 5120
 s_nop 0
 buffer_load_dwordx4 v3, s[20:23], s55 offen lds
 s_add_u32 s55, s55, s57
 s_add_u32 m0, s58, 6144
 s_nop 0
 buffer_load_dwordx4 v3, s[20:23], s55 offen lds
 s_add_u32 s55, s55, s57
 s_add_u32 m0, s58, 7168
 s_nop 0
 buffer_load_dwordx4 v3, s[20:23], s55 offen lds
 s_add_u32 s55, s55, s57
 s_add_u32 m0, s58, 8192
 s_nop 0
 buffer_load_dwordx4 v3, s[20:23], s55 offen lds
 s_add_u32 s55, s55, s57
 s_add_u32 m0, s58, 9216
 s_nop 0
 buffer_load_dwordx4 v3, s[20:23], s55 offen lds
 s_add_u32 s55, s55, s57
 s_add_u32 m0, s58, 10240
 s_nop 0
 buffer_load_dwordx4 v3, s[20:23], s55 offen lds
 s_add_u32 s55, s55, s57
 s_add_u32 m0, s58, 11264
 s_nop 0
 buffer_load_dwordx4 v3, s[20:23], s55 offen lds
 s_add_u32 s55, s55, s57
 s_add_u32 m0, s58, 12288
 s_nop 0
 buffer_load_dwordx4 v3, s[20:23], s55 offen lds
 s_add_u32 s55, s55, s57
 s_add_u32 m0, s58, 13312
 s_nop 0
 buffer_load_dwordx4 v3, s[20:23], s55 offen lds
 s_add_u32 s55, s55, s59
 s_add_u32 m0, s58, 14336
 s_nop 0
 buffer_load_dwordx4 v3, s[20:23], s55 offen lds
 s_add_u32 s55, s55, s57
 s_add_u32 m0, s58, 15360
 s_nop 0
 buffer_load_dwordx4 v3, s[20:23], s55 offen lds
 s_add_u32 s55, s55, s57
 s_add_u32 m0, s58, 16384
 s_nop 0
 buffer_load_dwordx4 v3, s[20:23], s55 offen lds
 s_add_u32 s55, s55, s57
 s_add_u32 m0, s58, 17408
 s_nop 0
 buffer_load_dwordx4 v3, s[20:23], s55 offen lds
 s_add_u32 s55, s55, s57
 s_add_u32 m0, s58, 18432
 s_nop 0
 buffer_load_dwordx4 v3, s[20:23], s55 offen lds
 s_add_u32 s55, s55, s57
 s_add_u32 m0, s58, 19456
 s_nop 0
 buffer_load_dwordx4 v3, s[20:23], s55 offen lds
 s_add_u32 s55, s55, s57
 s_add_u32 m0, s58, 20480
 s_nop 0
 buffer_load_dwordx4 v3, s[20:23], s55 offen lds
 s_add_u32 s55, s55, s57
 s_add_u32 m0, s58, 21504
 s_nop 0
 buffer_load_dwordx4 v3, s[20:23], s55 offen lds
 s_add_u32 s55, s55, s57
 s_add_u32 m0, s58, 22528
 s_nop 0
 buffer_load_dwordx4 v3, s[20:23], s55 offen lds
 s_add_u32 s55, s55, s57
 s_add_u32 m0, s58, 23552
 s_nop 0
 buffer_load_dwordx4 v3, s[20:23], s55 offen lds
 s_add_u32 s55, s55, s57
 s_add_u32 m0, s58, 24576
 s_nop 0
 buffer_load_dwordx4 v3, s[20:23], s55 offen lds
 s_add_u32 s55, s55, s57
 s_add_u32 m0, s58, 25600
 s_nop 0
 buffer_load_dwordx4 v3, s[20:23], s55 offen lds
 s_add_u32 s55, s55, s57
 s_add_u32 m0, s58, 26624
 s_nop 0
 buffer_load_dwordx4 v3, s[20:23], s55 offen lds
 s_add_u32 s55, s55, s57
 s_add_u32 m0, s58, 27648
 s_nop 0
 buffer_load_dwordx4 v3, s[20:23], s55 offen lds
 s_add_u32 s55, s55, s59
 s_waitcnt vmcnt(0)
 ds_read_b64_tr_b16 a[0:1], v7 offset:0
 ds_read_b64_tr_b16 a[2:3], v7 offset:512
 ds_read_b64_tr_b16 a[4:5], v7 offset:1024
 ds_read_b64_tr_b16 a[6:7], v7 offset:1536
 ds_read_b64_tr_b16 a[8:9], v7 offset:2048
 ds_read_b64_tr_b16 a[10:11], v7 offset:2560
 ds_read_b64_tr_b16 a[12:13], v7 offset:3072
 ds_read_b64_tr_b16 a[14:15], v7 offset:3584
 ds_read_b64_tr_b16 a[16:17], v7 offset:4096
 ds_read_b64_tr_b16 a[18:19], v7 offset:4608
 ds_read_b64_tr_b16 a[20:21], v7 offset:5120
 ds_read_b64_tr_b16 a[22:23], v7 offset:5632
 ds_read_b64_tr_b16 a[24:25], v7 offset:6144
 ds_read_b64_tr_b16 a[26:27], v7 offset:6656
 ds_read_b64_tr_b16 a[28:29], v7 offset:7168
 ds_read_b64_tr_b16 a[30:31], v7 offset:7680
 ds_read_b64_tr_b16 a[32:33], v7 offset:8192
 ds_read_b64_tr_b16 a[34:35], v7 offset:8704
 ds_read_b64_tr_b16 a[36:37], v7 offset:9216
 ds_read_b64_tr_b16 a[38:39], v7 offset:9728
 ds_read_b64_tr_b16 a[40:41], v7 offset:10240
 ds_read_b64_tr_b16 a[42:43], v7 offset:10752
 ds_read_b64_tr_b16 a[44:45], v7 offset:11264
 ds_read_b64_tr_b16 a[46:47], v7 offset:11776
 ds_read_b64_tr_b16 a[48:49], v7 offset:12288
 ds_read_b64_tr_b16 a[50:51], v7 offset:12800
 ds_read_b64_tr_b16 a[52:53], v7 offset:13312
 ds_read_b64_tr_b16 a[54:55], v7 offset:13824
 ds_read_b64_tr_b16 a[56:57], v7 offset:14336
 ds_read_b64_tr_b16 a[58:59], v7 offset:14848
 ds_read_b64_tr_b16 a[60:61], v7 offset:15360
 ds_read_b64_tr_b16 a[62:63], v7 offset:15872
 ds_read_b64_tr_b16 a[64:65], v7 offset:16384
 ds_read_b64_tr_b16 a[66:67], v7 offset:16896
 ds_read_b64_tr_b16 a[68:69], v7 offset:17408
 ds_read_b64_tr_b16 a[70:71], v7 offset:17920
 ds_read_b64_tr_b16 a[72:73], v7 offset:18432
 ds_read_b64_tr_b16 a[74:75], v7 offset:18944
 ds_read_b64_tr_b16 a[76:77], v7 offset:19456
 ds_read_b64_tr_b16 a[78:79], v7 offset:19968
 ds_read_b64_tr_b16 a[80:81], v7 offset:20480
 ds_read_b64_tr_b16 a[82:83], v7 offset:20992
 ds_read_b64_tr_b16 a[84:85], v7 offset:21504
 ds_read_b64_tr_b16 a[86:87], v7 offset:22016
 ds_read_b64_tr_b16 a[88:89], v7 offset:22528
 ds_read_b64_tr_b16 a[90:91], v7 offset:23040
 ds_read_b64_tr_b16 a[92:93], v7 offset:23552
 ds_read_b64_tr_b16 a[94:95], v7 offset:24064
 ds_read_b64_tr_b16 a[96:97], v7 offset:24576
 ds_read_b64_tr_b16 a[98:99], v7 offset:25088
 ds_read_b64_tr_b16 a[100:101], v7 offset:25600
 ds_read_b64_tr_b16 a[102:103], v7 offset:26112
 ds_read_b64_tr_b16 a[104:105], v7 offset:26624
 ds_read_b64_tr_b16 a[106:107], v7 offset:27136
 ds_read_b64_tr_b16 a[108:109], v7 offset:27648
 ds_read_b64_tr_b16 a[110:111], v7 offset:28160
 s_waitcnt lgkmcnt(0)
 s_add_u32 m0, s58, 0
 s_nop 0
 buffer_load_dwordx4 v3, s[20:23], s55 offen lds
 s_add_u32 s55, s55, s57
 s_add_u32 m0, s58, 1024
 s_nop 0
 buffer_load_dwordx4 v3, s[20:23], s55 offen lds
 s_add_u32 s55, s55, s57
 s_add_u32 m0, s58, 2048
 s_nop 0
 buffer_load_dwordx4 v3, s[20:23], s55 offen lds
 s_add_u32 s55, s55, s57
 s_add_u32 m0, s58, 3072
 s_nop 0
 buffer_load_dwordx4 v3, s[20:23], s55 offen lds
 s_add_u32 s55, s55, s57
 s_add_u32 m0, s58, 4096
 s_nop 0
 buffer_load_dwordx4 v3, s[20:23], s55 offen lds
 s_add_u32 s55, s55, s57
 s_add_u32 m0, s58, 5120
 s_nop 0
 buffer_load_dwordx4 v3, s[20:23], s55 offen lds
 s_add_u32 s55, s55, s57
 s_add_u32 m0, s58, 6144
 s_nop 0
 buffer_load_dwordx4 v3, s[20:23], s55 offen lds
 s_add_u32 s55, s55, s57
 s_add_u32 m0, s58, 7168
 s_nop 0
 buffer_load_dwordx4 v3, s[20:23], s55 offen lds
 s_add_u32 s55, s55, s57
 s_add_u32 m0, s58, 8192
 s_nop 0
 buffer_load_dwordx4 v3, s[20:23], s55 offen lds
 s_add_u32 s55, s55, s57
 s_add_u32 m0, s58, 9216
 s_nop 0
 buffer_load_dwordx4 v3, s[20:23], s55 offen lds
 s_add_u32 s55, s55, s57
 s_add_u32 m0, s58, 10240
 s_nop 0
 buffer_load_dwordx4 v3, s[20:23], s55 offen lds
 s_add_u32 s55, s55, s57
 s_add_u32 m0, s58, 11264
 s_nop 0
 buffer_load_dwordx4 v3, s[20:23], s55 offen lds
 s_add_u32 s55, s55, s57
 s_add_u32 m0, s58, 12288
 s_nop 0
 buffer_load_dwordx4 v3, s[20:23], s55 offen lds
 s_add_u32 s55, s55, s57
 s_add_u32 m0, s58, 13312
 s_nop 0
 buffer_load_dwordx4 v3, s[20:23], s55 offen lds
 s_add_u32 s55, s55, s59
 s_add_u32 m0, s58, 14336
 s_nop 0
 buffer_load_dwordx4 v3, s[20:23], s55 offen lds
 s_add_u32 s55, s55, s57
 s_add_u32 m0, s58, 15360
 s_nop 0
 buffer_load_dwordx4 v3, s[20:23], s55 offen lds
 s_add_u32 s55, s55, s57
 s_add_u32 m0, s58, 16384
 s_nop 0
 buffer_load_dwordx4 v3, s[20:23], s55 offen lds
 s_add_u32 s55, s55, s57
 s_add_u32 m0, s58, 17408
 s_nop 0
 buffer_load_dwordx4 v3, s[20:23], s55 offen lds
 s_add_u32 s55, s55, s57
 s_add_u32 m0, s58, 18432
 s_nop 0
 buffer_load_dwordx4 v3, s[20:23], s55 offen lds
 s_add_u32 s55, s55, s57
 s_add_u32 m0, s58, 19456
 s_nop 0
 buffer_load_dwordx4 v3, s[20:23], s55 offen lds
 s_add_u32 s55, s55, s57
 s_add_u32 m0, s58, 20480
 s_nop 0
 buffer_load_dwordx4 v3, s[20:23], s55 offen lds
 s_add_u32 s55, s55, s57
 s_add_u32 m0, s58, 21504
 s_nop 0
 buffer_load_dwordx4 v3, s[20:23], s55 offen lds
 s_add_u32 s55, s55, s57
 s_add_u32 m0, s58, 22528
 s_nop 0
 buffer_load_dwordx4 v3, s[20:23], s55 offen lds
 s_add_u32 s55, s55, s57
 s_add_u32 m0, s58, 23552
 s_nop 0
 buffer_load_dwordx4 v3, s[20:23], s55 offen lds
 s_add_u32 s55, s55, s57
 s_add_u32 m0, s58, 24576
 s_nop 0
 buffer_load_dwordx4 v3, s[20:23], s55 offen lds
 s_add_u32 s55, s55, s57
 s_add_u32 m0, s58, 25600
 s_nop 0
 buffer_load_dwordx4 v3, s[20:23], s55 offen lds
 s_add_u32 s55, s55, s57
 s_add_u32 m0, s58, 26624
 s_nop 0
 buffer_load_dwordx4 v3, s[20:23], s55 offen lds
 s_add_u32 s55, s55, s57
 s_add_u32 m0, s58, 27648
 s_nop 0
 buffer_load_dwordx4 v3, s[20:23], s55 offen lds
 s_add_u32 s55, s55, s59
 s_waitcnt vmcnt(0)
 ds_read_b64_tr_b16 a[112:113], v7 offset:0
 ds_read_b64_tr_b16 a[114:115], v7 offset:512
 ds_read_b64_tr_b16 a[116:117], v7 offset:1024
 ds_read_b64_tr_b16 a[118:119], v7 offset:1536
 ds_read_b64_tr_b16 a[120:121], v7 offset:2048
 ds_read_b64_tr_b16 a[122:123], v7 offset:2560
 ds_read_b64_tr_b16 a[124:125], v7 offset:3072
 ds_read_b64_tr_b16 a[126:127], v7 offset:3584
 ds_read_b64_tr_b16 a[128:129], v7 offset:4096
 ds_read_b64_tr_b16 a[130:131], v7 offset:4608
 ds_read_b64_tr_b16 a[132:133], v7 offset:5120
 ds_read_b64_tr_b16 a[134:135], v7 offset:5632
 ds_read_b64_tr_b16 a[136:137], v7 offset:6144
 ds_read_b64_tr_b16 a[138:139], v7 offset:6656
 ds_read_b64_tr_b16 a[140:141], v7 offset:7168
 ds_read_b64_tr_b16 a[142:143], v7 offset:7680
 ds_read_b64_tr_b16 a[144:145], v7 offset:8192
 ds_read_b64_tr_b16 a[146:147], v7 offset:8704
 ds_read_b64_tr_b16 a[148:149], v7 offset:9216
 ds_read_b64_tr_b16 a[150:151], v7 offset:9728
 ds_read_b64_tr_b16 a[152:153], v7 offset:10240
 ds_read_b64_tr_b16 a[154:155], v7 offset:10752
 ds_read_b64_tr_b16 a[156:157], v7 offset:11264
 ds_read_b64_tr_b16 a[158:159], v7 offset:11776
 ds_read_b64_tr_b16 a[160:161], v7 offset:12288
 ds_read_b64_tr_b16 a[162:163], v7 offset:12800
 ds_read_b64_tr_b16 a[164:165], v7 offset:13312
 ds_read_b64_tr_b16 a[166:167], v7 offset:13824
 ds_read_b64_tr_b16 a[168:169], v7 offset:14336
 ds_read_b64_tr_b16 a[170:171], v7 offset:14848
 ds_read_b64_tr_b16 a[172:173], v7 offset:15360
 ds_read_b64_tr_b16 a[174:175], v7 offset:15872
 ds_read_b64_tr_b16 a[176:177], v7 offset:16384
 ds_read_b64_tr_b16 a[178:179], v7 offset:16896
 ds_read_b64_tr_b16 a[180:181], v7 offset:17408
 ds_read_b64_tr_b16 a[182:183], v7 offset:17920
 ds_read_b64_tr_b16 a[184:185], v7 offset:18432
 ds_read_b64_tr_b16 a[186:187], v7 offset:18944
 ds_read_b64_tr_b16 a[188:189], v7 offset:19456
 ds_read_b64_tr_b16 a[190:191], v7 offset:19968
 ds_read_b64_tr_b16 a[192:193], v7 offset:20480
 ds_read_b64_tr_b16 a[194:195], v7 offset:20992
 ds_read_b64_tr_b16 a[196:197], v7 offset:21504
 ds_read_b64_tr_b16 a[198:199], v7 offset:22016
 ds_read_b64_tr_b16 a[200:201], v7 offset:22528
 ds_read_b64_tr_b16 a[202:203], v7 offset:23040
 ds_read_b64_tr_b16 a[204:205], v7 offset:23552
 ds_read_b64_tr_b16 a[206:207], v7 offset:24064
 ds_read_b64_tr_b16 a[208:209], v7 offset:24576
 ds_read_b64_tr_b16 a[210:211], v7 offset:25088
 ds_read_b64_tr_b16 a[212:213], v7 offset:25600
 ds_read_b64_tr_b16 a[214:215], v7 offset:26112
 ds_read_b64_tr_b16 a[216:217], v7 offset:26624
 ds_read_b64_tr_b16 a[218:219], v7 offset:27136
 ds_read_b64_tr_b16 a[220:221], v7 offset:27648
 ds_read_b64_tr_b16 a[222:223], v7 offset:28160
 s_waitcnt lgkmcnt(0)
 v_lshlrev_b32 v104, 16, v100
 v_and_b32 v105, 0xffff0000, v100
 v_lshlrev_b32 v106, 16, v101
 v_and_b32 v107, 0xffff0000, v101
 v_lshrrev_b32 v6, 5, v0
 v_lshlrev_b32 v4, 8, v6
 v_and_b32 v6, 15, v0
 v_lshl_add_u32 v4, v6, 4, v4
 v_bfe_u32 v6, v0, 4, 1
 v_lshl_add_u32 v4, v6, 3, v4
 v_and_b32 v6, 15, v0
 v_mul_u32_u24 v5, 896, v6
 v_lshrrev_b32 v6, 4, v0
 v_lshl_add_u32 v5, v6, 3, v5
 s_lshl_b32 s54, s40, 12
 v_add_u32 v3, s54, v1
 s_lshl_b32 s54, s40, 10
 v_add_u32 v6, s54, v1
 s_lshl_b32 s47, s47, 9
 s_mul_i32 s49, s40, 14336
 s_barrier
M2_loop:
 s_lshl_b32 s43, s41, 10
 s_add_u32 s43, s43, 57728
 s_mul_i32 s54, s45, 384
 s_add_u32 s43, s43, s54
 s_lshl_b32 s54, s41, 1
 s_add_u32 s54, s54, s45
 s_mul_i32 s56, s54, 14336
 s_mul_i32 s55, s54, 57344
 s_add_u32 s55, s55, s49
 s_add_u32 s55, s55, 35651584
 s_add_u32 s58, s56, s47
 s_add_u32 s58, s58, 31457280
 s_add_u32 s56, s56, s48
M2_w:
 buffer_load_dword v252, v253, s[16:19], s43 offen sc1
 s_waitcnt vmcnt(0)
 v_cmp_gt_u32 vcc, 14, v252
 s_cbranch_vccz M2_d
 s_sleep 1
 s_max_u32 s68, s68, 1
 s_sub_u32 s68, s68, 1
 s_cmp_lg_u32 s68, 0
 s_cbranch_scc1 M2_w
M2_d:
M2_ld:
 s_mov_b32 s57, s55
 buffer_load_dwordx4 v[8:11], v1, s[16:19], s57 offen offset:0 sc1
 buffer_load_dwordx4 v[12:15], v1, s[16:19], s57 offen offset:1024 sc1
 buffer_load_dwordx4 v[16:19], v1, s[16:19], s57 offen offset:2048 sc1
 buffer_load_dwordx4 v[20:23], v1, s[16:19], s57 offen offset:3072 sc1
 s_add_u32 s57, s57, 4096
 buffer_load_dwordx4 v[24:27], v1, s[16:19], s57 offen offset:0 sc1
 buffer_load_dwordx4 v[28:31], v1, s[16:19], s57 offen offset:1024 sc1
 buffer_load_dwordx4 v[32:35], v1, s[16:19], s57 offen offset:2048 sc1
 buffer_load_dwordx4 v[36:39], v1, s[16:19], s57 offen offset:3072 sc1
 s_add_u32 s57, s57, 4096
 buffer_load_dwordx4 v[40:43], v1, s[16:19], s57 offen offset:0 sc1
 buffer_load_dwordx4 v[44:47], v1, s[16:19], s57 offen offset:1024 sc1
 buffer_load_dwordx4 v[48:51], v1, s[16:19], s57 offen offset:2048 sc1
 buffer_load_dwordx4 v[52:55], v1, s[16:19], s57 offen offset:3072 sc1
 s_add_u32 s57, s57, 4096
 buffer_load_dwordx4 v[56:59], v1, s[16:19], s57 offen offset:0 sc1
 buffer_load_dwordx4 v[60:63], v1, s[16:19], s57 offen offset:1024 sc1
 buffer_load_dwordx2 v[102:103], v4, s[16:19], s58 offen sc1
 s_waitcnt vmcnt(14)
 v_mfma_f32_16x16x32_bf16 v[64:67], a[0:3], v[8:11], 0
 v_max_u32 v110, v8, v9
 v_mfma_f32_16x16x32_bf16 v[68:71], a[56:59], v[8:11], 0
 v_max3_u32 v110, v110, v10, v11
 v_mfma_f32_16x16x32_bf16 v[72:75], a[112:115], v[8:11], 0
 v_mfma_f32_16x16x32_bf16 v[76:79], a[168:171], v[8:11], 0
 s_waitcnt vmcnt(13)
 v_mfma_f32_16x16x32_bf16 v[64:67], a[4:7], v[12:15], v[64:67]
 v_max3_u32 v110, v110, v12, v13
 v_mfma_f32_16x16x32_bf16 v[68:71], a[60:63], v[12:15], v[68:71]
 v_max3_u32 v110, v110, v14, v15
 v_mfma_f32_16x16x32_bf16 v[72:75], a[116:119], v[12:15], v[72:75]
 v_mfma_f32_16x16x32_bf16 v[76:79], a[172:175], v[12:15], v[76:79]
 s_waitcnt vmcnt(12)
 v_mfma_f32_16x16x32_bf16 v[64:67], a[8:11], v[16:19], v[64:67]
 v_max3_u32 v110, v110, v16, v17
 v_mfma_f32_16x16x32_bf16 v[68:71], a[64:67], v[16:19], v[68:71]
 v_max3_u32 v110, v110, v18, v19
 v_mfma_f32_16x16x32_bf16 v[72:75], a[120:123], v[16:19], v[72:75]
 v_mfma_f32_16x16x32_bf16 v[76:79], a[176:179], v[16:19], v[76:79]
 s_waitcnt vmcnt(11)
 v_mfma_f32_16x16x32_bf16 v[64:67], a[12:15], v[20:23], v[64:67]
 v_max3_u32 v110, v110, v20, v21
 v_mfma_f32_16x16x32_bf16 v[68:71], a[68:71], v[20:23], v[68:71]
 v_max3_u32 v110, v110, v22, v23
 v_mfma_f32_16x16x32_bf16 v[72:75], a[124:127], v[20:23], v[72:75]
 v_mfma_f32_16x16x32_bf16 v[76:79], a[180:183], v[20:23], v[76:79]
 s_waitcnt vmcnt(10)
 v_mfma_f32_16x16x32_bf16 v[64:67], a[16:19], v[24:27], v[64:67]
 v_max3_u32 v110, v110, v24, v25
 v_mfma_f32_16x16x32_bf16 v[68:71], a[72:75], v[24:27], v[68:71]
 v_max3_u32 v110, v110, v26, v27
 v_mfma_f32_16x16x32_bf16 v[72:75], a[128:131], v[24:27], v[72:75]
 v_mfma_f32_16x16x32_bf16 v[76:79], a[184:187], v[24:27], v[76:79]
 s_waitcnt vmcnt(9)
 v_mfma_f32_16x16x32_bf16 v[64:67], a[20:23], v[28:31], v[64:67]
 v_max3_u32 v110, v110, v28, v29
 v_mfma_f32_16x16x32_bf16 v[68:71], a[76:79], v[28:31], v[68:71]
 v_max3_u32 v110, v110, v30, v31
 v_mfma_f32_16x16x32_bf16 v[72:75], a[132:135], v[28:31], v[72:75]
 v_mfma_f32_16x16x32_bf16 v[76:79], a[188:191], v[28:31], v[76:79]
 s_waitcnt vmcnt(8)
 v_mfma_f32_16x16x32_bf16 v[64:67], a[24:27], v[32:35], v[64:67]
 v_max3_u32 v110, v110, v32, v33
 v_mfma_f32_16x16x32_bf16 v[68:71], a[80:83], v[32:35], v[68:71]
 v_max3_u32 v110, v110, v34, v35
 v_mfma_f32_16x16x32_bf16 v[72:75], a[136:139], v[32:35], v[72:75]
 v_mfma_f32_16x16x32_bf16 v[76:79], a[192:195], v[32:35], v[76:79]
 s_waitcnt vmcnt(7)
 v_mfma_f32_16x16x32_bf16 v[64:67], a[28:31], v[36:39], v[64:67]
 v_max3_u32 v110, v110, v36, v37
 v_mfma_f32_16x16x32_bf16 v[68:71], a[84:87], v[36:39], v[68:71]
 v_max3_u32 v110, v110, v38, v39
 v_mfma_f32_16x16x32_bf16 v[72:75], a[140:143], v[36:39], v[72:75]
 v_mfma_f32_16x16x32_bf16 v[76:79], a[196:199], v[36:39], v[76:79]
 s_waitcnt vmcnt(6)
 v_mfma_f32_16x16x32_bf16 v[64:67], a[32:35], v[40:43], v[64:67]
 v_max3_u32 v110, v110, v40, v41
 v_mfma_f32_16x16x32_bf16 v[68:71], a[88:91], v[40:43], v[68:71]
 v_max3_u32 v110, v110, v42, v43
 v_mfma_f32_16x16x32_bf16 v[72:75], a[144:147], v[40:43], v[72:75]
 v_mfma_f32_16x16x32_bf16 v[76:79], a[200:203], v[40:43], v[76:79]
 s_waitcnt vmcnt(5)
 v_mfma_f32_16x16x32_bf16 v[64:67], a[36:39], v[44:47], v[64:67]
 v_max3_u32 v110, v110, v44, v45
 v_mfma_f32_16x16x32_bf16 v[68:71], a[92:95], v[44:47], v[68:71]
 v_max3_u32 v110, v110, v46, v47
 v_mfma_f32_16x16x32_bf16 v[72:75], a[148:151], v[44:47], v[72:75]
 v_mfma_f32_16x16x32_bf16 v[76:79], a[204:207], v[44:47], v[76:79]
 s_waitcnt vmcnt(4)
 v_mfma_f32_16x16x32_bf16 v[64:67], a[40:43], v[48:51], v[64:67]
 v_max3_u32 v110, v110, v48, v49
 v_mfma_f32_16x16x32_bf16 v[68:71], a[96:99], v[48:51], v[68:71]
 v_max3_u32 v110, v110, v50, v51
 v_mfma_f32_16x16x32_bf16 v[72:75], a[152:155], v[48:51], v[72:75]
 v_mfma_f32_16x16x32_bf16 v[76:79], a[208:211], v[48:51], v[76:79]
 s_waitcnt vmcnt(3)
 v_mfma_f32_16x16x32_bf16 v[64:67], a[44:47], v[52:55], v[64:67]
 v_max3_u32 v110, v110, v52, v53
 v_mfma_f32_16x16x32_bf16 v[68:71], a[100:103], v[52:55], v[68:71]
 v_max3_u32 v110, v110, v54, v55
 v_mfma_f32_16x16x32_bf16 v[72:75], a[156:159], v[52:55], v[72:75]
 v_mfma_f32_16x16x32_bf16 v[76:79], a[212:215], v[52:55], v[76:79]
 s_waitcnt vmcnt(2)
 v_mfma_f32_16x16x32_bf16 v[64:67], a[48:51], v[56:59], v[64:67]
 v_max3_u32 v110, v110, v56, v57
 v_mfma_f32_16x16x32_bf16 v[68:71], a[104:107], v[56:59], v[68:71]
 v_max3_u32 v110, v110, v58, v59
 v_mfma_f32_16x16x32_bf16 v[72:75], a[160:163], v[56:59], v[72:75]
 v_mfma_f32_16x16x32_bf16 v[76:79], a[216:219], v[56:59], v[76:79]
 s_waitcnt vmcnt(1)
 v_mfma_f32_16x16x32_bf16 v[64:67], a[52:55], v[60:63], v[64:67]
 v_max3_u32 v110, v110, v60, v61
 v_mfma_f32_16x16x32_bf16 v[68:71], a[108:111], v[60:63], v[68:71]
 v_max3_u32 v110, v110, v62, v63
 v_mfma_f32_16x16x32_bf16 v[72:75], a[164:167], v[60:63], v[72:75]
 v_cmp_eq_u32 vcc, -1, v110
 v_mfma_f32_16x16x32_bf16 v[76:79], a[220:223], v[60:63], v[76:79]
 s_cbranch_vccz M2_ok
 s_max_u32 s68, s68, 1
 s_sub_u32 s68, s68, 1
 s_cmp_lg_u32 s68, 0
 s_cbranch_scc1 M2_ld
M2_ok:
 ds_write_b128 v3, v[64:67] offset:0
 ds_write_b128 v3, v[68:71] offset:1024
 s_nop 0
 ds_write_b128 v3, v[72:75] offset:2048
 s_nop 2
 ds_write_b128 v3, v[76:79] offset:3072
 s_waitcnt lgkmcnt(0)
 s_barrier
 ds_read_b128 v[80:83], v6 offset:0
 ds_read_b128 v[84:87], v6 offset:4096
 ds_read_b128 v[88:91], v6 offset:8192
 ds_read_b128 v[92:95], v6 offset:12288
 s_waitcnt vmcnt(0)
 v_lshlrev_b32 v96, 16, v102
 v_and_b32 v97, 0xffff0000, v102
 v_lshlrev_b32 v98, 16, v103
 v_and_b32 v99, 0xffff0000, v103
 v_add_f32 v96, v96, v104
 v_add_f32 v97, v97, v105
 v_add_f32 v98, v98, v106
 v_add_f32 v99, v99, v107
 s_waitcnt lgkmcnt(2)
 v_add_f32 v80, v80, v84
 s_waitcnt lgkmcnt(0)
 v_add_f32 v88, v88, v92
 v_add_f32 v81, v81, v85
 v_add_f32 v89, v89, v93
 v_add_f32 v82, v82, v86
 v_add_f32 v90, v90, v94
 v_add_f32 v83, v83, v87
 v_add_f32 v91, v91, v95
 s_barrier
 v_add_f32 v80, v80, v88
 v_add_f32 v81, v81, v89
 v_add_f32 v82, v82, v90
 v_add_f32 v83, v83, v91
 v_add_f32 v80, v80, v96
 v_add_f32 v81, v81, v97
 v_add_f32 v82, v82, v98
 v_add_f32 v83, v83, v99
 v_cvt_pk_bf16_f32 v80, v80, v81
 v_cvt_pk_bf16_f32 v81, v82, v83
 buffer_store_dwordx2 v[80:81], v5, s[28:31], s56 offen
 s_add_u32 s41, s41, 2
 s_cmp_lt_u32 s41, 64
 s_cbranch_scc1 M2_loop
 s_endpgm
H_m1:
 s_load_dwordx2 s[20:21], s[0:1], 64
 s_mov_b32 s22, 1605632
 s_mov_b32 s23, 0x20000
 s_load_dwordx2 s[24:25], s[0:1], 72
 s_mov_b32 s26, 3584
 s_mov_b32 s27, 0x20000
 s_lshl_b32 s54, s42, 3
 s_lshl_b32 s55, s40, 1
 s_add_u32 s54, s54, s55
 s_lshl_b32 s55, s54, 5
 s_mov_b32 s57, 114688
 s_mov_b32 s59, 4293476384
 s_waitcnt lgkmcnt(0)
 v_lshrrev_b32 v8, 4, v0
 v_lshlrev_b32 v8, 3, v8
 buffer_load_dwordx2 v[96:97], v8, s[24:27], s55 offen
 buffer_load_dwordx2 v[98:99], v8, s[24:27], s55 offen offset:32
 s_barrier
 v_lshrrev_b32 v3, 1, v0
 v_mul_u32_u24 v3, 3584, v3
 v_and_b32 v4, 1, v0
 v_lshl_add_u32 v3, v4, 4, v3
 v_lshrrev_b32 v5, 4, v0
 v_and_b32 v6, 15, v0
 s_mul_i32 s58, s40, 28672
 v_lshlrev_b32 v7, 8, v5
 v_lshl_add_u32 v7, v6, 3, v7
 v_add_u32 v7, s58, v7
 s_add_u32 m0, s58, 0
 s_nop 0
 buffer_load_dwordx4 v3, s[20:23], s55 offen lds
 s_add_u32 s55, s55, s57
 s_add_u32 m0, s58, 1024
 s_nop 0
 buffer_load_dwordx4 v3, s[20:23], s55 offen lds
 s_add_u32 s55, s55, s57
 s_add_u32 m0, s58, 2048
 s_nop 0
 buffer_load_dwordx4 v3, s[20:23], s55 offen lds
 s_add_u32 s55, s55, s57
 s_add_u32 m0, s58, 3072
 s_nop 0
 buffer_load_dwordx4 v3, s[20:23], s55 offen lds
 s_add_u32 s55, s55, s57
 s_add_u32 m0, s58, 4096
 s_nop 0
 buffer_load_dwordx4 v3, s[20:23], s55 offen lds
 s_add_u32 s55, s55, s57
 s_add_u32 m0, s58, 5120
 s_nop 0
 buffer_load_dwordx4 v3, s[20:23], s55 offen lds
 s_add_u32 s55, s55, s57
 s_add_u32 m0, s58, 6144
 s_nop 0
 buffer_load_dwordx4 v3, s[20:23], s55 offen lds
 s_add_u32 s55, s55, s57
 s_add_u32 m0, s58, 7168
 s_nop 0
 buffer_load_dwordx4 v3, s[20:23], s55 offen lds
 s_add_u32 s55, s55, s57
 s_add_u32 m0, s58, 8192
 s_nop 0
 buffer_load_dwordx4 v3, s[20:23], s55 offen lds
 s_add_u32 s55, s55, s57
 s_add_u32 m0, s58, 9216
 s_nop 0
 buffer_load_dwordx4 v3, s[20:23], s55 offen lds
 s_add_u32 s55, s55, s57
 s_add_u32 m0, s58, 10240
 s_nop 0
 buffer_load_dwordx4 v3, s[20:23], s55 offen lds
 s_add_u32 s55, s55, s57
 s_add_u32 m0, s58, 11264
 s_nop 0
 buffer_load_dwordx4 v3, s[20:23], s55 offen lds
 s_add_u32 s55, s55, s57
 s_add_u32 m0, s58, 12288
 s_nop 0
 buffer_load_dwordx4 v3, s[20:23], s55 offen lds
 s_add_u32 s55, s55, s57
 s_add_u32 m0, s58, 13312
 s_nop 0
 buffer_load_dwordx4 v3, s[20:23], s55 offen lds
 s_add_u32 s55, s55, s59
 s_add_u32 m0, s58, 14336
 s_nop 0
 buffer_load_dwordx4 v3, s[20:23], s55 offen lds
 s_add_u32 s55, s55, s57
 s_add_u32 m0, s58, 15360
 s_nop 0
 buffer_load_dwordx4 v3, s[20:23], s55 offen lds
 s_add_u32 s55, s55, s57
 s_add_u32 m0, s58, 16384
 s_nop 0
 buffer_load_dwordx4 v3, s[20:23], s55 offen lds
 s_add_u32 s55, s55, s57
 s_add_u32 m0, s58, 17408
 s_nop 0
 buffer_load_dwordx4 v3, s[20:23], s55 offen lds
 s_add_u32 s55, s55, s57
 s_add_u32 m0, s58, 18432
 s_nop 0
 buffer_load_dwordx4 v3, s[20:23], s55 offen lds
 s_add_u32 s55, s55, s57
 s_add_u32 m0, s58, 19456
 s_nop 0
 buffer_load_dwordx4 v3, s[20:23], s55 offen lds
 s_add_u32 s55, s55, s57
 s_add_u32 m0, s58, 20480
 s_nop 0
 buffer_load_dwordx4 v3, s[20:23], s55 offen lds
 s_add_u32 s55, s55, s57
 s_add_u32 m0, s58, 21504
 s_nop 0
 buffer_load_dwordx4 v3, s[20:23], s55 offen lds
 s_add_u32 s55, s55, s57
 s_add_u32 m0, s58, 22528
 s_nop 0
 buffer_load_dwordx4 v3, s[20:23], s55 offen lds
 s_add_u32 s55, s55, s57
 s_add_u32 m0, s58, 23552
 s_nop 0
 buffer_load_dwordx4 v3, s[20:23], s55 offen lds
 s_add_u32 s55, s55, s57
 s_add_u32 m0, s58, 24576
 s_nop 0
 buffer_load_dwordx4 v3, s[20:23], s55 offen lds
 s_add_u32 s55, s55, s57
 s_add_u32 m0, s58, 25600
 s_nop 0
 buffer_load_dwordx4 v3, s[20:23], s55 offen lds
 s_add_u32 s55, s55, s57
 s_add_u32 m0, s58, 26624
 s_nop 0
 buffer_load_dwordx4 v3, s[20:23], s55 offen lds
 s_add_u32 s55, s55, s57
 s_add_u32 m0, s58, 27648
 s_nop 0
 buffer_load_dwordx4 v3, s[20:23], s55 offen lds
 s_add_u32 s55, s55, s59
 s_waitcnt vmcnt(0)
 ds_read_b64_tr_b16 a[0:1], v7 offset:0
 ds_read_b64_tr_b16 a[2:3], v7 offset:128
 ds_read_b64_tr_b16 a[4:5], v7 offset:1024
 ds_read_b64_tr_b16 a[6:7], v7 offset:1152
 ds_read_b64_tr_b16 a[8:9], v7 offset:2048
 ds_read_b64_tr_b16 a[10:11], v7 offset:2176
 ds_read_b64_tr_b16 a[12:13], v7 offset:3072
 ds_read_b64_tr_b16 a[14:15], v7 offset:3200
 ds_read_b64_tr_b16 a[16:17], v7 offset:4096
 ds_read_b64_tr_b16 a[18:19], v7 offset:4224
 ds_read_b64_tr_b16 a[20:21], v7 offset:5120
 ds_read_b64_tr_b16 a[22:23], v7 offset:5248
 ds_read_b64_tr_b16 a[24:25], v7 offset:6144
 ds_read_b64_tr_b16 a[26:27], v7 offset:6272
 ds_read_b64_tr_b16 a[28:29], v7 offset:7168
 ds_read_b64_tr_b16 a[30:31], v7 offset:7296
 ds_read_b64_tr_b16 a[32:33], v7 offset:8192
 ds_read_b64_tr_b16 a[34:35], v7 offset:8320
 ds_read_b64_tr_b16 a[36:37], v7 offset:9216
 ds_read_b64_tr_b16 a[38:39], v7 offset:9344
 ds_read_b64_tr_b16 a[40:41], v7 offset:10240
 ds_read_b64_tr_b16 a[42:43], v7 offset:10368
 ds_read_b64_tr_b16 a[44:45], v7 offset:11264
 ds_read_b64_tr_b16 a[46:47], v7 offset:11392
 ds_read_b64_tr_b16 a[48:49], v7 offset:12288
 ds_read_b64_tr_b16 a[50:51], v7 offset:12416
 ds_read_b64_tr_b16 a[52:53], v7 offset:13312
 ds_read_b64_tr_b16 a[54:55], v7 offset:13440
 ds_read_b64_tr_b16 a[56:57], v7 offset:14336
 ds_read_b64_tr_b16 a[58:59], v7 offset:14464
 ds_read_b64_tr_b16 a[60:61], v7 offset:15360
 ds_read_b64_tr_b16 a[62:63], v7 offset:15488
 ds_read_b64_tr_b16 a[64:65], v7 offset:16384
 ds_read_b64_tr_b16 a[66:67], v7 offset:16512
 ds_read_b64_tr_b16 a[68:69], v7 offset:17408
 ds_read_b64_tr_b16 a[70:71], v7 offset:17536
 ds_read_b64_tr_b16 a[72:73], v7 offset:18432
 ds_read_b64_tr_b16 a[74:75], v7 offset:18560
 ds_read_b64_tr_b16 a[76:77], v7 offset:19456
 ds_read_b64_tr_b16 a[78:79], v7 offset:19584
 ds_read_b64_tr_b16 a[80:81], v7 offset:20480
 ds_read_b64_tr_b16 a[82:83], v7 offset:20608
 ds_read_b64_tr_b16 a[84:85], v7 offset:21504
 ds_read_b64_tr_b16 a[86:87], v7 offset:21632
 ds_read_b64_tr_b16 a[88:89], v7 offset:22528
 ds_read_b64_tr_b16 a[90:91], v7 offset:22656
 ds_read_b64_tr_b16 a[92:93], v7 offset:23552
 ds_read_b64_tr_b16 a[94:95], v7 offset:23680
 ds_read_b64_tr_b16 a[96:97], v7 offset:24576
 ds_read_b64_tr_b16 a[98:99], v7 offset:24704
 ds_read_b64_tr_b16 a[100:101], v7 offset:25600
 ds_read_b64_tr_b16 a[102:103], v7 offset:25728
 ds_read_b64_tr_b16 a[104:105], v7 offset:26624
 ds_read_b64_tr_b16 a[106:107], v7 offset:26752
 ds_read_b64_tr_b16 a[108:109], v7 offset:27648
 ds_read_b64_tr_b16 a[110:111], v7 offset:27776
 s_waitcnt lgkmcnt(0)
 v_mov_b32 v92, 0x3f803f80
 v_lshlrev_b32 v80, 16, v96
 v_and_b32 v81, 0xffff0000, v96
 v_mov_b32 v93, 0x3f803f80
 v_lshlrev_b32 v82, 16, v97
 v_and_b32 v83, 0xffff0000, v97
 v_mov_b32 v94, 0x3f803f80
 v_lshlrev_b32 v84, 16, v98
 v_and_b32 v85, 0xffff0000, v98
 v_mov_b32 v95, 0x3f803f80
 v_lshlrev_b32 v86, 16, v99
 v_and_b32 v87, 0xffff0000, v99
 v_mfma_f32_16x16x32_bf16 v[72:75], a[0:3], v[92:95], 0
 v_mfma_f32_16x16x32_bf16 v[72:75], a[4:7], v[92:95], v[72:75]
 v_mfma_f32_16x16x32_bf16 v[72:75], a[8:11], v[92:95], v[72:75]
 v_mfma_f32_16x16x32_bf16 v[72:75], a[12:15], v[92:95], v[72:75]
 v_mfma_f32_16x16x32_bf16 v[72:75], a[16:19], v[92:95], v[72:75]
 v_mfma_f32_16x16x32_bf16 v[72:75], a[20:23], v[92:95], v[72:75]
 v_mfma_f32_16x16x32_bf16 v[72:75], a[24:27], v[92:95], v[72:75]
 v_mfma_f32_16x16x32_bf16 v[72:75], a[28:31], v[92:95], v[72:75]
 v_mfma_f32_16x16x32_bf16 v[72:75], a[32:35], v[92:95], v[72:75]
 v_mfma_f32_16x16x32_bf16 v[72:75], a[36:39], v[92:95], v[72:75]
 v_mfma_f32_16x16x32_bf16 v[72:75], a[40:43], v[92:95], v[72:75]
 v_mfma_f32_16x16x32_bf16 v[72:75], a[44:47], v[92:95], v[72:75]
 v_mfma_f32_16x16x32_bf16 v[72:75], a[48:51], v[92:95], v[72:75]
 v_mfma_f32_16x16x32_bf16 v[72:75], a[52:55], v[92:95], v[72:75]
 v_mfma_f32_16x16x32_bf16 v[76:79], a[56:59], v[92:95], 0
 v_mfma_f32_16x16x32_bf16 v[76:79], a[60:63], v[92:95], v[76:79]
 v_mfma_f32_16x16x32_bf16 v[76:79], a[64:67], v[92:95], v[76:79]
 v_mfma_f32_16x16x32_bf16 v[76:79], a[68:71], v[92:95], v[76:79]
 v_mfma_f32_16x16x32_bf16 v[76:79], a[72:75], v[92:95], v[76:79]
 v_mfma_f32_16x16x32_bf16 v[76:79], a[76:79], v[92:95], v[76:79]
 v_mfma_f32_16x16x32_bf16 v[76:79], a[80:83], v[92:95], v[76:79]
 v_mfma_f32_16x16x32_bf16 v[76:79], a[84:87], v[92:95], v[76:79]
 v_mfma_f32_16x16x32_bf16 v[76:79], a[88:91], v[92:95], v[76:79]
 v_mfma_f32_16x16x32_bf16 v[76:79], a[92:95], v[92:95], v[76:79]
 v_mfma_f32_16x16x32_bf16 v[76:79], a[96:99], v[92:95], v[76:79]
 v_mfma_f32_16x16x32_bf16 v[76:79], a[100:103], v[92:95], v[76:79]
 v_mfma_f32_16x16x32_bf16 v[76:79], a[104:107], v[92:95], v[76:79]
 v_mfma_f32_16x16x32_bf16 v[76:79], a[108:111], v[92:95], v[76:79]
 s_mov_b32 s70, 3184710632
 v_mov_b32 v104, 3222493025
 s_mov_b32 s71, 925353388
 s_lshl_b32 s72, s40, 12
 s_lshl_b32 s54, s40, 10
 v_add_u32 v3, s54, v1
 s_mov_b32 m0, s72
 s_barrier
M1_loop:
 s_lshr_b32 s44, s41, 1
 s_lshl_b32 s43, s44, 10
 s_add_u32 s43, s43, 57600
 s_mul_i32 s54, s41, 14336
 s_add_u32 s54, s54, s72
 s_add_u32 s54, s54, 31457280
 s_mul_i32 s56, s41, 57344
 s_lshl_b32 s57, s42, 12
 s_add_u32 s56, s56, s57
 s_add_u32 s56, s56, 35651584
 v_mov_b32 v88, 0
 v_mov_b32 v89, 0
 v_mov_b32 v90, 0
 v_mov_b32 v91, 0
 v_mov_b32 v96, -1
 v_mov_b32 v97, -1
 v_mov_b32 v98, -1
 v_mov_b32 v99, -1
 buffer_store_dwordx4 v[96:99], v3, s[16:19], s56 offen sc1
M1_w:
 buffer_load_dword v252, v253, s[16:19], s43 offen sc1
 s_waitcnt vmcnt(0)
 v_cmp_gt_u32 vcc, 7, v252
 s_cbranch_vccz M1_d
 s_sleep 1
 s_max_u32 s68, s68, 1
 s_sub_u32 s68, s68, 1
 s_cmp_lg_u32 s68, 0
 s_cbranch_scc1 M1_w
M1_d:
 s_and_b32 s55, s41, 1
 s_mul_i32 s55, s55, 384
 s_add_u32 s43, s43, s55
 s_add_u32 s43, s43, 128
M1_ld:
 buffer_load_dwordx4 v1, s[16:19], s54 offen offset:0 sc1 lds
 buffer_load_dwordx4 v1, s[16:19], s54 offen offset:1024 sc1 lds
 s_cmp_eq_u32 s40, 3
 s_cbranch_scc1 M1_dd
 buffer_load_dwordx4 v1, s[16:19], s54 offen offset:2048 sc1 lds
 buffer_load_dwordx4 v1, s[16:19], s54 offen offset:3072 sc1 lds
M1_dd:
 s_waitcnt vmcnt(0)
 s_barrier
 ds_read_b128 v[8:11], v1 offset:0
 ds_read_b128 v[12:15], v1 offset:1024
 ds_read_b128 v[16:19], v1 offset:2048
 ds_read_b128 v[20:23], v1 offset:3072
 ds_read_b128 v[24:27], v1 offset:4096
 ds_read_b128 v[28:31], v1 offset:5120
 ds_read_b128 v[32:35], v1 offset:6144
 ds_read_b128 v[36:39], v1 offset:7168
 ds_read_b128 v[40:43], v1 offset:8192
 ds_read_b128 v[44:47], v1 offset:9216
 ds_read_b128 v[48:51], v1 offset:10240
 ds_read_b128 v[52:55], v1 offset:11264
 ds_read_b128 v[56:59], v1 offset:12288
 ds_read_b128 v[60:63], v1 offset:13312
 s_waitcnt lgkmcnt(13)
 v_mfma_f32_16x16x32_bf16 v[64:67], a[0:3], v[8:11], 0
 v_dot2c_f32_bf16 v88, v8, v8
 v_dot2c_f32_bf16 v89, v9, v9
 v_mfma_f32_16x16x32_bf16 v[68:71], a[56:59], v[8:11], 0
 v_dot2c_f32_bf16 v90, v10, v10
 v_dot2c_f32_bf16 v91, v11, v11
 v_mfma_f32_16x16x32_bf16 v[112:115], v[92:95], v[8:11], 0
 v_max_u32 v116, v8, v9
 v_max3_u32 v116, v116, v10, v11
 s_waitcnt lgkmcnt(12)
 v_mfma_f32_16x16x32_bf16 v[64:67], a[4:7], v[12:15], v[64:67]
 v_dot2c_f32_bf16 v88, v12, v12
 v_dot2c_f32_bf16 v89, v13, v13
 v_mfma_f32_16x16x32_bf16 v[68:71], a[60:63], v[12:15], v[68:71]
 v_dot2c_f32_bf16 v90, v14, v14
 v_dot2c_f32_bf16 v91, v15, v15
 v_mfma_f32_16x16x32_bf16 v[112:115], v[92:95], v[12:15], v[112:115]
 v_max3_u32 v116, v116, v12, v13
 v_max3_u32 v116, v116, v14, v15
 s_waitcnt lgkmcnt(11)
 v_mfma_f32_16x16x32_bf16 v[64:67], a[8:11], v[16:19], v[64:67]
 v_dot2c_f32_bf16 v88, v16, v16
 v_dot2c_f32_bf16 v89, v17, v17
 v_mfma_f32_16x16x32_bf16 v[68:71], a[64:67], v[16:19], v[68:71]
 v_dot2c_f32_bf16 v90, v18, v18
 v_dot2c_f32_bf16 v91, v19, v19
 v_mfma_f32_16x16x32_bf16 v[112:115], v[92:95], v[16:19], v[112:115]
 v_max3_u32 v116, v116, v16, v17
 v_max3_u32 v116, v116, v18, v19
 s_waitcnt lgkmcnt(10)
 v_mfma_f32_16x16x32_bf16 v[64:67], a[12:15], v[20:23], v[64:67]
 v_dot2c_f32_bf16 v88, v20, v20
 v_dot2c_f32_bf16 v89, v21, v21
 v_mfma_f32_16x16x32_bf16 v[68:71], a[68:71], v[20:23], v[68:71]
 v_dot2c_f32_bf16 v90, v22, v22
 v_dot2c_f32_bf16 v91, v23, v23
 v_mfma_f32_16x16x32_bf16 v[112:115], v[92:95], v[20:23], v[112:115]
 v_max3_u32 v116, v116, v20, v21
 v_max3_u32 v116, v116, v22, v23
 s_waitcnt lgkmcnt(9)
 v_mfma_f32_16x16x32_bf16 v[64:67], a[16:19], v[24:27], v[64:67]
 v_dot2c_f32_bf16 v88, v24, v24
 v_dot2c_f32_bf16 v89, v25, v25
 v_mfma_f32_16x16x32_bf16 v[68:71], a[72:75], v[24:27], v[68:71]
 v_dot2c_f32_bf16 v90, v26, v26
 v_dot2c_f32_bf16 v91, v27, v27
 v_mfma_f32_16x16x32_bf16 v[112:115], v[92:95], v[24:27], v[112:115]
 v_max3_u32 v116, v116, v24, v25
 v_max3_u32 v116, v116, v26, v27
 s_waitcnt lgkmcnt(8)
 v_mfma_f32_16x16x32_bf16 v[64:67], a[20:23], v[28:31], v[64:67]
 v_dot2c_f32_bf16 v88, v28, v28
 v_dot2c_f32_bf16 v89, v29, v29
 v_mfma_f32_16x16x32_bf16 v[68:71], a[76:79], v[28:31], v[68:71]
 v_dot2c_f32_bf16 v90, v30, v30
 v_dot2c_f32_bf16 v91, v31, v31
 v_mfma_f32_16x16x32_bf16 v[112:115], v[92:95], v[28:31], v[112:115]
 v_max3_u32 v116, v116, v28, v29
 v_max3_u32 v116, v116, v30, v31
 s_waitcnt lgkmcnt(7)
 v_mfma_f32_16x16x32_bf16 v[64:67], a[24:27], v[32:35], v[64:67]
 v_dot2c_f32_bf16 v88, v32, v32
 v_dot2c_f32_bf16 v89, v33, v33
 v_mfma_f32_16x16x32_bf16 v[68:71], a[80:83], v[32:35], v[68:71]
 v_dot2c_f32_bf16 v90, v34, v34
 v_dot2c_f32_bf16 v91, v35, v35
 v_mfma_f32_16x16x32_bf16 v[112:115], v[92:95], v[32:35], v[112:115]
 v_max3_u32 v116, v116, v32, v33
 v_max3_u32 v116, v116, v34, v35
 s_waitcnt lgkmcnt(6)
 v_mfma_f32_16x16x32_bf16 v[64:67], a[28:31], v[36:39], v[64:67]
 v_dot2c_f32_bf16 v88, v36, v36
 v_dot2c_f32_bf16 v89, v37, v37
 v_mfma_f32_16x16x32_bf16 v[68:71], a[84:87], v[36:39], v[68:71]
 v_dot2c_f32_bf16 v90, v38, v38
 v_dot2c_f32_bf16 v91, v39, v39
 v_mfma_f32_16x16x32_bf16 v[112:115], v[92:95], v[36:39], v[112:115]
 v_max3_u32 v116, v116, v36, v37
 v_max3_u32 v116, v116, v38, v39
 s_waitcnt lgkmcnt(5)
 v_mfma_f32_16x16x32_bf16 v[64:67], a[32:35], v[40:43], v[64:67]
 v_dot2c_f32_bf16 v88, v40, v40
 v_dot2c_f32_bf16 v89, v41, v41
 v_mfma_f32_16x16x32_bf16 v[68:71], a[88:91], v[40:43], v[68:71]
 v_dot2c_f32_bf16 v90, v42, v42
 v_dot2c_f32_bf16 v91, v43, v43
 v_mfma_f32_16x16x32_bf16 v[112:115], v[92:95], v[40:43], v[112:115]
 v_max3_u32 v116, v116, v40, v41
 v_max3_u32 v116, v116, v42, v43
 s_waitcnt lgkmcnt(4)
 v_mfma_f32_16x16x32_bf16 v[64:67], a[36:39], v[44:47], v[64:67]
 v_dot2c_f32_bf16 v88, v44, v44
 v_dot2c_f32_bf16 v89, v45, v45
 v_mfma_f32_16x16x32_bf16 v[68:71], a[92:95], v[44:47], v[68:71]
 v_dot2c_f32_bf16 v90, v46, v46
 v_dot2c_f32_bf16 v91, v47, v47
 v_mfma_f32_16x16x32_bf16 v[112:115], v[92:95], v[44:47], v[112:115]
 v_max3_u32 v116, v116, v44, v45
 v_max3_u32 v116, v116, v46, v47
 s_waitcnt lgkmcnt(3)
 v_mfma_f32_16x16x32_bf16 v[64:67], a[40:43], v[48:51], v[64:67]
 v_dot2c_f32_bf16 v88, v48, v48
 v_dot2c_f32_bf16 v89, v49, v49
 v_mfma_f32_16x16x32_bf16 v[68:71], a[96:99], v[48:51], v[68:71]
 v_dot2c_f32_bf16 v90, v50, v50
 v_dot2c_f32_bf16 v91, v51, v51
 v_mfma_f32_16x16x32_bf16 v[112:115], v[92:95], v[48:51], v[112:115]
 v_max3_u32 v116, v116, v48, v49
 v_max3_u32 v116, v116, v50, v51
 s_waitcnt lgkmcnt(2)
 v_mfma_f32_16x16x32_bf16 v[64:67], a[44:47], v[52:55], v[64:67]
 v_dot2c_f32_bf16 v88, v52, v52
 v_dot2c_f32_bf16 v89, v53, v53
 v_mfma_f32_16x16x32_bf16 v[68:71], a[100:103], v[52:55], v[68:71]
 v_dot2c_f32_bf16 v90, v54, v54
 v_dot2c_f32_bf16 v91, v55, v55
 v_mfma_f32_16x16x32_bf16 v[112:115], v[92:95], v[52:55], v[112:115]
 v_max3_u32 v116, v116, v52, v53
 v_max3_u32 v116, v116, v54, v55
 s_waitcnt lgkmcnt(1)
 v_mfma_f32_16x16x32_bf16 v[64:67], a[48:51], v[56:59], v[64:67]
 v_dot2c_f32_bf16 v88, v56, v56
 v_dot2c_f32_bf16 v89, v57, v57
 v_mfma_f32_16x16x32_bf16 v[68:71], a[104:107], v[56:59], v[68:71]
 v_dot2c_f32_bf16 v90, v58, v58
 v_dot2c_f32_bf16 v91, v59, v59
 v_mfma_f32_16x16x32_bf16 v[112:115], v[92:95], v[56:59], v[112:115]
 v_max3_u32 v116, v116, v56, v57
 v_max3_u32 v116, v116, v58, v59
 s_waitcnt lgkmcnt(0)
 v_mfma_f32_16x16x32_bf16 v[64:67], a[52:55], v[60:63], v[64:67]
 v_dot2c_f32_bf16 v88, v60, v60
 v_dot2c_f32_bf16 v89, v61, v61
 v_mfma_f32_16x16x32_bf16 v[68:71], a[108:111], v[60:63], v[68:71]
 v_dot2c_f32_bf16 v90, v62, v62
 v_dot2c_f32_bf16 v91, v63, v63
 v_mfma_f32_16x16x32_bf16 v[112:115], v[92:95], v[60:63], v[112:115]
 v_max3_u32 v116, v116, v60, v61
 v_max3_u32 v116, v116, v62, v63
 v_cmp_eq_u32 vcc, -1, v116
 s_barrier
 s_cbranch_vccz M1_ok
 s_sub_u32 s67, s67, 1
 s_cmp_lt_i32 s67, 0
 s_cbranch_scc1 M1_ok
 v_mov_b32 v88, 0
 v_mov_b32 v89, 0
 v_mov_b32 v90, 0
 v_mov_b32 v91, 0
 s_branch M1_ld
M1_ok:
 s_nop 1
 v_add_f32 v88, v88, v89
 v_add_f32 v90, v90, v91
 v_add_f32 v89, v88, v90
 v_mov_b32 v96, v89
 s_nop 1
 v_permlane16_swap_b32 v89, v96
 v_add_f32 v89, v89, v96
 v_mov_b32 v96, v89
 s_nop 1
 v_permlane32_swap_b32 v89, v96
 v_add_f32 v89, v89, v96
 v_mul_f32 v88, 991054117, v112
 v_mul_f32 v89, 991054117, v89
 v_fma_f32 v89, -v88, v88, v89
 v_max_f32 v89, 0, v89
 v_add_f32 v96, s71, v89
 v_rsq_f32 v96, v96
 v_fma_f32 v64, -v88, v72, v64
 v_fma_f32 v65, -v88, v73, v65
 v_fma_f32 v66, -v88, v74, v66
 v_fma_f32 v67, -v88, v75, v67
 v_fma_f32 v68, -v88, v76, v68
 v_fma_f32 v69, -v88, v77, v69
 v_fma_f32 v70, -v88, v78, v70
 v_fma_f32 v71, -v88, v79, v71
 v_mul_f32 v97, v96, v96
 v_fma_f32 v97, v89, v97, s71
 v_rsq_f32 v97, v97
 s_nop 0
 v_mul_f32 v89, v96, v97
 v_fma_f32 v64, v64, v89, v80
 v_fma_f32 v65, v65, v89, v81
 v_fma_f32 v66, v66, v89, v82
 v_fma_f32 v67, v67, v89, v83
 v_fma_f32 v68, v68, v89, v84
 v_fma_f32 v69, v69, v89, v85
 v_fma_f32 v70, v70, v89, v86
 v_fma_f32 v71, v71, v89, v87
 v_mul_f32 v96, v64, v64
 v_mul_f32 v97, v65, v65
 v_mul_f32 v98, v66, v66
 v_mul_f32 v99, v67, v67
 v_mul_f32 v100, v68, v68
 v_mul_f32 v101, v69, v69
 v_mul_f32 v102, v70, v70
 v_mul_f32 v103, v71, v71
 v_fma_f32 v96, v96, s70, v104
 v_fma_f32 v97, v97, s70, v104
 v_fma_f32 v98, v98, s70, v104
 v_fma_f32 v99, v99, s70, v104
 v_fma_f32 v100, v100, s70, v104
 v_fma_f32 v101, v101, s70, v104
 v_fma_f32 v102, v102, s70, v104
 v_fma_f32 v103, v103, s70, v104
 v_mul_f32 v96, v96, v64
 v_mul_f32 v97, v97, v65
 v_mul_f32 v98, v98, v66
 v_mul_f32 v99, v99, v67
 v_mul_f32 v100, v100, v68
 v_mul_f32 v101, v101, v69
 v_mul_f32 v102, v102, v70
 v_mul_f32 v103, v103, v71
 s_cmp_lg_u32 s40, 0
 s_cbranch_scc1 M1s_ns
 s_atomic_add s32, s[16:17], s43
M1s_ns:
 v_exp_f32 v96, v96
 v_exp_f32 v97, v97
 v_exp_f32 v98, v98
 v_exp_f32 v99, v99
 v_exp_f32 v100, v100
 v_exp_f32 v101, v101
 v_exp_f32 v102, v102
 v_exp_f32 v103, v103
 v_add_f32 v96, 1.0, v96
 v_add_f32 v97, 1.0, v97
 v_add_f32 v98, 1.0, v98
 v_add_f32 v99, 1.0, v99
 v_add_f32 v100, 1.0, v100
 v_add_f32 v101, 1.0, v101
 v_add_f32 v102, 1.0, v102
 v_add_f32 v103, 1.0, v103
 v_rcp_f32 v96, v96
 v_rcp_f32 v97, v97
 v_rcp_f32 v98, v98
 v_rcp_f32 v99, v99
 v_rcp_f32 v100, v100
 v_rcp_f32 v101, v101
 v_rcp_f32 v102, v102
 v_rcp_f32 v103, v103
 v_mul_f32 v64, v64, v96
 v_mul_f32 v65, v65, v97
 v_mul_f32 v66, v66, v98
 v_mul_f32 v67, v67, v99
 v_mul_f32 v68, v68, v100
 v_mul_f32 v69, v69, v101
 v_mul_f32 v70, v70, v102
 v_mul_f32 v71, v71, v103
 v_cvt_pk_bf16_f32 v96, v64, v65
 v_cvt_pk_bf16_f32 v97, v66, v67
 v_cvt_pk_bf16_f32 v98, v68, v69
 v_cvt_pk_bf16_f32 v99, v70, v71
 v_min_u32 v96, -2, v96
 v_min_u32 v97, -2, v97
 v_min_u32 v98, -2, v98
 v_min_u32 v99, -2, v99
 buffer_store_dwordx4 v[96:99], v3, s[16:19], s56 offen sc1
 s_add_u32 s41, s41, 4
 s_cmp_lt_u32 s41, 126
 s_cbranch_scc1 M1_loop
 s_endpgm
H_py:
 s_sub_u32 s54, s54, 84
 s_mul_i32 s41, s54, 37
 s_lshr_b32 s41, s41, 8
 s_mul_i32 s55, s41, 7
 s_sub_u32 s42, s54, s55
 s_barrier
 s_load_dwordx2 s[20:21], s[0:1], 0
 s_mov_b32 s22, 1835008
 s_mov_b32 s23, 0x20000
 v_lshrrev_b32 v8, 5, v0
 v_mul_u32_u24 v9, 14336, v8
 v_and_b32 v10, 31, v0
 v_lshl_add_u32 v4, v10, 4, v9
 v_and_b32 v10, 15, v0
 v_mul_u32_u24 v5, 896, v10
 v_add_u32 v5, v5, v9
 v_bfe_u32 v11, v0, 4, 1
 v_lshl_add_u32 v5, v11, 4, v5
 v_lshlrev_b32 v6, 10, v8
 v_lshl_add_u32 v6, v11, 9, v6
 v_lshl_add_u32 v6, v10, 4, v6
 v_lshlrev_b32 v2, 2, v0
 s_lshl_b32 s54, s40, 13
 v_add_u32 v3, s54, v1
 s_lshl_b32 s54, s40, 11
 v_add_u32 v6, s54, v6
 v_and_b32 v7, 1, v0
 v_lshlrev_b32 v7, 7, v7
 s_waitcnt lgkmcnt(0)
PY_loop:
 s_lshr_b32 s43, s41, 2
 v_min_u32 v8, 55, v0
 v_lshlrev_b32 v8, 3, v8
 s_lshl_b32 s69, s43, 9
 s_add_u32 s69, s69, 8192
PYu_w:
 buffer_load_dwordx2 v[10:11], v8, s[16:19], s69 offen sc1
 s_waitcnt vmcnt(0)
 v_min_u32 v10, v10, v11
 v_cmp_eq_u32 vcc, 0, v10
 s_cbranch_vccz PYu_d
 s_sleep 2
 s_max_u32 s68, s68, 1
 s_sub_u32 s68, s68, 1
 s_cmp_lg_u32 s68, 0
 s_cbranch_scc1 PYu_w
PYu_d:
 s_mul_i32 s54, s41, 458752
 s_lshl_b32 s55, s42, 16
 s_add_u32 s54, s54, s55
 s_lshl_b32 s55, s40, 12
 s_add_u32 s54, s54, s55
 s_add_u32 s54, s54, 44040192
 buffer_load_dwordx4 a[0:3], v1, s[16:19], s54 offen offset:0 sc1
 buffer_load_dwordx4 a[4:7], v1, s[16:19], s54 offen offset:1024 sc1
 buffer_load_dwordx4 a[8:11], v1, s[16:19], s54 offen offset:2048 sc1
 buffer_load_dwordx4 a[12:15], v1, s[16:19], s54 offen offset:3072 sc1
 s_add_u32 s54, s54, 16384
 buffer_load_dwordx4 a[16:19], v1, s[16:19], s54 offen offset:0 sc1
 buffer_load_dwordx4 a[20:23], v1, s[16:19], s54 offen offset:1024 sc1
 buffer_load_dwordx4 a[24:27], v1, s[16:19], s54 offen offset:2048 sc1
 buffer_load_dwordx4 a[28:31], v1, s[16:19], s54 offen offset:3072 sc1
 s_add_u32 s54, s54, 16384
 buffer_load_dwordx4 a[32:35], v1, s[16:19], s54 offen offset:0 sc1
 buffer_load_dwordx4 a[36:39], v1, s[16:19], s54 offen offset:1024 sc1
 buffer_load_dwordx4 a[40:43], v1, s[16:19], s54 offen offset:2048 sc1
 buffer_load_dwordx4 a[44:47], v1, s[16:19], s54 offen offset:3072 sc1
 s_add_u32 s54, s54, 16384
 buffer_load_dwordx4 a[48:51], v1, s[16:19], s54 offen offset:0 sc1
 buffer_load_dwordx4 a[52:55], v1, s[16:19], s54 offen offset:1024 sc1
 buffer_load_dwordx4 a[56:59], v1, s[16:19], s54 offen offset:2048 sc1
 buffer_load_dwordx4 a[60:63], v1, s[16:19], s54 offen offset:3072 sc1
 s_add_u32 s54, s54, 16384
 s_mul_i32 s70, s41, 28672
 s_lshl_b32 s71, s42, 2
 s_add_u32 s71, s71, s40
 s_lshl_b32 s59, s71, 5
 s_add_u32 s59, s59, s70
 s_lshl_b32 s71, s71, 9
 s_add_u32 s71, s71, s70
 s_add_u32 s71, s71, 31457280
 s_add_u32 s72, s71, 14336
 buffer_load_dwordx4 v[96:99], v5, s[20:23], s59 offen
 s_lshl_b32 s43, s41, 10
 s_add_u32 s43, s43, 57344
 s_mul_i32 s76, s41, 114688
 s_lshl_b32 s57, s42, 14
 s_add_u32 s76, s76, s57
 s_lshl_b32 s57, s40, 10
 s_add_u32 s76, s76, s57
 s_add_u32 s76, s76, 19922944
 s_lshl_b32 s56, s41, 15
 s_add_u32 s56, s56, s55
 s_add_u32 s56, s56, 28311552
 s_add_u32 s57, s56, 16384
 s_lshl_b32 s58, s41, 13
 s_lshl_b32 s59, s40, 10
 s_add_u32 s58, s58, s59
 s_add_u32 s58, s58, 30408704
 s_add_u32 s59, s58, 4096
 v_mov_b32 v100, -1
 v_mov_b32 v101, -1
 v_mov_b32 v102, -1
 v_mov_b32 v103, -1
 buffer_store_dwordx4 v[100:103], v4, s[16:19], s71 offen sc1
PYw_w:
 buffer_load_dword v252, v7, s[16:19], s43 offen sc1
 s_waitcnt vmcnt(0)
 v_cmp_gt_u32 vcc, 16, v252
 s_cbranch_vccz PYw_d
 s_sleep 1
 s_max_u32 s68, s68, 1
 s_sub_u32 s68, s68, 1
 s_cmp_lg_u32 s68, 0
 s_cbranch_scc1 PYw_w
PYw_d:
 s_add_u32 s43, s43, 256
PY_ld:
 s_mov_b32 s77, s76
 buffer_load_dwordx4 v[8:11], v1, s[16:19], s56 offen offset:0 sc1
 buffer_load_dwordx4 v[28:31], v1, s[16:19], s57 offen offset:0 sc1
 buffer_load_dwordx4 v[12:15], v1, s[16:19], s56 offen offset:1024 sc1
 buffer_load_dwordx4 v[32:35], v1, s[16:19], s57 offen offset:1024 sc1
 buffer_load_dwordx4 v[16:19], v1, s[16:19], s56 offen offset:2048 sc1
 buffer_load_dwordx4 v[36:39], v1, s[16:19], s57 offen offset:2048 sc1
 buffer_load_dwordx4 v[20:23], v1, s[16:19], s56 offen offset:3072 sc1
 buffer_load_dwordx4 v[40:43], v1, s[16:19], s57 offen offset:3072 sc1
 buffer_load_dword v24, v2, s[16:19], s58 offen offset:0 sc1
 buffer_load_dword v25, v2, s[16:19], s58 offen offset:256 sc1
 buffer_load_dword v26, v2, s[16:19], s58 offen offset:512 sc1
 buffer_load_dword v27, v2, s[16:19], s58 offen offset:768 sc1
 buffer_load_dword v44, v2, s[16:19], s59 offen offset:0 sc1
 buffer_load_dword v45, v2, s[16:19], s59 offen offset:256 sc1
 buffer_load_dword v46, v2, s[16:19], s59 offen offset:512 sc1
 buffer_load_dword v47, v2, s[16:19], s59 offen offset:768 sc1
 buffer_load_dwordx4 v[48:51], v1, s[16:19], s77 offen sc1
 s_add_u32 s77, s77, 4096
 buffer_load_dwordx4 v[52:55], v1, s[16:19], s77 offen sc1
 s_add_u32 s77, s77, 4096
 buffer_load_dwordx4 v[56:59], v1, s[16:19], s77 offen sc1
 s_add_u32 s77, s77, 4096
 buffer_load_dwordx4 v[60:63], v1, s[16:19], s77 offen sc1
 s_add_u32 s77, s77, 4096
 v_lshlrev_b32 v132, 16, v96
 v_and_b32 v133, 0xffff0000, v96
 v_lshlrev_b32 v134, 16, v97
 v_and_b32 v135, 0xffff0000, v97
 v_lshlrev_b32 v136, 16, v98
 v_and_b32 v137, 0xffff0000, v98
 v_lshlrev_b32 v138, 16, v99
 v_and_b32 v139, 0xffff0000, v99
 s_waitcnt vmcnt(19)
 v_mfma_f32_16x16x32_bf16 v[64:67], a[0:3], v[8:11], 0
 v_max_u32 v100, v8, v9
 v_mfma_f32_16x16x32_bf16 v[72:75], a[16:19], v[8:11], 0
 v_max3_u32 v100, v100, v10, v11
 v_mfma_f32_16x16x32_bf16 v[80:83], a[32:35], v[8:11], 0
 v_mfma_f32_16x16x32_bf16 v[88:91], a[48:51], v[8:11], 0
 s_waitcnt vmcnt(18)
 v_mfma_f32_16x16x32_bf16 v[68:71], a[0:3], v[28:31], 0
 v_max3_u32 v100, v100, v28, v29
 v_mfma_f32_16x16x32_bf16 v[76:79], a[16:19], v[28:31], 0
 v_max3_u32 v100, v100, v30, v31
 v_mfma_f32_16x16x32_bf16 v[84:87], a[32:35], v[28:31], 0
 v_mfma_f32_16x16x32_bf16 v[92:95], a[48:51], v[28:31], 0
 s_waitcnt vmcnt(17)
 v_mfma_f32_16x16x32_bf16 v[64:67], a[4:7], v[12:15], v[64:67]
 v_max3_u32 v100, v100, v12, v13
 v_mfma_f32_16x16x32_bf16 v[72:75], a[20:23], v[12:15], v[72:75]
 v_max3_u32 v100, v100, v14, v15
 v_mfma_f32_16x16x32_bf16 v[80:83], a[36:39], v[12:15], v[80:83]
 v_mfma_f32_16x16x32_bf16 v[88:91], a[52:55], v[12:15], v[88:91]
 s_waitcnt vmcnt(16)
 v_mfma_f32_16x16x32_bf16 v[68:71], a[4:7], v[32:35], v[68:71]
 v_max3_u32 v100, v100, v32, v33
 v_mfma_f32_16x16x32_bf16 v[76:79], a[20:23], v[32:35], v[76:79]
 v_max3_u32 v100, v100, v34, v35
 v_mfma_f32_16x16x32_bf16 v[84:87], a[36:39], v[32:35], v[84:87]
 v_mfma_f32_16x16x32_bf16 v[92:95], a[52:55], v[32:35], v[92:95]
 s_waitcnt vmcnt(15)
 v_mfma_f32_16x16x32_bf16 v[64:67], a[8:11], v[16:19], v[64:67]
 v_max3_u32 v100, v100, v16, v17
 v_mfma_f32_16x16x32_bf16 v[72:75], a[24:27], v[16:19], v[72:75]
 v_max3_u32 v100, v100, v18, v19
 v_mfma_f32_16x16x32_bf16 v[80:83], a[40:43], v[16:19], v[80:83]
 v_mfma_f32_16x16x32_bf16 v[88:91], a[56:59], v[16:19], v[88:91]
 s_waitcnt vmcnt(14)
 v_mfma_f32_16x16x32_bf16 v[68:71], a[8:11], v[36:39], v[68:71]
 v_max3_u32 v100, v100, v36, v37
 v_mfma_f32_16x16x32_bf16 v[76:79], a[24:27], v[36:39], v[76:79]
 v_max3_u32 v100, v100, v38, v39
 v_mfma_f32_16x16x32_bf16 v[84:87], a[40:43], v[36:39], v[84:87]
 v_mfma_f32_16x16x32_bf16 v[92:95], a[56:59], v[36:39], v[92:95]
 s_waitcnt vmcnt(13)
 v_mfma_f32_16x16x32_bf16 v[64:67], a[12:15], v[20:23], v[64:67]
 v_max3_u32 v100, v100, v20, v21
 v_mfma_f32_16x16x32_bf16 v[72:75], a[28:31], v[20:23], v[72:75]
 v_max3_u32 v100, v100, v22, v23
 v_mfma_f32_16x16x32_bf16 v[80:83], a[44:47], v[20:23], v[80:83]
 v_mfma_f32_16x16x32_bf16 v[88:91], a[60:63], v[20:23], v[88:91]
 s_waitcnt vmcnt(12)
 v_mfma_f32_16x16x32_bf16 v[68:71], a[12:15], v[40:43], v[68:71]
 v_max3_u32 v100, v100, v40, v41
 v_mfma_f32_16x16x32_bf16 v[76:79], a[28:31], v[40:43], v[76:79]
 v_max3_u32 v100, v100, v42, v43
 v_mfma_f32_16x16x32_bf16 v[84:87], a[44:47], v[40:43], v[84:87]
 v_mfma_f32_16x16x32_bf16 v[92:95], a[60:63], v[40:43], v[92:95]
 s_waitcnt vmcnt(3)
 v_mfma_f32_16x16x32_bf16 v[64:67], v[48:51], v[24:27], v[64:67]
 v_max3_u32 v100, v100, v24, v25
 v_max3_u32 v100, v100, v48, v49
 s_waitcnt vmcnt(2)
 v_mfma_f32_16x16x32_bf16 v[72:75], v[52:55], v[24:27], v[72:75]
 v_max3_u32 v100, v100, v26, v27
 v_max3_u32 v100, v100, v52, v53
 s_waitcnt vmcnt(1)
 v_mfma_f32_16x16x32_bf16 v[80:83], v[56:59], v[24:27], v[80:83]
 v_max3_u32 v100, v100, v56, v57
 s_waitcnt vmcnt(0)
 v_mfma_f32_16x16x32_bf16 v[88:91], v[60:63], v[24:27], v[88:91]
 v_max3_u32 v100, v100, v60, v61
 v_mfma_f32_16x16x32_bf16 v[68:71], v[48:51], v[44:47], v[68:71]
 v_max3_u32 v100, v100, v44, v45
 v_max3_u32 v100, v100, v50, v51
 v_mfma_f32_16x16x32_bf16 v[76:79], v[52:55], v[44:47], v[76:79]
 v_max3_u32 v100, v100, v46, v47
 v_max3_u32 v100, v100, v54, v55
 v_mfma_f32_16x16x32_bf16 v[84:87], v[56:59], v[44:47], v[84:87]
 v_max3_u32 v100, v100, v58, v59
 v_mfma_f32_16x16x32_bf16 v[92:95], v[60:63], v[44:47], v[92:95]
 v_max3_u32 v100, v100, v62, v63
 v_cmp_eq_u32 vcc, -1, v100
 s_cbranch_vccz PY_ok
 s_max_u32 s68, s68, 1
 s_sub_u32 s68, s68, 1
 s_cmp_lg_u32 s68, 0
 s_cbranch_scc1 PY_ld
PY_ok:
 ds_write_b128 v3, v[64:67] offset:0
 ds_write_b128 v3, v[72:75] offset:2048
 ds_write_b128 v3, v[80:83] offset:4096
 ds_write_b128 v3, v[88:91] offset:6144
 ds_write_b128 v3, v[68:71] offset:1024
 ds_write_b128 v3, v[76:79] offset:3072
 ds_write_b128 v3, v[84:87] offset:5120
 ds_write_b128 v3, v[92:95] offset:7168
 s_waitcnt lgkmcnt(0)
 s_barrier
 ds_read_b128 v[100:103], v6 offset:0
 ds_read_b128 v[104:107], v6 offset:8192
 ds_read_b128 v[108:111], v6 offset:16384
 ds_read_b128 v[112:115], v6 offset:24576
 ds_read_b128 v[116:119], v6 offset:256
 ds_read_b128 v[120:123], v6 offset:8448
 ds_read_b128 v[124:127], v6 offset:16640
 ds_read_b128 v[128:131], v6 offset:24832
 s_waitcnt lgkmcnt(6)
 v_add_f32 v100, v100, v104
 s_waitcnt lgkmcnt(4)
 v_add_f32 v108, v108, v112
 v_add_f32 v101, v101, v105
 v_add_f32 v109, v109, v113
 v_add_f32 v102, v102, v106
 v_add_f32 v110, v110, v114
 v_add_f32 v103, v103, v107
 v_add_f32 v111, v111, v115
 v_add_f32 v100, v100, v132
 v_add_f32 v101, v101, v133
 v_add_f32 v102, v102, v134
 v_add_f32 v103, v103, v135
 v_add_f32 v100, v100, v108
 v_add_f32 v101, v101, v109
 v_add_f32 v102, v102, v110
 v_add_f32 v103, v103, v111
 v_cvt_pk_bf16_f32 v64, v100, v101
 v_cvt_pk_bf16_f32 v65, v102, v103
 v_min_u32 v64, -2, v64
 v_min_u32 v65, -2, v65
 s_waitcnt lgkmcnt(0)
 s_cmp_lg_u32 s40, 0
 s_cbranch_scc1 PYs_ns
 s_atomic_add s32, s[16:17], s43
PYs_ns:
 v_add_f32 v116, v116, v120
 v_add_f32 v124, v124, v128
 v_add_f32 v117, v117, v121
 v_add_f32 v125, v125, v129
 v_add_f32 v118, v118, v122
 v_add_f32 v126, v126, v130
 v_add_f32 v119, v119, v123
 v_add_f32 v127, v127, v131
 v_add_f32 v116, v116, v136
 v_add_f32 v117, v117, v137
 v_add_f32 v118, v118, v138
 v_add_f32 v119, v119, v139
 v_add_f32 v116, v116, v124
 v_add_f32 v117, v117, v125
 v_add_f32 v118, v118, v126
 v_add_f32 v119, v119, v127
 v_cvt_pk_bf16_f32 v66, v116, v117
 v_cvt_pk_bf16_f32 v67, v118, v119
 v_min_u32 v66, -2, v66
 v_min_u32 v67, -2, v67
 buffer_store_dwordx4 v[64:67], v4, s[16:19], s71 offen sc1
 s_barrier
 s_add_u32 s41, s41, 4
 s_cmp_lt_u32 s41, 64
 s_cbranch_scc1 PY_loop
 s_endpgm
H_w:
 s_sub_u32 s42, s54, 112
 s_cmp_ge_u32 s42, 28
 s_cbranch_scc0 WS_go
 s_endpgm
WS_go:
 s_cmp_ge_u32 s42, 14
 s_cselect_b32 s41, 1, 0
 s_mul_i32 s54, s41, 14
 s_sub_u32 s42, s42, s54
 v_bfe_u32 v8, v0, 1, 2
 v_lshlrev_b32 v8, 6, v8
 v_and_b32 v9, 1, v0
 v_lshl_add_u32 v8, v9, 2, v8
 s_lshl_b32 s69, s40, 8
 s_lshr_b32 s54, s42, 1
 s_lshl_b32 s54, s54, 3
 s_add_u32 s69, s69, s54
 s_add_u32 s69, s69, 2088960
WSb_w:
 buffer_load_dword v10, v8, s[16:19], s69 offen sc1
 s_waitcnt vmcnt(0)
 v_and_b32 v11, -16, v10
 v_cmp_ne_u32 vcc, s34, v11
 s_cbranch_vccz WSb_d
 s_sleep 1
 s_max_u32 s68, s68, 1
 s_sub_u32 s68, s68, 1
 s_cmp_lg_u32 s68, 0
 s_cbranch_scc1 WSb_w
WSb_d:
 v_mov_b32 v10, v250
 s_cmp_eq_u32 s42, 0
 s_cselect_b32 s33, 3, 1
 v_mov_b32 v8, 512
 s_mul_i32 s54, s40, 1605632
 s_mul_i32 s56, s42, 28672
 s_add_u32 s54, s54, s56
 s_add_u32 s54, s54, 8519680
 s_add_u32 s59, s54, 0
 buffer_load_dwordx4 a[0:3], v1, s[16:19], s59 offen offset:0 sc1
 buffer_load_dwordx4 a[4:7], v1, s[16:19], s59 offen offset:1024 sc1
 buffer_load_dwordx4 a[8:11], v1, s[16:19], s59 offen offset:2048 sc1
 buffer_load_dwordx4 a[12:15], v1, s[16:19], s59 offen offset:3072 sc1
 s_add_u32 s59, s59, 4096
 buffer_load_dwordx4 a[16:19], v1, s[16:19], s59 offen offset:0 sc1
 buffer_load_dwordx4 a[20:23], v1, s[16:19], s59 offen offset:1024 sc1
 buffer_load_dwordx4 a[24:27], v1, s[16:19], s59 offen offset:2048 sc1
 buffer_load_dwordx4 a[28:31], v1, s[16:19], s59 offen offset:3072 sc1
 s_add_u32 s59, s59, 4096
 buffer_load_dwordx4 a[32:35], v1, s[16:19], s59 offen offset:0 sc1
 buffer_load_dwordx4 a[36:39], v1, s[16:19], s59 offen offset:1024 sc1
 buffer_load_dwordx4 a[40:43], v1, s[16:19], s59 offen offset:2048 sc1
 buffer_load_dwordx4 a[44:47], v1, s[16:19], s59 offen offset:3072 sc1
 s_add_u32 s59, s59, 4096
 buffer_load_dwordx4 a[48:51], v1, s[16:19], s59 offen offset:0 sc1
 buffer_load_dwordx4 a[52:55], v1, s[16:19], s59 offen offset:1024 sc1
 s_add_u32 s59, s54, 401408
 buffer_load_dwordx4 a[56:59], v1, s[16:19], s59 offen offset:0 sc1
 buffer_load_dwordx4 a[60:63], v1, s[16:19], s59 offen offset:1024 sc1
 buffer_load_dwordx4 a[64:67], v1, s[16:19], s59 offen offset:2048 sc1
 buffer_load_dwordx4 a[68:71], v1, s[16:19], s59 offen offset:3072 sc1
 s_add_u32 s59, s59, 4096
 buffer_load_dwordx4 a[72:75], v1, s[16:19], s59 offen offset:0 sc1
 buffer_load_dwordx4 a[76:79], v1, s[16:19], s59 offen offset:1024 sc1
 buffer_load_dwordx4 a[80:83], v1, s[16:19], s59 offen offset:2048 sc1
 buffer_load_dwordx4 a[84:87], v1, s[16:19], s59 offen offset:3072 sc1
 s_add_u32 s59, s59, 4096
 buffer_load_dwordx4 a[88:91], v1, s[16:19], s59 offen offset:0 sc1
 buffer_load_dwordx4 a[92:95], v1, s[16:19], s59 offen offset:1024 sc1
 buffer_load_dwordx4 a[96:99], v1, s[16:19], s59 offen offset:2048 sc1
 buffer_load_dwordx4 a[100:103], v1, s[16:19], s59 offen offset:3072 sc1
 s_add_u32 s59, s59, 4096
 buffer_load_dwordx4 a[104:107], v1, s[16:19], s59 offen offset:0 sc1
 buffer_load_dwordx4 a[108:111], v1, s[16:19], s59 offen offset:1024 sc1
 s_add_u32 s59, s54, 802816
 buffer_load_dwordx4 a[112:115], v1, s[16:19], s59 offen offset:0 sc1
 buffer_load_dwordx4 a[116:119], v1, s[16:19], s59 offen offset:1024 sc1
 buffer_load_dwordx4 a[120:123], v1, s[16:19], s59 offen offset:2048 sc1
 buffer_load_dwordx4 a[124:127], v1, s[16:19], s59 offen offset:3072 sc1
 s_add_u32 s59, s59, 4096
 buffer_load_dwordx4 a[128:131], v1, s[16:19], s59 offen offset:0 sc1
 buffer_load_dwordx4 a[132:135], v1, s[16:19], s59 offen offset:1024 sc1
 buffer_load_dwordx4 a[136:139], v1, s[16:19], s59 offen offset:2048 sc1
 buffer_load_dwordx4 a[140:143], v1, s[16:19], s59 offen offset:3072 sc1
 s_add_u32 s59, s59, 4096
 buffer_load_dwordx4 a[144:147], v1, s[16:19], s59 offen offset:0 sc1
 buffer_load_dwordx4 a[148:151], v1, s[16:19], s59 offen offset:1024 sc1
 buffer_load_dwordx4 a[152:155], v1, s[16:19], s59 offen offset:2048 sc1
 buffer_load_dwordx4 a[156:159], v1, s[16:19], s59 offen offset:3072 sc1
 s_add_u32 s59, s59, 4096
 buffer_load_dwordx4 a[160:163], v1, s[16:19], s59 offen offset:0 sc1
 buffer_load_dwordx4 a[164:167], v1, s[16:19], s59 offen offset:1024 sc1
 s_add_u32 s59, s54, 1204224
 buffer_load_dwordx4 a[168:171], v1, s[16:19], s59 offen offset:0 sc1
 buffer_load_dwordx4 a[172:175], v1, s[16:19], s59 offen offset:1024 sc1
 buffer_load_dwordx4 a[176:179], v1, s[16:19], s59 offen offset:2048 sc1
 buffer_load_dwordx4 a[180:183], v1, s[16:19], s59 offen offset:3072 sc1
 s_add_u32 s59, s59, 4096
 buffer_load_dwordx4 a[184:187], v1, s[16:19], s59 offen offset:0 sc1
 buffer_load_dwordx4 a[188:191], v1, s[16:19], s59 offen offset:1024 sc1
 buffer_load_dwordx4 a[192:195], v1, s[16:19], s59 offen offset:2048 sc1
 buffer_load_dwordx4 a[196:199], v1, s[16:19], s59 offen offset:3072 sc1
 s_add_u32 s59, s59, 4096
 buffer_load_dwordx4 a[200:203], v1, s[16:19], s59 offen offset:0 sc1
 buffer_load_dwordx4 a[204:207], v1, s[16:19], s59 offen offset:1024 sc1
 buffer_load_dwordx4 a[208:211], v1, s[16:19], s59 offen offset:2048 sc1
 buffer_load_dwordx4 a[212:215], v1, s[16:19], s59 offen offset:3072 sc1
 s_add_u32 s59, s59, 4096
 buffer_load_dwordx4 a[216:219], v1, s[16:19], s59 offen offset:0 sc1
 buffer_load_dwordx4 a[220:223], v1, s[16:19], s59 offen offset:1024 sc1
 s_add_u32 s59, s54, 14336
 buffer_load_dwordx4 a[224:227], v1, s[16:19], s59 offen offset:0 sc1
 buffer_load_dwordx4 a[228:231], v1, s[16:19], s59 offen offset:1024 sc1
 buffer_load_dwordx4 a[232:235], v1, s[16:19], s59 offen offset:2048 sc1
 buffer_load_dwordx4 a[236:239], v1, s[16:19], s59 offen offset:3072 sc1
 s_add_u32 s59, s59, 4096
 buffer_load_dwordx4 a[240:243], v1, s[16:19], s59 offen offset:0 sc1
 buffer_load_dwordx4 a[244:247], v1, s[16:19], s59 offen offset:1024 sc1
 buffer_load_dwordx4 a[248:251], v1, s[16:19], s59 offen offset:2048 sc1
 buffer_load_dwordx4 a[252:255], v1, s[16:19], s59 offen offset:3072 sc1
 s_add_u32 s59, s59, 4096
 buffer_load_dwordx4 v[64:67], v1, s[16:19], s59 offen offset:0 sc1
 buffer_load_dwordx4 v[68:71], v1, s[16:19], s59 offen offset:1024 sc1
 buffer_load_dwordx4 v[72:75], v1, s[16:19], s59 offen offset:2048 sc1
 buffer_load_dwordx4 v[76:79], v1, s[16:19], s59 offen offset:3072 sc1
 s_add_u32 s59, s59, 4096
 buffer_load_dwordx4 v[80:83], v1, s[16:19], s59 offen offset:0 sc1
 buffer_load_dwordx4 v[84:87], v1, s[16:19], s59 offen offset:1024 sc1
 s_add_u32 s59, s54, 415744
 buffer_load_dwordx4 v[88:91], v1, s[16:19], s59 offen offset:0 sc1
 buffer_load_dwordx4 v[92:95], v1, s[16:19], s59 offen offset:1024 sc1
 buffer_load_dwordx4 v[96:99], v1, s[16:19], s59 offen offset:2048 sc1
 buffer_load_dwordx4 v[100:103], v1, s[16:19], s59 offen offset:3072 sc1
 s_add_u32 s59, s59, 4096
 buffer_load_dwordx4 v[104:107], v1, s[16:19], s59 offen offset:0 sc1
 buffer_load_dwordx4 v[108:111], v1, s[16:19], s59 offen offset:1024 sc1
 buffer_load_dwordx4 v[112:115], v1, s[16:19], s59 offen offset:2048 sc1
 buffer_load_dwordx4 v[116:119], v1, s[16:19], s59 offen offset:3072 sc1
 s_add_u32 s59, s59, 4096
 buffer_load_dwordx4 v[120:123], v1, s[16:19], s59 offen offset:0 sc1
 buffer_load_dwordx4 v[124:127], v1, s[16:19], s59 offen offset:1024 sc1
 buffer_load_dwordx4 v[128:131], v1, s[16:19], s59 offen offset:2048 sc1
 buffer_load_dwordx4 v[132:135], v1, s[16:19], s59 offen offset:3072 sc1
 s_add_u32 s59, s59, 4096
 buffer_load_dwordx4 v[136:139], v1, s[16:19], s59 offen offset:0 sc1
 buffer_load_dwordx4 v[140:143], v1, s[16:19], s59 offen offset:1024 sc1
 s_add_u32 s59, s54, 817152
 buffer_load_dwordx4 v[144:147], v1, s[16:19], s59 offen offset:0 sc1
 buffer_load_dwordx4 v[148:151], v1, s[16:19], s59 offen offset:1024 sc1
 buffer_load_dwordx4 v[152:155], v1, s[16:19], s59 offen offset:2048 sc1
 buffer_load_dwordx4 v[156:159], v1, s[16:19], s59 offen offset:3072 sc1
 s_add_u32 s59, s59, 4096
 buffer_load_dwordx4 v[160:163], v1, s[16:19], s59 offen offset:0 sc1
 buffer_load_dwordx4 v[164:167], v1, s[16:19], s59 offen offset:1024 sc1
 buffer_load_dwordx4 v[168:171], v1, s[16:19], s59 offen offset:2048 sc1
 buffer_load_dwordx4 v[172:175], v1, s[16:19], s59 offen offset:3072 sc1
 s_add_u32 s59, s59, 4096
 buffer_load_dwordx4 v[176:179], v1, s[16:19], s59 offen offset:0 sc1
 buffer_load_dwordx4 v[180:183], v1, s[16:19], s59 offen offset:1024 sc1
 buffer_load_dwordx4 v[184:187], v1, s[16:19], s59 offen offset:2048 sc1
 buffer_load_dwordx4 v[188:191], v1, s[16:19], s59 offen offset:3072 sc1
 s_add_u32 s59, s59, 4096
 buffer_load_dwordx4 v[192:195], v1, s[16:19], s59 offen offset:0 sc1
 buffer_load_dwordx4 v[196:199], v1, s[16:19], s59 offen offset:1024 sc1
 s_add_u32 s59, s54, 1218560
 buffer_load_dwordx4 v[200:203], v1, s[16:19], s59 offen offset:0 sc1
 buffer_load_dwordx4 v[204:207], v1, s[16:19], s59 offen offset:1024 sc1
 buffer_load_dwordx4 v[208:211], v1, s[16:19], s59 offen offset:2048 sc1
 buffer_load_dwordx4 v[212:215], v1, s[16:19], s59 offen offset:3072 sc1
 s_add_u32 s59, s59, 4096
 buffer_load_dwordx4 v[216:219], v1, s[16:19], s59 offen offset:0 sc1
 buffer_load_dwordx4 v[220:223], v1, s[16:19], s59 offen offset:1024 sc1
 buffer_load_dwordx4 v[224:227], v1, s[16:19], s59 offen offset:2048 sc1
 buffer_load_dwordx4 v[228:231], v1, s[16:19], s59 offen offset:3072 sc1
 s_add_u32 s59, s59, 4096
 buffer_load_dwordx4 v[232:235], v1, s[16:19], s59 offen offset:0 sc1
 buffer_load_dwordx4 v[236:239], v1, s[16:19], s59 offen offset:1024 sc1
 buffer_load_dwordx4 v[240:243], v1, s[16:19], s59 offen offset:2048 sc1
 buffer_load_dwordx4 v[244:247], v1, s[16:19], s59 offen offset:3072 sc1
 s_add_u32 s59, s59, 4096
 buffer_load_dwordx4 v[248:251], v1, s[16:19], s59 offen offset:0 sc1
 buffer_load_dwordx4 v[252:255], v1, s[16:19], s59 offen offset:1024 sc1
 v_bfe_u32 v20, v0, 1, 1
 v_mul_u32_u24 v20, 0xaaaa, v20
 v_add_u32 v2, 0x4444, v20
 s_lshl_b32 s76, s42, 13
 s_lshl_b32 s56, s40, 10
 s_add_u32 s76, s76, s56
 s_add_u32 s76, s76, 19922944
 s_mul_i32 s56, s41, 114688
 s_add_u32 s76, s76, s56
 s_lshl_b32 s44, s40, 11
 s_mul_i32 s51, s41, 7168
 s_add_u32 s51, s51, s44
 s_add_u32 s51, s51, 671744
 s_lshl_b32 s43, s41, 10
 s_add_u32 s43, s43, 57344
 s_mov_b32 s45, 0
 s_mov_b32 m0, s44
 s_mov_b32 s67, 0x10000
WS_loop:
 s_add_u32 s77, s76, 4096
 v_mov_b32 v40, -1
 v_mov_b32 v41, -1
 v_mov_b32 v42, -1
 v_mov_b32 v43, -1
 buffer_store_dwordx4 v[40:43], v1, s[16:19], s76 offen sc1
 buffer_store_dwordx4 v[40:43], v1, s[16:19], s77 offen sc1
 s_waitcnt vmcnt(2)
 s_cmp_lg_u32 s45, 0
 s_cbranch_scc1 WS_c
WS_f:
 buffer_load_dword v9, v8, s[16:19], s43 offen sc1
 s_waitcnt vmcnt(0)
 v_cmp_eq_u32 vcc, 0, v9
 s_cbranch_vccz WS_l
 s_sleep 2
 s_max_u32 s68, s68, 1
 s_sub_u32 s68, s68, 1
 s_cmp_lg_u32 s68, 0
 s_cbranch_scc1 WS_f
WS_l:
 buffer_load_dwordx4 v1, s[16:19], s51 offen sc1 lds
 buffer_load_dwordx4 v1, s[16:19], s51 offen offset:1024 sc1 lds
 s_waitcnt vmcnt(0)
WS_c:
 s_barrier
 ds_read_b128 v[12:15], v1 offset:0
 ds_read_b128 v[16:19], v1 offset:1024
 ds_read_b128 v[20:23], v1 offset:2048
 ds_read_b128 v[24:27], v1 offset:3072
 ds_read_b128 v[28:31], v1 offset:4096
 ds_read_b128 v[32:35], v1 offset:5120
 ds_read_b128 v[36:39], v1 offset:6144
 buffer_load_dword v9, v8, s[16:19], s43 offen offset:2048 sc1
 v_mov_b32 v40, 0
 v_mov_b32 v41, 0
 v_mov_b32 v42, 0
 v_mov_b32 v43, 0
 v_mov_b32 v44, 0
 v_mov_b32 v45, 0
 v_mov_b32 v46, 0
 v_mov_b32 v47, 0
 v_mov_b32 v48, 0
 v_mov_b32 v49, 0
 v_mov_b32 v50, 0
 v_mov_b32 v51, 0
 v_mov_b32 v52, 0
 v_mov_b32 v53, 0
 v_mov_b32 v54, 0
 v_mov_b32 v55, 0
 s_waitcnt lgkmcnt(0)
 v_max3_u32 v7, v12, v13, v14
 v_max3_u32 v7, v7, v15, v16
 v_max3_u32 v7, v7, v17, v18
 v_max3_u32 v7, v7, v19, v20
 v_max3_u32 v7, v7, v21, v22
 v_max3_u32 v7, v7, v23, v24
 v_max3_u32 v7, v7, v25, v26
 v_max3_u32 v7, v7, v27, v28
 v_max3_u32 v7, v7, v29, v30
 v_max3_u32 v7, v7, v31, v32
 v_max3_u32 v7, v7, v33, v34
 v_max3_u32 v7, v7, v35, v36
 v_max3_u32 v7, v7, v37, v38
 v_max_u32 v7, v7, v39
 v_cmp_eq_u32 vcc, -1, v7
 s_barrier
 s_cbranch_vccz WS_d
 s_sub_u32 s67, s67, 1
 s_cmp_gt_i32 s67, 0
 s_cbranch_scc1 WS_l
WS_d:
 s_add_u32 s51, s51, 14336
 s_add_u32 s77, s76, 4096
 v_smfmac_f32_16x16x64_bf16 v[40:43], v[12:15], a[0:7], v2
 v_smfmac_f32_16x16x64_bf16 v[40:43], v[16:19], a[8:15], v2
 v_smfmac_f32_16x16x64_bf16 v[40:43], v[20:23], a[16:23], v2
 v_smfmac_f32_16x16x64_bf16 v[40:43], v[24:27], a[24:31], v2
 v_smfmac_f32_16x16x64_bf16 v[40:43], v[28:31], a[32:39], v2
 v_smfmac_f32_16x16x64_bf16 v[40:43], v[32:35], a[40:47], v2
 v_smfmac_f32_16x16x64_bf16 v[40:43], v[36:39], a[48:55], v2
 v_smfmac_f32_16x16x64_bf16 v[44:47], v[12:15], a[56:63], v2
 v_smfmac_f32_16x16x64_bf16 v[44:47], v[16:19], a[64:71], v2
 v_add_f32 v40, v40, v42
 v_add_f32 v41, v41, v43
 v_smfmac_f32_16x16x64_bf16 v[44:47], v[20:23], a[72:79], v2
 v_cvt_pk_bf16_f32 v56, v40, v41
 v_min_u32 v56, -2, v56
 v_smfmac_f32_16x16x64_bf16 v[44:47], v[24:27], a[80:87], v2
 v_mov_b32 v40, 0
 v_mov_b32 v41, 0
 v_smfmac_f32_16x16x64_bf16 v[44:47], v[28:31], a[88:95], v2
 v_mov_b32 v42, 0
 v_mov_b32 v43, 0
 v_smfmac_f32_16x16x64_bf16 v[44:47], v[32:35], a[96:103], v2
 v_smfmac_f32_16x16x64_bf16 v[44:47], v[36:39], a[104:111], v2
 v_smfmac_f32_16x16x64_bf16 v[48:51], v[12:15], a[112:119], v2
 v_smfmac_f32_16x16x64_bf16 v[48:51], v[16:19], a[120:127], v2
 v_add_f32 v44, v44, v46
 v_add_f32 v45, v45, v47
 v_smfmac_f32_16x16x64_bf16 v[48:51], v[20:23], a[128:135], v2
 v_cvt_pk_bf16_f32 v57, v44, v45
 v_min_u32 v57, -2, v57
 v_smfmac_f32_16x16x64_bf16 v[48:51], v[24:27], a[136:143], v2
 v_mov_b32 v44, 0
 v_mov_b32 v45, 0
 v_smfmac_f32_16x16x64_bf16 v[48:51], v[28:31], a[144:151], v2
 v_mov_b32 v46, 0
 v_mov_b32 v47, 0
 v_smfmac_f32_16x16x64_bf16 v[48:51], v[32:35], a[152:159], v2
 v_smfmac_f32_16x16x64_bf16 v[48:51], v[36:39], a[160:167], v2
 v_smfmac_f32_16x16x64_bf16 v[52:55], v[12:15], a[168:175], v2
 v_smfmac_f32_16x16x64_bf16 v[52:55], v[16:19], a[176:183], v2
 v_add_f32 v48, v48, v50
 v_add_f32 v49, v49, v51
 v_smfmac_f32_16x16x64_bf16 v[52:55], v[20:23], a[184:191], v2
 v_cvt_pk_bf16_f32 v58, v48, v49
 v_min_u32 v58, -2, v58
 v_smfmac_f32_16x16x64_bf16 v[52:55], v[24:27], a[192:199], v2
 v_mov_b32 v48, 0
 v_mov_b32 v49, 0
 v_smfmac_f32_16x16x64_bf16 v[52:55], v[28:31], a[200:207], v2
 v_mov_b32 v50, 0
 v_mov_b32 v51, 0
 v_smfmac_f32_16x16x64_bf16 v[52:55], v[32:35], a[208:215], v2
 v_smfmac_f32_16x16x64_bf16 v[52:55], v[36:39], a[216:223], v2
 v_smfmac_f32_16x16x64_bf16 v[40:43], v[12:15], a[224:231], v2
 v_smfmac_f32_16x16x64_bf16 v[40:43], v[16:19], a[232:239], v2
 v_add_f32 v52, v52, v54
 v_add_f32 v53, v53, v55
 v_smfmac_f32_16x16x64_bf16 v[40:43], v[20:23], a[240:247], v2
 v_cvt_pk_bf16_f32 v59, v52, v53
 v_min_u32 v59, -2, v59
 v_smfmac_f32_16x16x64_bf16 v[40:43], v[24:27], a[248:255], v2
 v_mov_b32 v52, 0
 v_mov_b32 v53, 0
 v_smfmac_f32_16x16x64_bf16 v[40:43], v[28:31], v[64:71], v2
 v_mov_b32 v54, 0
 v_mov_b32 v55, 0
 v_smfmac_f32_16x16x64_bf16 v[40:43], v[32:35], v[72:79], v2
 v_smfmac_f32_16x16x64_bf16 v[40:43], v[36:39], v[80:87], v2
 v_smfmac_f32_16x16x64_bf16 v[44:47], v[12:15], v[88:95], v2
 v_smfmac_f32_16x16x64_bf16 v[44:47], v[16:19], v[96:103], v2
 v_add_f32 v40, v40, v42
 v_add_f32 v41, v41, v43
 v_smfmac_f32_16x16x64_bf16 v[44:47], v[20:23], v[104:111], v2
 v_cvt_pk_bf16_f32 v60, v40, v41
 v_min_u32 v60, -2, v60
 v_smfmac_f32_16x16x64_bf16 v[44:47], v[24:27], v[112:119], v2
 s_waitcnt vmcnt(0)
 s_barrier
 s_cmp_lg_u32 s40, 0
 s_cbranch_scc1 WS_ns
 s_atomic_add s33, s[16:17], s43
WS_ns:
 v_smfmac_f32_16x16x64_bf16 v[44:47], v[28:31], v[120:127], v2
 v_smfmac_f32_16x16x64_bf16 v[44:47], v[32:35], v[128:135], v2
 v_smfmac_f32_16x16x64_bf16 v[44:47], v[36:39], v[136:143], v2
 v_smfmac_f32_16x16x64_bf16 v[48:51], v[12:15], v[144:151], v2
 v_smfmac_f32_16x16x64_bf16 v[48:51], v[16:19], v[152:159], v2
 v_add_f32 v44, v44, v46
 v_add_f32 v45, v45, v47
 v_smfmac_f32_16x16x64_bf16 v[48:51], v[20:23], v[160:167], v2
 v_cvt_pk_bf16_f32 v61, v44, v45
 v_min_u32 v61, -2, v61
 v_smfmac_f32_16x16x64_bf16 v[48:51], v[24:27], v[168:175], v2
 v_smfmac_f32_16x16x64_bf16 v[48:51], v[28:31], v[176:183], v2
 v_smfmac_f32_16x16x64_bf16 v[48:51], v[32:35], v[184:191], v2
 v_smfmac_f32_16x16x64_bf16 v[48:51], v[36:39], v[192:199], v2
 v_smfmac_f32_16x16x64_bf16 v[52:55], v[12:15], v[200:207], v2
 v_smfmac_f32_16x16x64_bf16 v[52:55], v[16:19], v[208:215], v2
 v_add_f32 v48, v48, v50
 v_add_f32 v49, v49, v51
 v_smfmac_f32_16x16x64_bf16 v[52:55], v[20:23], v[216:223], v2
 v_cvt_pk_bf16_f32 v62, v48, v49
 v_min_u32 v62, -2, v62
 v_smfmac_f32_16x16x64_bf16 v[52:55], v[24:27], v[224:231], v2
 v_smfmac_f32_16x16x64_bf16 v[52:55], v[28:31], v[232:239], v2
 v_smfmac_f32_16x16x64_bf16 v[52:55], v[32:35], v[240:247], v2
 v_smfmac_f32_16x16x64_bf16 v[52:55], v[36:39], v[248:255], v2
 s_nop 7
 v_add_f32 v52, v52, v54
 v_add_f32 v53, v53, v55
 v_cvt_pk_bf16_f32 v63, v52, v53
 v_min_u32 v63, -2, v63
 s_waitcnt vmcnt(0)
 v_readfirstlane_b32 s45, v9
 s_nop 0
 s_cmp_eq_u32 s45, 0
 s_cbranch_scc1 WS_np
 buffer_load_dwordx4 v1, s[16:19], s51 offen sc1 lds
 buffer_load_dwordx4 v1, s[16:19], s51 offen offset:1024 sc1 lds
WS_np:
 buffer_store_dwordx4 v[56:59], v1, s[16:19], s76 offen sc1
 buffer_store_dwordx4 v[60:63], v1, s[16:19], s77 offen sc1
 s_add_u32 s76, s76, 229376
 s_add_u32 s43, s43, 2048
 s_add_u32 s41, s41, 2
 s_cmp_lt_u32 s41, 63
 s_cbranch_scc1 WS_loop
 s_endpgm
H_t0:
 s_mul_i32 s42, s36, 13108
 s_lshr_b32 s42, s42, 16
 s_mul_i32 s54, s42, 5
 s_sub_u32 s41, s36, s54
 v_min_u32 v8, 13, v0
 v_lshlrev_b32 v8, 2, v8
 s_lshl_b32 s69, s42, 6
 s_add_u32 s69, s69, 2089984
Hfa_w:
 buffer_load_dword v10, v8, s[16:19], s69 offen sc1
 s_waitcnt vmcnt(0)
 v_and_b32 v11, -16, v10
 v_cmp_ne_u32 vcc, s34, v11
 s_cbranch_vccz Hfa_d
 s_sleep 1
 s_max_u32 s68, s68, 1
 s_sub_u32 s68, s68, 1
 s_cmp_lg_u32 s68, 0
 s_cbranch_scc1 Hfa_w
Hfa_d:
H_t:
 s_lshl_b32 s43, s41, 2
 s_add_u32 s43, s43, s40
 s_mul_i32 s44, s42, 401408
 s_mul_i32 s45, s40, 7168
 s_add_u32 s44, s44, s45
 s_add_u32 s44, s44, 2097152
 s_barrier
 s_add_u32 m0, s45, 0
 s_add_u32 s46, s44, 4096
 buffer_load_dwordx4 v1, s[16:19], s44 offen offset:0 sc1 lds
 buffer_load_dwordx4 v1, s[16:19], s44 offen offset:1024 sc1 lds
 buffer_load_dwordx4 v1, s[16:19], s44 offen offset:2048 sc1 lds
 buffer_load_dwordx4 v1, s[16:19], s44 offen offset:3072 sc1 lds
 s_add_u32 m0, s45, 4096
 s_add_u32 s44, s44, 28672
 buffer_load_dwordx4 v1, s[16:19], s46 offen offset:0 sc1 lds
 buffer_load_dwordx4 v1, s[16:19], s46 offen offset:1024 sc1 lds
 buffer_load_dwordx4 v1, s[16:19], s46 offen offset:2048 sc1 lds
 s_mul_i32 s47, s43, 28672
 s_add_u32 s47, s47, 15728640
 buffer_load_dwordx4 a[0:3], v1, s[16:19], s47 offen offset:0 sc1
 buffer_load_dwordx4 a[4:7], v1, s[16:19], s47 offen offset:1024 sc1
 buffer_load_dwordx4 a[8:11], v1, s[16:19], s47 offen offset:2048 sc1
 buffer_load_dwordx4 a[12:15], v1, s[16:19], s47 offen offset:3072 sc1
 s_add_u32 s47, s47, 4096
 buffer_load_dwordx4 a[16:19], v1, s[16:19], s47 offen offset:0 sc1
 buffer_load_dwordx4 a[20:23], v1, s[16:19], s47 offen offset:1024 sc1
 buffer_load_dwordx4 a[24:27], v1, s[16:19], s47 offen offset:2048 sc1
 buffer_load_dwordx4 a[28:31], v1, s[16:19], s47 offen offset:3072 sc1
 s_add_u32 s47, s47, 4096
 buffer_load_dwordx4 a[32:35], v1, s[16:19], s47 offen offset:0 sc1
 buffer_load_dwordx4 a[36:39], v1, s[16:19], s47 offen offset:1024 sc1
 buffer_load_dwordx4 a[40:43], v1, s[16:19], s47 offen offset:2048 sc1
 buffer_load_dwordx4 a[44:47], v1, s[16:19], s47 offen offset:3072 sc1
 s_add_u32 s47, s47, 4096
 buffer_load_dwordx4 a[48:51], v1, s[16:19], s47 offen offset:0 sc1
 buffer_load_dwordx4 a[52:55], v1, s[16:19], s47 offen offset:1024 sc1
 buffer_load_dwordx4 a[56:59], v1, s[16:19], s47 offen offset:2048 sc1
 buffer_load_dwordx4 a[60:63], v1, s[16:19], s47 offen offset:3072 sc1
 s_add_u32 s47, s47, 4096
 buffer_load_dwordx4 a[64:67], v1, s[16:19], s47 offen offset:0 sc1
 buffer_load_dwordx4 a[68:71], v1, s[16:19], s47 offen offset:1024 sc1
 buffer_load_dwordx4 a[72:75], v1, s[16:19], s47 offen offset:2048 sc1
 buffer_load_dwordx4 a[76:79], v1, s[16:19], s47 offen offset:3072 sc1
 s_add_u32 s47, s47, 4096
 buffer_load_dwordx4 a[80:83], v1, s[16:19], s47 offen offset:0 sc1
 buffer_load_dwordx4 a[84:87], v1, s[16:19], s47 offen offset:1024 sc1
 buffer_load_dwordx4 a[88:91], v1, s[16:19], s47 offen offset:2048 sc1
 buffer_load_dwordx4 a[92:95], v1, s[16:19], s47 offen offset:3072 sc1
 s_add_u32 s47, s47, 4096
 buffer_load_dwordx4 a[96:99], v1, s[16:19], s47 offen offset:0 sc1
 buffer_load_dwordx4 a[100:103], v1, s[16:19], s47 offen offset:1024 sc1
 buffer_load_dwordx4 a[104:107], v1, s[16:19], s47 offen offset:2048 sc1
 buffer_load_dwordx4 a[108:111], v1, s[16:19], s47 offen offset:3072 sc1
 s_add_u32 m0, s45, 28672
 s_add_u32 s46, s44, 4096
 buffer_load_dwordx4 v1, s[16:19], s44 offen offset:0 sc1 lds
 buffer_load_dwordx4 v1, s[16:19], s44 offen offset:1024 sc1 lds
 buffer_load_dwordx4 v1, s[16:19], s44 offen offset:2048 sc1 lds
 buffer_load_dwordx4 v1, s[16:19], s44 offen offset:3072 sc1 lds
 s_add_u32 m0, s45, 32768
 s_add_u32 s44, s44, 28672
 buffer_load_dwordx4 v1, s[16:19], s46 offen offset:0 sc1 lds
 buffer_load_dwordx4 v1, s[16:19], s46 offen offset:1024 sc1 lds
 buffer_load_dwordx4 v1, s[16:19], s46 offen offset:2048 sc1 lds
 s_add_u32 m0, s45, 57344
 s_add_u32 s46, s44, 4096
 buffer_load_dwordx4 v1, s[16:19], s44 offen offset:0 sc1 lds
 buffer_load_dwordx4 v1, s[16:19], s44 offen offset:1024 sc1 lds
 buffer_load_dwordx4 v1, s[16:19], s44 offen offset:2048 sc1 lds
 buffer_load_dwordx4 v1, s[16:19], s44 offen offset:3072 sc1 lds
 s_add_u32 m0, s45, 61440
 s_add_u32 s44, s44, 28672
 buffer_load_dwordx4 v1, s[16:19], s46 offen offset:0 sc1 lds
 buffer_load_dwordx4 v1, s[16:19], s46 offen offset:1024 sc1 lds
 buffer_load_dwordx4 v1, s[16:19], s46 offen offset:2048 sc1 lds
 s_waitcnt vmcnt(14)
 s_barrier
 ds_read_b128 a[112:115], v1 offset:0
 ds_read_b128 a[116:119], v1 offset:14336
 ds_read_b128 a[120:123], v1 offset:1024
 ds_read_b128 a[124:127], v1 offset:15360
 ds_read_b128 a[128:131], v1 offset:2048
 ds_read_b128 a[132:135], v1 offset:16384
 ds_read_b128 a[136:139], v1 offset:3072
 ds_read_b128 a[140:143], v1 offset:17408
 s_waitcnt lgkmcnt(6)
 v_mfma_f32_16x16x32_bf16 v[64:67], a[112:115], a[0:3], 0
 v_mfma_f32_16x16x32_bf16 v[68:71], a[112:115], a[56:59], 0
 v_mfma_f32_16x16x32_bf16 v[72:75], a[116:119], a[0:3], 0
 v_mfma_f32_16x16x32_bf16 v[76:79], a[116:119], a[56:59], 0
 ds_read_b128 a[112:115], v1 offset:4096
 ds_read_b128 a[116:119], v1 offset:18432
 s_waitcnt lgkmcnt(6)
 v_mfma_f32_16x16x32_bf16 v[64:67], a[120:123], a[4:7], v[64:67]
 v_mfma_f32_16x16x32_bf16 v[68:71], a[120:123], a[60:63], v[68:71]
 v_mfma_f32_16x16x32_bf16 v[72:75], a[124:127], a[4:7], v[72:75]
 v_mfma_f32_16x16x32_bf16 v[76:79], a[124:127], a[60:63], v[76:79]
 ds_read_b128 a[120:123], v1 offset:5120
 ds_read_b128 a[124:127], v1 offset:19456
 s_waitcnt lgkmcnt(6)
 v_mfma_f32_16x16x32_bf16 v[64:67], a[128:131], a[8:11], v[64:67]
 v_mfma_f32_16x16x32_bf16 v[68:71], a[128:131], a[64:67], v[68:71]
 v_mfma_f32_16x16x32_bf16 v[72:75], a[132:135], a[8:11], v[72:75]
 v_mfma_f32_16x16x32_bf16 v[76:79], a[132:135], a[64:67], v[76:79]
 ds_read_b128 a[128:131], v1 offset:6144
 ds_read_b128 a[132:135], v1 offset:20480
 s_waitcnt lgkmcnt(6)
 v_mfma_f32_16x16x32_bf16 v[64:67], a[136:139], a[12:15], v[64:67]
 v_mfma_f32_16x16x32_bf16 v[68:71], a[136:139], a[68:71], v[68:71]
 v_mfma_f32_16x16x32_bf16 v[72:75], a[140:143], a[12:15], v[72:75]
 v_mfma_f32_16x16x32_bf16 v[76:79], a[140:143], a[68:71], v[76:79]
 ds_read_b128 a[136:139], v1 offset:7168
 ds_read_b128 a[140:143], v1 offset:21504
 s_waitcnt lgkmcnt(6)
 v_mfma_f32_16x16x32_bf16 v[64:67], a[112:115], a[16:19], v[64:67]
 v_mfma_f32_16x16x32_bf16 v[68:71], a[112:115], a[72:75], v[68:71]
 v_mfma_f32_16x16x32_bf16 v[72:75], a[116:119], a[16:19], v[72:75]
 v_mfma_f32_16x16x32_bf16 v[76:79], a[116:119], a[72:75], v[76:79]
 s_waitcnt vmcnt(7)
 s_barrier
 ds_read_b128 a[112:115], v1 offset:8192
 ds_read_b128 a[116:119], v1 offset:22528
 s_waitcnt lgkmcnt(6)
 v_mfma_f32_16x16x32_bf16 v[64:67], a[120:123], a[20:23], v[64:67]
 s_add_u32 m0, s45, 86016
 s_add_u32 s46, s44, 4096
 v_mfma_f32_16x16x32_bf16 v[68:71], a[120:123], a[76:79], v[68:71]
 v_mfma_f32_16x16x32_bf16 v[72:75], a[124:127], a[20:23], v[72:75]
 buffer_load_dwordx4 v1, s[16:19], s44 offen offset:0 sc1 lds
 v_mfma_f32_16x16x32_bf16 v[76:79], a[124:127], a[76:79], v[76:79]
 ds_read_b128 a[120:123], v1 offset:9216
 ds_read_b128 a[124:127], v1 offset:23552
 s_waitcnt lgkmcnt(6)
 v_mfma_f32_16x16x32_bf16 v[64:67], a[128:131], a[24:27], v[64:67]
 v_mfma_f32_16x16x32_bf16 v[68:71], a[128:131], a[80:83], v[68:71]
 v_mfma_f32_16x16x32_bf16 v[72:75], a[132:135], a[24:27], v[72:75]
 buffer_load_dwordx4 v1, s[16:19], s44 offen offset:1024 sc1 lds
 v_mfma_f32_16x16x32_bf16 v[76:79], a[132:135], a[80:83], v[76:79]
 ds_read_b128 a[128:131], v1 offset:10240
 ds_read_b128 a[132:135], v1 offset:24576
 s_waitcnt lgkmcnt(6)
 v_mfma_f32_16x16x32_bf16 v[64:67], a[136:139], a[28:31], v[64:67]
 v_mfma_f32_16x16x32_bf16 v[68:71], a[136:139], a[84:87], v[68:71]
 v_mfma_f32_16x16x32_bf16 v[72:75], a[140:143], a[28:31], v[72:75]
 buffer_load_dwordx4 v1, s[16:19], s44 offen offset:2048 sc1 lds
 v_mfma_f32_16x16x32_bf16 v[76:79], a[140:143], a[84:87], v[76:79]
 ds_read_b128 a[136:139], v1 offset:11264
 ds_read_b128 a[140:143], v1 offset:25600
 s_waitcnt lgkmcnt(6)
 v_mfma_f32_16x16x32_bf16 v[64:67], a[112:115], a[32:35], v[64:67]
 v_mfma_f32_16x16x32_bf16 v[68:71], a[112:115], a[88:91], v[68:71]
 v_mfma_f32_16x16x32_bf16 v[72:75], a[116:119], a[32:35], v[72:75]
 buffer_load_dwordx4 v1, s[16:19], s44 offen offset:3072 sc1 lds
 v_mfma_f32_16x16x32_bf16 v[76:79], a[116:119], a[88:91], v[76:79]
 ds_read_b128 a[112:115], v1 offset:12288
 ds_read_b128 a[116:119], v1 offset:26624
 s_waitcnt lgkmcnt(6)
 v_mfma_f32_16x16x32_bf16 v[64:67], a[120:123], a[36:39], v[64:67]
 s_add_u32 m0, s45, 90112
 s_add_u32 s44, s44, 28672
 v_mfma_f32_16x16x32_bf16 v[68:71], a[120:123], a[92:95], v[68:71]
 v_mfma_f32_16x16x32_bf16 v[72:75], a[124:127], a[36:39], v[72:75]
 buffer_load_dwordx4 v1, s[16:19], s46 offen offset:0 sc1 lds
 v_mfma_f32_16x16x32_bf16 v[76:79], a[124:127], a[92:95], v[76:79]
 ds_read_b128 a[120:123], v1 offset:13312
 ds_read_b128 a[124:127], v1 offset:27648
 s_waitcnt lgkmcnt(6)
 v_mfma_f32_16x16x32_bf16 v[64:67], a[128:131], a[40:43], v[64:67]
 v_mfma_f32_16x16x32_bf16 v[68:71], a[128:131], a[96:99], v[68:71]
 v_mfma_f32_16x16x32_bf16 v[72:75], a[132:135], a[40:43], v[72:75]
 buffer_load_dwordx4 v1, s[16:19], s46 offen offset:1024 sc1 lds
 v_mfma_f32_16x16x32_bf16 v[76:79], a[132:135], a[96:99], v[76:79]
 ds_read_b128 a[128:131], v1 offset:28672
 ds_read_b128 a[132:135], v1 offset:43008
 s_waitcnt lgkmcnt(6)
 v_mfma_f32_16x16x32_bf16 v[64:67], a[136:139], a[44:47], v[64:67]
 v_mfma_f32_16x16x32_bf16 v[68:71], a[136:139], a[100:103], v[68:71]
 v_mfma_f32_16x16x32_bf16 v[72:75], a[140:143], a[44:47], v[72:75]
 buffer_load_dwordx4 v1, s[16:19], s46 offen offset:2048 sc1 lds
 v_mfma_f32_16x16x32_bf16 v[76:79], a[140:143], a[100:103], v[76:79]
 ds_read_b128 a[136:139], v1 offset:29696
 ds_read_b128 a[140:143], v1 offset:44032
 s_waitcnt lgkmcnt(6)
 v_mfma_f32_16x16x32_bf16 v[64:67], a[112:115], a[48:51], v[64:67]
 v_mfma_f32_16x16x32_bf16 v[68:71], a[112:115], a[104:107], v[68:71]
 v_mfma_f32_16x16x32_bf16 v[72:75], a[116:119], a[48:51], v[72:75]
 v_mfma_f32_16x16x32_bf16 v[76:79], a[116:119], a[104:107], v[76:79]
 ds_read_b128 a[112:115], v1 offset:30720
 ds_read_b128 a[116:119], v1 offset:45056
 s_waitcnt lgkmcnt(6)
 v_mfma_f32_16x16x32_bf16 v[64:67], a[120:123], a[52:55], v[64:67]
 v_mfma_f32_16x16x32_bf16 v[68:71], a[120:123], a[108:111], v[68:71]
 v_mfma_f32_16x16x32_bf16 v[72:75], a[124:127], a[52:55], v[72:75]
 v_mfma_f32_16x16x32_bf16 v[76:79], a[124:127], a[108:111], v[76:79]
 ds_read_b128 a[120:123], v1 offset:31744
 ds_read_b128 a[124:127], v1 offset:46080
 s_waitcnt lgkmcnt(6)
 v_mfma_f32_16x16x32_bf16 v[80:83], a[128:131], a[0:3], 0
 v_mfma_f32_16x16x32_bf16 v[84:87], a[128:131], a[56:59], 0
 v_mfma_f32_16x16x32_bf16 v[88:91], a[132:135], a[0:3], 0
 v_mfma_f32_16x16x32_bf16 v[92:95], a[132:135], a[56:59], 0
 ds_read_b128 a[128:131], v1 offset:32768
 ds_read_b128 a[132:135], v1 offset:47104
 s_waitcnt lgkmcnt(6)
 v_mfma_f32_16x16x32_bf16 v[80:83], a[136:139], a[4:7], v[80:83]
 v_mfma_f32_16x16x32_bf16 v[84:87], a[136:139], a[60:63], v[84:87]
 v_mfma_f32_16x16x32_bf16 v[88:91], a[140:143], a[4:7], v[88:91]
 v_mfma_f32_16x16x32_bf16 v[92:95], a[140:143], a[60:63], v[92:95]
 ds_read_b128 a[136:139], v1 offset:33792
 ds_read_b128 a[140:143], v1 offset:48128
 s_waitcnt lgkmcnt(6)
 v_mfma_f32_16x16x32_bf16 v[80:83], a[112:115], a[8:11], v[80:83]
 v_cvt_pk_bf16_f32 v128, v64, v65
 v_mfma_f32_16x16x32_bf16 v[84:87], a[112:115], a[64:67], v[84:87]
 v_cvt_pk_bf16_f32 v130, v66, v67
 v_mfma_f32_16x16x32_bf16 v[88:91], a[116:119], a[8:11], v[88:91]
 v_cvt_pk_bf16_f32 v129, v72, v73
 v_mfma_f32_16x16x32_bf16 v[92:95], a[116:119], a[64:67], v[92:95]
 v_cvt_pk_bf16_f32 v131, v74, v75
 ds_read_b128 a[112:115], v1 offset:34816
 ds_read_b128 a[116:119], v1 offset:49152
 s_waitcnt lgkmcnt(6)
 v_mfma_f32_16x16x32_bf16 v[80:83], a[120:123], a[12:15], v[80:83]
 v_cvt_pk_bf16_f32 v184, v68, v69
 v_mfma_f32_16x16x32_bf16 v[84:87], a[120:123], a[68:71], v[84:87]
 v_cvt_pk_bf16_f32 v186, v70, v71
 v_mfma_f32_16x16x32_bf16 v[88:91], a[124:127], a[12:15], v[88:91]
 v_cvt_pk_bf16_f32 v185, v76, v77
 v_mfma_f32_16x16x32_bf16 v[92:95], a[124:127], a[68:71], v[92:95]
 v_cvt_pk_bf16_f32 v187, v78, v79
 ds_read_b128 a[120:123], v1 offset:35840
 ds_read_b128 a[124:127], v1 offset:50176
 s_waitcnt lgkmcnt(6)
 v_mfma_f32_16x16x32_bf16 v[80:83], a[128:131], a[16:19], v[80:83]
 v_mfma_f32_16x16x32_bf16 v[96:99], a[0:3], v[128:131], 0
 v_mfma_f32_16x16x32_bf16 v[84:87], a[128:131], a[72:75], v[84:87]
 v_mfma_f32_16x16x32_bf16 v[100:103], a[0:3], v[184:187], 0
 v_mfma_f32_16x16x32_bf16 v[88:91], a[132:135], a[16:19], v[88:91]
 v_mfma_f32_16x16x32_bf16 v[104:107], a[56:59], v[184:187], 0
 v_mfma_f32_16x16x32_bf16 v[92:95], a[132:135], a[72:75], v[92:95]
 s_waitcnt vmcnt(7)
 s_barrier
 ds_read_b128 a[128:131], v1 offset:36864
 ds_read_b128 a[132:135], v1 offset:51200
 s_waitcnt lgkmcnt(6)
 v_mfma_f32_16x16x32_bf16 v[80:83], a[136:139], a[20:23], v[80:83]
 s_add_u32 m0, s45, 0
 s_add_u32 s46, s44, 4096
 v_mfma_f32_16x16x32_bf16 v[84:87], a[136:139], a[76:79], v[84:87]
 v_mfma_f32_16x16x32_bf16 v[88:91], a[140:143], a[20:23], v[88:91]
 buffer_load_dwordx4 v1, s[16:19], s44 offen offset:0 sc1 lds
 v_mfma_f32_16x16x32_bf16 v[92:95], a[140:143], a[76:79], v[92:95]
 ds_read_b128 a[136:139], v1 offset:37888
 ds_read_b128 a[140:143], v1 offset:52224
 s_waitcnt lgkmcnt(6)
 v_mfma_f32_16x16x32_bf16 v[80:83], a[112:115], a[24:27], v[80:83]
 v_mfma_f32_16x16x32_bf16 v[84:87], a[112:115], a[80:83], v[84:87]
 v_mfma_f32_16x16x32_bf16 v[88:91], a[116:119], a[24:27], v[88:91]
 buffer_load_dwordx4 v1, s[16:19], s44 offen offset:1024 sc1 lds
 v_mfma_f32_16x16x32_bf16 v[92:95], a[116:119], a[80:83], v[92:95]
 ds_read_b128 a[112:115], v1 offset:38912
 ds_read_b128 a[116:119], v1 offset:53248
 s_waitcnt lgkmcnt(6)
 v_mfma_f32_16x16x32_bf16 v[80:83], a[120:123], a[28:31], v[80:83]
 v_mfma_f32_16x16x32_bf16 v[84:87], a[120:123], a[84:87], v[84:87]
 v_mfma_f32_16x16x32_bf16 v[88:91], a[124:127], a[28:31], v[88:91]
 buffer_load_dwordx4 v1, s[16:19], s44 offen offset:2048 sc1 lds
 v_mfma_f32_16x16x32_bf16 v[92:95], a[124:127], a[84:87], v[92:95]
 ds_read_b128 a[120:123], v1 offset:39936
 ds_read_b128 a[124:127], v1 offset:54272
 s_waitcnt lgkmcnt(6)
 v_mfma_f32_16x16x32_bf16 v[80:83], a[128:131], a[32:35], v[80:83]
 v_mfma_f32_16x16x32_bf16 v[84:87], a[128:131], a[88:91], v[84:87]
 v_mfma_f32_16x16x32_bf16 v[88:91], a[132:135], a[32:35], v[88:91]
 buffer_load_dwordx4 v1, s[16:19], s44 offen offset:3072 sc1 lds
 v_mfma_f32_16x16x32_bf16 v[92:95], a[132:135], a[88:91], v[92:95]
 ds_read_b128 a[128:131], v1 offset:40960
 ds_read_b128 a[132:135], v1 offset:55296
 s_waitcnt lgkmcnt(6)
 v_mfma_f32_16x16x32_bf16 v[80:83], a[136:139], a[36:39], v[80:83]
 s_add_u32 m0, s45, 4096
 s_add_u32 s44, s44, 28672
 v_mfma_f32_16x16x32_bf16 v[84:87], a[136:139], a[92:95], v[84:87]
 v_mfma_f32_16x16x32_bf16 v[88:91], a[140:143], a[36:39], v[88:91]
 buffer_load_dwordx4 v1, s[16:19], s46 offen offset:0 sc1 lds
 v_mfma_f32_16x16x32_bf16 v[92:95], a[140:143], a[92:95], v[92:95]
 ds_read_b128 a[136:139], v1 offset:41984
 ds_read_b128 a[140:143], v1 offset:56320
 s_waitcnt lgkmcnt(6)
 v_mfma_f32_16x16x32_bf16 v[80:83], a[112:115], a[40:43], v[80:83]
 v_mfma_f32_16x16x32_bf16 v[84:87], a[112:115], a[96:99], v[84:87]
 v_mfma_f32_16x16x32_bf16 v[88:91], a[116:119], a[40:43], v[88:91]
 buffer_load_dwordx4 v1, s[16:19], s46 offen offset:1024 sc1 lds
 v_mfma_f32_16x16x32_bf16 v[92:95], a[116:119], a[96:99], v[92:95]
 ds_read_b128 a[112:115], v2 offset:0
 ds_read_b128 a[116:119], v2 offset:14336
 s_waitcnt lgkmcnt(6)
 v_mfma_f32_16x16x32_bf16 v[80:83], a[120:123], a[44:47], v[80:83]
 v_mfma_f32_16x16x32_bf16 v[84:87], a[120:123], a[100:103], v[84:87]
 v_mfma_f32_16x16x32_bf16 v[88:91], a[124:127], a[44:47], v[88:91]
 buffer_load_dwordx4 v1, s[16:19], s46 offen offset:2048 sc1 lds
 v_mfma_f32_16x16x32_bf16 v[92:95], a[124:127], a[100:103], v[92:95]
 ds_read_b128 a[120:123], v2 offset:1024
 ds_read_b128 a[124:127], v2 offset:15360
 s_waitcnt lgkmcnt(6)
 v_mfma_f32_16x16x32_bf16 v[80:83], a[128:131], a[48:51], v[80:83]
 v_mfma_f32_16x16x32_bf16 v[84:87], a[128:131], a[104:107], v[84:87]
 v_mfma_f32_16x16x32_bf16 v[88:91], a[132:135], a[48:51], v[88:91]
 v_mfma_f32_16x16x32_bf16 v[92:95], a[132:135], a[104:107], v[92:95]
 ds_read_b128 a[128:131], v2 offset:2048
 ds_read_b128 a[132:135], v2 offset:16384
 s_waitcnt lgkmcnt(6)
 v_mfma_f32_16x16x32_bf16 v[80:83], a[136:139], a[52:55], v[80:83]
 v_mfma_f32_16x16x32_bf16 v[84:87], a[136:139], a[108:111], v[84:87]
 v_mfma_f32_16x16x32_bf16 v[88:91], a[140:143], a[52:55], v[88:91]
 v_mfma_f32_16x16x32_bf16 v[92:95], a[140:143], a[108:111], v[92:95]
 ds_read_b128 a[136:139], v2 offset:3072
 ds_read_b128 a[140:143], v2 offset:17408
 s_waitcnt lgkmcnt(6)
 v_mfma_f32_16x16x32_bf16 v[64:67], a[112:115], a[0:3], 0
 v_mfma_f32_16x16x32_bf16 v[68:71], a[112:115], a[56:59], 0
 v_mfma_f32_16x16x32_bf16 v[72:75], a[116:119], a[0:3], 0
 v_mfma_f32_16x16x32_bf16 v[76:79], a[116:119], a[56:59], 0
 ds_read_b128 a[112:115], v2 offset:4096
 ds_read_b128 a[116:119], v2 offset:18432
 s_waitcnt lgkmcnt(6)
 v_mfma_f32_16x16x32_bf16 v[64:67], a[120:123], a[4:7], v[64:67]
 v_mfma_f32_16x16x32_bf16 v[68:71], a[120:123], a[60:63], v[68:71]
 v_mfma_f32_16x16x32_bf16 v[72:75], a[124:127], a[4:7], v[72:75]
 v_mfma_f32_16x16x32_bf16 v[76:79], a[124:127], a[60:63], v[76:79]
 ds_read_b128 a[120:123], v2 offset:5120
 ds_read_b128 a[124:127], v2 offset:19456
 s_waitcnt lgkmcnt(6)
 v_mfma_f32_16x16x32_bf16 v[64:67], a[128:131], a[8:11], v[64:67]
 v_cvt_pk_bf16_f32 v132, v80, v81
 v_mfma_f32_16x16x32_bf16 v[68:71], a[128:131], a[64:67], v[68:71]
 v_cvt_pk_bf16_f32 v134, v82, v83
 v_mfma_f32_16x16x32_bf16 v[72:75], a[132:135], a[8:11], v[72:75]
 v_cvt_pk_bf16_f32 v133, v88, v89
 v_mfma_f32_16x16x32_bf16 v[76:79], a[132:135], a[64:67], v[76:79]
 v_cvt_pk_bf16_f32 v135, v90, v91
 ds_read_b128 a[128:131], v2 offset:6144
 ds_read_b128 a[132:135], v2 offset:20480
 s_waitcnt lgkmcnt(6)
 v_mfma_f32_16x16x32_bf16 v[64:67], a[136:139], a[12:15], v[64:67]
 v_cvt_pk_bf16_f32 v188, v84, v85
 v_mfma_f32_16x16x32_bf16 v[68:71], a[136:139], a[68:71], v[68:71]
 v_cvt_pk_bf16_f32 v190, v86, v87
 v_mfma_f32_16x16x32_bf16 v[72:75], a[140:143], a[12:15], v[72:75]
 v_cvt_pk_bf16_f32 v189, v92, v93
 v_mfma_f32_16x16x32_bf16 v[76:79], a[140:143], a[68:71], v[76:79]
 v_cvt_pk_bf16_f32 v191, v94, v95
 ds_read_b128 a[136:139], v2 offset:7168
 ds_read_b128 a[140:143], v2 offset:21504
 s_waitcnt lgkmcnt(6)
 v_mfma_f32_16x16x32_bf16 v[64:67], a[112:115], a[16:19], v[64:67]
 v_mfma_f32_16x16x32_bf16 v[96:99], a[4:7], v[132:135], v[96:99]
 v_mfma_f32_16x16x32_bf16 v[68:71], a[112:115], a[72:75], v[68:71]
 v_mfma_f32_16x16x32_bf16 v[100:103], a[4:7], v[188:191], v[100:103]
 v_mfma_f32_16x16x32_bf16 v[72:75], a[116:119], a[16:19], v[72:75]
 v_mfma_f32_16x16x32_bf16 v[104:107], a[60:63], v[188:191], v[104:107]
 v_mfma_f32_16x16x32_bf16 v[76:79], a[116:119], a[72:75], v[76:79]
 s_waitcnt vmcnt(7)
 s_barrier
 ds_read_b128 a[112:115], v2 offset:8192
 ds_read_b128 a[116:119], v2 offset:22528
 s_waitcnt lgkmcnt(6)
 v_mfma_f32_16x16x32_bf16 v[64:67], a[120:123], a[20:23], v[64:67]
 s_add_u32 m0, s45, 28672
 s_add_u32 s46, s44, 4096
 v_mfma_f32_16x16x32_bf16 v[68:71], a[120:123], a[76:79], v[68:71]
 v_mfma_f32_16x16x32_bf16 v[72:75], a[124:127], a[20:23], v[72:75]
 buffer_load_dwordx4 v1, s[16:19], s44 offen offset:0 sc1 lds
 v_mfma_f32_16x16x32_bf16 v[76:79], a[124:127], a[76:79], v[76:79]
 ds_read_b128 a[120:123], v2 offset:9216
 ds_read_b128 a[124:127], v2 offset:23552
 s_waitcnt lgkmcnt(6)
 v_mfma_f32_16x16x32_bf16 v[64:67], a[128:131], a[24:27], v[64:67]
 v_mfma_f32_16x16x32_bf16 v[68:71], a[128:131], a[80:83], v[68:71]
 v_mfma_f32_16x16x32_bf16 v[72:75], a[132:135], a[24:27], v[72:75]
 buffer_load_dwordx4 v1, s[16:19], s44 offen offset:1024 sc1 lds
 v_mfma_f32_16x16x32_bf16 v[76:79], a[132:135], a[80:83], v[76:79]
 ds_read_b128 a[128:131], v2 offset:10240
 ds_read_b128 a[132:135], v2 offset:24576
 s_waitcnt lgkmcnt(6)
 v_mfma_f32_16x16x32_bf16 v[64:67], a[136:139], a[28:31], v[64:67]
 v_mfma_f32_16x16x32_bf16 v[68:71], a[136:139], a[84:87], v[68:71]
 v_mfma_f32_16x16x32_bf16 v[72:75], a[140:143], a[28:31], v[72:75]
 buffer_load_dwordx4 v1, s[16:19], s44 offen offset:2048 sc1 lds
 v_mfma_f32_16x16x32_bf16 v[76:79], a[140:143], a[84:87], v[76:79]
 ds_read_b128 a[136:139], v2 offset:11264
 ds_read_b128 a[140:143], v2 offset:25600
 s_waitcnt lgkmcnt(6)
 v_mfma_f32_16x16x32_bf16 v[64:67], a[112:115], a[32:35], v[64:67]
 v_mfma_f32_16x16x32_bf16 v[68:71], a[112:115], a[88:91], v[68:71]
 v_mfma_f32_16x16x32_bf16 v[72:75], a[116:119], a[32:35], v[72:75]
 buffer_load_dwordx4 v1, s[16:19], s44 offen offset:3072 sc1 lds
 v_mfma_f32_16x16x32_bf16 v[76:79], a[116:119], a[88:91], v[76:79]
 ds_read_b128 a[112:115], v2 offset:12288
 ds_read_b128 a[116:119], v2 offset:26624
 s_waitcnt lgkmcnt(6)
 v_mfma_f32_16x16x32_bf16 v[64:67], a[120:123], a[36:39], v[64:67]
 s_add_u32 m0, s45, 32768
 s_add_u32 s44, s44, 28672
 v_mfma_f32_16x16x32_bf16 v[68:71], a[120:123], a[92:95], v[68:71]
 v_mfma_f32_16x16x32_bf16 v[72:75], a[124:127], a[36:39], v[72:75]
 buffer_load_dwordx4 v1, s[16:19], s46 offen offset:0 sc1 lds
 v_mfma_f32_16x16x32_bf16 v[76:79], a[124:127], a[92:95], v[76:79]
 ds_read_b128 a[120:123], v2 offset:13312
 ds_read_b128 a[124:127], v2 offset:27648
 s_waitcnt lgkmcnt(6)
 v_mfma_f32_16x16x32_bf16 v[64:67], a[128:131], a[40:43], v[64:67]
 v_mfma_f32_16x16x32_bf16 v[68:71], a[128:131], a[96:99], v[68:71]
 v_mfma_f32_16x16x32_bf16 v[72:75], a[132:135], a[40:43], v[72:75]
 buffer_load_dwordx4 v1, s[16:19], s46 offen offset:1024 sc1 lds
 v_mfma_f32_16x16x32_bf16 v[76:79], a[132:135], a[96:99], v[76:79]
 ds_read_b128 a[128:131], v2 offset:28672
 ds_read_b128 a[132:135], v2 offset:43008
 s_waitcnt lgkmcnt(6)
 v_mfma_f32_16x16x32_bf16 v[64:67], a[136:139], a[44:47], v[64:67]
 v_mfma_f32_16x16x32_bf16 v[68:71], a[136:139], a[100:103], v[68:71]
 v_mfma_f32_16x16x32_bf16 v[72:75], a[140:143], a[44:47], v[72:75]
 buffer_load_dwordx4 v1, s[16:19], s46 offen offset:2048 sc1 lds
 v_mfma_f32_16x16x32_bf16 v[76:79], a[140:143], a[100:103], v[76:79]
 ds_read_b128 a[136:139], v2 offset:29696
 ds_read_b128 a[140:143], v2 offset:44032
 s_waitcnt lgkmcnt(6)
 v_mfma_f32_16x16x32_bf16 v[64:67], a[112:115], a[48:51], v[64:67]
 v_mfma_f32_16x16x32_bf16 v[68:71], a[112:115], a[104:107], v[68:71]
 v_mfma_f32_16x16x32_bf16 v[72:75], a[116:119], a[48:51], v[72:75]
 v_mfma_f32_16x16x32_bf16 v[76:79], a[116:119], a[104:107], v[76:79]
 ds_read_b128 a[112:115], v2 offset:30720
 ds_read_b128 a[116:119], v2 offset:45056
 s_waitcnt lgkmcnt(6)
 v_mfma_f32_16x16x32_bf16 v[64:67], a[120:123], a[52:55], v[64:67]
 v_mfma_f32_16x16x32_bf16 v[68:71], a[120:123], a[108:111], v[68:71]
 v_mfma_f32_16x16x32_bf16 v[72:75], a[124:127], a[52:55], v[72:75]
 v_mfma_f32_16x16x32_bf16 v[76:79], a[124:127], a[108:111], v[76:79]
 ds_read_b128 a[120:123], v2 offset:31744
 ds_read_b128 a[124:127], v2 offset:46080
 s_waitcnt lgkmcnt(6)
 v_mfma_f32_16x16x32_bf16 v[80:83], a[128:131], a[0:3], 0
 v_mfma_f32_16x16x32_bf16 v[84:87], a[128:131], a[56:59], 0
 v_mfma_f32_16x16x32_bf16 v[88:91], a[132:135], a[0:3], 0
 v_mfma_f32_16x16x32_bf16 v[92:95], a[132:135], a[56:59], 0
 ds_read_b128 a[128:131], v2 offset:32768
 ds_read_b128 a[132:135], v2 offset:47104
 s_waitcnt lgkmcnt(6)
 v_mfma_f32_16x16x32_bf16 v[80:83], a[136:139], a[4:7], v[80:83]
 v_mfma_f32_16x16x32_bf16 v[84:87], a[136:139], a[60:63], v[84:87]
 v_mfma_f32_16x16x32_bf16 v[88:91], a[140:143], a[4:7], v[88:91]
 v_mfma_f32_16x16x32_bf16 v[92:95], a[140:143], a[60:63], v[92:95]
 ds_read_b128 a[136:139], v2 offset:33792
 ds_read_b128 a[140:143], v2 offset:48128
 s_waitcnt lgkmcnt(6)
 v_mfma_f32_16x16x32_bf16 v[80:83], a[112:115], a[8:11], v[80:83]
 v_cvt_pk_bf16_f32 v136, v64, v65
 v_mfma_f32_16x16x32_bf16 v[84:87], a[112:115], a[64:67], v[84:87]
 v_cvt_pk_bf16_f32 v138, v66, v67
 v_mfma_f32_16x16x32_bf16 v[88:91], a[116:119], a[8:11], v[88:91]
 v_cvt_pk_bf16_f32 v137, v72, v73
 v_mfma_f32_16x16x32_bf16 v[92:95], a[116:119], a[64:67], v[92:95]
 v_cvt_pk_bf16_f32 v139, v74, v75
 ds_read_b128 a[112:115], v2 offset:34816
 ds_read_b128 a[116:119], v2 offset:49152
 s_waitcnt lgkmcnt(6)
 v_mfma_f32_16x16x32_bf16 v[80:83], a[120:123], a[12:15], v[80:83]
 v_cvt_pk_bf16_f32 v192, v68, v69
 v_mfma_f32_16x16x32_bf16 v[84:87], a[120:123], a[68:71], v[84:87]
 v_cvt_pk_bf16_f32 v194, v70, v71
 v_mfma_f32_16x16x32_bf16 v[88:91], a[124:127], a[12:15], v[88:91]
 v_cvt_pk_bf16_f32 v193, v76, v77
 v_mfma_f32_16x16x32_bf16 v[92:95], a[124:127], a[68:71], v[92:95]
 v_cvt_pk_bf16_f32 v195, v78, v79
 ds_read_b128 a[120:123], v2 offset:35840
 ds_read_b128 a[124:127], v2 offset:50176
 s_waitcnt lgkmcnt(6)
 v_mfma_f32_16x16x32_bf16 v[80:83], a[128:131], a[16:19], v[80:83]
 v_mfma_f32_16x16x32_bf16 v[96:99], a[8:11], v[136:139], v[96:99]
 v_mfma_f32_16x16x32_bf16 v[84:87], a[128:131], a[72:75], v[84:87]
 v_mfma_f32_16x16x32_bf16 v[100:103], a[8:11], v[192:195], v[100:103]
 v_mfma_f32_16x16x32_bf16 v[88:91], a[132:135], a[16:19], v[88:91]
 v_mfma_f32_16x16x32_bf16 v[104:107], a[64:67], v[192:195], v[104:107]
 v_mfma_f32_16x16x32_bf16 v[92:95], a[132:135], a[72:75], v[92:95]
 s_waitcnt vmcnt(7)
 s_barrier
 ds_read_b128 a[128:131], v2 offset:36864
 ds_read_b128 a[132:135], v2 offset:51200
 s_waitcnt lgkmcnt(6)
 v_mfma_f32_16x16x32_bf16 v[80:83], a[136:139], a[20:23], v[80:83]
 s_add_u32 m0, s45, 57344
 s_add_u32 s46, s44, 4096
 v_mfma_f32_16x16x32_bf16 v[84:87], a[136:139], a[76:79], v[84:87]
 v_mfma_f32_16x16x32_bf16 v[88:91], a[140:143], a[20:23], v[88:91]
 buffer_load_dwordx4 v1, s[16:19], s44 offen offset:0 sc1 lds
 v_mfma_f32_16x16x32_bf16 v[92:95], a[140:143], a[76:79], v[92:95]
 ds_read_b128 a[136:139], v2 offset:37888
 ds_read_b128 a[140:143], v2 offset:52224
 s_waitcnt lgkmcnt(6)
 v_mfma_f32_16x16x32_bf16 v[80:83], a[112:115], a[24:27], v[80:83]
 v_mfma_f32_16x16x32_bf16 v[84:87], a[112:115], a[80:83], v[84:87]
 v_mfma_f32_16x16x32_bf16 v[88:91], a[116:119], a[24:27], v[88:91]
 buffer_load_dwordx4 v1, s[16:19], s44 offen offset:1024 sc1 lds
 v_mfma_f32_16x16x32_bf16 v[92:95], a[116:119], a[80:83], v[92:95]
 ds_read_b128 a[112:115], v2 offset:38912
 ds_read_b128 a[116:119], v2 offset:53248
 s_waitcnt lgkmcnt(6)
 v_mfma_f32_16x16x32_bf16 v[80:83], a[120:123], a[28:31], v[80:83]
 v_mfma_f32_16x16x32_bf16 v[84:87], a[120:123], a[84:87], v[84:87]
 v_mfma_f32_16x16x32_bf16 v[88:91], a[124:127], a[28:31], v[88:91]
 buffer_load_dwordx4 v1, s[16:19], s44 offen offset:2048 sc1 lds
 v_mfma_f32_16x16x32_bf16 v[92:95], a[124:127], a[84:87], v[92:95]
 ds_read_b128 a[120:123], v2 offset:39936
 ds_read_b128 a[124:127], v2 offset:54272
 s_waitcnt lgkmcnt(6)
 v_mfma_f32_16x16x32_bf16 v[80:83], a[128:131], a[32:35], v[80:83]
 v_mfma_f32_16x16x32_bf16 v[84:87], a[128:131], a[88:91], v[84:87]
 v_mfma_f32_16x16x32_bf16 v[88:91], a[132:135], a[32:35], v[88:91]
 buffer_load_dwordx4 v1, s[16:19], s44 offen offset:3072 sc1 lds
 v_mfma_f32_16x16x32_bf16 v[92:95], a[132:135], a[88:91], v[92:95]
 ds_read_b128 a[128:131], v2 offset:40960
 ds_read_b128 a[132:135], v2 offset:55296
 s_waitcnt lgkmcnt(6)
 v_mfma_f32_16x16x32_bf16 v[80:83], a[136:139], a[36:39], v[80:83]
 s_add_u32 m0, s45, 61440
 s_add_u32 s44, s44, 28672
 v_mfma_f32_16x16x32_bf16 v[84:87], a[136:139], a[92:95], v[84:87]
 v_mfma_f32_16x16x32_bf16 v[88:91], a[140:143], a[36:39], v[88:91]
 buffer_load_dwordx4 v1, s[16:19], s46 offen offset:0 sc1 lds
 v_mfma_f32_16x16x32_bf16 v[92:95], a[140:143], a[92:95], v[92:95]
 ds_read_b128 a[136:139], v2 offset:41984
 ds_read_b128 a[140:143], v2 offset:56320
 s_waitcnt lgkmcnt(6)
 v_mfma_f32_16x16x32_bf16 v[80:83], a[112:115], a[40:43], v[80:83]
 v_mfma_f32_16x16x32_bf16 v[84:87], a[112:115], a[96:99], v[84:87]
 v_mfma_f32_16x16x32_bf16 v[88:91], a[116:119], a[40:43], v[88:91]
 buffer_load_dwordx4 v1, s[16:19], s46 offen offset:1024 sc1 lds
 v_mfma_f32_16x16x32_bf16 v[92:95], a[116:119], a[96:99], v[92:95]
 ds_read_b128 a[112:115], v1 offset:0
 ds_read_b128 a[116:119], v1 offset:14336
 s_waitcnt lgkmcnt(6)
 v_mfma_f32_16x16x32_bf16 v[80:83], a[120:123], a[44:47], v[80:83]
 v_mfma_f32_16x16x32_bf16 v[84:87], a[120:123], a[100:103], v[84:87]
 v_mfma_f32_16x16x32_bf16 v[88:91], a[124:127], a[44:47], v[88:91]
 buffer_load_dwordx4 v1, s[16:19], s46 offen offset:2048 sc1 lds
 v_mfma_f32_16x16x32_bf16 v[92:95], a[124:127], a[100:103], v[92:95]
 ds_read_b128 a[120:123], v1 offset:1024
 ds_read_b128 a[124:127], v1 offset:15360
 s_waitcnt lgkmcnt(6)
 v_mfma_f32_16x16x32_bf16 v[80:83], a[128:131], a[48:51], v[80:83]
 v_mfma_f32_16x16x32_bf16 v[84:87], a[128:131], a[104:107], v[84:87]
 v_mfma_f32_16x16x32_bf16 v[88:91], a[132:135], a[48:51], v[88:91]
 v_mfma_f32_16x16x32_bf16 v[92:95], a[132:135], a[104:107], v[92:95]
 ds_read_b128 a[128:131], v1 offset:2048
 ds_read_b128 a[132:135], v1 offset:16384
 s_waitcnt lgkmcnt(6)
 v_mfma_f32_16x16x32_bf16 v[80:83], a[136:139], a[52:55], v[80:83]
 v_mfma_f32_16x16x32_bf16 v[84:87], a[136:139], a[108:111], v[84:87]
 v_mfma_f32_16x16x32_bf16 v[88:91], a[140:143], a[52:55], v[88:91]
 v_mfma_f32_16x16x32_bf16 v[92:95], a[140:143], a[108:111], v[92:95]
 ds_read_b128 a[136:139], v1 offset:3072
 ds_read_b128 a[140:143], v1 offset:17408
 s_waitcnt lgkmcnt(6)
 v_mfma_f32_16x16x32_bf16 v[64:67], a[112:115], a[0:3], 0
 v_mfma_f32_16x16x32_bf16 v[68:71], a[112:115], a[56:59], 0
 v_mfma_f32_16x16x32_bf16 v[72:75], a[116:119], a[0:3], 0
 v_mfma_f32_16x16x32_bf16 v[76:79], a[116:119], a[56:59], 0
 ds_read_b128 a[112:115], v1 offset:4096
 ds_read_b128 a[116:119], v1 offset:18432
 s_waitcnt lgkmcnt(6)
 v_mfma_f32_16x16x32_bf16 v[64:67], a[120:123], a[4:7], v[64:67]
 v_mfma_f32_16x16x32_bf16 v[68:71], a[120:123], a[60:63], v[68:71]
 v_mfma_f32_16x16x32_bf16 v[72:75], a[124:127], a[4:7], v[72:75]
 v_mfma_f32_16x16x32_bf16 v[76:79], a[124:127], a[60:63], v[76:79]
 ds_read_b128 a[120:123], v1 offset:5120
 ds_read_b128 a[124:127], v1 offset:19456
 s_waitcnt lgkmcnt(6)
 v_mfma_f32_16x16x32_bf16 v[64:67], a[128:131], a[8:11], v[64:67]
 v_cvt_pk_bf16_f32 v140, v80, v81
 v_mfma_f32_16x16x32_bf16 v[68:71], a[128:131], a[64:67], v[68:71]
 v_cvt_pk_bf16_f32 v142, v82, v83
 v_mfma_f32_16x16x32_bf16 v[72:75], a[132:135], a[8:11], v[72:75]
 v_cvt_pk_bf16_f32 v141, v88, v89
 v_mfma_f32_16x16x32_bf16 v[76:79], a[132:135], a[64:67], v[76:79]
 v_cvt_pk_bf16_f32 v143, v90, v91
 ds_read_b128 a[128:131], v1 offset:6144
 ds_read_b128 a[132:135], v1 offset:20480
 s_waitcnt lgkmcnt(6)
 v_mfma_f32_16x16x32_bf16 v[64:67], a[136:139], a[12:15], v[64:67]
 v_cvt_pk_bf16_f32 v196, v84, v85
 v_mfma_f32_16x16x32_bf16 v[68:71], a[136:139], a[68:71], v[68:71]
 v_cvt_pk_bf16_f32 v198, v86, v87
 v_mfma_f32_16x16x32_bf16 v[72:75], a[140:143], a[12:15], v[72:75]
 v_cvt_pk_bf16_f32 v197, v92, v93
 v_mfma_f32_16x16x32_bf16 v[76:79], a[140:143], a[68:71], v[76:79]
 v_cvt_pk_bf16_f32 v199, v94, v95
 ds_read_b128 a[136:139], v1 offset:7168
 ds_read_b128 a[140:143], v1 offset:21504
 s_waitcnt lgkmcnt(6)
 v_mfma_f32_16x16x32_bf16 v[64:67], a[112:115], a[16:19], v[64:67]
 v_mfma_f32_16x16x32_bf16 v[96:99], a[12:15], v[140:143], v[96:99]
 v_mfma_f32_16x16x32_bf16 v[68:71], a[112:115], a[72:75], v[68:71]
 v_mfma_f32_16x16x32_bf16 v[100:103], a[12:15], v[196:199], v[100:103]
 v_mfma_f32_16x16x32_bf16 v[72:75], a[116:119], a[16:19], v[72:75]
 v_mfma_f32_16x16x32_bf16 v[104:107], a[68:71], v[196:199], v[104:107]
 v_mfma_f32_16x16x32_bf16 v[76:79], a[116:119], a[72:75], v[76:79]
 s_waitcnt vmcnt(7)
 s_barrier
 ds_read_b128 a[112:115], v1 offset:8192
 ds_read_b128 a[116:119], v1 offset:22528
 s_waitcnt lgkmcnt(6)
 v_mfma_f32_16x16x32_bf16 v[64:67], a[120:123], a[20:23], v[64:67]
 s_add_u32 m0, s45, 86016
 s_add_u32 s46, s44, 4096
 v_mfma_f32_16x16x32_bf16 v[68:71], a[120:123], a[76:79], v[68:71]
 v_mfma_f32_16x16x32_bf16 v[72:75], a[124:127], a[20:23], v[72:75]
 buffer_load_dwordx4 v1, s[16:19], s44 offen offset:0 sc1 lds
 v_mfma_f32_16x16x32_bf16 v[76:79], a[124:127], a[76:79], v[76:79]
 ds_read_b128 a[120:123], v1 offset:9216
 ds_read_b128 a[124:127], v1 offset:23552
 s_waitcnt lgkmcnt(6)
 v_mfma_f32_16x16x32_bf16 v[64:67], a[128:131], a[24:27], v[64:67]
 v_mfma_f32_16x16x32_bf16 v[68:71], a[128:131], a[80:83], v[68:71]
 v_mfma_f32_16x16x32_bf16 v[72:75], a[132:135], a[24:27], v[72:75]
 buffer_load_dwordx4 v1, s[16:19], s44 offen offset:1024 sc1 lds
 v_mfma_f32_16x16x32_bf16 v[76:79], a[132:135], a[80:83], v[76:79]
 ds_read_b128 a[128:131], v1 offset:10240
 ds_read_b128 a[132:135], v1 offset:24576
 s_waitcnt lgkmcnt(6)
 v_mfma_f32_16x16x32_bf16 v[64:67], a[136:139], a[28:31], v[64:67]
 v_mfma_f32_16x16x32_bf16 v[68:71], a[136:139], a[84:87], v[68:71]
 v_mfma_f32_16x16x32_bf16 v[72:75], a[140:143], a[28:31], v[72:75]
 buffer_load_dwordx4 v1, s[16:19], s44 offen offset:2048 sc1 lds
 v_mfma_f32_16x16x32_bf16 v[76:79], a[140:143], a[84:87], v[76:79]
 ds_read_b128 a[136:139], v1 offset:11264
 ds_read_b128 a[140:143], v1 offset:25600
 s_waitcnt lgkmcnt(6)
 v_mfma_f32_16x16x32_bf16 v[64:67], a[112:115], a[32:35], v[64:67]
 v_mfma_f32_16x16x32_bf16 v[68:71], a[112:115], a[88:91], v[68:71]
 v_mfma_f32_16x16x32_bf16 v[72:75], a[116:119], a[32:35], v[72:75]
 buffer_load_dwordx4 v1, s[16:19], s44 offen offset:3072 sc1 lds
 v_mfma_f32_16x16x32_bf16 v[76:79], a[116:119], a[88:91], v[76:79]
 ds_read_b128 a[112:115], v1 offset:12288
 ds_read_b128 a[116:119], v1 offset:26624
 s_waitcnt lgkmcnt(6)
 v_mfma_f32_16x16x32_bf16 v[64:67], a[120:123], a[36:39], v[64:67]
 s_add_u32 m0, s45, 90112
 s_add_u32 s44, s44, 28672
 v_mfma_f32_16x16x32_bf16 v[68:71], a[120:123], a[92:95], v[68:71]
 v_mfma_f32_16x16x32_bf16 v[72:75], a[124:127], a[36:39], v[72:75]
 buffer_load_dwordx4 v1, s[16:19], s46 offen offset:0 sc1 lds
 v_mfma_f32_16x16x32_bf16 v[76:79], a[124:127], a[92:95], v[76:79]
 ds_read_b128 a[120:123], v1 offset:13312
 ds_read_b128 a[124:127], v1 offset:27648
 s_waitcnt lgkmcnt(6)
 v_mfma_f32_16x16x32_bf16 v[64:67], a[128:131], a[40:43], v[64:67]
 v_mfma_f32_16x16x32_bf16 v[68:71], a[128:131], a[96:99], v[68:71]
 v_mfma_f32_16x16x32_bf16 v[72:75], a[132:135], a[40:43], v[72:75]
 buffer_load_dwordx4 v1, s[16:19], s46 offen offset:1024 sc1 lds
 v_mfma_f32_16x16x32_bf16 v[76:79], a[132:135], a[96:99], v[76:79]
 ds_read_b128 a[128:131], v1 offset:28672
 ds_read_b128 a[132:135], v1 offset:43008
 s_waitcnt lgkmcnt(6)
 v_mfma_f32_16x16x32_bf16 v[64:67], a[136:139], a[44:47], v[64:67]
 v_mfma_f32_16x16x32_bf16 v[68:71], a[136:139], a[100:103], v[68:71]
 v_mfma_f32_16x16x32_bf16 v[72:75], a[140:143], a[44:47], v[72:75]
 buffer_load_dwordx4 v1, s[16:19], s46 offen offset:2048 sc1 lds
 v_mfma_f32_16x16x32_bf16 v[76:79], a[140:143], a[100:103], v[76:79]
 ds_read_b128 a[136:139], v1 offset:29696
 ds_read_b128 a[140:143], v1 offset:44032
 s_waitcnt lgkmcnt(6)
 v_mfma_f32_16x16x32_bf16 v[64:67], a[112:115], a[48:51], v[64:67]
 v_mfma_f32_16x16x32_bf16 v[68:71], a[112:115], a[104:107], v[68:71]
 v_mfma_f32_16x16x32_bf16 v[72:75], a[116:119], a[48:51], v[72:75]
 v_mfma_f32_16x16x32_bf16 v[76:79], a[116:119], a[104:107], v[76:79]
 ds_read_b128 a[112:115], v1 offset:30720
 ds_read_b128 a[116:119], v1 offset:45056
 s_waitcnt lgkmcnt(6)
 v_mfma_f32_16x16x32_bf16 v[64:67], a[120:123], a[52:55], v[64:67]
 v_mfma_f32_16x16x32_bf16 v[68:71], a[120:123], a[108:111], v[68:71]
 v_mfma_f32_16x16x32_bf16 v[72:75], a[124:127], a[52:55], v[72:75]
 v_mfma_f32_16x16x32_bf16 v[76:79], a[124:127], a[108:111], v[76:79]
 ds_read_b128 a[120:123], v1 offset:31744
 ds_read_b128 a[124:127], v1 offset:46080
 s_waitcnt lgkmcnt(6)
 v_mfma_f32_16x16x32_bf16 v[80:83], a[128:131], a[0:3], 0
 v_mfma_f32_16x16x32_bf16 v[84:87], a[128:131], a[56:59], 0
 v_mfma_f32_16x16x32_bf16 v[88:91], a[132:135], a[0:3], 0
 v_mfma_f32_16x16x32_bf16 v[92:95], a[132:135], a[56:59], 0
 ds_read_b128 a[128:131], v1 offset:32768
 ds_read_b128 a[132:135], v1 offset:47104
 s_waitcnt lgkmcnt(6)
 v_mfma_f32_16x16x32_bf16 v[80:83], a[136:139], a[4:7], v[80:83]
 v_mfma_f32_16x16x32_bf16 v[84:87], a[136:139], a[60:63], v[84:87]
 v_mfma_f32_16x16x32_bf16 v[88:91], a[140:143], a[4:7], v[88:91]
 v_mfma_f32_16x16x32_bf16 v[92:95], a[140:143], a[60:63], v[92:95]
 ds_read_b128 a[136:139], v1 offset:33792
 ds_read_b128 a[140:143], v1 offset:48128
 s_waitcnt lgkmcnt(6)
 v_mfma_f32_16x16x32_bf16 v[80:83], a[112:115], a[8:11], v[80:83]
 v_cvt_pk_bf16_f32 v144, v64, v65
 v_mfma_f32_16x16x32_bf16 v[84:87], a[112:115], a[64:67], v[84:87]
 v_cvt_pk_bf16_f32 v146, v66, v67
 v_mfma_f32_16x16x32_bf16 v[88:91], a[116:119], a[8:11], v[88:91]
 v_cvt_pk_bf16_f32 v145, v72, v73
 v_mfma_f32_16x16x32_bf16 v[92:95], a[116:119], a[64:67], v[92:95]
 v_cvt_pk_bf16_f32 v147, v74, v75
 ds_read_b128 a[112:115], v1 offset:34816
 ds_read_b128 a[116:119], v1 offset:49152
 s_waitcnt lgkmcnt(6)
 v_mfma_f32_16x16x32_bf16 v[80:83], a[120:123], a[12:15], v[80:83]
 v_cvt_pk_bf16_f32 v200, v68, v69
 v_mfma_f32_16x16x32_bf16 v[84:87], a[120:123], a[68:71], v[84:87]
 v_cvt_pk_bf16_f32 v202, v70, v71
 v_mfma_f32_16x16x32_bf16 v[88:91], a[124:127], a[12:15], v[88:91]
 v_cvt_pk_bf16_f32 v201, v76, v77
 v_mfma_f32_16x16x32_bf16 v[92:95], a[124:127], a[68:71], v[92:95]
 v_cvt_pk_bf16_f32 v203, v78, v79
 ds_read_b128 a[120:123], v1 offset:35840
 ds_read_b128 a[124:127], v1 offset:50176
 s_waitcnt lgkmcnt(6)
 v_mfma_f32_16x16x32_bf16 v[80:83], a[128:131], a[16:19], v[80:83]
 v_mfma_f32_16x16x32_bf16 v[96:99], a[16:19], v[144:147], v[96:99]
 v_mfma_f32_16x16x32_bf16 v[84:87], a[128:131], a[72:75], v[84:87]
 v_mfma_f32_16x16x32_bf16 v[100:103], a[16:19], v[200:203], v[100:103]
 v_mfma_f32_16x16x32_bf16 v[88:91], a[132:135], a[16:19], v[88:91]
 v_mfma_f32_16x16x32_bf16 v[104:107], a[72:75], v[200:203], v[104:107]
 v_mfma_f32_16x16x32_bf16 v[92:95], a[132:135], a[72:75], v[92:95]
 s_waitcnt vmcnt(7)
 s_barrier
 ds_read_b128 a[128:131], v1 offset:36864
 ds_read_b128 a[132:135], v1 offset:51200
 s_waitcnt lgkmcnt(6)
 v_mfma_f32_16x16x32_bf16 v[80:83], a[136:139], a[20:23], v[80:83]
 s_add_u32 m0, s45, 0
 s_add_u32 s46, s44, 4096
 v_mfma_f32_16x16x32_bf16 v[84:87], a[136:139], a[76:79], v[84:87]
 v_mfma_f32_16x16x32_bf16 v[88:91], a[140:143], a[20:23], v[88:91]
 buffer_load_dwordx4 v1, s[16:19], s44 offen offset:0 sc1 lds
 v_mfma_f32_16x16x32_bf16 v[92:95], a[140:143], a[76:79], v[92:95]
 ds_read_b128 a[136:139], v1 offset:37888
 ds_read_b128 a[140:143], v1 offset:52224
 s_waitcnt lgkmcnt(6)
 v_mfma_f32_16x16x32_bf16 v[80:83], a[112:115], a[24:27], v[80:83]
 v_mfma_f32_16x16x32_bf16 v[84:87], a[112:115], a[80:83], v[84:87]
 v_mfma_f32_16x16x32_bf16 v[88:91], a[116:119], a[24:27], v[88:91]
 buffer_load_dwordx4 v1, s[16:19], s44 offen offset:1024 sc1 lds
 v_mfma_f32_16x16x32_bf16 v[92:95], a[116:119], a[80:83], v[92:95]
 ds_read_b128 a[112:115], v1 offset:38912
 ds_read_b128 a[116:119], v1 offset:53248
 s_waitcnt lgkmcnt(6)
 v_mfma_f32_16x16x32_bf16 v[80:83], a[120:123], a[28:31], v[80:83]
 v_mfma_f32_16x16x32_bf16 v[84:87], a[120:123], a[84:87], v[84:87]
 v_mfma_f32_16x16x32_bf16 v[88:91], a[124:127], a[28:31], v[88:91]
 buffer_load_dwordx4 v1, s[16:19], s44 offen offset:2048 sc1 lds
 v_mfma_f32_16x16x32_bf16 v[92:95], a[124:127], a[84:87], v[92:95]
 ds_read_b128 a[120:123], v1 offset:39936
 ds_read_b128 a[124:127], v1 offset:54272
 s_waitcnt lgkmcnt(6)
 v_mfma_f32_16x16x32_bf16 v[80:83], a[128:131], a[32:35], v[80:83]
 v_mfma_f32_16x16x32_bf16 v[84:87], a[128:131], a[88:91], v[84:87]
 v_mfma_f32_16x16x32_bf16 v[88:91], a[132:135], a[32:35], v[88:91]
 buffer_load_dwordx4 v1, s[16:19], s44 offen offset:3072 sc1 lds
 v_mfma_f32_16x16x32_bf16 v[92:95], a[132:135], a[88:91], v[92:95]
 ds_read_b128 a[128:131], v1 offset:40960
 ds_read_b128 a[132:135], v1 offset:55296
 s_waitcnt lgkmcnt(6)
 v_mfma_f32_16x16x32_bf16 v[80:83], a[136:139], a[36:39], v[80:83]
 s_add_u32 m0, s45, 4096
 s_add_u32 s44, s44, 28672
 v_mfma_f32_16x16x32_bf16 v[84:87], a[136:139], a[92:95], v[84:87]
 v_mfma_f32_16x16x32_bf16 v[88:91], a[140:143], a[36:39], v[88:91]
 buffer_load_dwordx4 v1, s[16:19], s46 offen offset:0 sc1 lds
 v_mfma_f32_16x16x32_bf16 v[92:95], a[140:143], a[92:95], v[92:95]
 ds_read_b128 a[136:139], v1 offset:41984
 ds_read_b128 a[140:143], v1 offset:56320
 s_waitcnt lgkmcnt(6)
 v_mfma_f32_16x16x32_bf16 v[80:83], a[112:115], a[40:43], v[80:83]
 v_mfma_f32_16x16x32_bf16 v[84:87], a[112:115], a[96:99], v[84:87]
 v_mfma_f32_16x16x32_bf16 v[88:91], a[116:119], a[40:43], v[88:91]
 buffer_load_dwordx4 v1, s[16:19], s46 offen offset:1024 sc1 lds
 v_mfma_f32_16x16x32_bf16 v[92:95], a[116:119], a[96:99], v[92:95]
 ds_read_b128 a[112:115], v2 offset:0
 ds_read_b128 a[116:119], v2 offset:14336
 s_waitcnt lgkmcnt(6)
 v_mfma_f32_16x16x32_bf16 v[80:83], a[120:123], a[44:47], v[80:83]
 v_mfma_f32_16x16x32_bf16 v[84:87], a[120:123], a[100:103], v[84:87]
 v_mfma_f32_16x16x32_bf16 v[88:91], a[124:127], a[44:47], v[88:91]
 buffer_load_dwordx4 v1, s[16:19], s46 offen offset:2048 sc1 lds
 v_mfma_f32_16x16x32_bf16 v[92:95], a[124:127], a[100:103], v[92:95]
 ds_read_b128 a[120:123], v2 offset:1024
 ds_read_b128 a[124:127], v2 offset:15360
 s_waitcnt lgkmcnt(6)
 v_mfma_f32_16x16x32_bf16 v[80:83], a[128:131], a[48:51], v[80:83]
 v_mfma_f32_16x16x32_bf16 v[84:87], a[128:131], a[104:107], v[84:87]
 v_mfma_f32_16x16x32_bf16 v[88:91], a[132:135], a[48:51], v[88:91]
 v_mfma_f32_16x16x32_bf16 v[92:95], a[132:135], a[104:107], v[92:95]
 ds_read_b128 a[128:131], v2 offset:2048
 ds_read_b128 a[132:135], v2 offset:16384
 s_waitcnt lgkmcnt(6)
 v_mfma_f32_16x16x32_bf16 v[80:83], a[136:139], a[52:55], v[80:83]
 v_mfma_f32_16x16x32_bf16 v[84:87], a[136:139], a[108:111], v[84:87]
 v_mfma_f32_16x16x32_bf16 v[88:91], a[140:143], a[52:55], v[88:91]
 v_mfma_f32_16x16x32_bf16 v[92:95], a[140:143], a[108:111], v[92:95]
 ds_read_b128 a[136:139], v2 offset:3072
 ds_read_b128 a[140:143], v2 offset:17408
 s_waitcnt lgkmcnt(6)
 v_mfma_f32_16x16x32_bf16 v[64:67], a[112:115], a[0:3], 0
 v_mfma_f32_16x16x32_bf16 v[68:71], a[112:115], a[56:59], 0
 v_mfma_f32_16x16x32_bf16 v[72:75], a[116:119], a[0:3], 0
 v_mfma_f32_16x16x32_bf16 v[76:79], a[116:119], a[56:59], 0
 ds_read_b128 a[112:115], v2 offset:4096
 ds_read_b128 a[116:119], v2 offset:18432
 s_waitcnt lgkmcnt(6)
 v_mfma_f32_16x16x32_bf16 v[64:67], a[120:123], a[4:7], v[64:67]
 v_mfma_f32_16x16x32_bf16 v[68:71], a[120:123], a[60:63], v[68:71]
 v_mfma_f32_16x16x32_bf16 v[72:75], a[124:127], a[4:7], v[72:75]
 v_mfma_f32_16x16x32_bf16 v[76:79], a[124:127], a[60:63], v[76:79]
 ds_read_b128 a[120:123], v2 offset:5120
 ds_read_b128 a[124:127], v2 offset:19456
 s_waitcnt lgkmcnt(6)
 v_mfma_f32_16x16x32_bf16 v[64:67], a[128:131], a[8:11], v[64:67]
 v_cvt_pk_bf16_f32 v148, v80, v81
 v_mfma_f32_16x16x32_bf16 v[68:71], a[128:131], a[64:67], v[68:71]
 v_cvt_pk_bf16_f32 v150, v82, v83
 v_mfma_f32_16x16x32_bf16 v[72:75], a[132:135], a[8:11], v[72:75]
 v_cvt_pk_bf16_f32 v149, v88, v89
 v_mfma_f32_16x16x32_bf16 v[76:79], a[132:135], a[64:67], v[76:79]
 v_cvt_pk_bf16_f32 v151, v90, v91
 ds_read_b128 a[128:131], v2 offset:6144
 ds_read_b128 a[132:135], v2 offset:20480
 s_waitcnt lgkmcnt(6)
 v_mfma_f32_16x16x32_bf16 v[64:67], a[136:139], a[12:15], v[64:67]
 v_cvt_pk_bf16_f32 v204, v84, v85
 v_mfma_f32_16x16x32_bf16 v[68:71], a[136:139], a[68:71], v[68:71]
 v_cvt_pk_bf16_f32 v206, v86, v87
 v_mfma_f32_16x16x32_bf16 v[72:75], a[140:143], a[12:15], v[72:75]
 v_cvt_pk_bf16_f32 v205, v92, v93
 v_mfma_f32_16x16x32_bf16 v[76:79], a[140:143], a[68:71], v[76:79]
 v_cvt_pk_bf16_f32 v207, v94, v95
 ds_read_b128 a[136:139], v2 offset:7168
 ds_read_b128 a[140:143], v2 offset:21504
 s_waitcnt lgkmcnt(6)
 v_mfma_f32_16x16x32_bf16 v[64:67], a[112:115], a[16:19], v[64:67]
 v_mfma_f32_16x16x32_bf16 v[96:99], a[20:23], v[148:151], v[96:99]
 v_mfma_f32_16x16x32_bf16 v[68:71], a[112:115], a[72:75], v[68:71]
 v_mfma_f32_16x16x32_bf16 v[100:103], a[20:23], v[204:207], v[100:103]
 v_mfma_f32_16x16x32_bf16 v[72:75], a[116:119], a[16:19], v[72:75]
 v_mfma_f32_16x16x32_bf16 v[104:107], a[76:79], v[204:207], v[104:107]
 v_mfma_f32_16x16x32_bf16 v[76:79], a[116:119], a[72:75], v[76:79]
 s_waitcnt vmcnt(7)
 s_barrier
 ds_read_b128 a[112:115], v2 offset:8192
 ds_read_b128 a[116:119], v2 offset:22528
 s_waitcnt lgkmcnt(6)
 v_mfma_f32_16x16x32_bf16 v[64:67], a[120:123], a[20:23], v[64:67]
 s_add_u32 m0, s45, 28672
 s_add_u32 s46, s44, 4096
 v_mfma_f32_16x16x32_bf16 v[68:71], a[120:123], a[76:79], v[68:71]
 v_mfma_f32_16x16x32_bf16 v[72:75], a[124:127], a[20:23], v[72:75]
 buffer_load_dwordx4 v1, s[16:19], s44 offen offset:0 sc1 lds
 v_mfma_f32_16x16x32_bf16 v[76:79], a[124:127], a[76:79], v[76:79]
 ds_read_b128 a[120:123], v2 offset:9216
 ds_read_b128 a[124:127], v2 offset:23552
 s_waitcnt lgkmcnt(6)
 v_mfma_f32_16x16x32_bf16 v[64:67], a[128:131], a[24:27], v[64:67]
 v_mfma_f32_16x16x32_bf16 v[68:71], a[128:131], a[80:83], v[68:71]
 v_mfma_f32_16x16x32_bf16 v[72:75], a[132:135], a[24:27], v[72:75]
 buffer_load_dwordx4 v1, s[16:19], s44 offen offset:1024 sc1 lds
 v_mfma_f32_16x16x32_bf16 v[76:79], a[132:135], a[80:83], v[76:79]
 ds_read_b128 a[128:131], v2 offset:10240
 ds_read_b128 a[132:135], v2 offset:24576
 s_waitcnt lgkmcnt(6)
 v_mfma_f32_16x16x32_bf16 v[64:67], a[136:139], a[28:31], v[64:67]
 v_mfma_f32_16x16x32_bf16 v[68:71], a[136:139], a[84:87], v[68:71]
 v_mfma_f32_16x16x32_bf16 v[72:75], a[140:143], a[28:31], v[72:75]
 buffer_load_dwordx4 v1, s[16:19], s44 offen offset:2048 sc1 lds
 v_mfma_f32_16x16x32_bf16 v[76:79], a[140:143], a[84:87], v[76:79]
 ds_read_b128 a[136:139], v2 offset:11264
 ds_read_b128 a[140:143], v2 offset:25600
 s_waitcnt lgkmcnt(6)
 v_mfma_f32_16x16x32_bf16 v[64:67], a[112:115], a[32:35], v[64:67]
 v_mfma_f32_16x16x32_bf16 v[68:71], a[112:115], a[88:91], v[68:71]
 v_mfma_f32_16x16x32_bf16 v[72:75], a[116:119], a[32:35], v[72:75]
 buffer_load_dwordx4 v1, s[16:19], s44 offen offset:3072 sc1 lds
 v_mfma_f32_16x16x32_bf16 v[76:79], a[116:119], a[88:91], v[76:79]
 ds_read_b128 a[112:115], v2 offset:12288
 ds_read_b128 a[116:119], v2 offset:26624
 s_waitcnt lgkmcnt(6)
 v_mfma_f32_16x16x32_bf16 v[64:67], a[120:123], a[36:39], v[64:67]
 s_add_u32 m0, s45, 32768
 s_add_u32 s44, s44, 28672
 v_mfma_f32_16x16x32_bf16 v[68:71], a[120:123], a[92:95], v[68:71]
 v_mfma_f32_16x16x32_bf16 v[72:75], a[124:127], a[36:39], v[72:75]
 buffer_load_dwordx4 v1, s[16:19], s46 offen offset:0 sc1 lds
 v_mfma_f32_16x16x32_bf16 v[76:79], a[124:127], a[92:95], v[76:79]
 ds_read_b128 a[120:123], v2 offset:13312
 ds_read_b128 a[124:127], v2 offset:27648
 s_waitcnt lgkmcnt(6)
 v_mfma_f32_16x16x32_bf16 v[64:67], a[128:131], a[40:43], v[64:67]
 v_mfma_f32_16x16x32_bf16 v[68:71], a[128:131], a[96:99], v[68:71]
 v_mfma_f32_16x16x32_bf16 v[72:75], a[132:135], a[40:43], v[72:75]
 buffer_load_dwordx4 v1, s[16:19], s46 offen offset:1024 sc1 lds
 v_mfma_f32_16x16x32_bf16 v[76:79], a[132:135], a[96:99], v[76:79]
 ds_read_b128 a[128:131], v2 offset:28672
 ds_read_b128 a[132:135], v2 offset:43008
 s_waitcnt lgkmcnt(6)
 v_mfma_f32_16x16x32_bf16 v[64:67], a[136:139], a[44:47], v[64:67]
 v_mfma_f32_16x16x32_bf16 v[68:71], a[136:139], a[100:103], v[68:71]
 v_mfma_f32_16x16x32_bf16 v[72:75], a[140:143], a[44:47], v[72:75]
 buffer_load_dwordx4 v1, s[16:19], s46 offen offset:2048 sc1 lds
 v_mfma_f32_16x16x32_bf16 v[76:79], a[140:143], a[100:103], v[76:79]
 ds_read_b128 a[136:139], v2 offset:29696
 ds_read_b128 a[140:143], v2 offset:44032
 s_waitcnt lgkmcnt(6)
 v_mfma_f32_16x16x32_bf16 v[64:67], a[112:115], a[48:51], v[64:67]
 v_mfma_f32_16x16x32_bf16 v[68:71], a[112:115], a[104:107], v[68:71]
 v_mfma_f32_16x16x32_bf16 v[72:75], a[116:119], a[48:51], v[72:75]
 v_mfma_f32_16x16x32_bf16 v[76:79], a[116:119], a[104:107], v[76:79]
 ds_read_b128 a[112:115], v2 offset:30720
 ds_read_b128 a[116:119], v2 offset:45056
 s_waitcnt lgkmcnt(6)
 v_mfma_f32_16x16x32_bf16 v[64:67], a[120:123], a[52:55], v[64:67]
 v_mfma_f32_16x16x32_bf16 v[68:71], a[120:123], a[108:111], v[68:71]
 v_mfma_f32_16x16x32_bf16 v[72:75], a[124:127], a[52:55], v[72:75]
 v_mfma_f32_16x16x32_bf16 v[76:79], a[124:127], a[108:111], v[76:79]
 ds_read_b128 a[120:123], v2 offset:31744
 ds_read_b128 a[124:127], v2 offset:46080
 s_waitcnt lgkmcnt(6)
 v_mfma_f32_16x16x32_bf16 v[80:83], a[128:131], a[0:3], 0
 v_mfma_f32_16x16x32_bf16 v[84:87], a[128:131], a[56:59], 0
 v_mfma_f32_16x16x32_bf16 v[88:91], a[132:135], a[0:3], 0
 v_mfma_f32_16x16x32_bf16 v[92:95], a[132:135], a[56:59], 0
 ds_read_b128 a[128:131], v2 offset:32768
 ds_read_b128 a[132:135], v2 offset:47104
 s_waitcnt lgkmcnt(6)
 v_mfma_f32_16x16x32_bf16 v[80:83], a[136:139], a[4:7], v[80:83]
 v_mfma_f32_16x16x32_bf16 v[84:87], a[136:139], a[60:63], v[84:87]
 v_mfma_f32_16x16x32_bf16 v[88:91], a[140:143], a[4:7], v[88:91]
 v_mfma_f32_16x16x32_bf16 v[92:95], a[140:143], a[60:63], v[92:95]
 ds_read_b128 a[136:139], v2 offset:33792
 ds_read_b128 a[140:143], v2 offset:48128
 s_waitcnt lgkmcnt(6)
 v_mfma_f32_16x16x32_bf16 v[80:83], a[112:115], a[8:11], v[80:83]
 v_cvt_pk_bf16_f32 v152, v64, v65
 v_mfma_f32_16x16x32_bf16 v[84:87], a[112:115], a[64:67], v[84:87]
 v_cvt_pk_bf16_f32 v154, v66, v67
 v_mfma_f32_16x16x32_bf16 v[88:91], a[116:119], a[8:11], v[88:91]
 v_cvt_pk_bf16_f32 v153, v72, v73
 v_mfma_f32_16x16x32_bf16 v[92:95], a[116:119], a[64:67], v[92:95]
 v_cvt_pk_bf16_f32 v155, v74, v75
 ds_read_b128 a[112:115], v2 offset:34816
 ds_read_b128 a[116:119], v2 offset:49152
 s_waitcnt lgkmcnt(6)
 v_mfma_f32_16x16x32_bf16 v[80:83], a[120:123], a[12:15], v[80:83]
 v_cvt_pk_bf16_f32 v208, v68, v69
 v_mfma_f32_16x16x32_bf16 v[84:87], a[120:123], a[68:71], v[84:87]
 v_cvt_pk_bf16_f32 v210, v70, v71
 v_mfma_f32_16x16x32_bf16 v[88:91], a[124:127], a[12:15], v[88:91]
 v_cvt_pk_bf16_f32 v209, v76, v77
 v_mfma_f32_16x16x32_bf16 v[92:95], a[124:127], a[68:71], v[92:95]
 v_cvt_pk_bf16_f32 v211, v78, v79
 ds_read_b128 a[120:123], v2 offset:35840
 ds_read_b128 a[124:127], v2 offset:50176
 s_waitcnt lgkmcnt(6)
 v_mfma_f32_16x16x32_bf16 v[80:83], a[128:131], a[16:19], v[80:83]
 v_mfma_f32_16x16x32_bf16 v[96:99], a[24:27], v[152:155], v[96:99]
 v_mfma_f32_16x16x32_bf16 v[84:87], a[128:131], a[72:75], v[84:87]
 v_mfma_f32_16x16x32_bf16 v[100:103], a[24:27], v[208:211], v[100:103]
 v_mfma_f32_16x16x32_bf16 v[88:91], a[132:135], a[16:19], v[88:91]
 v_mfma_f32_16x16x32_bf16 v[104:107], a[80:83], v[208:211], v[104:107]
 v_mfma_f32_16x16x32_bf16 v[92:95], a[132:135], a[72:75], v[92:95]
 s_waitcnt vmcnt(7)
 s_barrier
 ds_read_b128 a[128:131], v2 offset:36864
 ds_read_b128 a[132:135], v2 offset:51200
 s_waitcnt lgkmcnt(6)
 v_mfma_f32_16x16x32_bf16 v[80:83], a[136:139], a[20:23], v[80:83]
 s_add_u32 m0, s45, 57344
 s_add_u32 s46, s44, 4096
 v_mfma_f32_16x16x32_bf16 v[84:87], a[136:139], a[76:79], v[84:87]
 v_mfma_f32_16x16x32_bf16 v[88:91], a[140:143], a[20:23], v[88:91]
 buffer_load_dwordx4 v1, s[16:19], s44 offen offset:0 sc1 lds
 v_mfma_f32_16x16x32_bf16 v[92:95], a[140:143], a[76:79], v[92:95]
 ds_read_b128 a[136:139], v2 offset:37888
 ds_read_b128 a[140:143], v2 offset:52224
 s_waitcnt lgkmcnt(6)
 v_mfma_f32_16x16x32_bf16 v[80:83], a[112:115], a[24:27], v[80:83]
 v_mfma_f32_16x16x32_bf16 v[84:87], a[112:115], a[80:83], v[84:87]
 v_mfma_f32_16x16x32_bf16 v[88:91], a[116:119], a[24:27], v[88:91]
 buffer_load_dwordx4 v1, s[16:19], s44 offen offset:1024 sc1 lds
 v_mfma_f32_16x16x32_bf16 v[92:95], a[116:119], a[80:83], v[92:95]
 ds_read_b128 a[112:115], v2 offset:38912
 ds_read_b128 a[116:119], v2 offset:53248
 s_waitcnt lgkmcnt(6)
 v_mfma_f32_16x16x32_bf16 v[80:83], a[120:123], a[28:31], v[80:83]
 v_mfma_f32_16x16x32_bf16 v[84:87], a[120:123], a[84:87], v[84:87]
 v_mfma_f32_16x16x32_bf16 v[88:91], a[124:127], a[28:31], v[88:91]
 buffer_load_dwordx4 v1, s[16:19], s44 offen offset:2048 sc1 lds
 v_mfma_f32_16x16x32_bf16 v[92:95], a[124:127], a[84:87], v[92:95]
 ds_read_b128 a[120:123], v2 offset:39936
 ds_read_b128 a[124:127], v2 offset:54272
 s_waitcnt lgkmcnt(6)
 v_mfma_f32_16x16x32_bf16 v[80:83], a[128:131], a[32:35], v[80:83]
 v_mfma_f32_16x16x32_bf16 v[84:87], a[128:131], a[88:91], v[84:87]
 v_mfma_f32_16x16x32_bf16 v[88:91], a[132:135], a[32:35], v[88:91]
 buffer_load_dwordx4 v1, s[16:19], s44 offen offset:3072 sc1 lds
 v_mfma_f32_16x16x32_bf16 v[92:95], a[132:135], a[88:91], v[92:95]
 ds_read_b128 a[128:131], v2 offset:40960
 ds_read_b128 a[132:135], v2 offset:55296
 s_waitcnt lgkmcnt(6)
 v_mfma_f32_16x16x32_bf16 v[80:83], a[136:139], a[36:39], v[80:83]
 s_add_u32 m0, s45, 61440
 s_add_u32 s44, s44, 28672
 v_mfma_f32_16x16x32_bf16 v[84:87], a[136:139], a[92:95], v[84:87]
 v_mfma_f32_16x16x32_bf16 v[88:91], a[140:143], a[36:39], v[88:91]
 buffer_load_dwordx4 v1, s[16:19], s46 offen offset:0 sc1 lds
 v_mfma_f32_16x16x32_bf16 v[92:95], a[140:143], a[92:95], v[92:95]
 ds_read_b128 a[136:139], v2 offset:41984
 ds_read_b128 a[140:143], v2 offset:56320
 s_waitcnt lgkmcnt(6)
 v_mfma_f32_16x16x32_bf16 v[80:83], a[112:115], a[40:43], v[80:83]
 v_mfma_f32_16x16x32_bf16 v[84:87], a[112:115], a[96:99], v[84:87]
 v_mfma_f32_16x16x32_bf16 v[88:91], a[116:119], a[40:43], v[88:91]
 buffer_load_dwordx4 v1, s[16:19], s46 offen offset:1024 sc1 lds
 v_mfma_f32_16x16x32_bf16 v[92:95], a[116:119], a[96:99], v[92:95]
 ds_read_b128 a[112:115], v1 offset:0
 ds_read_b128 a[116:119], v1 offset:14336
 s_waitcnt lgkmcnt(6)
 v_mfma_f32_16x16x32_bf16 v[80:83], a[120:123], a[44:47], v[80:83]
 v_mfma_f32_16x16x32_bf16 v[84:87], a[120:123], a[100:103], v[84:87]
 v_mfma_f32_16x16x32_bf16 v[88:91], a[124:127], a[44:47], v[88:91]
 buffer_load_dwordx4 v1, s[16:19], s46 offen offset:2048 sc1 lds
 v_mfma_f32_16x16x32_bf16 v[92:95], a[124:127], a[100:103], v[92:95]
 ds_read_b128 a[120:123], v1 offset:1024
 ds_read_b128 a[124:127], v1 offset:15360
 s_waitcnt lgkmcnt(6)
 v_mfma_f32_16x16x32_bf16 v[80:83], a[128:131], a[48:51], v[80:83]
 v_mfma_f32_16x16x32_bf16 v[84:87], a[128:131], a[104:107], v[84:87]
 v_mfma_f32_16x16x32_bf16 v[88:91], a[132:135], a[48:51], v[88:91]
 v_mfma_f32_16x16x32_bf16 v[92:95], a[132:135], a[104:107], v[92:95]
 ds_read_b128 a[128:131], v1 offset:2048
 ds_read_b128 a[132:135], v1 offset:16384
 s_waitcnt lgkmcnt(6)
 v_mfma_f32_16x16x32_bf16 v[80:83], a[136:139], a[52:55], v[80:83]
 v_mfma_f32_16x16x32_bf16 v[84:87], a[136:139], a[108:111], v[84:87]
 v_mfma_f32_16x16x32_bf16 v[88:91], a[140:143], a[52:55], v[88:91]
 v_mfma_f32_16x16x32_bf16 v[92:95], a[140:143], a[108:111], v[92:95]
 ds_read_b128 a[136:139], v1 offset:3072
 ds_read_b128 a[140:143], v1 offset:17408
 s_waitcnt lgkmcnt(6)
 v_mfma_f32_16x16x32_bf16 v[64:67], a[112:115], a[0:3], 0
 v_mfma_f32_16x16x32_bf16 v[68:71], a[112:115], a[56:59], 0
 v_mfma_f32_16x16x32_bf16 v[72:75], a[116:119], a[0:3], 0
 v_mfma_f32_16x16x32_bf16 v[76:79], a[116:119], a[56:59], 0
 ds_read_b128 a[112:115], v1 offset:4096
 ds_read_b128 a[116:119], v1 offset:18432
 s_waitcnt lgkmcnt(6)
 v_mfma_f32_16x16x32_bf16 v[64:67], a[120:123], a[4:7], v[64:67]
 v_mfma_f32_16x16x32_bf16 v[68:71], a[120:123], a[60:63], v[68:71]
 v_mfma_f32_16x16x32_bf16 v[72:75], a[124:127], a[4:7], v[72:75]
 v_mfma_f32_16x16x32_bf16 v[76:79], a[124:127], a[60:63], v[76:79]
 ds_read_b128 a[120:123], v1 offset:5120
 ds_read_b128 a[124:127], v1 offset:19456
 s_waitcnt lgkmcnt(6)
 v_mfma_f32_16x16x32_bf16 v[64:67], a[128:131], a[8:11], v[64:67]
 v_cvt_pk_bf16_f32 v156, v80, v81
 v_mfma_f32_16x16x32_bf16 v[68:71], a[128:131], a[64:67], v[68:71]
 v_cvt_pk_bf16_f32 v158, v82, v83
 v_mfma_f32_16x16x32_bf16 v[72:75], a[132:135], a[8:11], v[72:75]
 v_cvt_pk_bf16_f32 v157, v88, v89
 v_mfma_f32_16x16x32_bf16 v[76:79], a[132:135], a[64:67], v[76:79]
 v_cvt_pk_bf16_f32 v159, v90, v91
 ds_read_b128 a[128:131], v1 offset:6144
 ds_read_b128 a[132:135], v1 offset:20480
 s_waitcnt lgkmcnt(6)
 v_mfma_f32_16x16x32_bf16 v[64:67], a[136:139], a[12:15], v[64:67]
 v_cvt_pk_bf16_f32 v212, v84, v85
 v_mfma_f32_16x16x32_bf16 v[68:71], a[136:139], a[68:71], v[68:71]
 v_cvt_pk_bf16_f32 v214, v86, v87
 v_mfma_f32_16x16x32_bf16 v[72:75], a[140:143], a[12:15], v[72:75]
 v_cvt_pk_bf16_f32 v213, v92, v93
 v_mfma_f32_16x16x32_bf16 v[76:79], a[140:143], a[68:71], v[76:79]
 v_cvt_pk_bf16_f32 v215, v94, v95
 ds_read_b128 a[136:139], v1 offset:7168
 ds_read_b128 a[140:143], v1 offset:21504
 s_waitcnt lgkmcnt(6)
 v_mfma_f32_16x16x32_bf16 v[64:67], a[112:115], a[16:19], v[64:67]
 v_mfma_f32_16x16x32_bf16 v[96:99], a[28:31], v[156:159], v[96:99]
 v_mfma_f32_16x16x32_bf16 v[68:71], a[112:115], a[72:75], v[68:71]
 v_mfma_f32_16x16x32_bf16 v[100:103], a[28:31], v[212:215], v[100:103]
 v_mfma_f32_16x16x32_bf16 v[72:75], a[116:119], a[16:19], v[72:75]
 v_mfma_f32_16x16x32_bf16 v[104:107], a[84:87], v[212:215], v[104:107]
 v_mfma_f32_16x16x32_bf16 v[76:79], a[116:119], a[72:75], v[76:79]
 s_waitcnt vmcnt(7)
 s_barrier
 ds_read_b128 a[112:115], v1 offset:8192
 ds_read_b128 a[116:119], v1 offset:22528
 s_waitcnt lgkmcnt(6)
 v_mfma_f32_16x16x32_bf16 v[64:67], a[120:123], a[20:23], v[64:67]
 s_add_u32 m0, s45, 86016
 s_add_u32 s46, s44, 4096
 v_mfma_f32_16x16x32_bf16 v[68:71], a[120:123], a[76:79], v[68:71]
 v_mfma_f32_16x16x32_bf16 v[72:75], a[124:127], a[20:23], v[72:75]
 buffer_load_dwordx4 v1, s[16:19], s44 offen offset:0 sc1 lds
 v_mfma_f32_16x16x32_bf16 v[76:79], a[124:127], a[76:79], v[76:79]
 ds_read_b128 a[120:123], v1 offset:9216
 ds_read_b128 a[124:127], v1 offset:23552
 s_waitcnt lgkmcnt(6)
 v_mfma_f32_16x16x32_bf16 v[64:67], a[128:131], a[24:27], v[64:67]
 v_mfma_f32_16x16x32_bf16 v[68:71], a[128:131], a[80:83], v[68:71]
 v_mfma_f32_16x16x32_bf16 v[72:75], a[132:135], a[24:27], v[72:75]
 buffer_load_dwordx4 v1, s[16:19], s44 offen offset:1024 sc1 lds
 v_mfma_f32_16x16x32_bf16 v[76:79], a[132:135], a[80:83], v[76:79]
 ds_read_b128 a[128:131], v1 offset:10240
 ds_read_b128 a[132:135], v1 offset:24576
 s_waitcnt lgkmcnt(6)
 v_mfma_f32_16x16x32_bf16 v[64:67], a[136:139], a[28:31], v[64:67]
 v_mfma_f32_16x16x32_bf16 v[68:71], a[136:139], a[84:87], v[68:71]
 v_mfma_f32_16x16x32_bf16 v[72:75], a[140:143], a[28:31], v[72:75]
 buffer_load_dwordx4 v1, s[16:19], s44 offen offset:2048 sc1 lds
 v_mfma_f32_16x16x32_bf16 v[76:79], a[140:143], a[84:87], v[76:79]
 ds_read_b128 a[136:139], v1 offset:11264
 ds_read_b128 a[140:143], v1 offset:25600
 s_waitcnt lgkmcnt(6)
 v_mfma_f32_16x16x32_bf16 v[64:67], a[112:115], a[32:35], v[64:67]
 v_mfma_f32_16x16x32_bf16 v[68:71], a[112:115], a[88:91], v[68:71]
 v_mfma_f32_16x16x32_bf16 v[72:75], a[116:119], a[32:35], v[72:75]
 buffer_load_dwordx4 v1, s[16:19], s44 offen offset:3072 sc1 lds
 v_mfma_f32_16x16x32_bf16 v[76:79], a[116:119], a[88:91], v[76:79]
 ds_read_b128 a[112:115], v1 offset:12288
 ds_read_b128 a[116:119], v1 offset:26624
 s_waitcnt lgkmcnt(6)
 v_mfma_f32_16x16x32_bf16 v[64:67], a[120:123], a[36:39], v[64:67]
 s_add_u32 m0, s45, 90112
 s_add_u32 s44, s44, 28672
 v_mfma_f32_16x16x32_bf16 v[68:71], a[120:123], a[92:95], v[68:71]
 v_mfma_f32_16x16x32_bf16 v[72:75], a[124:127], a[36:39], v[72:75]
 buffer_load_dwordx4 v1, s[16:19], s46 offen offset:0 sc1 lds
 v_mfma_f32_16x16x32_bf16 v[76:79], a[124:127], a[92:95], v[76:79]
 ds_read_b128 a[120:123], v1 offset:13312
 ds_read_b128 a[124:127], v1 offset:27648
 s_waitcnt lgkmcnt(6)
 v_mfma_f32_16x16x32_bf16 v[64:67], a[128:131], a[40:43], v[64:67]
 v_mfma_f32_16x16x32_bf16 v[68:71], a[128:131], a[96:99], v[68:71]
 v_mfma_f32_16x16x32_bf16 v[72:75], a[132:135], a[40:43], v[72:75]
 buffer_load_dwordx4 v1, s[16:19], s46 offen offset:1024 sc1 lds
 v_mfma_f32_16x16x32_bf16 v[76:79], a[132:135], a[96:99], v[76:79]
 ds_read_b128 a[128:131], v1 offset:28672
 ds_read_b128 a[132:135], v1 offset:43008
 s_waitcnt lgkmcnt(6)
 v_mfma_f32_16x16x32_bf16 v[64:67], a[136:139], a[44:47], v[64:67]
 v_mfma_f32_16x16x32_bf16 v[68:71], a[136:139], a[100:103], v[68:71]
 v_mfma_f32_16x16x32_bf16 v[72:75], a[140:143], a[44:47], v[72:75]
 buffer_load_dwordx4 v1, s[16:19], s46 offen offset:2048 sc1 lds
 v_mfma_f32_16x16x32_bf16 v[76:79], a[140:143], a[100:103], v[76:79]
 ds_read_b128 a[136:139], v1 offset:29696
 ds_read_b128 a[140:143], v1 offset:44032
 s_waitcnt lgkmcnt(6)
 v_mfma_f32_16x16x32_bf16 v[64:67], a[112:115], a[48:51], v[64:67]
 v_mfma_f32_16x16x32_bf16 v[68:71], a[112:115], a[104:107], v[68:71]
 v_mfma_f32_16x16x32_bf16 v[72:75], a[116:119], a[48:51], v[72:75]
 v_mfma_f32_16x16x32_bf16 v[76:79], a[116:119], a[104:107], v[76:79]
 ds_read_b128 a[112:115], v1 offset:30720
 ds_read_b128 a[116:119], v1 offset:45056
 s_waitcnt lgkmcnt(6)
 v_mfma_f32_16x16x32_bf16 v[64:67], a[120:123], a[52:55], v[64:67]
 v_mfma_f32_16x16x32_bf16 v[68:71], a[120:123], a[108:111], v[68:71]
 v_mfma_f32_16x16x32_bf16 v[72:75], a[124:127], a[52:55], v[72:75]
 v_mfma_f32_16x16x32_bf16 v[76:79], a[124:127], a[108:111], v[76:79]
 ds_read_b128 a[120:123], v1 offset:31744
 ds_read_b128 a[124:127], v1 offset:46080
 s_waitcnt lgkmcnt(6)
 v_mfma_f32_16x16x32_bf16 v[80:83], a[128:131], a[0:3], 0
 v_mfma_f32_16x16x32_bf16 v[84:87], a[128:131], a[56:59], 0
 v_mfma_f32_16x16x32_bf16 v[88:91], a[132:135], a[0:3], 0
 v_mfma_f32_16x16x32_bf16 v[92:95], a[132:135], a[56:59], 0
 ds_read_b128 a[128:131], v1 offset:32768
 ds_read_b128 a[132:135], v1 offset:47104
 s_waitcnt lgkmcnt(6)
 v_mfma_f32_16x16x32_bf16 v[80:83], a[136:139], a[4:7], v[80:83]
 v_mfma_f32_16x16x32_bf16 v[84:87], a[136:139], a[60:63], v[84:87]
 v_mfma_f32_16x16x32_bf16 v[88:91], a[140:143], a[4:7], v[88:91]
 v_mfma_f32_16x16x32_bf16 v[92:95], a[140:143], a[60:63], v[92:95]
 ds_read_b128 a[136:139], v1 offset:33792
 ds_read_b128 a[140:143], v1 offset:48128
 s_waitcnt lgkmcnt(6)
 v_mfma_f32_16x16x32_bf16 v[80:83], a[112:115], a[8:11], v[80:83]
 v_cvt_pk_bf16_f32 v160, v64, v65
 v_mfma_f32_16x16x32_bf16 v[84:87], a[112:115], a[64:67], v[84:87]
 v_cvt_pk_bf16_f32 v162, v66, v67
 v_mfma_f32_16x16x32_bf16 v[88:91], a[116:119], a[8:11], v[88:91]
 v_cvt_pk_bf16_f32 v161, v72, v73
 v_mfma_f32_16x16x32_bf16 v[92:95], a[116:119], a[64:67], v[92:95]
 v_cvt_pk_bf16_f32 v163, v74, v75
 ds_read_b128 a[112:115], v1 offset:34816
 ds_read_b128 a[116:119], v1 offset:49152
 s_waitcnt lgkmcnt(6)
 v_mfma_f32_16x16x32_bf16 v[80:83], a[120:123], a[12:15], v[80:83]
 v_cvt_pk_bf16_f32 v216, v68, v69
 v_mfma_f32_16x16x32_bf16 v[84:87], a[120:123], a[68:71], v[84:87]
 v_cvt_pk_bf16_f32 v218, v70, v71
 v_mfma_f32_16x16x32_bf16 v[88:91], a[124:127], a[12:15], v[88:91]
 v_cvt_pk_bf16_f32 v217, v76, v77
 v_mfma_f32_16x16x32_bf16 v[92:95], a[124:127], a[68:71], v[92:95]
 v_cvt_pk_bf16_f32 v219, v78, v79
 ds_read_b128 a[120:123], v1 offset:35840
 ds_read_b128 a[124:127], v1 offset:50176
 s_waitcnt lgkmcnt(6)
 v_mfma_f32_16x16x32_bf16 v[80:83], a[128:131], a[16:19], v[80:83]
 v_mfma_f32_16x16x32_bf16 v[96:99], a[32:35], v[160:163], v[96:99]
 v_mfma_f32_16x16x32_bf16 v[84:87], a[128:131], a[72:75], v[84:87]
 v_mfma_f32_16x16x32_bf16 v[100:103], a[32:35], v[216:219], v[100:103]
 v_mfma_f32_16x16x32_bf16 v[88:91], a[132:135], a[16:19], v[88:91]
 v_mfma_f32_16x16x32_bf16 v[104:107], a[88:91], v[216:219], v[104:107]
 v_mfma_f32_16x16x32_bf16 v[92:95], a[132:135], a[72:75], v[92:95]
 s_waitcnt vmcnt(7)
 s_barrier
 ds_read_b128 a[128:131], v1 offset:36864
 ds_read_b128 a[132:135], v1 offset:51200
 s_waitcnt lgkmcnt(6)
 v_mfma_f32_16x16x32_bf16 v[80:83], a[136:139], a[20:23], v[80:83]
 s_add_u32 m0, s45, 0
 s_add_u32 s46, s44, 4096
 v_mfma_f32_16x16x32_bf16 v[84:87], a[136:139], a[76:79], v[84:87]
 v_mfma_f32_16x16x32_bf16 v[88:91], a[140:143], a[20:23], v[88:91]
 buffer_load_dwordx4 v1, s[16:19], s44 offen offset:0 sc1 lds
 v_mfma_f32_16x16x32_bf16 v[92:95], a[140:143], a[76:79], v[92:95]
 ds_read_b128 a[136:139], v1 offset:37888
 ds_read_b128 a[140:143], v1 offset:52224
 s_waitcnt lgkmcnt(6)
 v_mfma_f32_16x16x32_bf16 v[80:83], a[112:115], a[24:27], v[80:83]
 v_mfma_f32_16x16x32_bf16 v[84:87], a[112:115], a[80:83], v[84:87]
 v_mfma_f32_16x16x32_bf16 v[88:91], a[116:119], a[24:27], v[88:91]
 buffer_load_dwordx4 v1, s[16:19], s44 offen offset:1024 sc1 lds
 v_mfma_f32_16x16x32_bf16 v[92:95], a[116:119], a[80:83], v[92:95]
 ds_read_b128 a[112:115], v1 offset:38912
 ds_read_b128 a[116:119], v1 offset:53248
 s_waitcnt lgkmcnt(6)
 v_mfma_f32_16x16x32_bf16 v[80:83], a[120:123], a[28:31], v[80:83]
 v_mfma_f32_16x16x32_bf16 v[84:87], a[120:123], a[84:87], v[84:87]
 v_mfma_f32_16x16x32_bf16 v[88:91], a[124:127], a[28:31], v[88:91]
 buffer_load_dwordx4 v1, s[16:19], s44 offen offset:2048 sc1 lds
 v_mfma_f32_16x16x32_bf16 v[92:95], a[124:127], a[84:87], v[92:95]
 ds_read_b128 a[120:123], v1 offset:39936
 ds_read_b128 a[124:127], v1 offset:54272
 s_waitcnt lgkmcnt(6)
 v_mfma_f32_16x16x32_bf16 v[80:83], a[128:131], a[32:35], v[80:83]
 v_mfma_f32_16x16x32_bf16 v[84:87], a[128:131], a[88:91], v[84:87]
 v_mfma_f32_16x16x32_bf16 v[88:91], a[132:135], a[32:35], v[88:91]
 buffer_load_dwordx4 v1, s[16:19], s44 offen offset:3072 sc1 lds
 v_mfma_f32_16x16x32_bf16 v[92:95], a[132:135], a[88:91], v[92:95]
 ds_read_b128 a[128:131], v1 offset:40960
 ds_read_b128 a[132:135], v1 offset:55296
 s_waitcnt lgkmcnt(6)
 v_mfma_f32_16x16x32_bf16 v[80:83], a[136:139], a[36:39], v[80:83]
 s_add_u32 m0, s45, 4096
 s_add_u32 s44, s44, 28672
 v_mfma_f32_16x16x32_bf16 v[84:87], a[136:139], a[92:95], v[84:87]
 v_mfma_f32_16x16x32_bf16 v[88:91], a[140:143], a[36:39], v[88:91]
 buffer_load_dwordx4 v1, s[16:19], s46 offen offset:0 sc1 lds
 v_mfma_f32_16x16x32_bf16 v[92:95], a[140:143], a[92:95], v[92:95]
 ds_read_b128 a[136:139], v1 offset:41984
 ds_read_b128 a[140:143], v1 offset:56320
 s_waitcnt lgkmcnt(6)
 v_mfma_f32_16x16x32_bf16 v[80:83], a[112:115], a[40:43], v[80:83]
 v_mfma_f32_16x16x32_bf16 v[84:87], a[112:115], a[96:99], v[84:87]
 v_mfma_f32_16x16x32_bf16 v[88:91], a[116:119], a[40:43], v[88:91]
 buffer_load_dwordx4 v1, s[16:19], s46 offen offset:1024 sc1 lds
 v_mfma_f32_16x16x32_bf16 v[92:95], a[116:119], a[96:99], v[92:95]
 ds_read_b128 a[112:115], v2 offset:0
 ds_read_b128 a[116:119], v2 offset:14336
 s_waitcnt lgkmcnt(6)
 v_mfma_f32_16x16x32_bf16 v[80:83], a[120:123], a[44:47], v[80:83]
 v_mfma_f32_16x16x32_bf16 v[84:87], a[120:123], a[100:103], v[84:87]
 v_mfma_f32_16x16x32_bf16 v[88:91], a[124:127], a[44:47], v[88:91]
 buffer_load_dwordx4 v1, s[16:19], s46 offen offset:2048 sc1 lds
 v_mfma_f32_16x16x32_bf16 v[92:95], a[124:127], a[100:103], v[92:95]
 ds_read_b128 a[120:123], v2 offset:1024
 ds_read_b128 a[124:127], v2 offset:15360
 s_waitcnt lgkmcnt(6)
 v_mfma_f32_16x16x32_bf16 v[80:83], a[128:131], a[48:51], v[80:83]
 v_mfma_f32_16x16x32_bf16 v[84:87], a[128:131], a[104:107], v[84:87]
 v_mfma_f32_16x16x32_bf16 v[88:91], a[132:135], a[48:51], v[88:91]
 v_mfma_f32_16x16x32_bf16 v[92:95], a[132:135], a[104:107], v[92:95]
 ds_read_b128 a[128:131], v2 offset:2048
 ds_read_b128 a[132:135], v2 offset:16384
 s_waitcnt lgkmcnt(6)
 v_mfma_f32_16x16x32_bf16 v[80:83], a[136:139], a[52:55], v[80:83]
 v_mfma_f32_16x16x32_bf16 v[84:87], a[136:139], a[108:111], v[84:87]
 v_mfma_f32_16x16x32_bf16 v[88:91], a[140:143], a[52:55], v[88:91]
 v_mfma_f32_16x16x32_bf16 v[92:95], a[140:143], a[108:111], v[92:95]
 ds_read_b128 a[136:139], v2 offset:3072
 ds_read_b128 a[140:143], v2 offset:17408
 s_waitcnt lgkmcnt(6)
 v_mfma_f32_16x16x32_bf16 v[64:67], a[112:115], a[0:3], 0
 v_mfma_f32_16x16x32_bf16 v[68:71], a[112:115], a[56:59], 0
 v_mfma_f32_16x16x32_bf16 v[72:75], a[116:119], a[0:3], 0
 v_mfma_f32_16x16x32_bf16 v[76:79], a[116:119], a[56:59], 0
 ds_read_b128 a[112:115], v2 offset:4096
 ds_read_b128 a[116:119], v2 offset:18432
 s_waitcnt lgkmcnt(6)
 v_mfma_f32_16x16x32_bf16 v[64:67], a[120:123], a[4:7], v[64:67]
 v_mfma_f32_16x16x32_bf16 v[68:71], a[120:123], a[60:63], v[68:71]
 v_mfma_f32_16x16x32_bf16 v[72:75], a[124:127], a[4:7], v[72:75]
 v_mfma_f32_16x16x32_bf16 v[76:79], a[124:127], a[60:63], v[76:79]
 ds_read_b128 a[120:123], v2 offset:5120
 ds_read_b128 a[124:127], v2 offset:19456
 s_waitcnt lgkmcnt(6)
 v_mfma_f32_16x16x32_bf16 v[64:67], a[128:131], a[8:11], v[64:67]
 v_cvt_pk_bf16_f32 v164, v80, v81
 v_mfma_f32_16x16x32_bf16 v[68:71], a[128:131], a[64:67], v[68:71]
 v_cvt_pk_bf16_f32 v166, v82, v83
 v_mfma_f32_16x16x32_bf16 v[72:75], a[132:135], a[8:11], v[72:75]
 v_cvt_pk_bf16_f32 v165, v88, v89
 v_mfma_f32_16x16x32_bf16 v[76:79], a[132:135], a[64:67], v[76:79]
 v_cvt_pk_bf16_f32 v167, v90, v91
 ds_read_b128 a[128:131], v2 offset:6144
 ds_read_b128 a[132:135], v2 offset:20480
 s_waitcnt lgkmcnt(6)
 v_mfma_f32_16x16x32_bf16 v[64:67], a[136:139], a[12:15], v[64:67]
 v_cvt_pk_bf16_f32 v220, v84, v85
 v_mfma_f32_16x16x32_bf16 v[68:71], a[136:139], a[68:71], v[68:71]
 v_cvt_pk_bf16_f32 v222, v86, v87
 v_mfma_f32_16x16x32_bf16 v[72:75], a[140:143], a[12:15], v[72:75]
 v_cvt_pk_bf16_f32 v221, v92, v93
 v_mfma_f32_16x16x32_bf16 v[76:79], a[140:143], a[68:71], v[76:79]
 v_cvt_pk_bf16_f32 v223, v94, v95
 ds_read_b128 a[136:139], v2 offset:7168
 ds_read_b128 a[140:143], v2 offset:21504
 s_waitcnt lgkmcnt(6)
 v_mfma_f32_16x16x32_bf16 v[64:67], a[112:115], a[16:19], v[64:67]
 v_mfma_f32_16x16x32_bf16 v[96:99], a[36:39], v[164:167], v[96:99]
 v_mfma_f32_16x16x32_bf16 v[68:71], a[112:115], a[72:75], v[68:71]
 v_mfma_f32_16x16x32_bf16 v[100:103], a[36:39], v[220:223], v[100:103]
 v_mfma_f32_16x16x32_bf16 v[72:75], a[116:119], a[16:19], v[72:75]
 v_mfma_f32_16x16x32_bf16 v[104:107], a[92:95], v[220:223], v[104:107]
 v_mfma_f32_16x16x32_bf16 v[76:79], a[116:119], a[72:75], v[76:79]
 s_waitcnt vmcnt(7)
 s_barrier
 ds_read_b128 a[112:115], v2 offset:8192
 ds_read_b128 a[116:119], v2 offset:22528
 s_waitcnt lgkmcnt(6)
 v_mfma_f32_16x16x32_bf16 v[64:67], a[120:123], a[20:23], v[64:67]
 s_add_u32 m0, s45, 28672
 s_add_u32 s46, s44, 4096
 v_mfma_f32_16x16x32_bf16 v[68:71], a[120:123], a[76:79], v[68:71]
 v_mfma_f32_16x16x32_bf16 v[72:75], a[124:127], a[20:23], v[72:75]
 buffer_load_dwordx4 v1, s[16:19], s44 offen offset:0 sc1 lds
 v_mfma_f32_16x16x32_bf16 v[76:79], a[124:127], a[76:79], v[76:79]
 ds_read_b128 a[120:123], v2 offset:9216
 ds_read_b128 a[124:127], v2 offset:23552
 s_waitcnt lgkmcnt(6)
 v_mfma_f32_16x16x32_bf16 v[64:67], a[128:131], a[24:27], v[64:67]
 v_mfma_f32_16x16x32_bf16 v[68:71], a[128:131], a[80:83], v[68:71]
 v_mfma_f32_16x16x32_bf16 v[72:75], a[132:135], a[24:27], v[72:75]
 buffer_load_dwordx4 v1, s[16:19], s44 offen offset:1024 sc1 lds
 v_mfma_f32_16x16x32_bf16 v[76:79], a[132:135], a[80:83], v[76:79]
 ds_read_b128 a[128:131], v2 offset:10240
 ds_read_b128 a[132:135], v2 offset:24576
 s_waitcnt lgkmcnt(6)
 v_mfma_f32_16x16x32_bf16 v[64:67], a[136:139], a[28:31], v[64:67]
 v_mfma_f32_16x16x32_bf16 v[68:71], a[136:139], a[84:87], v[68:71]
 v_mfma_f32_16x16x32_bf16 v[72:75], a[140:143], a[28:31], v[72:75]
 buffer_load_dwordx4 v1, s[16:19], s44 offen offset:2048 sc1 lds
 v_mfma_f32_16x16x32_bf16 v[76:79], a[140:143], a[84:87], v[76:79]
 ds_read_b128 a[136:139], v2 offset:11264
 ds_read_b128 a[140:143], v2 offset:25600
 s_waitcnt lgkmcnt(6)
 v_mfma_f32_16x16x32_bf16 v[64:67], a[112:115], a[32:35], v[64:67]
 v_mfma_f32_16x16x32_bf16 v[68:71], a[112:115], a[88:91], v[68:71]
 v_mfma_f32_16x16x32_bf16 v[72:75], a[116:119], a[32:35], v[72:75]
 buffer_load_dwordx4 v1, s[16:19], s44 offen offset:3072 sc1 lds
 v_mfma_f32_16x16x32_bf16 v[76:79], a[116:119], a[88:91], v[76:79]
 ds_read_b128 a[112:115], v2 offset:12288
 ds_read_b128 a[116:119], v2 offset:26624
 s_waitcnt lgkmcnt(6)
 v_mfma_f32_16x16x32_bf16 v[64:67], a[120:123], a[36:39], v[64:67]
 s_add_u32 m0, s45, 32768
 s_add_u32 s44, s44, 28672
 v_mfma_f32_16x16x32_bf16 v[68:71], a[120:123], a[92:95], v[68:71]
 v_mfma_f32_16x16x32_bf16 v[72:75], a[124:127], a[36:39], v[72:75]
 buffer_load_dwordx4 v1, s[16:19], s46 offen offset:0 sc1 lds
 v_mfma_f32_16x16x32_bf16 v[76:79], a[124:127], a[92:95], v[76:79]
 ds_read_b128 a[120:123], v2 offset:13312
 ds_read_b128 a[124:127], v2 offset:27648
 s_waitcnt lgkmcnt(6)
 v_mfma_f32_16x16x32_bf16 v[64:67], a[128:131], a[40:43], v[64:67]
 v_mfma_f32_16x16x32_bf16 v[68:71], a[128:131], a[96:99], v[68:71]
 v_mfma_f32_16x16x32_bf16 v[72:75], a[132:135], a[40:43], v[72:75]
 buffer_load_dwordx4 v1, s[16:19], s46 offen offset:1024 sc1 lds
 v_mfma_f32_16x16x32_bf16 v[76:79], a[132:135], a[96:99], v[76:79]
 ds_read_b128 a[128:131], v2 offset:28672
 ds_read_b128 a[132:135], v2 offset:43008
 s_waitcnt lgkmcnt(6)
 v_mfma_f32_16x16x32_bf16 v[64:67], a[136:139], a[44:47], v[64:67]
 v_mfma_f32_16x16x32_bf16 v[68:71], a[136:139], a[100:103], v[68:71]
 v_mfma_f32_16x16x32_bf16 v[72:75], a[140:143], a[44:47], v[72:75]
 buffer_load_dwordx4 v1, s[16:19], s46 offen offset:2048 sc1 lds
 v_mfma_f32_16x16x32_bf16 v[76:79], a[140:143], a[100:103], v[76:79]
 ds_read_b128 a[136:139], v2 offset:29696
 ds_read_b128 a[140:143], v2 offset:44032
 s_waitcnt lgkmcnt(6)
 v_mfma_f32_16x16x32_bf16 v[64:67], a[112:115], a[48:51], v[64:67]
 v_mfma_f32_16x16x32_bf16 v[68:71], a[112:115], a[104:107], v[68:71]
 v_mfma_f32_16x16x32_bf16 v[72:75], a[116:119], a[48:51], v[72:75]
 v_mfma_f32_16x16x32_bf16 v[76:79], a[116:119], a[104:107], v[76:79]
 ds_read_b128 a[112:115], v2 offset:30720
 ds_read_b128 a[116:119], v2 offset:45056
 s_waitcnt lgkmcnt(6)
 v_mfma_f32_16x16x32_bf16 v[64:67], a[120:123], a[52:55], v[64:67]
 v_mfma_f32_16x16x32_bf16 v[68:71], a[120:123], a[108:111], v[68:71]
 v_mfma_f32_16x16x32_bf16 v[72:75], a[124:127], a[52:55], v[72:75]
 v_mfma_f32_16x16x32_bf16 v[76:79], a[124:127], a[108:111], v[76:79]
 ds_read_b128 a[120:123], v2 offset:31744
 ds_read_b128 a[124:127], v2 offset:46080
 s_waitcnt lgkmcnt(6)
 v_mfma_f32_16x16x32_bf16 v[80:83], a[128:131], a[0:3], 0
 v_mfma_f32_16x16x32_bf16 v[84:87], a[128:131], a[56:59], 0
 v_mfma_f32_16x16x32_bf16 v[88:91], a[132:135], a[0:3], 0
 v_mfma_f32_16x16x32_bf16 v[92:95], a[132:135], a[56:59], 0
 ds_read_b128 a[128:131], v2 offset:32768
 ds_read_b128 a[132:135], v2 offset:47104
 s_waitcnt lgkmcnt(6)
 v_mfma_f32_16x16x32_bf16 v[80:83], a[136:139], a[4:7], v[80:83]
 v_mfma_f32_16x16x32_bf16 v[84:87], a[136:139], a[60:63], v[84:87]
 v_mfma_f32_16x16x32_bf16 v[88:91], a[140:143], a[4:7], v[88:91]
 v_mfma_f32_16x16x32_bf16 v[92:95], a[140:143], a[60:63], v[92:95]
 ds_read_b128 a[136:139], v2 offset:33792
 ds_read_b128 a[140:143], v2 offset:48128
 s_waitcnt lgkmcnt(6)
 v_mfma_f32_16x16x32_bf16 v[80:83], a[112:115], a[8:11], v[80:83]
 v_cvt_pk_bf16_f32 v168, v64, v65
 v_mfma_f32_16x16x32_bf16 v[84:87], a[112:115], a[64:67], v[84:87]
 v_cvt_pk_bf16_f32 v170, v66, v67
 v_mfma_f32_16x16x32_bf16 v[88:91], a[116:119], a[8:11], v[88:91]
 v_cvt_pk_bf16_f32 v169, v72, v73
 v_mfma_f32_16x16x32_bf16 v[92:95], a[116:119], a[64:67], v[92:95]
 v_cvt_pk_bf16_f32 v171, v74, v75
 ds_read_b128 a[112:115], v2 offset:34816
 ds_read_b128 a[116:119], v2 offset:49152
 s_waitcnt lgkmcnt(6)
 v_mfma_f32_16x16x32_bf16 v[80:83], a[120:123], a[12:15], v[80:83]
 v_cvt_pk_bf16_f32 v224, v68, v69
 v_mfma_f32_16x16x32_bf16 v[84:87], a[120:123], a[68:71], v[84:87]
 v_cvt_pk_bf16_f32 v226, v70, v71
 v_mfma_f32_16x16x32_bf16 v[88:91], a[124:127], a[12:15], v[88:91]
 v_cvt_pk_bf16_f32 v225, v76, v77
 v_mfma_f32_16x16x32_bf16 v[92:95], a[124:127], a[68:71], v[92:95]
 v_cvt_pk_bf16_f32 v227, v78, v79
 ds_read_b128 a[120:123], v2 offset:35840
 ds_read_b128 a[124:127], v2 offset:50176
 s_waitcnt lgkmcnt(6)
 v_mfma_f32_16x16x32_bf16 v[80:83], a[128:131], a[16:19], v[80:83]
 v_mfma_f32_16x16x32_bf16 v[96:99], a[40:43], v[168:171], v[96:99]
 v_mfma_f32_16x16x32_bf16 v[84:87], a[128:131], a[72:75], v[84:87]
 v_mfma_f32_16x16x32_bf16 v[100:103], a[40:43], v[224:227], v[100:103]
 v_mfma_f32_16x16x32_bf16 v[88:91], a[132:135], a[16:19], v[88:91]
 v_mfma_f32_16x16x32_bf16 v[104:107], a[96:99], v[224:227], v[104:107]
 v_mfma_f32_16x16x32_bf16 v[92:95], a[132:135], a[72:75], v[92:95]
 s_waitcnt vmcnt(7)
 s_barrier
 ds_read_b128 a[128:131], v2 offset:36864
 ds_read_b128 a[132:135], v2 offset:51200
 s_waitcnt lgkmcnt(6)
 v_mfma_f32_16x16x32_bf16 v[80:83], a[136:139], a[20:23], v[80:83]
 v_mfma_f32_16x16x32_bf16 v[84:87], a[136:139], a[76:79], v[84:87]
 v_mfma_f32_16x16x32_bf16 v[88:91], a[140:143], a[20:23], v[88:91]
 v_mfma_f32_16x16x32_bf16 v[92:95], a[140:143], a[76:79], v[92:95]
 ds_read_b128 a[136:139], v2 offset:37888
 ds_read_b128 a[140:143], v2 offset:52224
 s_waitcnt lgkmcnt(6)
 v_mfma_f32_16x16x32_bf16 v[80:83], a[112:115], a[24:27], v[80:83]
 v_mfma_f32_16x16x32_bf16 v[84:87], a[112:115], a[80:83], v[84:87]
 v_mfma_f32_16x16x32_bf16 v[88:91], a[116:119], a[24:27], v[88:91]
 v_mfma_f32_16x16x32_bf16 v[92:95], a[116:119], a[80:83], v[92:95]
 ds_read_b128 a[112:115], v2 offset:38912
 ds_read_b128 a[116:119], v2 offset:53248
 s_waitcnt lgkmcnt(6)
 v_mfma_f32_16x16x32_bf16 v[80:83], a[120:123], a[28:31], v[80:83]
 v_mfma_f32_16x16x32_bf16 v[84:87], a[120:123], a[84:87], v[84:87]
 v_mfma_f32_16x16x32_bf16 v[88:91], a[124:127], a[28:31], v[88:91]
 v_mfma_f32_16x16x32_bf16 v[92:95], a[124:127], a[84:87], v[92:95]
 ds_read_b128 a[120:123], v2 offset:39936
 ds_read_b128 a[124:127], v2 offset:54272
 s_waitcnt lgkmcnt(6)
 v_mfma_f32_16x16x32_bf16 v[80:83], a[128:131], a[32:35], v[80:83]
 v_mfma_f32_16x16x32_bf16 v[84:87], a[128:131], a[88:91], v[84:87]
 v_mfma_f32_16x16x32_bf16 v[88:91], a[132:135], a[32:35], v[88:91]
 v_mfma_f32_16x16x32_bf16 v[92:95], a[132:135], a[88:91], v[92:95]
 ds_read_b128 a[128:131], v2 offset:40960
 ds_read_b128 a[132:135], v2 offset:55296
 s_waitcnt lgkmcnt(6)
 v_mfma_f32_16x16x32_bf16 v[80:83], a[136:139], a[36:39], v[80:83]
 v_mfma_f32_16x16x32_bf16 v[84:87], a[136:139], a[92:95], v[84:87]
 v_mfma_f32_16x16x32_bf16 v[88:91], a[140:143], a[36:39], v[88:91]
 v_mfma_f32_16x16x32_bf16 v[92:95], a[140:143], a[92:95], v[92:95]
 ds_read_b128 a[136:139], v2 offset:41984
 ds_read_b128 a[140:143], v2 offset:56320
 s_waitcnt lgkmcnt(6)
 v_mfma_f32_16x16x32_bf16 v[80:83], a[112:115], a[40:43], v[80:83]
 v_mfma_f32_16x16x32_bf16 v[84:87], a[112:115], a[96:99], v[84:87]
 v_mfma_f32_16x16x32_bf16 v[88:91], a[116:119], a[40:43], v[88:91]
 v_mfma_f32_16x16x32_bf16 v[92:95], a[116:119], a[96:99], v[92:95]
 ds_read_b128 a[112:115], v1 offset:0
 ds_read_b128 a[116:119], v1 offset:14336
 s_waitcnt lgkmcnt(6)
 v_mfma_f32_16x16x32_bf16 v[80:83], a[120:123], a[44:47], v[80:83]
 v_mfma_f32_16x16x32_bf16 v[84:87], a[120:123], a[100:103], v[84:87]
 v_mfma_f32_16x16x32_bf16 v[88:91], a[124:127], a[44:47], v[88:91]
 v_mfma_f32_16x16x32_bf16 v[92:95], a[124:127], a[100:103], v[92:95]
 ds_read_b128 a[120:123], v1 offset:1024
 ds_read_b128 a[124:127], v1 offset:15360
 s_waitcnt lgkmcnt(6)
 v_mfma_f32_16x16x32_bf16 v[80:83], a[128:131], a[48:51], v[80:83]
 v_mfma_f32_16x16x32_bf16 v[84:87], a[128:131], a[104:107], v[84:87]
 v_mfma_f32_16x16x32_bf16 v[88:91], a[132:135], a[48:51], v[88:91]
 v_mfma_f32_16x16x32_bf16 v[92:95], a[132:135], a[104:107], v[92:95]
 ds_read_b128 a[128:131], v1 offset:2048
 ds_read_b128 a[132:135], v1 offset:16384
 s_waitcnt lgkmcnt(6)
 v_mfma_f32_16x16x32_bf16 v[80:83], a[136:139], a[52:55], v[80:83]
 v_mfma_f32_16x16x32_bf16 v[84:87], a[136:139], a[108:111], v[84:87]
 v_mfma_f32_16x16x32_bf16 v[88:91], a[140:143], a[52:55], v[88:91]
 v_mfma_f32_16x16x32_bf16 v[92:95], a[140:143], a[108:111], v[92:95]
 ds_read_b128 a[136:139], v1 offset:3072
 ds_read_b128 a[140:143], v1 offset:17408
 s_waitcnt lgkmcnt(6)
 v_mfma_f32_16x16x32_bf16 v[64:67], a[112:115], a[0:3], 0
 v_mfma_f32_16x16x32_bf16 v[68:71], a[112:115], a[56:59], 0
 v_mfma_f32_16x16x32_bf16 v[72:75], a[116:119], a[0:3], 0
 v_mfma_f32_16x16x32_bf16 v[76:79], a[116:119], a[56:59], 0
 ds_read_b128 a[112:115], v1 offset:4096
 ds_read_b128 a[116:119], v1 offset:18432
 s_waitcnt lgkmcnt(6)
 v_mfma_f32_16x16x32_bf16 v[64:67], a[120:123], a[4:7], v[64:67]
 v_mfma_f32_16x16x32_bf16 v[68:71], a[120:123], a[60:63], v[68:71]
 v_mfma_f32_16x16x32_bf16 v[72:75], a[124:127], a[4:7], v[72:75]
 v_mfma_f32_16x16x32_bf16 v[76:79], a[124:127], a[60:63], v[76:79]
 ds_read_b128 a[120:123], v1 offset:5120
 ds_read_b128 a[124:127], v1 offset:19456
 s_waitcnt lgkmcnt(6)
 v_mfma_f32_16x16x32_bf16 v[64:67], a[128:131], a[8:11], v[64:67]
 v_cvt_pk_bf16_f32 v172, v80, v81
 v_mfma_f32_16x16x32_bf16 v[68:71], a[128:131], a[64:67], v[68:71]
 v_cvt_pk_bf16_f32 v174, v82, v83
 v_mfma_f32_16x16x32_bf16 v[72:75], a[132:135], a[8:11], v[72:75]
 v_cvt_pk_bf16_f32 v173, v88, v89
 v_mfma_f32_16x16x32_bf16 v[76:79], a[132:135], a[64:67], v[76:79]
 v_cvt_pk_bf16_f32 v175, v90, v91
 ds_read_b128 a[128:131], v1 offset:6144
 ds_read_b128 a[132:135], v1 offset:20480
 s_waitcnt lgkmcnt(6)
 v_mfma_f32_16x16x32_bf16 v[64:67], a[136:139], a[12:15], v[64:67]
 v_cvt_pk_bf16_f32 v228, v84, v85
 v_mfma_f32_16x16x32_bf16 v[68:71], a[136:139], a[68:71], v[68:71]
 v_cvt_pk_bf16_f32 v230, v86, v87
 v_mfma_f32_16x16x32_bf16 v[72:75], a[140:143], a[12:15], v[72:75]
 v_cvt_pk_bf16_f32 v229, v92, v93
 v_mfma_f32_16x16x32_bf16 v[76:79], a[140:143], a[68:71], v[76:79]
 v_cvt_pk_bf16_f32 v231, v94, v95
 ds_read_b128 a[136:139], v1 offset:7168
 ds_read_b128 a[140:143], v1 offset:21504
 s_waitcnt lgkmcnt(6)
 v_mfma_f32_16x16x32_bf16 v[64:67], a[112:115], a[16:19], v[64:67]
 v_mfma_f32_16x16x32_bf16 v[96:99], a[44:47], v[172:175], v[96:99]
 v_mfma_f32_16x16x32_bf16 v[68:71], a[112:115], a[72:75], v[68:71]
 v_mfma_f32_16x16x32_bf16 v[100:103], a[44:47], v[228:231], v[100:103]
 v_mfma_f32_16x16x32_bf16 v[72:75], a[116:119], a[16:19], v[72:75]
 v_mfma_f32_16x16x32_bf16 v[104:107], a[100:103], v[228:231], v[104:107]
 v_mfma_f32_16x16x32_bf16 v[76:79], a[116:119], a[72:75], v[76:79]
 s_waitcnt vmcnt(0)
 s_barrier
 ds_read_b128 a[112:115], v1 offset:8192
 ds_read_b128 a[116:119], v1 offset:22528
 s_waitcnt lgkmcnt(6)
 v_mfma_f32_16x16x32_bf16 v[64:67], a[120:123], a[20:23], v[64:67]
 v_mfma_f32_16x16x32_bf16 v[68:71], a[120:123], a[76:79], v[68:71]
 v_mfma_f32_16x16x32_bf16 v[72:75], a[124:127], a[20:23], v[72:75]
 v_mfma_f32_16x16x32_bf16 v[76:79], a[124:127], a[76:79], v[76:79]
 ds_read_b128 a[120:123], v1 offset:9216
 ds_read_b128 a[124:127], v1 offset:23552
 s_waitcnt lgkmcnt(6)
 v_mfma_f32_16x16x32_bf16 v[64:67], a[128:131], a[24:27], v[64:67]
 v_mfma_f32_16x16x32_bf16 v[68:71], a[128:131], a[80:83], v[68:71]
 v_mfma_f32_16x16x32_bf16 v[72:75], a[132:135], a[24:27], v[72:75]
 v_mfma_f32_16x16x32_bf16 v[76:79], a[132:135], a[80:83], v[76:79]
 ds_read_b128 a[128:131], v1 offset:10240
 ds_read_b128 a[132:135], v1 offset:24576
 s_waitcnt lgkmcnt(6)
 v_mfma_f32_16x16x32_bf16 v[64:67], a[136:139], a[28:31], v[64:67]
 v_mfma_f32_16x16x32_bf16 v[68:71], a[136:139], a[84:87], v[68:71]
 v_mfma_f32_16x16x32_bf16 v[72:75], a[140:143], a[28:31], v[72:75]
 v_mfma_f32_16x16x32_bf16 v[76:79], a[140:143], a[84:87], v[76:79]
 ds_read_b128 a[136:139], v1 offset:11264
 ds_read_b128 a[140:143], v1 offset:25600
 s_waitcnt lgkmcnt(6)
 v_mfma_f32_16x16x32_bf16 v[64:67], a[112:115], a[32:35], v[64:67]
 v_mfma_f32_16x16x32_bf16 v[68:71], a[112:115], a[88:91], v[68:71]
 v_mfma_f32_16x16x32_bf16 v[72:75], a[116:119], a[32:35], v[72:75]
 v_mfma_f32_16x16x32_bf16 v[76:79], a[116:119], a[88:91], v[76:79]
 ds_read_b128 a[112:115], v1 offset:12288
 ds_read_b128 a[116:119], v1 offset:26624
 s_waitcnt lgkmcnt(6)
 v_mfma_f32_16x16x32_bf16 v[64:67], a[120:123], a[36:39], v[64:67]
 v_mfma_f32_16x16x32_bf16 v[68:71], a[120:123], a[92:95], v[68:71]
 v_mfma_f32_16x16x32_bf16 v[72:75], a[124:127], a[36:39], v[72:75]
 v_mfma_f32_16x16x32_bf16 v[76:79], a[124:127], a[92:95], v[76:79]
 ds_read_b128 a[120:123], v1 offset:13312
 ds_read_b128 a[124:127], v1 offset:27648
 s_waitcnt lgkmcnt(6)
 v_mfma_f32_16x16x32_bf16 v[64:67], a[128:131], a[40:43], v[64:67]
 v_mfma_f32_16x16x32_bf16 v[68:71], a[128:131], a[96:99], v[68:71]
 v_mfma_f32_16x16x32_bf16 v[72:75], a[132:135], a[40:43], v[72:75]
 v_mfma_f32_16x16x32_bf16 v[76:79], a[132:135], a[96:99], v[76:79]
 ds_read_b128 a[128:131], v1 offset:28672
 ds_read_b128 a[132:135], v1 offset:43008
 s_waitcnt lgkmcnt(6)
 v_mfma_f32_16x16x32_bf16 v[64:67], a[136:139], a[44:47], v[64:67]
 v_mfma_f32_16x16x32_bf16 v[68:71], a[136:139], a[100:103], v[68:71]
 v_mfma_f32_16x16x32_bf16 v[72:75], a[140:143], a[44:47], v[72:75]
 v_mfma_f32_16x16x32_bf16 v[76:79], a[140:143], a[100:103], v[76:79]
 ds_read_b128 a[136:139], v1 offset:29696
 ds_read_b128 a[140:143], v1 offset:44032
 s_waitcnt lgkmcnt(6)
 v_mfma_f32_16x16x32_bf16 v[64:67], a[112:115], a[48:51], v[64:67]
 v_mfma_f32_16x16x32_bf16 v[68:71], a[112:115], a[104:107], v[68:71]
 v_mfma_f32_16x16x32_bf16 v[72:75], a[116:119], a[48:51], v[72:75]
 v_mfma_f32_16x16x32_bf16 v[76:79], a[116:119], a[104:107], v[76:79]
 ds_read_b128 a[112:115], v1 offset:30720
 ds_read_b128 a[116:119], v1 offset:45056
 s_waitcnt lgkmcnt(6)
 v_mfma_f32_16x16x32_bf16 v[64:67], a[120:123], a[52:55], v[64:67]
 v_mfma_f32_16x16x32_bf16 v[68:71], a[120:123], a[108:111], v[68:71]
 v_mfma_f32_16x16x32_bf16 v[72:75], a[124:127], a[52:55], v[72:75]
 v_mfma_f32_16x16x32_bf16 v[76:79], a[124:127], a[108:111], v[76:79]
 ds_read_b128 a[120:123], v1 offset:31744
 ds_read_b128 a[124:127], v1 offset:46080
 s_waitcnt lgkmcnt(6)
 v_mfma_f32_16x16x32_bf16 v[80:83], a[128:131], a[0:3], 0
 v_mfma_f32_16x16x32_bf16 v[84:87], a[128:131], a[56:59], 0
 v_mfma_f32_16x16x32_bf16 v[88:91], a[132:135], a[0:3], 0
 v_mfma_f32_16x16x32_bf16 v[92:95], a[132:135], a[56:59], 0
 ds_read_b128 a[128:131], v1 offset:32768
 ds_read_b128 a[132:135], v1 offset:47104
 s_waitcnt lgkmcnt(6)
 v_mfma_f32_16x16x32_bf16 v[80:83], a[136:139], a[4:7], v[80:83]
 v_mfma_f32_16x16x32_bf16 v[84:87], a[136:139], a[60:63], v[84:87]
 v_mfma_f32_16x16x32_bf16 v[88:91], a[140:143], a[4:7], v[88:91]
 v_mfma_f32_16x16x32_bf16 v[92:95], a[140:143], a[60:63], v[92:95]
 ds_read_b128 a[136:139], v1 offset:33792
 ds_read_b128 a[140:143], v1 offset:48128
 s_waitcnt lgkmcnt(6)
 v_mfma_f32_16x16x32_bf16 v[80:83], a[112:115], a[8:11], v[80:83]
 v_cvt_pk_bf16_f32 v176, v64, v65
 v_mfma_f32_16x16x32_bf16 v[84:87], a[112:115], a[64:67], v[84:87]
 v_cvt_pk_bf16_f32 v178, v66, v67
 v_mfma_f32_16x16x32_bf16 v[88:91], a[116:119], a[8:11], v[88:91]
 v_cvt_pk_bf16_f32 v177, v72, v73
 v_mfma_f32_16x16x32_bf16 v[92:95], a[116:119], a[64:67], v[92:95]
 v_cvt_pk_bf16_f32 v179, v74, v75
 ds_read_b128 a[112:115], v1 offset:34816
 ds_read_b128 a[116:119], v1 offset:49152
 s_waitcnt lgkmcnt(6)
 v_mfma_f32_16x16x32_bf16 v[80:83], a[120:123], a[12:15], v[80:83]
 v_cvt_pk_bf16_f32 v232, v68, v69
 v_mfma_f32_16x16x32_bf16 v[84:87], a[120:123], a[68:71], v[84:87]
 v_cvt_pk_bf16_f32 v234, v70, v71
 v_mfma_f32_16x16x32_bf16 v[88:91], a[124:127], a[12:15], v[88:91]
 v_cvt_pk_bf16_f32 v233, v76, v77
 v_mfma_f32_16x16x32_bf16 v[92:95], a[124:127], a[68:71], v[92:95]
 v_cvt_pk_bf16_f32 v235, v78, v79
 ds_read_b128 a[120:123], v1 offset:35840
 ds_read_b128 a[124:127], v1 offset:50176
 s_waitcnt lgkmcnt(6)
 v_mfma_f32_16x16x32_bf16 v[80:83], a[128:131], a[16:19], v[80:83]
 v_mfma_f32_16x16x32_bf16 v[96:99], a[48:51], v[176:179], v[96:99]
 v_mfma_f32_16x16x32_bf16 v[84:87], a[128:131], a[72:75], v[84:87]
 v_mfma_f32_16x16x32_bf16 v[100:103], a[48:51], v[232:235], v[100:103]
 v_mfma_f32_16x16x32_bf16 v[88:91], a[132:135], a[16:19], v[88:91]
 v_mfma_f32_16x16x32_bf16 v[104:107], a[104:107], v[232:235], v[104:107]
 v_mfma_f32_16x16x32_bf16 v[92:95], a[132:135], a[72:75], v[92:95]
 ds_read_b128 a[128:131], v1 offset:36864
 ds_read_b128 a[132:135], v1 offset:51200
 s_waitcnt lgkmcnt(6)
 v_mfma_f32_16x16x32_bf16 v[80:83], a[136:139], a[20:23], v[80:83]
 v_mfma_f32_16x16x32_bf16 v[84:87], a[136:139], a[76:79], v[84:87]
 v_mfma_f32_16x16x32_bf16 v[88:91], a[140:143], a[20:23], v[88:91]
 v_mfma_f32_16x16x32_bf16 v[92:95], a[140:143], a[76:79], v[92:95]
 ds_read_b128 a[136:139], v1 offset:37888
 ds_read_b128 a[140:143], v1 offset:52224
 s_waitcnt lgkmcnt(6)
 v_mfma_f32_16x16x32_bf16 v[80:83], a[112:115], a[24:27], v[80:83]
 v_mfma_f32_16x16x32_bf16 v[84:87], a[112:115], a[80:83], v[84:87]
 v_mfma_f32_16x16x32_bf16 v[88:91], a[116:119], a[24:27], v[88:91]
 v_mfma_f32_16x16x32_bf16 v[92:95], a[116:119], a[80:83], v[92:95]
 ds_read_b128 a[112:115], v1 offset:38912
 ds_read_b128 a[116:119], v1 offset:53248
 s_waitcnt lgkmcnt(6)
 v_mfma_f32_16x16x32_bf16 v[80:83], a[120:123], a[28:31], v[80:83]
 v_mfma_f32_16x16x32_bf16 v[84:87], a[120:123], a[84:87], v[84:87]
 v_mfma_f32_16x16x32_bf16 v[88:91], a[124:127], a[28:31], v[88:91]
 v_mfma_f32_16x16x32_bf16 v[92:95], a[124:127], a[84:87], v[92:95]
 ds_read_b128 a[120:123], v1 offset:39936
 ds_read_b128 a[124:127], v1 offset:54272
 s_waitcnt lgkmcnt(6)
 v_mfma_f32_16x16x32_bf16 v[80:83], a[128:131], a[32:35], v[80:83]
 v_mfma_f32_16x16x32_bf16 v[84:87], a[128:131], a[88:91], v[84:87]
 v_mfma_f32_16x16x32_bf16 v[88:91], a[132:135], a[32:35], v[88:91]
 v_mfma_f32_16x16x32_bf16 v[92:95], a[132:135], a[88:91], v[92:95]
 ds_read_b128 a[128:131], v1 offset:40960
 ds_read_b128 a[132:135], v1 offset:55296
 s_waitcnt lgkmcnt(6)
 v_mfma_f32_16x16x32_bf16 v[80:83], a[136:139], a[36:39], v[80:83]
 v_mfma_f32_16x16x32_bf16 v[84:87], a[136:139], a[92:95], v[84:87]
 v_mfma_f32_16x16x32_bf16 v[88:91], a[140:143], a[36:39], v[88:91]
 v_mfma_f32_16x16x32_bf16 v[92:95], a[140:143], a[92:95], v[92:95]
 ds_read_b128 a[136:139], v1 offset:41984
 ds_read_b128 a[140:143], v1 offset:56320
 s_waitcnt lgkmcnt(6)
 v_mfma_f32_16x16x32_bf16 v[80:83], a[112:115], a[40:43], v[80:83]
 v_mfma_f32_16x16x32_bf16 v[84:87], a[112:115], a[96:99], v[84:87]
 v_mfma_f32_16x16x32_bf16 v[88:91], a[116:119], a[40:43], v[88:91]
 v_mfma_f32_16x16x32_bf16 v[92:95], a[116:119], a[96:99], v[92:95]
 s_waitcnt lgkmcnt(4)
 v_mfma_f32_16x16x32_bf16 v[80:83], a[120:123], a[44:47], v[80:83]
 v_mfma_f32_16x16x32_bf16 v[84:87], a[120:123], a[100:103], v[84:87]
 v_mfma_f32_16x16x32_bf16 v[88:91], a[124:127], a[44:47], v[88:91]
 v_mfma_f32_16x16x32_bf16 v[92:95], a[124:127], a[100:103], v[92:95]
 s_waitcnt lgkmcnt(2)
 v_mfma_f32_16x16x32_bf16 v[80:83], a[128:131], a[48:51], v[80:83]
 v_mfma_f32_16x16x32_bf16 v[84:87], a[128:131], a[104:107], v[84:87]
 v_mfma_f32_16x16x32_bf16 v[88:91], a[132:135], a[48:51], v[88:91]
 v_mfma_f32_16x16x32_bf16 v[92:95], a[132:135], a[104:107], v[92:95]
 s_waitcnt lgkmcnt(0)
 v_mfma_f32_16x16x32_bf16 v[80:83], a[136:139], a[52:55], v[80:83]
 v_mfma_f32_16x16x32_bf16 v[84:87], a[136:139], a[108:111], v[84:87]
 v_mfma_f32_16x16x32_bf16 v[88:91], a[140:143], a[52:55], v[88:91]
 v_mfma_f32_16x16x32_bf16 v[92:95], a[140:143], a[108:111], v[92:95]
 v_cvt_pk_bf16_f32 v180, v80, v81
 v_cvt_pk_bf16_f32 v182, v82, v83
 s_nop 1
 v_cvt_pk_bf16_f32 v181, v88, v89
 v_cvt_pk_bf16_f32 v183, v90, v91
 v_cvt_pk_bf16_f32 v236, v84, v85
 v_cvt_pk_bf16_f32 v238, v86, v87
 v_cvt_pk_bf16_f32 v237, v92, v93
 v_cvt_pk_bf16_f32 v239, v94, v95
 v_mfma_f32_16x16x32_bf16 v[96:99], a[52:55], v[180:183], v[96:99]
 s_nop 0
 v_mfma_f32_16x16x32_bf16 v[100:103], a[52:55], v[236:239], v[100:103]
 v_mfma_f32_16x16x32_bf16 v[104:107], a[108:111], v[236:239], v[104:107]
 v_bfe_u32 v3, v0, 2, 2
 v_and_b32 v4, 1, v0
 v_lshl_add_u32 v3, v3, 1, v4
 v_mul_u32_u24 v3, 896, v3
 v_lshrrev_b32 v4, 4, v0
 v_lshl_add_u32 v3, v4, 4, v3
 s_mul_i32 s47, s43, 7168
 s_add_u32 s47, s47, 212992
 v_and_b32 v5, 15, v0
 v_lshlrev_b32 v4, 2, v4
 v_sub_u32 v5, v5, v4
 v_mov_b32 v6, 0xff800000
 v_cmp_gt_i32 vcc, 0, v5
 s_nop 1
 v_cndmask_b32 v96, v96, v6, vcc
 v_cndmask_b32 v104, v104, v6, vcc
 v_cmp_gt_i32 vcc, 1, v5
 s_nop 1
 v_cndmask_b32 v97, v97, v6, vcc
 v_cndmask_b32 v105, v105, v6, vcc
 v_cmp_gt_i32 vcc, 2, v5
 s_nop 1
 v_cndmask_b32 v98, v98, v6, vcc
 v_cndmask_b32 v106, v106, v6, vcc
 v_cmp_gt_i32 vcc, 3, v5
 s_nop 1
 v_cndmask_b32 v99, v99, v6, vcc
 v_cndmask_b32 v107, v107, v6, vcc
 s_lshl_b32 s70, s43, 15
 s_lshl_b32 s71, s42, 10
 s_add_u32 s70, s70, s71
 s_add_u32 s70, s70, 28311552
 s_add_u32 s71, s70, 16384
 s_lshl_b32 s72, s43, 13
 s_lshl_b32 s73, s42, 8
 s_add_u32 s72, s72, s73
 s_add_u32 s72, s72, 30408704
 s_add_u32 s73, s72, 4096
 v_lshlrev_b32 v7, 2, v0
 v_mov_b32 v116, -1
 v_mov_b32 v117, -1
 v_mov_b32 v118, -1
 v_mov_b32 v119, -1
 buffer_store_dwordx4 v[116:119], v1, s[16:19], s70 offen sc1
 buffer_store_dwordx4 v[116:119], v1, s[16:19], s71 offen sc1
 buffer_store_dword v116, v7, s[16:19], s72 offen sc1
 buffer_store_dword v116, v7, s[16:19], s73 offen sc1
 s_lshl_b32 s49, s43, 10
 s_add_u32 s49, s49, 57856
 s_cmp_lt_u32 s43, 2
 s_cbranch_scc1 Htg_d
 s_sub_u32 s48, s49, 2048
Htg_w:
 buffer_load_dword v252, v253, s[16:19], s48 offen sc1
 s_waitcnt vmcnt(0)
 v_cmp_gt_u32 vcc, 1, v252
 s_cbranch_vccz Htg_d
 s_sleep 12
 s_max_u32 s68, s68, 1
 s_sub_u32 s68, s68, 1
 s_cmp_lg_u32 s68, 0
 s_cbranch_scc1 Htg_w
Htg_d:
Htf_w:
 buffer_load_dword v252, v253, s[16:19], s49 offen sc1
 s_waitcnt vmcnt(0)
 v_cmp_gt_u32 vcc, 1, v252
 s_cbranch_vccz Htf_d
 s_sleep 1
 s_max_u32 s68, s68, 1
 s_sub_u32 s68, s68, 1
 s_cmp_lg_u32 s68, 0
 s_cbranch_scc1 Htf_w
Htf_d:
 s_sub_u32 s49, s49, 384
Ht_l:
 buffer_load_dwordx4 v[8:11], v3, s[16:19], s47 offen offset:0 sc1
 buffer_load_dwordx4 v[12:15], v3, s[16:19], s47 offen offset:64 sc1
 buffer_load_dwordx4 v[16:19], v3, s[16:19], s47 offen offset:128 sc1
 buffer_load_dwordx4 v[20:23], v3, s[16:19], s47 offen offset:192 sc1
 buffer_load_dwordx4 v[24:27], v3, s[16:19], s47 offen offset:256 sc1
 buffer_load_dwordx4 v[28:31], v3, s[16:19], s47 offen offset:320 sc1
 buffer_load_dwordx4 v[32:35], v3, s[16:19], s47 offen offset:384 sc1
 buffer_load_dwordx4 v[36:39], v3, s[16:19], s47 offen offset:448 sc1
 buffer_load_dwordx4 v[40:43], v3, s[16:19], s47 offen offset:512 sc1
 buffer_load_dwordx4 v[44:47], v3, s[16:19], s47 offen offset:576 sc1
 buffer_load_dwordx4 v[48:51], v3, s[16:19], s47 offen offset:640 sc1
 buffer_load_dwordx4 v[52:55], v3, s[16:19], s47 offen offset:704 sc1
 buffer_load_dwordx4 v[56:59], v3, s[16:19], s47 offen offset:768 sc1
 buffer_load_dwordx4 v[60:63], v3, s[16:19], s47 offen offset:832 sc1
 s_waitcnt vmcnt(0)
 v_max3_u32 v252, v8, v9, v10
 v_max3_u32 v252, v252, v11, v12
 v_max3_u32 v252, v252, v13, v14
 v_max3_u32 v252, v252, v15, v16
 v_max3_u32 v252, v252, v17, v18
 v_max3_u32 v252, v252, v19, v20
 v_max3_u32 v252, v252, v21, v22
 v_max3_u32 v252, v252, v23, v24
 v_max3_u32 v252, v252, v25, v26
 v_max3_u32 v252, v252, v27, v28
 v_max3_u32 v252, v252, v29, v30
 v_max3_u32 v252, v252, v31, v32
 v_max3_u32 v252, v252, v33, v34
 v_max3_u32 v252, v252, v35, v36
 v_max3_u32 v252, v252, v37, v38
 v_max3_u32 v252, v252, v39, v40
 v_max3_u32 v252, v252, v41, v42
 v_max3_u32 v252, v252, v43, v44
 v_max3_u32 v252, v252, v45, v46
 v_max3_u32 v252, v252, v47, v48
 v_max3_u32 v252, v252, v49, v50
 v_max3_u32 v252, v252, v51, v52
 v_max3_u32 v252, v252, v53, v54
 v_max3_u32 v252, v252, v55, v56
 v_max3_u32 v252, v252, v57, v58
 v_max3_u32 v252, v252, v59, v60
 v_max3_u32 v252, v252, v61, v62
 v_max_u32 v252, v252, v63
 v_cmp_eq_u32 vcc, -1, v252
 s_cbranch_vccz Ht_d
 s_max_u32 s68, s68, 1
 s_sub_u32 s68, s68, 1
 s_cmp_lg_u32 s68, 0
 s_cbranch_scc1 Ht_l
Ht_d:
 v_mfma_f32_16x16x32_bf16 v[108:111], v[8:11], v[128:131], 0
 v_mfma_f32_16x16x32_bf16 v[112:115], v[8:11], v[184:187], 0
 v_mfma_f32_16x16x32_bf16 v[108:111], v[12:15], v[132:135], v[108:111]
 v_mfma_f32_16x16x32_bf16 v[112:115], v[12:15], v[188:191], v[112:115]
 v_mfma_f32_16x16x32_bf16 v[108:111], v[16:19], v[136:139], v[108:111]
 v_mfma_f32_16x16x32_bf16 v[112:115], v[16:19], v[192:195], v[112:115]
 v_mfma_f32_16x16x32_bf16 v[108:111], v[20:23], v[140:143], v[108:111]
 v_mfma_f32_16x16x32_bf16 v[112:115], v[20:23], v[196:199], v[112:115]
 v_mfma_f32_16x16x32_bf16 v[108:111], v[24:27], v[144:147], v[108:111]
 v_mfma_f32_16x16x32_bf16 v[112:115], v[24:27], v[200:203], v[112:115]
 v_mfma_f32_16x16x32_bf16 v[108:111], v[28:31], v[148:151], v[108:111]
 v_mfma_f32_16x16x32_bf16 v[112:115], v[28:31], v[204:207], v[112:115]
 v_mfma_f32_16x16x32_bf16 v[108:111], v[32:35], v[152:155], v[108:111]
 v_mfma_f32_16x16x32_bf16 v[112:115], v[32:35], v[208:211], v[112:115]
 v_mfma_f32_16x16x32_bf16 v[108:111], v[36:39], v[156:159], v[108:111]
 v_mfma_f32_16x16x32_bf16 v[112:115], v[36:39], v[212:215], v[112:115]
 v_mfma_f32_16x16x32_bf16 v[108:111], v[40:43], v[160:163], v[108:111]
 v_mfma_f32_16x16x32_bf16 v[112:115], v[40:43], v[216:219], v[112:115]
 v_mfma_f32_16x16x32_bf16 v[108:111], v[44:47], v[164:167], v[108:111]
 v_mfma_f32_16x16x32_bf16 v[112:115], v[44:47], v[220:223], v[112:115]
 v_mfma_f32_16x16x32_bf16 v[108:111], v[48:51], v[168:171], v[108:111]
 v_mfma_f32_16x16x32_bf16 v[112:115], v[48:51], v[224:227], v[112:115]
 v_mfma_f32_16x16x32_bf16 v[108:111], v[52:55], v[172:175], v[108:111]
 v_mfma_f32_16x16x32_bf16 v[112:115], v[52:55], v[228:231], v[112:115]
 v_mfma_f32_16x16x32_bf16 v[108:111], v[56:59], v[176:179], v[108:111]
 v_mfma_f32_16x16x32_bf16 v[112:115], v[56:59], v[232:235], v[112:115]
 v_mfma_f32_16x16x32_bf16 v[108:111], v[60:63], v[180:183], v[108:111]
 v_mfma_f32_16x16x32_bf16 v[112:115], v[60:63], v[236:239], v[112:115]
 v_max3_f32 v32, v96, v97, v98
 s_nop 2
 v_max3_f32 v32, v32, v99, v108
 v_max_f32 v32, v32, v109
 v_max3_f32 v34, v100, v101, v102
 v_max3_f32 v34, v34, v103, v104
 v_max3_f32 v34, v34, v105, v106
 v_max3_f32 v34, v34, v107, v112
 v_max_f32 v34, v34, v113
 v_mov_b32 v33, v32
 v_mov_b32 v35, v34
 s_nop 0
 v_permlane16_swap_b32 v32, v33
 v_permlane16_swap_b32 v34, v35
 v_max_f32 v32, v32, v33
 v_max_f32 v34, v34, v35
 v_mov_b32 v33, v32
 v_mov_b32 v35, v34
 s_nop 0
 v_permlane32_swap_b32 v32, v33
 v_permlane32_swap_b32 v34, v35
 v_max_f32 v32, v32, v33
 v_max_f32 v34, v34, v35
 s_atomic_add s32, s[16:17], s49
 v_sub_f32 v96, v96, v32
 v_sub_f32 v97, v97, v32
 v_sub_f32 v98, v98, v32
 v_sub_f32 v99, v99, v32
 v_sub_f32 v108, v108, v32
 v_sub_f32 v109, v109, v32
 v_exp_f32 v96, v96
 v_exp_f32 v97, v97
 v_exp_f32 v98, v98
 v_exp_f32 v99, v99
 v_exp_f32 v108, v108
 v_exp_f32 v109, v109
 v_sub_f32 v100, v100, v34
 v_sub_f32 v101, v101, v34
 v_sub_f32 v102, v102, v34
 v_sub_f32 v103, v103, v34
 v_sub_f32 v104, v104, v34
 v_sub_f32 v105, v105, v34
 v_sub_f32 v106, v106, v34
 v_sub_f32 v107, v107, v34
 v_sub_f32 v112, v112, v34
 v_sub_f32 v113, v113, v34
 v_exp_f32 v100, v100
 v_exp_f32 v101, v101
 v_exp_f32 v102, v102
 v_exp_f32 v103, v103
 v_exp_f32 v104, v104
 v_exp_f32 v105, v105
 v_exp_f32 v106, v106
 v_exp_f32 v107, v107
 v_exp_f32 v112, v112
 v_exp_f32 v113, v113
 v_add_f32 v36, v96, v97
 v_add_f32 v36, v36, v98
 v_add_f32 v36, v36, v99
 v_add_f32 v36, v36, v108
 v_add_f32 v36, v36, v109
 v_add_f32 v38, v100, v101
 v_add_f32 v38, v38, v102
 v_add_f32 v38, v38, v103
 v_add_f32 v38, v38, v104
 v_add_f32 v38, v38, v105
 v_add_f32 v38, v38, v106
 v_add_f32 v38, v38, v107
 v_add_f32 v38, v38, v112
 v_add_f32 v38, v38, v113
 v_mov_b32 v37, v36
 v_mov_b32 v39, v38
 s_nop 0
 v_permlane16_swap_b32 v36, v37
 v_permlane16_swap_b32 v38, v39
 v_add_f32 v36, v36, v37
 v_add_f32 v38, v38, v39
 v_mov_b32 v37, v36
 v_mov_b32 v39, v38
 s_nop 0
 v_permlane32_swap_b32 v36, v37
 v_permlane32_swap_b32 v38, v39
 v_add_f32 v36, v36, v37
 v_add_f32 v38, v38, v39
 v_rcp_f32 v36, v36
 v_rcp_f32 v38, v38
 v_mul_f32 v96, v96, v36
 v_mul_f32 v97, v97, v36
 v_mul_f32 v98, v98, v36
 v_mul_f32 v99, v99, v36
 v_mul_f32 v108, v108, v36
 v_mul_f32 v109, v109, v36
 v_mul_f32 v100, v100, v38
 v_mul_f32 v101, v101, v38
 v_mul_f32 v102, v102, v38
 v_mul_f32 v103, v103, v38
 v_mul_f32 v104, v104, v38
 v_mul_f32 v105, v105, v38
 v_mul_f32 v106, v106, v38
 v_mul_f32 v107, v107, v38
 v_mul_f32 v112, v112, v38
 v_mul_f32 v113, v113, v38
 v_cvt_pk_bf16_f32 v40, v96, v97
 v_cvt_pk_bf16_f32 v41, v98, v99
 v_mov_b32 v42, 0
 v_mov_b32 v43, 0
 v_cvt_pk_bf16_f32 v44, v100, v101
 v_cvt_pk_bf16_f32 v45, v102, v103
 v_cvt_pk_bf16_f32 v46, v104, v105
 v_cvt_pk_bf16_f32 v47, v106, v107
 v_cvt_pk_bf16_f32 v48, v108, v109
 v_cvt_pk_bf16_f32 v49, v112, v113
 v_min_u32 v40, -2, v40
 v_min_u32 v41, -2, v41
 v_min_u32 v44, -2, v44
 v_min_u32 v45, -2, v45
 v_min_u32 v46, -2, v46
 v_min_u32 v47, -2, v47
 v_min_u32 v48, -2, v48
 v_min_u32 v49, -2, v49
 buffer_store_dwordx4 v[40:43], v1, s[16:19], s70 offen sc1
 buffer_store_dwordx4 v[44:47], v1, s[16:19], s71 offen sc1
 buffer_store_dword v48, v7, s[16:19], s72 offen sc1
 buffer_store_dword v49, v7, s[16:19], s73 offen sc1
 s_add_u32 s41, s41, 5
 s_cmp_lt_u32 s41, 16
 s_cbranch_scc1 H_t
 s_cmp_ge_u32 s42, 14
 s_cbranch_scc1 H_x
 s_cmp_ge_u32 s41, 18
 s_cbranch_scc1 H_x
 s_add_u32 s41, s41, 110
 s_branch H_m1
H_x:
 s_endpgm
CH_start:
 s_cmp_ge_u32 s46, 16
 s_cbranch_scc1 AL_done
 s_lshl_b32 s59, s40, 11
 s_mov_b32 s37, 1035512379
 v_add_u32 v113, 49152, v108
 v_add_u32 v114, 98304, v108
 ds_read_b128 a[0:3], v109 offset:0
 ds_read_b128 a[4:7], v109 offset:1024
 ds_read_b128 a[8:11], v109 offset:2048
 ds_read_b128 a[12:15], v109 offset:3072
 ds_read_b128 a[16:19], v109 offset:4096
 ds_read_b128 a[20:23], v109 offset:5120
 ds_read_b128 a[24:27], v109 offset:6144
 ds_read_b128 a[28:31], v109 offset:7168
 ds_read_b128 a[32:35], v109 offset:8192
 ds_read_b128 a[36:39], v109 offset:9216
 ds_read_b128 a[40:43], v109 offset:10240
 ds_read_b128 a[44:47], v109 offset:11264
 ds_read_b128 a[48:51], v109 offset:12288
 ds_read_b128 a[52:55], v109 offset:13312
 ds_read_b128 a[56:59], v109 offset:14336
 ds_read_b128 a[60:63], v109 offset:15360
 ds_read_b128 a[64:67], v109 offset:16384
 ds_read_b128 a[68:71], v109 offset:17408
 ds_read_b128 a[72:75], v109 offset:18432
 ds_read_b128 a[76:79], v109 offset:19456
 ds_read_b128 a[80:83], v109 offset:20480
 ds_read_b128 a[84:87], v109 offset:21504
 ds_read_b128 a[88:91], v109 offset:22528
 ds_read_b128 a[92:95], v109 offset:23552
 s_waitcnt lgkmcnt(0)
 s_barrier
 ds_read_b128 v[40:43], v108 offset:0
 ds_read_b128 v[44:47], v108 offset:1024
 ds_read_b128 v[48:51], v108 offset:2048
 ds_read_b128 v[52:55], v108 offset:3072
 ds_read_b128 v[56:59], v108 offset:4096
 ds_read_b128 v[60:63], v108 offset:5120
 ds_read_b128 v[64:67], v108 offset:6144
 ds_read_b128 v[68:71], v108 offset:7168
 s_waitcnt lgkmcnt(7)
 v_mfma_f32_16x16x32_bf16 v[8:11], v[40:43], a[0:3], 0
 s_add_u32 m0, s59, 49152
 v_mfma_f32_16x16x32_bf16 v[16:19], v[40:43], a[32:35], 0
 buffer_load_dwordx4 v104, s[8:11], s66 offen lds
 v_mfma_f32_16x16x32_bf16 v[24:27], v[40:43], a[64:67], 0
 ds_read_b128 v[40:43], v108 offset:8192
 s_waitcnt lgkmcnt(7)
 v_mfma_f32_16x16x32_bf16 v[8:11], v[44:47], a[4:7], v[8:11]
 v_mfma_f32_16x16x32_bf16 v[16:19], v[44:47], a[36:39], v[16:19]
 v_mfma_f32_16x16x32_bf16 v[24:27], v[44:47], a[68:71], v[24:27]
 ds_read_b128 v[44:47], v108 offset:9216
 s_waitcnt lgkmcnt(7)
 v_mfma_f32_16x16x32_bf16 v[8:11], v[48:51], a[8:11], v[8:11]
 s_add_u32 m0, s59, 50112
 v_mfma_f32_16x16x32_bf16 v[16:19], v[48:51], a[40:43], v[16:19]
 buffer_load_dwordx4 v104, s[8:11], s66 offen offset:64 lds
 s_add_u32 s66, s66, 32768
 v_mfma_f32_16x16x32_bf16 v[24:27], v[48:51], a[72:75], v[24:27]
 ds_read_b128 v[48:51], v108 offset:10240
 s_waitcnt lgkmcnt(7)
 v_mfma_f32_16x16x32_bf16 v[8:11], v[52:55], a[12:15], v[8:11]
 v_mfma_f32_16x16x32_bf16 v[16:19], v[52:55], a[44:47], v[16:19]
 v_mfma_f32_16x16x32_bf16 v[24:27], v[52:55], a[76:79], v[24:27]
 ds_read_b128 v[52:55], v108 offset:11264
 s_waitcnt lgkmcnt(7)
 v_mfma_f32_16x16x32_bf16 v[8:11], v[56:59], a[16:19], v[8:11]
 s_add_u32 m0, s59, 57344
 v_mfma_f32_16x16x32_bf16 v[16:19], v[56:59], a[48:51], v[16:19]
 buffer_load_dwordx4 v104, s[8:11], s66 offen lds
 v_mfma_f32_16x16x32_bf16 v[24:27], v[56:59], a[80:83], v[24:27]
 ds_read_b128 v[56:59], v108 offset:12288
 s_waitcnt lgkmcnt(7)
 v_mfma_f32_16x16x32_bf16 v[8:11], v[60:63], a[20:23], v[8:11]
 v_mfma_f32_16x16x32_bf16 v[16:19], v[60:63], a[52:55], v[16:19]
 v_mfma_f32_16x16x32_bf16 v[24:27], v[60:63], a[84:87], v[24:27]
 ds_read_b128 v[60:63], v108 offset:13312
 s_waitcnt lgkmcnt(7)
 v_mfma_f32_16x16x32_bf16 v[8:11], v[64:67], a[24:27], v[8:11]
 s_add_u32 m0, s59, 58304
 v_mfma_f32_16x16x32_bf16 v[16:19], v[64:67], a[56:59], v[16:19]
 buffer_load_dwordx4 v104, s[8:11], s66 offen offset:64 lds
 s_add_u32 s66, s66, 229376
 v_mfma_f32_16x16x32_bf16 v[24:27], v[64:67], a[88:91], v[24:27]
 ds_read_b128 v[64:67], v108 offset:14336
 s_waitcnt lgkmcnt(7)
 v_mfma_f32_16x16x32_bf16 v[8:11], v[68:71], a[28:31], v[8:11]
 v_mfma_f32_16x16x32_bf16 v[16:19], v[68:71], a[60:63], v[16:19]
 v_mfma_f32_16x16x32_bf16 v[24:27], v[68:71], a[92:95], v[24:27]
 ds_read_b128 v[68:71], v108 offset:15360
 s_waitcnt lgkmcnt(7)
 v_mfma_f32_16x16x32_bf16 v[12:15], v[40:43], a[0:3], 0
 s_add_u32 m0, s59, 65536
 v_mfma_f32_16x16x32_bf16 v[20:23], v[40:43], a[32:35], 0
 buffer_load_dwordx4 v104, s[8:11], s66 offen lds
 v_mfma_f32_16x16x32_bf16 v[28:31], v[40:43], a[64:67], 0
 ds_read_b128 v[40:43], v108 offset:16384
 s_waitcnt lgkmcnt(7)
 v_mfma_f32_16x16x32_bf16 v[12:15], v[44:47], a[4:7], v[12:15]
 v_mfma_f32_16x16x32_bf16 v[20:23], v[44:47], a[36:39], v[20:23]
 v_mfma_f32_16x16x32_bf16 v[28:31], v[44:47], a[68:71], v[28:31]
 ds_read_b128 v[44:47], v108 offset:17408
 s_waitcnt lgkmcnt(7)
 v_mfma_f32_16x16x32_bf16 v[12:15], v[48:51], a[8:11], v[12:15]
 s_add_u32 m0, s59, 66496
 v_mfma_f32_16x16x32_bf16 v[20:23], v[48:51], a[40:43], v[20:23]
 buffer_load_dwordx4 v104, s[8:11], s66 offen offset:64 lds
 s_add_u32 s66, s66, 32768
 v_mfma_f32_16x16x32_bf16 v[28:31], v[48:51], a[72:75], v[28:31]
 ds_read_b128 v[48:51], v108 offset:18432
 s_waitcnt lgkmcnt(7)
 v_mfma_f32_16x16x32_bf16 v[12:15], v[52:55], a[12:15], v[12:15]
 v_mfma_f32_16x16x32_bf16 v[20:23], v[52:55], a[44:47], v[20:23]
 v_mfma_f32_16x16x32_bf16 v[28:31], v[52:55], a[76:79], v[28:31]
 ds_read_b128 v[52:55], v108 offset:19456
 s_waitcnt lgkmcnt(7)
 v_mfma_f32_16x16x32_bf16 v[12:15], v[56:59], a[16:19], v[12:15]
 s_add_u32 m0, s59, 73728
 v_mfma_f32_16x16x32_bf16 v[20:23], v[56:59], a[48:51], v[20:23]
 buffer_load_dwordx4 v104, s[8:11], s66 offen lds
 v_mfma_f32_16x16x32_bf16 v[28:31], v[56:59], a[80:83], v[28:31]
 ds_read_b128 v[56:59], v108 offset:20480
 s_waitcnt lgkmcnt(7)
 v_mfma_f32_16x16x32_bf16 v[12:15], v[60:63], a[20:23], v[12:15]
 v_mfma_f32_16x16x32_bf16 v[20:23], v[60:63], a[52:55], v[20:23]
 v_mfma_f32_16x16x32_bf16 v[28:31], v[60:63], a[84:87], v[28:31]
 ds_read_b128 v[60:63], v108 offset:21504
 s_waitcnt lgkmcnt(7)
 v_mfma_f32_16x16x32_bf16 v[12:15], v[64:67], a[24:27], v[12:15]
 s_add_u32 m0, s59, 74688
 v_mfma_f32_16x16x32_bf16 v[20:23], v[64:67], a[56:59], v[20:23]
 buffer_load_dwordx4 v104, s[8:11], s66 offen offset:64 lds
 s_add_u32 s66, s66, 229376
 v_mfma_f32_16x16x32_bf16 v[28:31], v[64:67], a[88:91], v[28:31]
 ds_read_b128 v[64:67], v108 offset:22528
 s_waitcnt lgkmcnt(7)
 v_mfma_f32_16x16x32_bf16 v[12:15], v[68:71], a[28:31], v[12:15]
 v_mfma_f32_16x16x32_bf16 v[20:23], v[68:71], a[60:63], v[20:23]
 v_mfma_f32_16x16x32_bf16 v[28:31], v[68:71], a[92:95], v[28:31]
 ds_read_b128 v[68:71], v108 offset:23552
 s_waitcnt lgkmcnt(7)
 v_mfma_f32_16x16x32_bf16 v[72:75], v[40:43], a[0:3], 0
 s_add_u32 m0, s59, 81920
 v_mfma_f32_16x16x32_bf16 v[80:83], v[40:43], a[32:35], 0
 buffer_load_dwordx4 v104, s[8:11], s66 offen lds
 v_mfma_f32_16x16x32_bf16 v[88:91], v[40:43], a[64:67], 0
 ds_read_b128 v[40:43], v108 offset:24576
 s_waitcnt lgkmcnt(7)
 v_mfma_f32_16x16x32_bf16 v[72:75], v[44:47], a[4:7], v[72:75]
 v_mul_f32 v8, s37, v8
 v_mfma_f32_16x16x32_bf16 v[80:83], v[44:47], a[36:39], v[80:83]
 v_mul_f32 v9, s37, v9
 v_mfma_f32_16x16x32_bf16 v[88:91], v[44:47], a[68:71], v[88:91]
 ds_read_b128 v[44:47], v108 offset:25600
 v_mul_f32 v10, s37, v10
 s_waitcnt lgkmcnt(7)
 v_mfma_f32_16x16x32_bf16 v[72:75], v[48:51], a[8:11], v[72:75]
 s_add_u32 m0, s59, 82880
 v_mul_f32 v11, s37, v11
 v_mfma_f32_16x16x32_bf16 v[80:83], v[48:51], a[40:43], v[80:83]
 buffer_load_dwordx4 v104, s[8:11], s66 offen offset:64 lds
 s_add_u32 s66, s66, 32768
 v_mul_f32 v12, s37, v12
 v_mfma_f32_16x16x32_bf16 v[88:91], v[48:51], a[72:75], v[88:91]
 ds_read_b128 v[48:51], v108 offset:26624
 v_mul_f32 v13, s37, v13
 s_waitcnt lgkmcnt(7)
 v_mfma_f32_16x16x32_bf16 v[72:75], v[52:55], a[12:15], v[72:75]
 v_mul_f32 v14, s37, v14
 v_mfma_f32_16x16x32_bf16 v[80:83], v[52:55], a[44:47], v[80:83]
 v_mul_f32 v15, s37, v15
 v_mfma_f32_16x16x32_bf16 v[88:91], v[52:55], a[76:79], v[88:91]
 ds_read_b128 v[52:55], v108 offset:27648
 v_cvt_pk_bf16_f32 v32, v8, v9
 s_waitcnt lgkmcnt(7)
 v_mfma_f32_16x16x32_bf16 v[72:75], v[56:59], a[16:19], v[72:75]
 s_add_u32 m0, s59, 90112
 v_cvt_pk_bf16_f32 v33, v10, v11
 v_mfma_f32_16x16x32_bf16 v[80:83], v[56:59], a[48:51], v[80:83]
 buffer_load_dwordx4 v104, s[8:11], s66 offen lds
 v_cvt_pk_bf16_f32 v34, v12, v13
 v_mfma_f32_16x16x32_bf16 v[88:91], v[56:59], a[80:83], v[88:91]
 ds_read_b128 v[56:59], v108 offset:28672
 v_cvt_pk_bf16_f32 v35, v14, v15
 s_waitcnt lgkmcnt(7)
 v_mfma_f32_16x16x32_bf16 v[72:75], v[60:63], a[20:23], v[72:75]
 v_accvgpr_write_b32 a224, v32
 v_mfma_f32_16x16x32_bf16 v[80:83], v[60:63], a[52:55], v[80:83]
 v_accvgpr_write_b32 a225, v33
 v_mfma_f32_16x16x32_bf16 v[88:91], v[60:63], a[84:87], v[88:91]
 ds_read_b128 v[60:63], v108 offset:29696
 v_accvgpr_write_b32 a226, v34
 s_waitcnt lgkmcnt(7)
 v_mfma_f32_16x16x32_bf16 v[72:75], v[64:67], a[24:27], v[72:75]
 s_add_u32 m0, s59, 91072
 v_accvgpr_write_b32 a227, v35
 v_mfma_f32_16x16x32_bf16 v[80:83], v[64:67], a[56:59], v[80:83]
 buffer_load_dwordx4 v104, s[8:11], s66 offen offset:64 lds
 s_add_u32 s66, s66, 229376
 v_mul_f32 v16, s37, v16
 v_mfma_f32_16x16x32_bf16 v[88:91], v[64:67], a[88:91], v[88:91]
 ds_read_b128 v[64:67], v108 offset:30720
 v_mul_f32 v17, s37, v17
 s_waitcnt lgkmcnt(7)
 v_mfma_f32_16x16x32_bf16 v[72:75], v[68:71], a[28:31], v[72:75]
 v_mul_f32 v18, s37, v18
 v_mfma_f32_16x16x32_bf16 v[80:83], v[68:71], a[60:63], v[80:83]
 v_mul_f32 v19, s37, v19
 v_mfma_f32_16x16x32_bf16 v[88:91], v[68:71], a[92:95], v[88:91]
 ds_read_b128 v[68:71], v108 offset:31744
 v_mul_f32 v20, s37, v20
 s_waitcnt lgkmcnt(7)
 v_mfma_f32_16x16x32_bf16 v[76:79], v[40:43], a[0:3], 0
 s_add_u32 m0, s59, 98304
 v_mul_f32 v21, s37, v21
 v_mfma_f32_16x16x32_bf16 v[84:87], v[40:43], a[32:35], 0
 buffer_load_dwordx4 v104, s[8:11], s66 offen lds
 v_mul_f32 v22, s37, v22
 v_mfma_f32_16x16x32_bf16 v[92:95], v[40:43], a[64:67], 0
 ds_read_b128 v[40:43], v108 offset:32768
 v_mul_f32 v23, s37, v23
 s_waitcnt lgkmcnt(7)
 v_mfma_f32_16x16x32_bf16 v[76:79], v[44:47], a[4:7], v[76:79]
 v_cvt_pk_bf16_f32 v144, v16, v17
 v_mfma_f32_16x16x32_bf16 v[84:87], v[44:47], a[36:39], v[84:87]
 v_cvt_pk_bf16_f32 v145, v18, v19
 v_mfma_f32_16x16x32_bf16 v[92:95], v[44:47], a[68:71], v[92:95]
 ds_read_b128 v[44:47], v108 offset:33792
 v_cvt_pk_bf16_f32 v146, v20, v21
 s_waitcnt lgkmcnt(7)
 v_mfma_f32_16x16x32_bf16 v[76:79], v[48:51], a[8:11], v[76:79]
 s_add_u32 m0, s59, 99264
 v_cvt_pk_bf16_f32 v147, v22, v23
 v_mfma_f32_16x16x32_bf16 v[84:87], v[48:51], a[40:43], v[84:87]
 buffer_load_dwordx4 v104, s[8:11], s66 offen offset:64 lds
 s_add_u32 s66, s66, 32768
 v_mul_f32 v24, s37, v24
 v_mfma_f32_16x16x32_bf16 v[92:95], v[48:51], a[72:75], v[92:95]
 ds_read_b128 v[48:51], v108 offset:34816
 v_mul_f32 v25, s37, v25
 s_waitcnt lgkmcnt(7)
 v_mfma_f32_16x16x32_bf16 v[76:79], v[52:55], a[12:15], v[76:79]
 v_mul_f32 v26, s37, v26
 v_mfma_f32_16x16x32_bf16 v[84:87], v[52:55], a[44:47], v[84:87]
 v_mul_f32 v27, s37, v27
 v_mfma_f32_16x16x32_bf16 v[92:95], v[52:55], a[76:79], v[92:95]
 ds_read_b128 v[52:55], v108 offset:35840
 v_mul_f32 v28, s37, v28
 s_waitcnt lgkmcnt(7)
 v_mfma_f32_16x16x32_bf16 v[76:79], v[56:59], a[16:19], v[76:79]
 s_add_u32 m0, s59, 106496
 v_mul_f32 v29, s37, v29
 v_mfma_f32_16x16x32_bf16 v[84:87], v[56:59], a[48:51], v[84:87]
 buffer_load_dwordx4 v104, s[8:11], s66 offen lds
 v_mul_f32 v30, s37, v30
 v_mfma_f32_16x16x32_bf16 v[92:95], v[56:59], a[80:83], v[92:95]
 ds_read_b128 v[56:59], v108 offset:36864
 v_mul_f32 v31, s37, v31
 s_waitcnt lgkmcnt(7)
 v_mfma_f32_16x16x32_bf16 v[76:79], v[60:63], a[20:23], v[76:79]
 v_cvt_pk_bf16_f32 v200, v24, v25
 v_mfma_f32_16x16x32_bf16 v[84:87], v[60:63], a[52:55], v[84:87]
 v_cvt_pk_bf16_f32 v201, v26, v27
 v_mfma_f32_16x16x32_bf16 v[92:95], v[60:63], a[84:87], v[92:95]
 ds_read_b128 v[60:63], v108 offset:37888
 v_cvt_pk_bf16_f32 v202, v28, v29
 s_waitcnt lgkmcnt(7)
 v_mfma_f32_16x16x32_bf16 v[76:79], v[64:67], a[24:27], v[76:79]
 s_add_u32 m0, s59, 107456
 v_cvt_pk_bf16_f32 v203, v30, v31
 v_mfma_f32_16x16x32_bf16 v[84:87], v[64:67], a[56:59], v[84:87]
 buffer_load_dwordx4 v104, s[8:11], s66 offen offset:64 lds
 s_add_u32 s66, s66, 229376
 v_mfma_f32_16x16x32_bf16 v[92:95], v[64:67], a[88:91], v[92:95]
 ds_read_b128 v[64:67], v108 offset:38912
 s_waitcnt lgkmcnt(7)
 v_mfma_f32_16x16x32_bf16 v[76:79], v[68:71], a[28:31], v[76:79]
 v_mfma_f32_16x16x32_bf16 v[84:87], v[68:71], a[60:63], v[84:87]
 v_mfma_f32_16x16x32_bf16 v[92:95], v[68:71], a[92:95], v[92:95]
 ds_read_b128 v[68:71], v108 offset:39936
 s_waitcnt lgkmcnt(7)
 v_mfma_f32_16x16x32_bf16 v[8:11], v[40:43], a[0:3], 0
 s_add_u32 m0, s59, 114688
 v_mfma_f32_16x16x32_bf16 v[16:19], v[40:43], a[32:35], 0
 buffer_load_dwordx4 v104, s[8:11], s66 offen lds
 v_mfma_f32_16x16x32_bf16 v[24:27], v[40:43], a[64:67], 0
 ds_read_b128 v[40:43], v108 offset:40960
 s_waitcnt lgkmcnt(7)
 v_mfma_f32_16x16x32_bf16 v[8:11], v[44:47], a[4:7], v[8:11]
 v_mul_f32 v72, s37, v72
 v_mfma_f32_16x16x32_bf16 v[16:19], v[44:47], a[36:39], v[16:19]
 v_mul_f32 v73, s37, v73
 v_mfma_f32_16x16x32_bf16 v[24:27], v[44:47], a[68:71], v[24:27]
 ds_read_b128 v[44:47], v108 offset:41984
 v_mul_f32 v74, s37, v74
 s_waitcnt lgkmcnt(7)
 v_mfma_f32_16x16x32_bf16 v[8:11], v[48:51], a[8:11], v[8:11]
 s_add_u32 m0, s59, 115648
 v_mul_f32 v75, s37, v75
 v_mfma_f32_16x16x32_bf16 v[16:19], v[48:51], a[40:43], v[16:19]
 buffer_load_dwordx4 v104, s[8:11], s66 offen offset:64 lds
 s_add_u32 s66, s66, 32768
 v_mul_f32 v76, s37, v76
 v_mfma_f32_16x16x32_bf16 v[24:27], v[48:51], a[72:75], v[24:27]
 ds_read_b128 v[48:51], v108 offset:43008
 v_mul_f32 v77, s37, v77
 s_waitcnt lgkmcnt(7)
 v_mfma_f32_16x16x32_bf16 v[8:11], v[52:55], a[12:15], v[8:11]
 v_mul_f32 v78, s37, v78
 v_mfma_f32_16x16x32_bf16 v[16:19], v[52:55], a[44:47], v[16:19]
 v_mul_f32 v79, s37, v79
 v_mfma_f32_16x16x32_bf16 v[24:27], v[52:55], a[76:79], v[24:27]
 ds_read_b128 v[52:55], v108 offset:44032
 v_cvt_pk_bf16_f32 v32, v72, v73
 s_waitcnt lgkmcnt(7)
 v_mfma_f32_16x16x32_bf16 v[8:11], v[56:59], a[16:19], v[8:11]
 s_add_u32 m0, s59, 122880
 v_cvt_pk_bf16_f32 v33, v74, v75
 v_mfma_f32_16x16x32_bf16 v[16:19], v[56:59], a[48:51], v[16:19]
 buffer_load_dwordx4 v104, s[8:11], s66 offen lds
 v_cvt_pk_bf16_f32 v34, v76, v77
 v_mfma_f32_16x16x32_bf16 v[24:27], v[56:59], a[80:83], v[24:27]
 ds_read_b128 v[56:59], v108 offset:45056
 v_cvt_pk_bf16_f32 v35, v78, v79
 s_waitcnt lgkmcnt(7)
 v_mfma_f32_16x16x32_bf16 v[8:11], v[60:63], a[20:23], v[8:11]
 v_accvgpr_write_b32 a228, v32
 v_mfma_f32_16x16x32_bf16 v[16:19], v[60:63], a[52:55], v[16:19]
 v_accvgpr_write_b32 a229, v33
 v_mfma_f32_16x16x32_bf16 v[24:27], v[60:63], a[84:87], v[24:27]
 ds_read_b128 v[60:63], v108 offset:46080
 v_accvgpr_write_b32 a230, v34
 s_waitcnt lgkmcnt(7)
 v_mfma_f32_16x16x32_bf16 v[8:11], v[64:67], a[24:27], v[8:11]
 s_add_u32 m0, s59, 123840
 v_accvgpr_write_b32 a231, v35
 v_mfma_f32_16x16x32_bf16 v[16:19], v[64:67], a[56:59], v[16:19]
 buffer_load_dwordx4 v104, s[8:11], s66 offen offset:64 lds
 s_add_u32 s66, s66, 229376
 v_mul_f32 v80, s37, v80
 v_mfma_f32_16x16x32_bf16 v[24:27], v[64:67], a[88:91], v[24:27]
 ds_read_b128 v[64:67], v108 offset:47104
 v_mul_f32 v81, s37, v81
 s_waitcnt lgkmcnt(7)
 v_mfma_f32_16x16x32_bf16 v[8:11], v[68:71], a[28:31], v[8:11]
 v_mul_f32 v82, s37, v82
 v_mfma_f32_16x16x32_bf16 v[16:19], v[68:71], a[60:63], v[16:19]
 v_mul_f32 v83, s37, v83
 v_mfma_f32_16x16x32_bf16 v[24:27], v[68:71], a[92:95], v[24:27]
 ds_read_b128 v[68:71], v108 offset:48128
 v_mul_f32 v84, s37, v84
 s_waitcnt lgkmcnt(7)
 v_mfma_f32_16x16x32_bf16 v[12:15], v[40:43], a[0:3], 0
 s_add_u32 m0, s59, 131072
 v_mul_f32 v85, s37, v85
 v_mfma_f32_16x16x32_bf16 v[20:23], v[40:43], a[32:35], 0
 buffer_load_dwordx4 v104, s[8:11], s66 offen lds
 v_mul_f32 v86, s37, v86
 v_mfma_f32_16x16x32_bf16 v[28:31], v[40:43], a[64:67], 0
 v_mul_f32 v87, s37, v87
 s_waitcnt lgkmcnt(6)
 v_mfma_f32_16x16x32_bf16 v[12:15], v[44:47], a[4:7], v[12:15]
 v_cvt_pk_bf16_f32 v148, v80, v81
 v_mfma_f32_16x16x32_bf16 v[20:23], v[44:47], a[36:39], v[20:23]
 v_cvt_pk_bf16_f32 v149, v82, v83
 v_mfma_f32_16x16x32_bf16 v[28:31], v[44:47], a[68:71], v[28:31]
 v_cvt_pk_bf16_f32 v150, v84, v85
 s_waitcnt lgkmcnt(5)
 v_mfma_f32_16x16x32_bf16 v[12:15], v[48:51], a[8:11], v[12:15]
 s_add_u32 m0, s59, 132032
 v_cvt_pk_bf16_f32 v151, v86, v87
 v_mfma_f32_16x16x32_bf16 v[20:23], v[48:51], a[40:43], v[20:23]
 buffer_load_dwordx4 v104, s[8:11], s66 offen offset:64 lds
 s_add_u32 s66, s66, 32768
 v_mul_f32 v88, s37, v88
 v_mfma_f32_16x16x32_bf16 v[28:31], v[48:51], a[72:75], v[28:31]
 v_mul_f32 v89, s37, v89
 s_waitcnt lgkmcnt(4)
 v_mfma_f32_16x16x32_bf16 v[12:15], v[52:55], a[12:15], v[12:15]
 v_mul_f32 v90, s37, v90
 v_mfma_f32_16x16x32_bf16 v[20:23], v[52:55], a[44:47], v[20:23]
 v_mul_f32 v91, s37, v91
 v_mfma_f32_16x16x32_bf16 v[28:31], v[52:55], a[76:79], v[28:31]
 v_mul_f32 v92, s37, v92
 s_waitcnt lgkmcnt(3)
 v_mfma_f32_16x16x32_bf16 v[12:15], v[56:59], a[16:19], v[12:15]
 s_add_u32 m0, s59, 139264
 v_mul_f32 v93, s37, v93
 v_mfma_f32_16x16x32_bf16 v[20:23], v[56:59], a[48:51], v[20:23]
 buffer_load_dwordx4 v104, s[8:11], s66 offen lds
 v_mul_f32 v94, s37, v94
 v_mfma_f32_16x16x32_bf16 v[28:31], v[56:59], a[80:83], v[28:31]
 v_mul_f32 v95, s37, v95
 s_waitcnt lgkmcnt(2)
 v_mfma_f32_16x16x32_bf16 v[12:15], v[60:63], a[20:23], v[12:15]
 v_cvt_pk_bf16_f32 v204, v88, v89
 v_mfma_f32_16x16x32_bf16 v[20:23], v[60:63], a[52:55], v[20:23]
 v_cvt_pk_bf16_f32 v205, v90, v91
 v_mfma_f32_16x16x32_bf16 v[28:31], v[60:63], a[84:87], v[28:31]
 v_cvt_pk_bf16_f32 v206, v92, v93
 s_waitcnt lgkmcnt(1)
 v_mfma_f32_16x16x32_bf16 v[12:15], v[64:67], a[24:27], v[12:15]
 s_add_u32 m0, s59, 140224
 v_cvt_pk_bf16_f32 v207, v94, v95
 v_mfma_f32_16x16x32_bf16 v[20:23], v[64:67], a[56:59], v[20:23]
 buffer_load_dwordx4 v104, s[8:11], s66 offen offset:64 lds
 s_add_u32 s66, s66, 229376
 v_mfma_f32_16x16x32_bf16 v[28:31], v[64:67], a[88:91], v[28:31]
 s_waitcnt lgkmcnt(0)
 v_mfma_f32_16x16x32_bf16 v[12:15], v[68:71], a[28:31], v[12:15]
 v_mfma_f32_16x16x32_bf16 v[20:23], v[68:71], a[60:63], v[20:23]
 v_mfma_f32_16x16x32_bf16 v[28:31], v[68:71], a[92:95], v[28:31]
 s_waitcnt vmcnt(12)
 s_barrier
 ds_read_b128 v[40:43], v113 offset:0
 ds_read_b128 v[44:47], v113 offset:1024
 ds_read_b128 v[48:51], v113 offset:2048
 ds_read_b128 v[52:55], v113 offset:3072
 ds_read_b128 v[56:59], v113 offset:4096
 ds_read_b128 v[60:63], v113 offset:5120
 ds_read_b128 v[64:67], v113 offset:6144
 ds_read_b128 v[68:71], v113 offset:7168
 s_waitcnt lgkmcnt(7)
 v_mfma_f32_16x16x32_bf16 v[72:75], v[40:43], a[0:3], 0
 s_add_u32 m0, s59, 0
 v_mfma_f32_16x16x32_bf16 v[80:83], v[40:43], a[32:35], 0
 buffer_load_dwordx4 v104, s[8:11], s66 offen lds
 v_mfma_f32_16x16x32_bf16 v[88:91], v[40:43], a[64:67], 0
 ds_read_b128 v[40:43], v113 offset:8192
 s_waitcnt lgkmcnt(7)
 v_mfma_f32_16x16x32_bf16 v[72:75], v[44:47], a[4:7], v[72:75]
 v_mul_f32 v8, s37, v8
 v_mfma_f32_16x16x32_bf16 v[80:83], v[44:47], a[36:39], v[80:83]
 v_mul_f32 v9, s37, v9
 v_mfma_f32_16x16x32_bf16 v[88:91], v[44:47], a[68:71], v[88:91]
 ds_read_b128 v[44:47], v113 offset:9216
 v_mul_f32 v10, s37, v10
 s_waitcnt lgkmcnt(7)
 v_mfma_f32_16x16x32_bf16 v[72:75], v[48:51], a[8:11], v[72:75]
 s_add_u32 m0, s59, 960
 v_mul_f32 v11, s37, v11
 v_mfma_f32_16x16x32_bf16 v[80:83], v[48:51], a[40:43], v[80:83]
 buffer_load_dwordx4 v104, s[8:11], s66 offen offset:64 lds
 s_add_u32 s66, s66, 32768
 v_mul_f32 v12, s37, v12
 v_mfma_f32_16x16x32_bf16 v[88:91], v[48:51], a[72:75], v[88:91]
 ds_read_b128 v[48:51], v113 offset:10240
 v_mul_f32 v13, s37, v13
 s_waitcnt lgkmcnt(7)
 v_mfma_f32_16x16x32_bf16 v[72:75], v[52:55], a[12:15], v[72:75]
 v_mul_f32 v14, s37, v14
 v_mfma_f32_16x16x32_bf16 v[80:83], v[52:55], a[44:47], v[80:83]
 v_mul_f32 v15, s37, v15
 v_mfma_f32_16x16x32_bf16 v[88:91], v[52:55], a[76:79], v[88:91]
 ds_read_b128 v[52:55], v113 offset:11264
 v_cvt_pk_bf16_f32 v32, v8, v9
 s_waitcnt lgkmcnt(7)
 v_mfma_f32_16x16x32_bf16 v[72:75], v[56:59], a[16:19], v[72:75]
 s_add_u32 m0, s59, 8192
 v_cvt_pk_bf16_f32 v33, v10, v11
 v_mfma_f32_16x16x32_bf16 v[80:83], v[56:59], a[48:51], v[80:83]
 buffer_load_dwordx4 v104, s[8:11], s66 offen lds
 v_cvt_pk_bf16_f32 v34, v12, v13
 v_mfma_f32_16x16x32_bf16 v[88:91], v[56:59], a[80:83], v[88:91]
 ds_read_b128 v[56:59], v113 offset:12288
 v_cvt_pk_bf16_f32 v35, v14, v15
 s_waitcnt lgkmcnt(7)
 v_mfma_f32_16x16x32_bf16 v[72:75], v[60:63], a[20:23], v[72:75]
 v_accvgpr_write_b32 a232, v32
 v_mfma_f32_16x16x32_bf16 v[80:83], v[60:63], a[52:55], v[80:83]
 v_accvgpr_write_b32 a233, v33
 v_mfma_f32_16x16x32_bf16 v[88:91], v[60:63], a[84:87], v[88:91]
 ds_read_b128 v[60:63], v113 offset:13312
 v_accvgpr_write_b32 a234, v34
 s_waitcnt lgkmcnt(7)
 v_mfma_f32_16x16x32_bf16 v[72:75], v[64:67], a[24:27], v[72:75]
 s_add_u32 m0, s59, 9152
 v_accvgpr_write_b32 a235, v35
 v_mfma_f32_16x16x32_bf16 v[80:83], v[64:67], a[56:59], v[80:83]
 buffer_load_dwordx4 v104, s[8:11], s66 offen offset:64 lds
 s_add_u32 s66, s66, 229376
 v_mul_f32 v16, s37, v16
 v_mfma_f32_16x16x32_bf16 v[88:91], v[64:67], a[88:91], v[88:91]
 ds_read_b128 v[64:67], v113 offset:14336
 v_mul_f32 v17, s37, v17
 s_waitcnt lgkmcnt(7)
 v_mfma_f32_16x16x32_bf16 v[72:75], v[68:71], a[28:31], v[72:75]
 v_mul_f32 v18, s37, v18
 v_mfma_f32_16x16x32_bf16 v[80:83], v[68:71], a[60:63], v[80:83]
 v_mul_f32 v19, s37, v19
 v_mfma_f32_16x16x32_bf16 v[88:91], v[68:71], a[92:95], v[88:91]
 ds_read_b128 v[68:71], v113 offset:15360
 v_mul_f32 v20, s37, v20
 s_waitcnt lgkmcnt(7)
 v_mfma_f32_16x16x32_bf16 v[76:79], v[40:43], a[0:3], 0
 s_add_u32 m0, s59, 16384
 v_mul_f32 v21, s37, v21
 v_mfma_f32_16x16x32_bf16 v[84:87], v[40:43], a[32:35], 0
 buffer_load_dwordx4 v104, s[8:11], s66 offen lds
 v_mul_f32 v22, s37, v22
 v_mfma_f32_16x16x32_bf16 v[92:95], v[40:43], a[64:67], 0
 ds_read_b128 v[40:43], v113 offset:16384
 v_mul_f32 v23, s37, v23
 s_waitcnt lgkmcnt(7)
 v_mfma_f32_16x16x32_bf16 v[76:79], v[44:47], a[4:7], v[76:79]
 v_cvt_pk_bf16_f32 v152, v16, v17
 v_mfma_f32_16x16x32_bf16 v[84:87], v[44:47], a[36:39], v[84:87]
 v_cvt_pk_bf16_f32 v153, v18, v19
 v_mfma_f32_16x16x32_bf16 v[92:95], v[44:47], a[68:71], v[92:95]
 ds_read_b128 v[44:47], v113 offset:17408
 v_cvt_pk_bf16_f32 v154, v20, v21
 s_waitcnt lgkmcnt(7)
 v_mfma_f32_16x16x32_bf16 v[76:79], v[48:51], a[8:11], v[76:79]
 s_add_u32 m0, s59, 17344
 v_cvt_pk_bf16_f32 v155, v22, v23
 v_mfma_f32_16x16x32_bf16 v[84:87], v[48:51], a[40:43], v[84:87]
 buffer_load_dwordx4 v104, s[8:11], s66 offen offset:64 lds
 s_add_u32 s66, s66, 32768
 v_mul_f32 v24, s37, v24
 v_mfma_f32_16x16x32_bf16 v[92:95], v[48:51], a[72:75], v[92:95]
 ds_read_b128 v[48:51], v113 offset:18432
 v_mul_f32 v25, s37, v25
 s_waitcnt lgkmcnt(7)
 v_mfma_f32_16x16x32_bf16 v[76:79], v[52:55], a[12:15], v[76:79]
 v_mul_f32 v26, s37, v26
 v_mfma_f32_16x16x32_bf16 v[84:87], v[52:55], a[44:47], v[84:87]
 v_mul_f32 v27, s37, v27
 v_mfma_f32_16x16x32_bf16 v[92:95], v[52:55], a[76:79], v[92:95]
 ds_read_b128 v[52:55], v113 offset:19456
 v_mul_f32 v28, s37, v28
 s_waitcnt lgkmcnt(7)
 v_mfma_f32_16x16x32_bf16 v[76:79], v[56:59], a[16:19], v[76:79]
 s_add_u32 m0, s59, 24576
 v_mul_f32 v29, s37, v29
 v_mfma_f32_16x16x32_bf16 v[84:87], v[56:59], a[48:51], v[84:87]
 buffer_load_dwordx4 v104, s[8:11], s66 offen lds
 v_mul_f32 v30, s37, v30
 v_mfma_f32_16x16x32_bf16 v[92:95], v[56:59], a[80:83], v[92:95]
 ds_read_b128 v[56:59], v113 offset:20480
 v_mul_f32 v31, s37, v31
 s_waitcnt lgkmcnt(7)
 v_mfma_f32_16x16x32_bf16 v[76:79], v[60:63], a[20:23], v[76:79]
 v_cvt_pk_bf16_f32 v208, v24, v25
 v_mfma_f32_16x16x32_bf16 v[84:87], v[60:63], a[52:55], v[84:87]
 v_cvt_pk_bf16_f32 v209, v26, v27
 v_mfma_f32_16x16x32_bf16 v[92:95], v[60:63], a[84:87], v[92:95]
 ds_read_b128 v[60:63], v113 offset:21504
 v_cvt_pk_bf16_f32 v210, v28, v29
 s_waitcnt lgkmcnt(7)
 v_mfma_f32_16x16x32_bf16 v[76:79], v[64:67], a[24:27], v[76:79]
 s_add_u32 m0, s59, 25536
 v_cvt_pk_bf16_f32 v211, v30, v31
 v_mfma_f32_16x16x32_bf16 v[84:87], v[64:67], a[56:59], v[84:87]
 buffer_load_dwordx4 v104, s[8:11], s66 offen offset:64 lds
 s_add_u32 s66, s66, 229376
 v_mfma_f32_16x16x32_bf16 v[92:95], v[64:67], a[88:91], v[92:95]
 ds_read_b128 v[64:67], v113 offset:22528
 s_waitcnt lgkmcnt(7)
 v_mfma_f32_16x16x32_bf16 v[76:79], v[68:71], a[28:31], v[76:79]
 v_mfma_f32_16x16x32_bf16 v[84:87], v[68:71], a[60:63], v[84:87]
 v_mfma_f32_16x16x32_bf16 v[92:95], v[68:71], a[92:95], v[92:95]
 ds_read_b128 v[68:71], v113 offset:23552
 s_waitcnt lgkmcnt(7)
 v_mfma_f32_16x16x32_bf16 v[8:11], v[40:43], a[0:3], 0
 s_add_u32 m0, s59, 32768
 v_mfma_f32_16x16x32_bf16 v[16:19], v[40:43], a[32:35], 0
 buffer_load_dwordx4 v104, s[8:11], s66 offen lds
 v_mfma_f32_16x16x32_bf16 v[24:27], v[40:43], a[64:67], 0
 ds_read_b128 v[40:43], v113 offset:24576
 s_waitcnt lgkmcnt(7)
 v_mfma_f32_16x16x32_bf16 v[8:11], v[44:47], a[4:7], v[8:11]
 v_mul_f32 v72, s37, v72
 v_mfma_f32_16x16x32_bf16 v[16:19], v[44:47], a[36:39], v[16:19]
 v_mul_f32 v73, s37, v73
 v_mfma_f32_16x16x32_bf16 v[24:27], v[44:47], a[68:71], v[24:27]
 ds_read_b128 v[44:47], v113 offset:25600
 v_mul_f32 v74, s37, v74
 s_waitcnt lgkmcnt(7)
 v_mfma_f32_16x16x32_bf16 v[8:11], v[48:51], a[8:11], v[8:11]
 s_add_u32 m0, s59, 33728
 v_mul_f32 v75, s37, v75
 v_mfma_f32_16x16x32_bf16 v[16:19], v[48:51], a[40:43], v[16:19]
 buffer_load_dwordx4 v104, s[8:11], s66 offen offset:64 lds
 s_add_u32 s66, s66, 32768
 v_mul_f32 v76, s37, v76
 v_mfma_f32_16x16x32_bf16 v[24:27], v[48:51], a[72:75], v[24:27]
 ds_read_b128 v[48:51], v113 offset:26624
 v_mul_f32 v77, s37, v77
 s_waitcnt lgkmcnt(7)
 v_mfma_f32_16x16x32_bf16 v[8:11], v[52:55], a[12:15], v[8:11]
 v_mul_f32 v78, s37, v78
 v_mfma_f32_16x16x32_bf16 v[16:19], v[52:55], a[44:47], v[16:19]
 v_mul_f32 v79, s37, v79
 v_mfma_f32_16x16x32_bf16 v[24:27], v[52:55], a[76:79], v[24:27]
 ds_read_b128 v[52:55], v113 offset:27648
 v_cvt_pk_bf16_f32 v32, v72, v73
 s_waitcnt lgkmcnt(7)
 v_mfma_f32_16x16x32_bf16 v[8:11], v[56:59], a[16:19], v[8:11]
 s_add_u32 m0, s59, 40960
 v_cvt_pk_bf16_f32 v33, v74, v75
 v_mfma_f32_16x16x32_bf16 v[16:19], v[56:59], a[48:51], v[16:19]
 buffer_load_dwordx4 v104, s[8:11], s66 offen lds
 v_cvt_pk_bf16_f32 v34, v76, v77
 v_mfma_f32_16x16x32_bf16 v[24:27], v[56:59], a[80:83], v[24:27]
 ds_read_b128 v[56:59], v113 offset:28672
 v_cvt_pk_bf16_f32 v35, v78, v79
 s_waitcnt lgkmcnt(7)
 v_mfma_f32_16x16x32_bf16 v[8:11], v[60:63], a[20:23], v[8:11]
 v_accvgpr_write_b32 a236, v32
 v_mfma_f32_16x16x32_bf16 v[16:19], v[60:63], a[52:55], v[16:19]
 v_accvgpr_write_b32 a237, v33
 v_mfma_f32_16x16x32_bf16 v[24:27], v[60:63], a[84:87], v[24:27]
 ds_read_b128 v[60:63], v113 offset:29696
 v_accvgpr_write_b32 a238, v34
 s_waitcnt lgkmcnt(7)
 v_mfma_f32_16x16x32_bf16 v[8:11], v[64:67], a[24:27], v[8:11]
 s_add_u32 m0, s59, 41920
 v_accvgpr_write_b32 a239, v35
 v_mfma_f32_16x16x32_bf16 v[16:19], v[64:67], a[56:59], v[16:19]
 buffer_load_dwordx4 v104, s[8:11], s66 offen offset:64 lds
 s_add_u32 s66, s66, 229376
 v_mul_f32 v80, s37, v80
 v_mfma_f32_16x16x32_bf16 v[24:27], v[64:67], a[88:91], v[24:27]
 ds_read_b128 v[64:67], v113 offset:30720
 v_mul_f32 v81, s37, v81
 s_waitcnt lgkmcnt(7)
 v_mfma_f32_16x16x32_bf16 v[8:11], v[68:71], a[28:31], v[8:11]
 v_mul_f32 v82, s37, v82
 v_mfma_f32_16x16x32_bf16 v[16:19], v[68:71], a[60:63], v[16:19]
 v_mul_f32 v83, s37, v83
 v_mfma_f32_16x16x32_bf16 v[24:27], v[68:71], a[92:95], v[24:27]
 ds_read_b128 v[68:71], v113 offset:31744
 v_mul_f32 v84, s37, v84
 s_waitcnt lgkmcnt(7)
 v_mfma_f32_16x16x32_bf16 v[12:15], v[40:43], a[0:3], 0
 v_mul_f32 v85, s37, v85
 v_mfma_f32_16x16x32_bf16 v[20:23], v[40:43], a[32:35], 0
 v_mul_f32 v86, s37, v86
 v_mfma_f32_16x16x32_bf16 v[28:31], v[40:43], a[64:67], 0
 ds_read_b128 v[40:43], v113 offset:32768
 v_mul_f32 v87, s37, v87
 s_waitcnt lgkmcnt(7)
 v_mfma_f32_16x16x32_bf16 v[12:15], v[44:47], a[4:7], v[12:15]
 v_cvt_pk_bf16_f32 v156, v80, v81
 v_mfma_f32_16x16x32_bf16 v[20:23], v[44:47], a[36:39], v[20:23]
 v_cvt_pk_bf16_f32 v157, v82, v83
 v_mfma_f32_16x16x32_bf16 v[28:31], v[44:47], a[68:71], v[28:31]
 ds_read_b128 v[44:47], v113 offset:33792
 v_cvt_pk_bf16_f32 v158, v84, v85
 s_waitcnt lgkmcnt(7)
 v_mfma_f32_16x16x32_bf16 v[12:15], v[48:51], a[8:11], v[12:15]
 v_cvt_pk_bf16_f32 v159, v86, v87
 v_mfma_f32_16x16x32_bf16 v[20:23], v[48:51], a[40:43], v[20:23]
 v_mul_f32 v88, s37, v88
 v_mfma_f32_16x16x32_bf16 v[28:31], v[48:51], a[72:75], v[28:31]
 ds_read_b128 v[48:51], v113 offset:34816
 v_mul_f32 v89, s37, v89
 s_waitcnt lgkmcnt(7)
 v_mfma_f32_16x16x32_bf16 v[12:15], v[52:55], a[12:15], v[12:15]
 v_mul_f32 v90, s37, v90
 v_mfma_f32_16x16x32_bf16 v[20:23], v[52:55], a[44:47], v[20:23]
 v_mul_f32 v91, s37, v91
 v_mfma_f32_16x16x32_bf16 v[28:31], v[52:55], a[76:79], v[28:31]
 ds_read_b128 v[52:55], v113 offset:35840
 v_mul_f32 v92, s37, v92
 s_waitcnt lgkmcnt(7)
 v_mfma_f32_16x16x32_bf16 v[12:15], v[56:59], a[16:19], v[12:15]
 v_mul_f32 v93, s37, v93
 v_mfma_f32_16x16x32_bf16 v[20:23], v[56:59], a[48:51], v[20:23]
 v_mul_f32 v94, s37, v94
 v_mfma_f32_16x16x32_bf16 v[28:31], v[56:59], a[80:83], v[28:31]
 ds_read_b128 v[56:59], v113 offset:36864
 v_mul_f32 v95, s37, v95
 s_waitcnt lgkmcnt(7)
 v_mfma_f32_16x16x32_bf16 v[12:15], v[60:63], a[20:23], v[12:15]
 v_cvt_pk_bf16_f32 v212, v88, v89
 v_mfma_f32_16x16x32_bf16 v[20:23], v[60:63], a[52:55], v[20:23]
 v_cvt_pk_bf16_f32 v213, v90, v91
 v_mfma_f32_16x16x32_bf16 v[28:31], v[60:63], a[84:87], v[28:31]
 ds_read_b128 v[60:63], v113 offset:37888
 v_cvt_pk_bf16_f32 v214, v92, v93
 s_waitcnt lgkmcnt(7)
 v_mfma_f32_16x16x32_bf16 v[12:15], v[64:67], a[24:27], v[12:15]
 v_cvt_pk_bf16_f32 v215, v94, v95
 v_mfma_f32_16x16x32_bf16 v[20:23], v[64:67], a[56:59], v[20:23]
 v_mfma_f32_16x16x32_bf16 v[28:31], v[64:67], a[88:91], v[28:31]
 ds_read_b128 v[64:67], v113 offset:38912
 s_waitcnt lgkmcnt(7)
 v_mfma_f32_16x16x32_bf16 v[12:15], v[68:71], a[28:31], v[12:15]
 v_mfma_f32_16x16x32_bf16 v[20:23], v[68:71], a[60:63], v[20:23]
 v_mfma_f32_16x16x32_bf16 v[28:31], v[68:71], a[92:95], v[28:31]
 ds_read_b128 v[68:71], v113 offset:39936
 s_waitcnt lgkmcnt(7)
 v_mfma_f32_16x16x32_bf16 v[72:75], v[40:43], a[0:3], 0
 v_mfma_f32_16x16x32_bf16 v[80:83], v[40:43], a[32:35], 0
 v_mfma_f32_16x16x32_bf16 v[88:91], v[40:43], a[64:67], 0
 ds_read_b128 v[40:43], v113 offset:40960
 s_waitcnt lgkmcnt(7)
 v_mfma_f32_16x16x32_bf16 v[72:75], v[44:47], a[4:7], v[72:75]
 v_mul_f32 v8, s37, v8
 v_mfma_f32_16x16x32_bf16 v[80:83], v[44:47], a[36:39], v[80:83]
 v_mul_f32 v9, s37, v9
 v_mfma_f32_16x16x32_bf16 v[88:91], v[44:47], a[68:71], v[88:91]
 ds_read_b128 v[44:47], v113 offset:41984
 v_mul_f32 v10, s37, v10
 s_waitcnt lgkmcnt(7)
 v_mfma_f32_16x16x32_bf16 v[72:75], v[48:51], a[8:11], v[72:75]
 v_mul_f32 v11, s37, v11
 v_mfma_f32_16x16x32_bf16 v[80:83], v[48:51], a[40:43], v[80:83]
 v_mul_f32 v12, s37, v12
 v_mfma_f32_16x16x32_bf16 v[88:91], v[48:51], a[72:75], v[88:91]
 ds_read_b128 v[48:51], v113 offset:43008
 v_mul_f32 v13, s37, v13
 s_waitcnt lgkmcnt(7)
 v_mfma_f32_16x16x32_bf16 v[72:75], v[52:55], a[12:15], v[72:75]
 v_mul_f32 v14, s37, v14
 v_mfma_f32_16x16x32_bf16 v[80:83], v[52:55], a[44:47], v[80:83]
 v_mul_f32 v15, s37, v15
 v_mfma_f32_16x16x32_bf16 v[88:91], v[52:55], a[76:79], v[88:91]
 ds_read_b128 v[52:55], v113 offset:44032
 v_cvt_pk_bf16_f32 v32, v8, v9
 s_waitcnt lgkmcnt(7)
 v_mfma_f32_16x16x32_bf16 v[72:75], v[56:59], a[16:19], v[72:75]
 v_cvt_pk_bf16_f32 v33, v10, v11
 v_mfma_f32_16x16x32_bf16 v[80:83], v[56:59], a[48:51], v[80:83]
 v_cvt_pk_bf16_f32 v34, v12, v13
 v_mfma_f32_16x16x32_bf16 v[88:91], v[56:59], a[80:83], v[88:91]
 ds_read_b128 v[56:59], v113 offset:45056
 v_cvt_pk_bf16_f32 v35, v14, v15
 s_waitcnt lgkmcnt(7)
 v_mfma_f32_16x16x32_bf16 v[72:75], v[60:63], a[20:23], v[72:75]
 v_accvgpr_write_b32 a240, v32
 v_mfma_f32_16x16x32_bf16 v[80:83], v[60:63], a[52:55], v[80:83]
 v_accvgpr_write_b32 a241, v33
 v_mfma_f32_16x16x32_bf16 v[88:91], v[60:63], a[84:87], v[88:91]
 ds_read_b128 v[60:63], v113 offset:46080
 v_accvgpr_write_b32 a242, v34
 s_waitcnt lgkmcnt(7)
 v_mfma_f32_16x16x32_bf16 v[72:75], v[64:67], a[24:27], v[72:75]
 v_accvgpr_write_b32 a243, v35
 v_mfma_f32_16x16x32_bf16 v[80:83], v[64:67], a[56:59], v[80:83]
 v_mul_f32 v16, s37, v16
 v_mfma_f32_16x16x32_bf16 v[88:91], v[64:67], a[88:91], v[88:91]
 ds_read_b128 v[64:67], v113 offset:47104
 v_mul_f32 v17, s37, v17
 s_waitcnt lgkmcnt(7)
 v_mfma_f32_16x16x32_bf16 v[72:75], v[68:71], a[28:31], v[72:75]
 v_mul_f32 v18, s37, v18
 v_mfma_f32_16x16x32_bf16 v[80:83], v[68:71], a[60:63], v[80:83]
 v_mul_f32 v19, s37, v19
 v_mfma_f32_16x16x32_bf16 v[88:91], v[68:71], a[92:95], v[88:91]
 ds_read_b128 v[68:71], v113 offset:48128
 v_mul_f32 v20, s37, v20
 s_waitcnt lgkmcnt(7)
 v_mfma_f32_16x16x32_bf16 v[76:79], v[40:43], a[0:3], 0
 v_mul_f32 v21, s37, v21
 v_mfma_f32_16x16x32_bf16 v[84:87], v[40:43], a[32:35], 0
 v_mul_f32 v22, s37, v22
 v_mfma_f32_16x16x32_bf16 v[92:95], v[40:43], a[64:67], 0
 v_mul_f32 v23, s37, v23
 s_waitcnt lgkmcnt(6)
 v_mfma_f32_16x16x32_bf16 v[76:79], v[44:47], a[4:7], v[76:79]
 v_cvt_pk_bf16_f32 v160, v16, v17
 v_mfma_f32_16x16x32_bf16 v[84:87], v[44:47], a[36:39], v[84:87]
 v_cvt_pk_bf16_f32 v161, v18, v19
 v_mfma_f32_16x16x32_bf16 v[92:95], v[44:47], a[68:71], v[92:95]
 v_cvt_pk_bf16_f32 v162, v20, v21
 s_waitcnt lgkmcnt(5)
 v_mfma_f32_16x16x32_bf16 v[76:79], v[48:51], a[8:11], v[76:79]
 v_cvt_pk_bf16_f32 v163, v22, v23
 v_mfma_f32_16x16x32_bf16 v[84:87], v[48:51], a[40:43], v[84:87]
 v_mul_f32 v24, s37, v24
 v_mfma_f32_16x16x32_bf16 v[92:95], v[48:51], a[72:75], v[92:95]
 v_mul_f32 v25, s37, v25
 s_waitcnt lgkmcnt(4)
 v_mfma_f32_16x16x32_bf16 v[76:79], v[52:55], a[12:15], v[76:79]
 v_mul_f32 v26, s37, v26
 v_mfma_f32_16x16x32_bf16 v[84:87], v[52:55], a[44:47], v[84:87]
 v_mul_f32 v27, s37, v27
 v_mfma_f32_16x16x32_bf16 v[92:95], v[52:55], a[76:79], v[92:95]
 v_mul_f32 v28, s37, v28
 s_waitcnt lgkmcnt(3)
 v_mfma_f32_16x16x32_bf16 v[76:79], v[56:59], a[16:19], v[76:79]
 v_mul_f32 v29, s37, v29
 v_mfma_f32_16x16x32_bf16 v[84:87], v[56:59], a[48:51], v[84:87]
 v_mul_f32 v30, s37, v30
 v_mfma_f32_16x16x32_bf16 v[92:95], v[56:59], a[80:83], v[92:95]
 v_mul_f32 v31, s37, v31
 s_waitcnt lgkmcnt(2)
 v_mfma_f32_16x16x32_bf16 v[76:79], v[60:63], a[20:23], v[76:79]
 v_cvt_pk_bf16_f32 v216, v24, v25
 v_mfma_f32_16x16x32_bf16 v[84:87], v[60:63], a[52:55], v[84:87]
 v_cvt_pk_bf16_f32 v217, v26, v27
 v_mfma_f32_16x16x32_bf16 v[92:95], v[60:63], a[84:87], v[92:95]
 v_cvt_pk_bf16_f32 v218, v28, v29
 s_waitcnt lgkmcnt(1)
 v_mfma_f32_16x16x32_bf16 v[76:79], v[64:67], a[24:27], v[76:79]
 v_cvt_pk_bf16_f32 v219, v30, v31
 v_mfma_f32_16x16x32_bf16 v[84:87], v[64:67], a[56:59], v[84:87]
 v_mfma_f32_16x16x32_bf16 v[92:95], v[64:67], a[88:91], v[92:95]
 s_waitcnt lgkmcnt(0)
 v_mfma_f32_16x16x32_bf16 v[76:79], v[68:71], a[28:31], v[76:79]
 v_mfma_f32_16x16x32_bf16 v[84:87], v[68:71], a[60:63], v[84:87]
 v_mfma_f32_16x16x32_bf16 v[92:95], v[68:71], a[92:95], v[92:95]
 s_waitcnt vmcnt(12)
 s_barrier
 ds_read_b128 v[40:43], v114 offset:0
 ds_read_b128 v[44:47], v114 offset:1024
 ds_read_b128 v[48:51], v114 offset:2048
 ds_read_b128 v[52:55], v114 offset:3072
 ds_read_b128 v[56:59], v114 offset:4096
 ds_read_b128 v[60:63], v114 offset:5120
 ds_read_b128 v[64:67], v114 offset:6144
 ds_read_b128 v[68:71], v114 offset:7168
 s_waitcnt lgkmcnt(7)
 v_mfma_f32_16x16x32_bf16 v[8:11], v[40:43], a[0:3], 0
 s_add_u32 m0, s59, 49152
 v_mfma_f32_16x16x32_bf16 v[16:19], v[40:43], a[32:35], 0
 buffer_load_dwordx4 v104, s[8:11], s66 offen lds
 v_mfma_f32_16x16x32_bf16 v[24:27], v[40:43], a[64:67], 0
 ds_read_b128 v[40:43], v114 offset:8192
 s_waitcnt lgkmcnt(7)
 v_mfma_f32_16x16x32_bf16 v[8:11], v[44:47], a[4:7], v[8:11]
 v_mul_f32 v72, s37, v72
 v_mfma_f32_16x16x32_bf16 v[16:19], v[44:47], a[36:39], v[16:19]
 v_mul_f32 v73, s37, v73
 v_mfma_f32_16x16x32_bf16 v[24:27], v[44:47], a[68:71], v[24:27]
 ds_read_b128 v[44:47], v114 offset:9216
 v_mul_f32 v74, s37, v74
 s_waitcnt lgkmcnt(7)
 v_mfma_f32_16x16x32_bf16 v[8:11], v[48:51], a[8:11], v[8:11]
 s_add_u32 m0, s59, 50112
 v_mul_f32 v75, s37, v75
 v_mfma_f32_16x16x32_bf16 v[16:19], v[48:51], a[40:43], v[16:19]
 buffer_load_dwordx4 v104, s[8:11], s66 offen offset:64 lds
 s_add_u32 s66, s66, 32768
 v_mul_f32 v76, s37, v76
 v_mfma_f32_16x16x32_bf16 v[24:27], v[48:51], a[72:75], v[24:27]
 ds_read_b128 v[48:51], v114 offset:10240
 v_mul_f32 v77, s37, v77
 s_waitcnt lgkmcnt(7)
 v_mfma_f32_16x16x32_bf16 v[8:11], v[52:55], a[12:15], v[8:11]
 v_mul_f32 v78, s37, v78
 v_mfma_f32_16x16x32_bf16 v[16:19], v[52:55], a[44:47], v[16:19]
 v_mul_f32 v79, s37, v79
 v_mfma_f32_16x16x32_bf16 v[24:27], v[52:55], a[76:79], v[24:27]
 ds_read_b128 v[52:55], v114 offset:11264
 v_cvt_pk_bf16_f32 v32, v72, v73
 s_waitcnt lgkmcnt(7)
 v_mfma_f32_16x16x32_bf16 v[8:11], v[56:59], a[16:19], v[8:11]
 s_add_u32 m0, s59, 57344
 v_cvt_pk_bf16_f32 v33, v74, v75
 v_mfma_f32_16x16x32_bf16 v[16:19], v[56:59], a[48:51], v[16:19]
 buffer_load_dwordx4 v104, s[8:11], s66 offen lds
 v_cvt_pk_bf16_f32 v34, v76, v77
 v_mfma_f32_16x16x32_bf16 v[24:27], v[56:59], a[80:83], v[24:27]
 ds_read_b128 v[56:59], v114 offset:12288
 v_cvt_pk_bf16_f32 v35, v78, v79
 s_waitcnt lgkmcnt(7)
 v_mfma_f32_16x16x32_bf16 v[8:11], v[60:63], a[20:23], v[8:11]
 v_accvgpr_write_b32 a244, v32
 v_mfma_f32_16x16x32_bf16 v[16:19], v[60:63], a[52:55], v[16:19]
 v_accvgpr_write_b32 a245, v33
 v_mfma_f32_16x16x32_bf16 v[24:27], v[60:63], a[84:87], v[24:27]
 ds_read_b128 v[60:63], v114 offset:13312
 v_accvgpr_write_b32 a246, v34
 s_waitcnt lgkmcnt(7)
 v_mfma_f32_16x16x32_bf16 v[8:11], v[64:67], a[24:27], v[8:11]
 s_add_u32 m0, s59, 58304
 v_accvgpr_write_b32 a247, v35
 v_mfma_f32_16x16x32_bf16 v[16:19], v[64:67], a[56:59], v[16:19]
 buffer_load_dwordx4 v104, s[8:11], s66 offen offset:64 lds
 s_add_u32 s66, s66, 229376
 v_mul_f32 v80, s37, v80
 v_mfma_f32_16x16x32_bf16 v[24:27], v[64:67], a[88:91], v[24:27]
 ds_read_b128 v[64:67], v114 offset:14336
 v_mul_f32 v81, s37, v81
 s_waitcnt lgkmcnt(7)
 v_mfma_f32_16x16x32_bf16 v[8:11], v[68:71], a[28:31], v[8:11]
 v_mul_f32 v82, s37, v82
 v_mfma_f32_16x16x32_bf16 v[16:19], v[68:71], a[60:63], v[16:19]
 v_mul_f32 v83, s37, v83
 v_mfma_f32_16x16x32_bf16 v[24:27], v[68:71], a[92:95], v[24:27]
 ds_read_b128 v[68:71], v114 offset:15360
 v_mul_f32 v84, s37, v84
 s_waitcnt lgkmcnt(7)
 v_mfma_f32_16x16x32_bf16 v[12:15], v[40:43], a[0:3], 0
 s_add_u32 m0, s59, 65536
 v_mul_f32 v85, s37, v85
 v_mfma_f32_16x16x32_bf16 v[20:23], v[40:43], a[32:35], 0
 buffer_load_dwordx4 v104, s[8:11], s66 offen lds
 v_mul_f32 v86, s37, v86
 v_mfma_f32_16x16x32_bf16 v[28:31], v[40:43], a[64:67], 0
 ds_read_b128 v[40:43], v114 offset:16384
 v_mul_f32 v87, s37, v87
 s_waitcnt lgkmcnt(7)
 v_mfma_f32_16x16x32_bf16 v[12:15], v[44:47], a[4:7], v[12:15]
 v_cvt_pk_bf16_f32 v164, v80, v81
 v_mfma_f32_16x16x32_bf16 v[20:23], v[44:47], a[36:39], v[20:23]
 v_cvt_pk_bf16_f32 v165, v82, v83
 v_mfma_f32_16x16x32_bf16 v[28:31], v[44:47], a[68:71], v[28:31]
 ds_read_b128 v[44:47], v114 offset:17408
 v_cvt_pk_bf16_f32 v166, v84, v85
 s_waitcnt lgkmcnt(7)
 v_mfma_f32_16x16x32_bf16 v[12:15], v[48:51], a[8:11], v[12:15]
 s_add_u32 m0, s59, 66496
 v_cvt_pk_bf16_f32 v167, v86, v87
 v_mfma_f32_16x16x32_bf16 v[20:23], v[48:51], a[40:43], v[20:23]
 buffer_load_dwordx4 v104, s[8:11], s66 offen offset:64 lds
 s_add_u32 s66, s66, 32768
 v_mul_f32 v88, s37, v88
 v_mfma_f32_16x16x32_bf16 v[28:31], v[48:51], a[72:75], v[28:31]
 ds_read_b128 v[48:51], v114 offset:18432
 v_mul_f32 v89, s37, v89
 s_waitcnt lgkmcnt(7)
 v_mfma_f32_16x16x32_bf16 v[12:15], v[52:55], a[12:15], v[12:15]
 v_mul_f32 v90, s37, v90
 v_mfma_f32_16x16x32_bf16 v[20:23], v[52:55], a[44:47], v[20:23]
 v_mul_f32 v91, s37, v91
 v_mfma_f32_16x16x32_bf16 v[28:31], v[52:55], a[76:79], v[28:31]
 ds_read_b128 v[52:55], v114 offset:19456
 v_mul_f32 v92, s37, v92
 s_waitcnt lgkmcnt(7)
 v_mfma_f32_16x16x32_bf16 v[12:15], v[56:59], a[16:19], v[12:15]
 s_add_u32 m0, s59, 73728
 v_mul_f32 v93, s37, v93
 v_mfma_f32_16x16x32_bf16 v[20:23], v[56:59], a[48:51], v[20:23]
 buffer_load_dwordx4 v104, s[8:11], s66 offen lds
 v_mul_f32 v94, s37, v94
 v_mfma_f32_16x16x32_bf16 v[28:31], v[56:59], a[80:83], v[28:31]
 ds_read_b128 v[56:59], v114 offset:20480
 v_mul_f32 v95, s37, v95
 s_waitcnt lgkmcnt(7)
 v_mfma_f32_16x16x32_bf16 v[12:15], v[60:63], a[20:23], v[12:15]
 v_cvt_pk_bf16_f32 v220, v88, v89
 v_mfma_f32_16x16x32_bf16 v[20:23], v[60:63], a[52:55], v[20:23]
 v_cvt_pk_bf16_f32 v221, v90, v91
 v_mfma_f32_16x16x32_bf16 v[28:31], v[60:63], a[84:87], v[28:31]
 ds_read_b128 v[60:63], v114 offset:21504
 v_cvt_pk_bf16_f32 v222, v92, v93
 s_waitcnt lgkmcnt(7)
 v_mfma_f32_16x16x32_bf16 v[12:15], v[64:67], a[24:27], v[12:15]
 s_add_u32 m0, s59, 74688
 v_cvt_pk_bf16_f32 v223, v94, v95
 v_mfma_f32_16x16x32_bf16 v[20:23], v[64:67], a[56:59], v[20:23]
 buffer_load_dwordx4 v104, s[8:11], s66 offen offset:64 lds
 s_add_u32 s66, s66, 229376
 v_mfma_f32_16x16x32_bf16 v[28:31], v[64:67], a[88:91], v[28:31]
 ds_read_b128 v[64:67], v114 offset:22528
 s_waitcnt lgkmcnt(7)
 v_mfma_f32_16x16x32_bf16 v[12:15], v[68:71], a[28:31], v[12:15]
 v_mfma_f32_16x16x32_bf16 v[20:23], v[68:71], a[60:63], v[20:23]
 v_mfma_f32_16x16x32_bf16 v[28:31], v[68:71], a[92:95], v[28:31]
 ds_read_b128 v[68:71], v114 offset:23552
 s_waitcnt lgkmcnt(7)
 v_mfma_f32_16x16x32_bf16 v[72:75], v[40:43], a[0:3], 0
 v_mfma_f32_16x16x32_bf16 v[80:83], v[40:43], a[32:35], 0
 v_mfma_f32_16x16x32_bf16 v[88:91], v[40:43], a[64:67], 0
 ds_read_b128 v[40:43], v114 offset:24576
 s_waitcnt lgkmcnt(7)
 v_mfma_f32_16x16x32_bf16 v[72:75], v[44:47], a[4:7], v[72:75]
 v_mul_f32 v8, s37, v8
 v_mfma_f32_16x16x32_bf16 v[80:83], v[44:47], a[36:39], v[80:83]
 v_mul_f32 v9, s37, v9
 v_mfma_f32_16x16x32_bf16 v[88:91], v[44:47], a[68:71], v[88:91]
 ds_read_b128 v[44:47], v114 offset:25600
 v_mul_f32 v10, s37, v10
 s_waitcnt lgkmcnt(7)
 v_mfma_f32_16x16x32_bf16 v[72:75], v[48:51], a[8:11], v[72:75]
 v_mul_f32 v11, s37, v11
 v_mfma_f32_16x16x32_bf16 v[80:83], v[48:51], a[40:43], v[80:83]
 v_mul_f32 v12, s37, v12
 v_mfma_f32_16x16x32_bf16 v[88:91], v[48:51], a[72:75], v[88:91]
 ds_read_b128 v[48:51], v114 offset:26624
 v_mul_f32 v13, s37, v13
 s_waitcnt lgkmcnt(7)
 v_mfma_f32_16x16x32_bf16 v[72:75], v[52:55], a[12:15], v[72:75]
 v_mul_f32 v14, s37, v14
 v_mfma_f32_16x16x32_bf16 v[80:83], v[52:55], a[44:47], v[80:83]
 v_mul_f32 v15, s37, v15
 v_mfma_f32_16x16x32_bf16 v[88:91], v[52:55], a[76:79], v[88:91]
 ds_read_b128 v[52:55], v114 offset:27648
 v_cvt_pk_bf16_f32 v32, v8, v9
 s_waitcnt lgkmcnt(7)
 v_mfma_f32_16x16x32_bf16 v[72:75], v[56:59], a[16:19], v[72:75]
 v_cvt_pk_bf16_f32 v33, v10, v11
 v_mfma_f32_16x16x32_bf16 v[80:83], v[56:59], a[48:51], v[80:83]
 v_cvt_pk_bf16_f32 v34, v12, v13
 v_mfma_f32_16x16x32_bf16 v[88:91], v[56:59], a[80:83], v[88:91]
 ds_read_b128 v[56:59], v114 offset:28672
 v_cvt_pk_bf16_f32 v35, v14, v15
 s_waitcnt lgkmcnt(7)
 v_mfma_f32_16x16x32_bf16 v[72:75], v[60:63], a[20:23], v[72:75]
 v_accvgpr_write_b32 a248, v32
 v_mfma_f32_16x16x32_bf16 v[80:83], v[60:63], a[52:55], v[80:83]
 v_accvgpr_write_b32 a249, v33
 v_mfma_f32_16x16x32_bf16 v[88:91], v[60:63], a[84:87], v[88:91]
 ds_read_b128 v[60:63], v114 offset:29696
 v_accvgpr_write_b32 a250, v34
 s_waitcnt lgkmcnt(7)
 v_mfma_f32_16x16x32_bf16 v[72:75], v[64:67], a[24:27], v[72:75]
 v_accvgpr_write_b32 a251, v35
 v_mfma_f32_16x16x32_bf16 v[80:83], v[64:67], a[56:59], v[80:83]
 v_mul_f32 v16, s37, v16
 v_mfma_f32_16x16x32_bf16 v[88:91], v[64:67], a[88:91], v[88:91]
 ds_read_b128 v[64:67], v114 offset:30720
 v_mul_f32 v17, s37, v17
 s_waitcnt lgkmcnt(7)
 v_mfma_f32_16x16x32_bf16 v[72:75], v[68:71], a[28:31], v[72:75]
 v_mul_f32 v18, s37, v18
 v_mfma_f32_16x16x32_bf16 v[80:83], v[68:71], a[60:63], v[80:83]
 v_mul_f32 v19, s37, v19
 v_mfma_f32_16x16x32_bf16 v[88:91], v[68:71], a[92:95], v[88:91]
 ds_read_b128 v[68:71], v114 offset:31744
 v_mul_f32 v20, s37, v20
 s_waitcnt lgkmcnt(7)
 v_mfma_f32_16x16x32_bf16 v[76:79], v[40:43], a[0:3], 0
 v_mul_f32 v21, s37, v21
 v_mfma_f32_16x16x32_bf16 v[84:87], v[40:43], a[32:35], 0
 v_mul_f32 v22, s37, v22
 v_mfma_f32_16x16x32_bf16 v[92:95], v[40:43], a[64:67], 0
 ds_read_b128 v[40:43], v114 offset:32768
 v_mul_f32 v23, s37, v23
 s_waitcnt lgkmcnt(7)
 v_mfma_f32_16x16x32_bf16 v[76:79], v[44:47], a[4:7], v[76:79]
 v_cvt_pk_bf16_f32 v168, v16, v17
 v_mfma_f32_16x16x32_bf16 v[84:87], v[44:47], a[36:39], v[84:87]
 v_cvt_pk_bf16_f32 v169, v18, v19
 v_mfma_f32_16x16x32_bf16 v[92:95], v[44:47], a[68:71], v[92:95]
 ds_read_b128 v[44:47], v114 offset:33792
 v_cvt_pk_bf16_f32 v170, v20, v21
 s_waitcnt lgkmcnt(7)
 v_mfma_f32_16x16x32_bf16 v[76:79], v[48:51], a[8:11], v[76:79]
 v_cvt_pk_bf16_f32 v171, v22, v23
 v_mfma_f32_16x16x32_bf16 v[84:87], v[48:51], a[40:43], v[84:87]
 v_mul_f32 v24, s37, v24
 v_mfma_f32_16x16x32_bf16 v[92:95], v[48:51], a[72:75], v[92:95]
 ds_read_b128 v[48:51], v114 offset:34816
 v_mul_f32 v25, s37, v25
 s_waitcnt lgkmcnt(7)
 v_mfma_f32_16x16x32_bf16 v[76:79], v[52:55], a[12:15], v[76:79]
 v_mul_f32 v26, s37, v26
 v_mfma_f32_16x16x32_bf16 v[84:87], v[52:55], a[44:47], v[84:87]
 v_mul_f32 v27, s37, v27
 v_mfma_f32_16x16x32_bf16 v[92:95], v[52:55], a[76:79], v[92:95]
 ds_read_b128 v[52:55], v114 offset:35840
 v_mul_f32 v28, s37, v28
 s_waitcnt lgkmcnt(7)
 v_mfma_f32_16x16x32_bf16 v[76:79], v[56:59], a[16:19], v[76:79]
 v_mul_f32 v29, s37, v29
 v_mfma_f32_16x16x32_bf16 v[84:87], v[56:59], a[48:51], v[84:87]
 v_mul_f32 v30, s37, v30
 v_mfma_f32_16x16x32_bf16 v[92:95], v[56:59], a[80:83], v[92:95]
 ds_read_b128 v[56:59], v114 offset:36864
 v_mul_f32 v31, s37, v31
 s_waitcnt lgkmcnt(7)
 v_mfma_f32_16x16x32_bf16 v[76:79], v[60:63], a[20:23], v[76:79]
 v_cvt_pk_bf16_f32 v224, v24, v25
 v_mfma_f32_16x16x32_bf16 v[84:87], v[60:63], a[52:55], v[84:87]
 v_cvt_pk_bf16_f32 v225, v26, v27
 v_mfma_f32_16x16x32_bf16 v[92:95], v[60:63], a[84:87], v[92:95]
 ds_read_b128 v[60:63], v114 offset:37888
 v_cvt_pk_bf16_f32 v226, v28, v29
 s_waitcnt lgkmcnt(7)
 v_mfma_f32_16x16x32_bf16 v[76:79], v[64:67], a[24:27], v[76:79]
 v_cvt_pk_bf16_f32 v227, v30, v31
 v_mfma_f32_16x16x32_bf16 v[84:87], v[64:67], a[56:59], v[84:87]
 v_mfma_f32_16x16x32_bf16 v[92:95], v[64:67], a[88:91], v[92:95]
 ds_read_b128 v[64:67], v114 offset:38912
 s_waitcnt lgkmcnt(7)
 v_mfma_f32_16x16x32_bf16 v[76:79], v[68:71], a[28:31], v[76:79]
 v_mfma_f32_16x16x32_bf16 v[84:87], v[68:71], a[60:63], v[84:87]
 v_mfma_f32_16x16x32_bf16 v[92:95], v[68:71], a[92:95], v[92:95]
 ds_read_b128 v[68:71], v114 offset:39936
 s_waitcnt lgkmcnt(7)
 v_mfma_f32_16x16x32_bf16 v[8:11], v[40:43], a[0:3], 0
 v_mfma_f32_16x16x32_bf16 v[16:19], v[40:43], a[32:35], 0
 v_mfma_f32_16x16x32_bf16 v[24:27], v[40:43], a[64:67], 0
 ds_read_b128 v[40:43], v114 offset:40960
 s_waitcnt lgkmcnt(7)
 v_mfma_f32_16x16x32_bf16 v[8:11], v[44:47], a[4:7], v[8:11]
 v_mul_f32 v72, s37, v72
 v_mfma_f32_16x16x32_bf16 v[16:19], v[44:47], a[36:39], v[16:19]
 v_mul_f32 v73, s37, v73
 v_mfma_f32_16x16x32_bf16 v[24:27], v[44:47], a[68:71], v[24:27]
 ds_read_b128 v[44:47], v114 offset:41984
 v_mul_f32 v74, s37, v74
 s_waitcnt lgkmcnt(7)
 v_mfma_f32_16x16x32_bf16 v[8:11], v[48:51], a[8:11], v[8:11]
 v_mul_f32 v75, s37, v75
 v_mfma_f32_16x16x32_bf16 v[16:19], v[48:51], a[40:43], v[16:19]
 v_mul_f32 v76, s37, v76
 v_mfma_f32_16x16x32_bf16 v[24:27], v[48:51], a[72:75], v[24:27]
 ds_read_b128 v[48:51], v114 offset:43008
 v_mul_f32 v77, s37, v77
 s_waitcnt lgkmcnt(7)
 v_mfma_f32_16x16x32_bf16 v[8:11], v[52:55], a[12:15], v[8:11]
 v_mul_f32 v78, s37, v78
 v_mfma_f32_16x16x32_bf16 v[16:19], v[52:55], a[44:47], v[16:19]
 v_mul_f32 v79, s37, v79
 v_mfma_f32_16x16x32_bf16 v[24:27], v[52:55], a[76:79], v[24:27]
 ds_read_b128 v[52:55], v114 offset:44032
 v_cvt_pk_bf16_f32 v32, v72, v73
 s_waitcnt lgkmcnt(7)
 v_mfma_f32_16x16x32_bf16 v[8:11], v[56:59], a[16:19], v[8:11]
 v_cvt_pk_bf16_f32 v33, v74, v75
 v_mfma_f32_16x16x32_bf16 v[16:19], v[56:59], a[48:51], v[16:19]
 v_cvt_pk_bf16_f32 v34, v76, v77
 v_mfma_f32_16x16x32_bf16 v[24:27], v[56:59], a[80:83], v[24:27]
 ds_read_b128 v[56:59], v114 offset:45056
 v_cvt_pk_bf16_f32 v35, v78, v79
 s_waitcnt lgkmcnt(7)
 v_mfma_f32_16x16x32_bf16 v[8:11], v[60:63], a[20:23], v[8:11]
 v_accvgpr_write_b32 a252, v32
 v_mfma_f32_16x16x32_bf16 v[16:19], v[60:63], a[52:55], v[16:19]
 v_accvgpr_write_b32 a253, v33
 v_mfma_f32_16x16x32_bf16 v[24:27], v[60:63], a[84:87], v[24:27]
 ds_read_b128 v[60:63], v114 offset:46080
 v_accvgpr_write_b32 a254, v34
 s_waitcnt lgkmcnt(7)
 v_mfma_f32_16x16x32_bf16 v[8:11], v[64:67], a[24:27], v[8:11]
 v_accvgpr_write_b32 a255, v35
 v_mfma_f32_16x16x32_bf16 v[16:19], v[64:67], a[56:59], v[16:19]
 v_mul_f32 v80, s37, v80
 v_mfma_f32_16x16x32_bf16 v[24:27], v[64:67], a[88:91], v[24:27]
 ds_read_b128 v[64:67], v114 offset:47104
 v_mul_f32 v81, s37, v81
 s_waitcnt lgkmcnt(7)
 v_mfma_f32_16x16x32_bf16 v[8:11], v[68:71], a[28:31], v[8:11]
 v_mul_f32 v82, s37, v82
 v_mfma_f32_16x16x32_bf16 v[16:19], v[68:71], a[60:63], v[16:19]
 v_mul_f32 v83, s37, v83
 v_mfma_f32_16x16x32_bf16 v[24:27], v[68:71], a[92:95], v[24:27]
 ds_read_b128 v[68:71], v114 offset:48128
 v_mul_f32 v84, s37, v84
 s_waitcnt lgkmcnt(7)
 v_mfma_f32_16x16x32_bf16 v[12:15], v[40:43], a[0:3], 0
 v_mul_f32 v85, s37, v85
 v_mfma_f32_16x16x32_bf16 v[20:23], v[40:43], a[32:35], 0
 v_mul_f32 v86, s37, v86
 v_mfma_f32_16x16x32_bf16 v[28:31], v[40:43], a[64:67], 0
 v_mul_f32 v87, s37, v87
 s_waitcnt lgkmcnt(6)
 v_mfma_f32_16x16x32_bf16 v[12:15], v[44:47], a[4:7], v[12:15]
 v_cvt_pk_bf16_f32 v172, v80, v81
 v_mfma_f32_16x16x32_bf16 v[20:23], v[44:47], a[36:39], v[20:23]
 v_cvt_pk_bf16_f32 v173, v82, v83
 v_mfma_f32_16x16x32_bf16 v[28:31], v[44:47], a[68:71], v[28:31]
 v_cvt_pk_bf16_f32 v174, v84, v85
 s_waitcnt lgkmcnt(5)
 v_mfma_f32_16x16x32_bf16 v[12:15], v[48:51], a[8:11], v[12:15]
 v_cvt_pk_bf16_f32 v175, v86, v87
 v_mfma_f32_16x16x32_bf16 v[20:23], v[48:51], a[40:43], v[20:23]
 v_mul_f32 v88, s37, v88
 v_mfma_f32_16x16x32_bf16 v[28:31], v[48:51], a[72:75], v[28:31]
 v_mul_f32 v89, s37, v89
 s_waitcnt lgkmcnt(4)
 v_mfma_f32_16x16x32_bf16 v[12:15], v[52:55], a[12:15], v[12:15]
 v_mul_f32 v90, s37, v90
 v_mfma_f32_16x16x32_bf16 v[20:23], v[52:55], a[44:47], v[20:23]
 v_mul_f32 v91, s37, v91
 v_mfma_f32_16x16x32_bf16 v[28:31], v[52:55], a[76:79], v[28:31]
 v_mul_f32 v92, s37, v92
 s_waitcnt lgkmcnt(3)
 v_mfma_f32_16x16x32_bf16 v[12:15], v[56:59], a[16:19], v[12:15]
 v_mul_f32 v93, s37, v93
 v_mfma_f32_16x16x32_bf16 v[20:23], v[56:59], a[48:51], v[20:23]
 v_mul_f32 v94, s37, v94
 v_mfma_f32_16x16x32_bf16 v[28:31], v[56:59], a[80:83], v[28:31]
 v_mul_f32 v95, s37, v95
 s_waitcnt lgkmcnt(2)
 v_mfma_f32_16x16x32_bf16 v[12:15], v[60:63], a[20:23], v[12:15]
 v_cvt_pk_bf16_f32 v228, v88, v89
 v_mfma_f32_16x16x32_bf16 v[20:23], v[60:63], a[52:55], v[20:23]
 v_cvt_pk_bf16_f32 v229, v90, v91
 v_mfma_f32_16x16x32_bf16 v[28:31], v[60:63], a[84:87], v[28:31]
 v_cvt_pk_bf16_f32 v230, v92, v93
 s_waitcnt lgkmcnt(1)
 v_mfma_f32_16x16x32_bf16 v[12:15], v[64:67], a[24:27], v[12:15]
 v_cvt_pk_bf16_f32 v231, v94, v95
 v_mfma_f32_16x16x32_bf16 v[20:23], v[64:67], a[56:59], v[20:23]
 v_mfma_f32_16x16x32_bf16 v[28:31], v[64:67], a[88:91], v[28:31]
 s_waitcnt lgkmcnt(0)
 v_mfma_f32_16x16x32_bf16 v[12:15], v[68:71], a[28:31], v[12:15]
 v_mfma_f32_16x16x32_bf16 v[20:23], v[68:71], a[60:63], v[20:23]
 v_mfma_f32_16x16x32_bf16 v[28:31], v[68:71], a[92:95], v[28:31]
 s_waitcnt vmcnt(8)
 s_barrier
 ds_read_b128 v[40:43], v108 offset:0
 ds_read_b128 v[44:47], v108 offset:1024
 ds_read_b128 v[48:51], v108 offset:2048
 ds_read_b128 v[52:55], v108 offset:3072
 ds_read_b128 v[56:59], v108 offset:4096
 ds_read_b128 v[60:63], v108 offset:5120
 ds_read_b128 v[64:67], v108 offset:6144
 ds_read_b128 v[68:71], v108 offset:7168
 s_waitcnt lgkmcnt(7)
 v_mfma_f32_16x16x32_bf16 v[72:75], v[40:43], a[0:3], 0
 v_mfma_f32_16x16x32_bf16 v[80:83], v[40:43], a[32:35], 0
 v_mfma_f32_16x16x32_bf16 v[88:91], v[40:43], a[64:67], 0
 ds_read_b128 v[40:43], v108 offset:8192
 s_waitcnt lgkmcnt(7)
 v_mfma_f32_16x16x32_bf16 v[72:75], v[44:47], a[4:7], v[72:75]
 v_mul_f32 v8, s37, v8
 v_mfma_f32_16x16x32_bf16 v[80:83], v[44:47], a[36:39], v[80:83]
 v_mul_f32 v9, s37, v9
 v_mfma_f32_16x16x32_bf16 v[88:91], v[44:47], a[68:71], v[88:91]
 ds_read_b128 v[44:47], v108 offset:9216
 v_mul_f32 v10, s37, v10
 s_waitcnt lgkmcnt(7)
 v_mfma_f32_16x16x32_bf16 v[72:75], v[48:51], a[8:11], v[72:75]
 v_mul_f32 v11, s37, v11
 v_mfma_f32_16x16x32_bf16 v[80:83], v[48:51], a[40:43], v[80:83]
 v_mul_f32 v12, s37, v12
 v_mfma_f32_16x16x32_bf16 v[88:91], v[48:51], a[72:75], v[88:91]
 ds_read_b128 v[48:51], v108 offset:10240
 v_mul_f32 v13, s37, v13
 s_waitcnt lgkmcnt(7)
 v_mfma_f32_16x16x32_bf16 v[72:75], v[52:55], a[12:15], v[72:75]
 v_mul_f32 v14, s37, v14
 v_mfma_f32_16x16x32_bf16 v[80:83], v[52:55], a[44:47], v[80:83]
 v_mul_f32 v15, s37, v15
 v_mfma_f32_16x16x32_bf16 v[88:91], v[52:55], a[76:79], v[88:91]
 ds_read_b128 v[52:55], v108 offset:11264
 v_cvt_pk_bf16_f32 v120, v8, v9
 s_waitcnt lgkmcnt(7)
 v_mfma_f32_16x16x32_bf16 v[72:75], v[56:59], a[16:19], v[72:75]
 v_cvt_pk_bf16_f32 v121, v10, v11
 v_mfma_f32_16x16x32_bf16 v[80:83], v[56:59], a[48:51], v[80:83]
 v_cvt_pk_bf16_f32 v122, v12, v13
 v_mfma_f32_16x16x32_bf16 v[88:91], v[56:59], a[80:83], v[88:91]
 ds_read_b128 v[56:59], v108 offset:12288
 v_cvt_pk_bf16_f32 v123, v14, v15
 s_waitcnt lgkmcnt(7)
 v_mfma_f32_16x16x32_bf16 v[72:75], v[60:63], a[20:23], v[72:75]
 v_mul_f32 v16, s37, v16
 v_mfma_f32_16x16x32_bf16 v[80:83], v[60:63], a[52:55], v[80:83]
 v_mul_f32 v17, s37, v17
 v_mfma_f32_16x16x32_bf16 v[88:91], v[60:63], a[84:87], v[88:91]
 ds_read_b128 v[60:63], v108 offset:13312
 v_mul_f32 v18, s37, v18
 s_waitcnt lgkmcnt(7)
 v_mfma_f32_16x16x32_bf16 v[72:75], v[64:67], a[24:27], v[72:75]
 v_mul_f32 v19, s37, v19
 v_mfma_f32_16x16x32_bf16 v[80:83], v[64:67], a[56:59], v[80:83]
 v_mul_f32 v20, s37, v20
 v_mfma_f32_16x16x32_bf16 v[88:91], v[64:67], a[88:91], v[88:91]
 ds_read_b128 v[64:67], v108 offset:14336
 v_mul_f32 v21, s37, v21
 s_waitcnt lgkmcnt(7)
 v_mfma_f32_16x16x32_bf16 v[72:75], v[68:71], a[28:31], v[72:75]
 v_mul_f32 v22, s37, v22
 v_mfma_f32_16x16x32_bf16 v[80:83], v[68:71], a[60:63], v[80:83]
 v_mul_f32 v23, s37, v23
 v_mfma_f32_16x16x32_bf16 v[88:91], v[68:71], a[92:95], v[88:91]
 ds_read_b128 v[68:71], v108 offset:15360
 v_cvt_pk_bf16_f32 v176, v16, v17
 s_waitcnt lgkmcnt(7)
 v_mfma_f32_16x16x32_bf16 v[76:79], v[40:43], a[0:3], 0
 v_cvt_pk_bf16_f32 v177, v18, v19
 v_mfma_f32_16x16x32_bf16 v[84:87], v[40:43], a[32:35], 0
 v_cvt_pk_bf16_f32 v178, v20, v21
 v_mfma_f32_16x16x32_bf16 v[92:95], v[40:43], a[64:67], 0
 ds_read_b128 v[40:43], v108 offset:16384
 v_cvt_pk_bf16_f32 v179, v22, v23
 s_waitcnt lgkmcnt(7)
 v_mfma_f32_16x16x32_bf16 v[76:79], v[44:47], a[4:7], v[76:79]
 v_mul_f32 v24, s37, v24
 v_mfma_f32_16x16x32_bf16 v[84:87], v[44:47], a[36:39], v[84:87]
 v_mul_f32 v25, s37, v25
 v_mfma_f32_16x16x32_bf16 v[92:95], v[44:47], a[68:71], v[92:95]
 ds_read_b128 v[44:47], v108 offset:17408
 v_mul_f32 v26, s37, v26
 s_waitcnt lgkmcnt(7)
 v_mfma_f32_16x16x32_bf16 v[76:79], v[48:51], a[8:11], v[76:79]
 v_mul_f32 v27, s37, v27
 v_mfma_f32_16x16x32_bf16 v[84:87], v[48:51], a[40:43], v[84:87]
 v_mul_f32 v28, s37, v28
 v_mfma_f32_16x16x32_bf16 v[92:95], v[48:51], a[72:75], v[92:95]
 ds_read_b128 v[48:51], v108 offset:18432
 v_mul_f32 v29, s37, v29
 s_waitcnt lgkmcnt(7)
 v_mfma_f32_16x16x32_bf16 v[76:79], v[52:55], a[12:15], v[76:79]
 v_mul_f32 v30, s37, v30
 v_mfma_f32_16x16x32_bf16 v[84:87], v[52:55], a[44:47], v[84:87]
 v_mul_f32 v31, s37, v31
 v_mfma_f32_16x16x32_bf16 v[92:95], v[52:55], a[76:79], v[92:95]
 ds_read_b128 v[52:55], v108 offset:19456
 v_cvt_pk_bf16_f32 v232, v24, v25
 s_waitcnt lgkmcnt(7)
 v_mfma_f32_16x16x32_bf16 v[76:79], v[56:59], a[16:19], v[76:79]
 v_cvt_pk_bf16_f32 v233, v26, v27
 v_mfma_f32_16x16x32_bf16 v[84:87], v[56:59], a[48:51], v[84:87]
 v_cvt_pk_bf16_f32 v234, v28, v29
 v_mfma_f32_16x16x32_bf16 v[92:95], v[56:59], a[80:83], v[92:95]
 ds_read_b128 v[56:59], v108 offset:20480
 v_cvt_pk_bf16_f32 v235, v30, v31
 s_waitcnt lgkmcnt(7)
 v_mfma_f32_16x16x32_bf16 v[76:79], v[60:63], a[20:23], v[76:79]
 v_mfma_f32_16x16x32_bf16 v[84:87], v[60:63], a[52:55], v[84:87]
 v_mfma_f32_16x16x32_bf16 v[92:95], v[60:63], a[84:87], v[92:95]
 ds_read_b128 v[60:63], v108 offset:21504
 s_waitcnt lgkmcnt(7)
 v_mfma_f32_16x16x32_bf16 v[76:79], v[64:67], a[24:27], v[76:79]
 v_mfma_f32_16x16x32_bf16 v[84:87], v[64:67], a[56:59], v[84:87]
 v_mfma_f32_16x16x32_bf16 v[92:95], v[64:67], a[88:91], v[92:95]
 ds_read_b128 v[64:67], v108 offset:22528
 s_waitcnt lgkmcnt(7)
 v_mfma_f32_16x16x32_bf16 v[76:79], v[68:71], a[28:31], v[76:79]
 v_mfma_f32_16x16x32_bf16 v[84:87], v[68:71], a[60:63], v[84:87]
 v_mfma_f32_16x16x32_bf16 v[92:95], v[68:71], a[92:95], v[92:95]
 ds_read_b128 v[68:71], v108 offset:23552
 s_waitcnt lgkmcnt(7)
 v_mfma_f32_16x16x32_bf16 v[8:11], v[40:43], a[0:3], 0
 v_mfma_f32_16x16x32_bf16 v[16:19], v[40:43], a[32:35], 0
 v_mfma_f32_16x16x32_bf16 v[24:27], v[40:43], a[64:67], 0
 ds_read_b128 v[40:43], v108 offset:24576
 s_waitcnt lgkmcnt(7)
 v_mfma_f32_16x16x32_bf16 v[8:11], v[44:47], a[4:7], v[8:11]
 v_mul_f32 v72, s37, v72
 v_mfma_f32_16x16x32_bf16 v[16:19], v[44:47], a[36:39], v[16:19]
 v_mul_f32 v73, s37, v73
 v_mfma_f32_16x16x32_bf16 v[24:27], v[44:47], a[68:71], v[24:27]
 ds_read_b128 v[44:47], v108 offset:25600
 v_mul_f32 v74, s37, v74
 s_waitcnt lgkmcnt(7)
 v_mfma_f32_16x16x32_bf16 v[8:11], v[48:51], a[8:11], v[8:11]
 v_mul_f32 v75, s37, v75
 v_mfma_f32_16x16x32_bf16 v[16:19], v[48:51], a[40:43], v[16:19]
 v_mul_f32 v76, s37, v76
 v_mfma_f32_16x16x32_bf16 v[24:27], v[48:51], a[72:75], v[24:27]
 ds_read_b128 v[48:51], v108 offset:26624
 v_mul_f32 v77, s37, v77
 s_waitcnt lgkmcnt(7)
 v_mfma_f32_16x16x32_bf16 v[8:11], v[52:55], a[12:15], v[8:11]
 v_mul_f32 v78, s37, v78
 v_mfma_f32_16x16x32_bf16 v[16:19], v[52:55], a[44:47], v[16:19]
 v_mul_f32 v79, s37, v79
 v_mfma_f32_16x16x32_bf16 v[24:27], v[52:55], a[76:79], v[24:27]
 ds_read_b128 v[52:55], v108 offset:27648
 v_cvt_pk_bf16_f32 v124, v72, v73
 s_waitcnt lgkmcnt(7)
 v_mfma_f32_16x16x32_bf16 v[8:11], v[56:59], a[16:19], v[8:11]
 v_cvt_pk_bf16_f32 v125, v74, v75
 v_mfma_f32_16x16x32_bf16 v[16:19], v[56:59], a[48:51], v[16:19]
 v_cvt_pk_bf16_f32 v126, v76, v77
 v_mfma_f32_16x16x32_bf16 v[24:27], v[56:59], a[80:83], v[24:27]
 ds_read_b128 v[56:59], v108 offset:28672
 v_cvt_pk_bf16_f32 v127, v78, v79
 s_waitcnt lgkmcnt(7)
 v_mfma_f32_16x16x32_bf16 v[8:11], v[60:63], a[20:23], v[8:11]
 v_mul_f32 v80, s37, v80
 v_mfma_f32_16x16x32_bf16 v[16:19], v[60:63], a[52:55], v[16:19]
 v_mul_f32 v81, s37, v81
 v_mfma_f32_16x16x32_bf16 v[24:27], v[60:63], a[84:87], v[24:27]
 ds_read_b128 v[60:63], v108 offset:29696
 v_mul_f32 v82, s37, v82
 s_waitcnt lgkmcnt(7)
 v_mfma_f32_16x16x32_bf16 v[8:11], v[64:67], a[24:27], v[8:11]
 v_mul_f32 v83, s37, v83
 v_mfma_f32_16x16x32_bf16 v[16:19], v[64:67], a[56:59], v[16:19]
 v_mul_f32 v84, s37, v84
 v_mfma_f32_16x16x32_bf16 v[24:27], v[64:67], a[88:91], v[24:27]
 ds_read_b128 v[64:67], v108 offset:30720
 v_mul_f32 v85, s37, v85
 s_waitcnt lgkmcnt(7)
 v_mfma_f32_16x16x32_bf16 v[8:11], v[68:71], a[28:31], v[8:11]
 v_mul_f32 v86, s37, v86
 v_mfma_f32_16x16x32_bf16 v[16:19], v[68:71], a[60:63], v[16:19]
 v_mul_f32 v87, s37, v87
 v_mfma_f32_16x16x32_bf16 v[24:27], v[68:71], a[92:95], v[24:27]
 ds_read_b128 v[68:71], v108 offset:31744
 v_cvt_pk_bf16_f32 v180, v80, v81
 s_waitcnt lgkmcnt(7)
 v_mfma_f32_16x16x32_bf16 v[12:15], v[40:43], a[0:3], 0
 v_cvt_pk_bf16_f32 v181, v82, v83
 v_mfma_f32_16x16x32_bf16 v[20:23], v[40:43], a[32:35], 0
 v_cvt_pk_bf16_f32 v182, v84, v85
 v_mfma_f32_16x16x32_bf16 v[28:31], v[40:43], a[64:67], 0
 ds_read_b128 v[40:43], v108 offset:32768
 v_cvt_pk_bf16_f32 v183, v86, v87
 s_waitcnt lgkmcnt(7)
 v_mfma_f32_16x16x32_bf16 v[12:15], v[44:47], a[4:7], v[12:15]
 v_mul_f32 v88, s37, v88
 v_mfma_f32_16x16x32_bf16 v[20:23], v[44:47], a[36:39], v[20:23]
 v_mul_f32 v89, s37, v89
 v_mfma_f32_16x16x32_bf16 v[28:31], v[44:47], a[68:71], v[28:31]
 ds_read_b128 v[44:47], v108 offset:33792
 v_mul_f32 v90, s37, v90
 s_waitcnt lgkmcnt(7)
 v_mfma_f32_16x16x32_bf16 v[12:15], v[48:51], a[8:11], v[12:15]
 v_mul_f32 v91, s37, v91
 v_mfma_f32_16x16x32_bf16 v[20:23], v[48:51], a[40:43], v[20:23]
 v_mul_f32 v92, s37, v92
 v_mfma_f32_16x16x32_bf16 v[28:31], v[48:51], a[72:75], v[28:31]
 ds_read_b128 v[48:51], v108 offset:34816
 v_mul_f32 v93, s37, v93
 s_waitcnt lgkmcnt(7)
 v_mfma_f32_16x16x32_bf16 v[12:15], v[52:55], a[12:15], v[12:15]
 v_mul_f32 v94, s37, v94
 v_mfma_f32_16x16x32_bf16 v[20:23], v[52:55], a[44:47], v[20:23]
 v_mul_f32 v95, s37, v95
 v_mfma_f32_16x16x32_bf16 v[28:31], v[52:55], a[76:79], v[28:31]
 ds_read_b128 v[52:55], v108 offset:35840
 v_cvt_pk_bf16_f32 v236, v88, v89
 s_waitcnt lgkmcnt(7)
 v_mfma_f32_16x16x32_bf16 v[12:15], v[56:59], a[16:19], v[12:15]
 v_cvt_pk_bf16_f32 v237, v90, v91
 v_mfma_f32_16x16x32_bf16 v[20:23], v[56:59], a[48:51], v[20:23]
 v_cvt_pk_bf16_f32 v238, v92, v93
 v_mfma_f32_16x16x32_bf16 v[28:31], v[56:59], a[80:83], v[28:31]
 ds_read_b128 v[56:59], v108 offset:36864
 v_cvt_pk_bf16_f32 v239, v94, v95
 s_waitcnt lgkmcnt(7)
 v_mfma_f32_16x16x32_bf16 v[12:15], v[60:63], a[20:23], v[12:15]
 v_mfma_f32_16x16x32_bf16 v[20:23], v[60:63], a[52:55], v[20:23]
 v_mfma_f32_16x16x32_bf16 v[28:31], v[60:63], a[84:87], v[28:31]
 ds_read_b128 v[60:63], v108 offset:37888
 s_waitcnt lgkmcnt(7)
 v_mfma_f32_16x16x32_bf16 v[12:15], v[64:67], a[24:27], v[12:15]
 v_mfma_f32_16x16x32_bf16 v[20:23], v[64:67], a[56:59], v[20:23]
 v_mfma_f32_16x16x32_bf16 v[28:31], v[64:67], a[88:91], v[28:31]
 ds_read_b128 v[64:67], v108 offset:38912
 s_waitcnt lgkmcnt(7)
 v_mfma_f32_16x16x32_bf16 v[12:15], v[68:71], a[28:31], v[12:15]
 v_mfma_f32_16x16x32_bf16 v[20:23], v[68:71], a[60:63], v[20:23]
 v_mfma_f32_16x16x32_bf16 v[28:31], v[68:71], a[92:95], v[28:31]
 ds_read_b128 v[68:71], v108 offset:39936
 s_waitcnt lgkmcnt(7)
 v_mfma_f32_16x16x32_bf16 v[72:75], v[40:43], a[0:3], 0
 v_mfma_f32_16x16x32_bf16 v[80:83], v[40:43], a[32:35], 0
 v_mfma_f32_16x16x32_bf16 v[88:91], v[40:43], a[64:67], 0
 ds_read_b128 v[40:43], v108 offset:40960
 s_waitcnt lgkmcnt(7)
 v_mfma_f32_16x16x32_bf16 v[72:75], v[44:47], a[4:7], v[72:75]
 v_mul_f32 v8, s37, v8
 v_mfma_f32_16x16x32_bf16 v[80:83], v[44:47], a[36:39], v[80:83]
 v_mul_f32 v9, s37, v9
 v_mfma_f32_16x16x32_bf16 v[88:91], v[44:47], a[68:71], v[88:91]
 ds_read_b128 v[44:47], v108 offset:41984
 v_mul_f32 v10, s37, v10
 s_waitcnt lgkmcnt(7)
 v_mfma_f32_16x16x32_bf16 v[72:75], v[48:51], a[8:11], v[72:75]
 v_mul_f32 v11, s37, v11
 v_mfma_f32_16x16x32_bf16 v[80:83], v[48:51], a[40:43], v[80:83]
 v_mul_f32 v12, s37, v12
 v_mfma_f32_16x16x32_bf16 v[88:91], v[48:51], a[72:75], v[88:91]
 ds_read_b128 v[48:51], v108 offset:43008
 v_mul_f32 v13, s37, v13
 s_waitcnt lgkmcnt(7)
 v_mfma_f32_16x16x32_bf16 v[72:75], v[52:55], a[12:15], v[72:75]
 v_mul_f32 v14, s37, v14
 v_mfma_f32_16x16x32_bf16 v[80:83], v[52:55], a[44:47], v[80:83]
 v_mul_f32 v15, s37, v15
 v_mfma_f32_16x16x32_bf16 v[88:91], v[52:55], a[76:79], v[88:91]
 ds_read_b128 v[52:55], v108 offset:44032
 v_cvt_pk_bf16_f32 v128, v8, v9
 s_waitcnt lgkmcnt(7)
 v_mfma_f32_16x16x32_bf16 v[72:75], v[56:59], a[16:19], v[72:75]
 v_cvt_pk_bf16_f32 v129, v10, v11
 v_mfma_f32_16x16x32_bf16 v[80:83], v[56:59], a[48:51], v[80:83]
 v_cvt_pk_bf16_f32 v130, v12, v13
 v_mfma_f32_16x16x32_bf16 v[88:91], v[56:59], a[80:83], v[88:91]
 ds_read_b128 v[56:59], v108 offset:45056
 v_cvt_pk_bf16_f32 v131, v14, v15
 s_waitcnt lgkmcnt(7)
 v_mfma_f32_16x16x32_bf16 v[72:75], v[60:63], a[20:23], v[72:75]
 v_mul_f32 v16, s37, v16
 v_mfma_f32_16x16x32_bf16 v[80:83], v[60:63], a[52:55], v[80:83]
 v_mul_f32 v17, s37, v17
 v_mfma_f32_16x16x32_bf16 v[88:91], v[60:63], a[84:87], v[88:91]
 ds_read_b128 v[60:63], v108 offset:46080
 v_mul_f32 v18, s37, v18
 s_waitcnt lgkmcnt(7)
 v_mfma_f32_16x16x32_bf16 v[72:75], v[64:67], a[24:27], v[72:75]
 v_mul_f32 v19, s37, v19
 v_mfma_f32_16x16x32_bf16 v[80:83], v[64:67], a[56:59], v[80:83]
 v_mul_f32 v20, s37, v20
 v_mfma_f32_16x16x32_bf16 v[88:91], v[64:67], a[88:91], v[88:91]
 ds_read_b128 v[64:67], v108 offset:47104
 v_mul_f32 v21, s37, v21
 s_waitcnt lgkmcnt(7)
 v_mfma_f32_16x16x32_bf16 v[72:75], v[68:71], a[28:31], v[72:75]
 v_mul_f32 v22, s37, v22
 v_mfma_f32_16x16x32_bf16 v[80:83], v[68:71], a[60:63], v[80:83]
 v_mul_f32 v23, s37, v23
 v_mfma_f32_16x16x32_bf16 v[88:91], v[68:71], a[92:95], v[88:91]
 ds_read_b128 v[68:71], v108 offset:48128
 v_cvt_pk_bf16_f32 v184, v16, v17
 s_waitcnt lgkmcnt(7)
 v_mfma_f32_16x16x32_bf16 v[76:79], v[40:43], a[0:3], 0
 v_cvt_pk_bf16_f32 v185, v18, v19
 v_mfma_f32_16x16x32_bf16 v[84:87], v[40:43], a[32:35], 0
 v_cvt_pk_bf16_f32 v186, v20, v21
 v_mfma_f32_16x16x32_bf16 v[92:95], v[40:43], a[64:67], 0
 v_cvt_pk_bf16_f32 v187, v22, v23
 s_waitcnt lgkmcnt(6)
 v_mfma_f32_16x16x32_bf16 v[76:79], v[44:47], a[4:7], v[76:79]
 v_mul_f32 v24, s37, v24
 v_mfma_f32_16x16x32_bf16 v[84:87], v[44:47], a[36:39], v[84:87]
 v_mul_f32 v25, s37, v25
 v_mfma_f32_16x16x32_bf16 v[92:95], v[44:47], a[68:71], v[92:95]
 v_mul_f32 v26, s37, v26
 s_waitcnt lgkmcnt(5)
 v_mfma_f32_16x16x32_bf16 v[76:79], v[48:51], a[8:11], v[76:79]
 v_mul_f32 v27, s37, v27
 v_mfma_f32_16x16x32_bf16 v[84:87], v[48:51], a[40:43], v[84:87]
 v_mul_f32 v28, s37, v28
 v_mfma_f32_16x16x32_bf16 v[92:95], v[48:51], a[72:75], v[92:95]
 v_mul_f32 v29, s37, v29
 s_waitcnt lgkmcnt(4)
 v_mfma_f32_16x16x32_bf16 v[76:79], v[52:55], a[12:15], v[76:79]
 v_mul_f32 v30, s37, v30
 v_mfma_f32_16x16x32_bf16 v[84:87], v[52:55], a[44:47], v[84:87]
 v_mul_f32 v31, s37, v31
 v_mfma_f32_16x16x32_bf16 v[92:95], v[52:55], a[76:79], v[92:95]
 v_cvt_pk_bf16_f32 v240, v24, v25
 s_waitcnt lgkmcnt(3)
 v_mfma_f32_16x16x32_bf16 v[76:79], v[56:59], a[16:19], v[76:79]
 v_cvt_pk_bf16_f32 v241, v26, v27
 v_mfma_f32_16x16x32_bf16 v[84:87], v[56:59], a[48:51], v[84:87]
 v_cvt_pk_bf16_f32 v242, v28, v29
 v_mfma_f32_16x16x32_bf16 v[92:95], v[56:59], a[80:83], v[92:95]
 v_cvt_pk_bf16_f32 v243, v30, v31
 s_waitcnt lgkmcnt(2)
 v_mfma_f32_16x16x32_bf16 v[76:79], v[60:63], a[20:23], v[76:79]
 v_mfma_f32_16x16x32_bf16 v[84:87], v[60:63], a[52:55], v[84:87]
 v_mfma_f32_16x16x32_bf16 v[92:95], v[60:63], a[84:87], v[92:95]
 s_waitcnt lgkmcnt(1)
 v_mfma_f32_16x16x32_bf16 v[76:79], v[64:67], a[24:27], v[76:79]
 v_mfma_f32_16x16x32_bf16 v[84:87], v[64:67], a[56:59], v[84:87]
 v_mfma_f32_16x16x32_bf16 v[92:95], v[64:67], a[88:91], v[92:95]
 s_waitcnt lgkmcnt(0)
 v_mfma_f32_16x16x32_bf16 v[76:79], v[68:71], a[28:31], v[76:79]
 v_mfma_f32_16x16x32_bf16 v[84:87], v[68:71], a[60:63], v[84:87]
 v_mfma_f32_16x16x32_bf16 v[92:95], v[68:71], a[92:95], v[92:95]
 s_waitcnt vmcnt(0)
 s_barrier
 ds_read_b128 v[40:43], v113 offset:0
 ds_read_b128 v[44:47], v113 offset:1024
 ds_read_b128 v[48:51], v113 offset:2048
 ds_read_b128 v[52:55], v113 offset:3072
 ds_read_b128 v[56:59], v113 offset:4096
 ds_read_b128 v[60:63], v113 offset:5120
 ds_read_b128 v[64:67], v113 offset:6144
 ds_read_b128 v[68:71], v113 offset:7168
 s_waitcnt lgkmcnt(7)
 v_mfma_f32_16x16x32_bf16 v[8:11], v[40:43], a[0:3], 0
 v_mfma_f32_16x16x32_bf16 v[16:19], v[40:43], a[32:35], 0
 v_mfma_f32_16x16x32_bf16 v[24:27], v[40:43], a[64:67], 0
 ds_read_b128 v[40:43], v113 offset:8192
 s_waitcnt lgkmcnt(7)
 v_mfma_f32_16x16x32_bf16 v[8:11], v[44:47], a[4:7], v[8:11]
 v_mul_f32 v72, s37, v72
 v_mfma_f32_16x16x32_bf16 v[16:19], v[44:47], a[36:39], v[16:19]
 v_mul_f32 v73, s37, v73
 v_mfma_f32_16x16x32_bf16 v[24:27], v[44:47], a[68:71], v[24:27]
 ds_read_b128 v[44:47], v113 offset:9216
 v_mul_f32 v74, s37, v74
 s_waitcnt lgkmcnt(7)
 v_mfma_f32_16x16x32_bf16 v[8:11], v[48:51], a[8:11], v[8:11]
 v_mul_f32 v75, s37, v75
 v_mfma_f32_16x16x32_bf16 v[16:19], v[48:51], a[40:43], v[16:19]
 v_mul_f32 v76, s37, v76
 v_mfma_f32_16x16x32_bf16 v[24:27], v[48:51], a[72:75], v[24:27]
 ds_read_b128 v[48:51], v113 offset:10240
 v_mul_f32 v77, s37, v77
 s_waitcnt lgkmcnt(7)
 v_mfma_f32_16x16x32_bf16 v[8:11], v[52:55], a[12:15], v[8:11]
 v_mul_f32 v78, s37, v78
 v_mfma_f32_16x16x32_bf16 v[16:19], v[52:55], a[44:47], v[16:19]
 v_mul_f32 v79, s37, v79
 v_mfma_f32_16x16x32_bf16 v[24:27], v[52:55], a[76:79], v[24:27]
 ds_read_b128 v[52:55], v113 offset:11264
 v_cvt_pk_bf16_f32 v132, v72, v73
 s_waitcnt lgkmcnt(7)
 v_mfma_f32_16x16x32_bf16 v[8:11], v[56:59], a[16:19], v[8:11]
 v_cvt_pk_bf16_f32 v133, v74, v75
 v_mfma_f32_16x16x32_bf16 v[16:19], v[56:59], a[48:51], v[16:19]
 v_cvt_pk_bf16_f32 v134, v76, v77
 v_mfma_f32_16x16x32_bf16 v[24:27], v[56:59], a[80:83], v[24:27]
 ds_read_b128 v[56:59], v113 offset:12288
 v_cvt_pk_bf16_f32 v135, v78, v79
 s_waitcnt lgkmcnt(7)
 v_mfma_f32_16x16x32_bf16 v[8:11], v[60:63], a[20:23], v[8:11]
 v_mul_f32 v80, s37, v80
 v_mfma_f32_16x16x32_bf16 v[16:19], v[60:63], a[52:55], v[16:19]
 v_mul_f32 v81, s37, v81
 v_mfma_f32_16x16x32_bf16 v[24:27], v[60:63], a[84:87], v[24:27]
 ds_read_b128 v[60:63], v113 offset:13312
 v_mul_f32 v82, s37, v82
 s_waitcnt lgkmcnt(7)
 v_mfma_f32_16x16x32_bf16 v[8:11], v[64:67], a[24:27], v[8:11]
 v_mul_f32 v83, s37, v83
 v_mfma_f32_16x16x32_bf16 v[16:19], v[64:67], a[56:59], v[16:19]
 v_mul_f32 v84, s37, v84
 v_mfma_f32_16x16x32_bf16 v[24:27], v[64:67], a[88:91], v[24:27]
 ds_read_b128 v[64:67], v113 offset:14336
 v_mul_f32 v85, s37, v85
 s_waitcnt lgkmcnt(7)
 v_mfma_f32_16x16x32_bf16 v[8:11], v[68:71], a[28:31], v[8:11]
 v_mul_f32 v86, s37, v86
 v_mfma_f32_16x16x32_bf16 v[16:19], v[68:71], a[60:63], v[16:19]
 v_mul_f32 v87, s37, v87
 v_mfma_f32_16x16x32_bf16 v[24:27], v[68:71], a[92:95], v[24:27]
 ds_read_b128 v[68:71], v113 offset:15360
 v_cvt_pk_bf16_f32 v188, v80, v81
 s_waitcnt lgkmcnt(7)
 v_mfma_f32_16x16x32_bf16 v[12:15], v[40:43], a[0:3], 0
 v_cvt_pk_bf16_f32 v189, v82, v83
 v_mfma_f32_16x16x32_bf16 v[20:23], v[40:43], a[32:35], 0
 v_cvt_pk_bf16_f32 v190, v84, v85
 v_mfma_f32_16x16x32_bf16 v[28:31], v[40:43], a[64:67], 0
 ds_read_b128 v[40:43], v113 offset:16384
 v_cvt_pk_bf16_f32 v191, v86, v87
 s_waitcnt lgkmcnt(7)
 v_mfma_f32_16x16x32_bf16 v[12:15], v[44:47], a[4:7], v[12:15]
 v_mul_f32 v88, s37, v88
 v_mfma_f32_16x16x32_bf16 v[20:23], v[44:47], a[36:39], v[20:23]
 v_mul_f32 v89, s37, v89
 v_mfma_f32_16x16x32_bf16 v[28:31], v[44:47], a[68:71], v[28:31]
 ds_read_b128 v[44:47], v113 offset:17408
 v_mul_f32 v90, s37, v90
 s_waitcnt lgkmcnt(7)
 v_mfma_f32_16x16x32_bf16 v[12:15], v[48:51], a[8:11], v[12:15]
 v_mul_f32 v91, s37, v91
 v_mfma_f32_16x16x32_bf16 v[20:23], v[48:51], a[40:43], v[20:23]
 v_mul_f32 v92, s37, v92
 v_mfma_f32_16x16x32_bf16 v[28:31], v[48:51], a[72:75], v[28:31]
 ds_read_b128 v[48:51], v113 offset:18432
 v_mul_f32 v93, s37, v93
 s_waitcnt lgkmcnt(7)
 v_mfma_f32_16x16x32_bf16 v[12:15], v[52:55], a[12:15], v[12:15]
 v_mul_f32 v94, s37, v94
 v_mfma_f32_16x16x32_bf16 v[20:23], v[52:55], a[44:47], v[20:23]
 v_mul_f32 v95, s37, v95
 v_mfma_f32_16x16x32_bf16 v[28:31], v[52:55], a[76:79], v[28:31]
 ds_read_b128 v[52:55], v113 offset:19456
 v_cvt_pk_bf16_f32 v244, v88, v89
 s_waitcnt lgkmcnt(7)
 v_mfma_f32_16x16x32_bf16 v[12:15], v[56:59], a[16:19], v[12:15]
 v_cvt_pk_bf16_f32 v245, v90, v91
 v_mfma_f32_16x16x32_bf16 v[20:23], v[56:59], a[48:51], v[20:23]
 v_cvt_pk_bf16_f32 v246, v92, v93
 v_mfma_f32_16x16x32_bf16 v[28:31], v[56:59], a[80:83], v[28:31]
 ds_read_b128 v[56:59], v113 offset:20480
 v_cvt_pk_bf16_f32 v247, v94, v95
 s_waitcnt lgkmcnt(7)
 v_mfma_f32_16x16x32_bf16 v[12:15], v[60:63], a[20:23], v[12:15]
 v_mfma_f32_16x16x32_bf16 v[20:23], v[60:63], a[52:55], v[20:23]
 v_mfma_f32_16x16x32_bf16 v[28:31], v[60:63], a[84:87], v[28:31]
 ds_read_b128 v[60:63], v113 offset:21504
 s_waitcnt lgkmcnt(7)
 v_mfma_f32_16x16x32_bf16 v[12:15], v[64:67], a[24:27], v[12:15]
 v_mfma_f32_16x16x32_bf16 v[20:23], v[64:67], a[56:59], v[20:23]
 v_mfma_f32_16x16x32_bf16 v[28:31], v[64:67], a[88:91], v[28:31]
 ds_read_b128 v[64:67], v113 offset:22528
 s_waitcnt lgkmcnt(7)
 v_mfma_f32_16x16x32_bf16 v[12:15], v[68:71], a[28:31], v[12:15]
 v_mfma_f32_16x16x32_bf16 v[20:23], v[68:71], a[60:63], v[20:23]
 v_mfma_f32_16x16x32_bf16 v[28:31], v[68:71], a[92:95], v[28:31]
 ds_read_b128 v[68:71], v113 offset:23552
 s_waitcnt lgkmcnt(7)
 v_mfma_f32_16x16x32_bf16 v[72:75], v[40:43], a[0:3], 0
 v_mfma_f32_16x16x32_bf16 v[80:83], v[40:43], a[32:35], 0
 v_mfma_f32_16x16x32_bf16 v[88:91], v[40:43], a[64:67], 0
 ds_read_b128 v[40:43], v113 offset:24576
 s_waitcnt lgkmcnt(7)
 v_mfma_f32_16x16x32_bf16 v[72:75], v[44:47], a[4:7], v[72:75]
 v_mul_f32 v8, s37, v8
 v_mfma_f32_16x16x32_bf16 v[80:83], v[44:47], a[36:39], v[80:83]
 v_mul_f32 v9, s37, v9
 v_mfma_f32_16x16x32_bf16 v[88:91], v[44:47], a[68:71], v[88:91]
 ds_read_b128 v[44:47], v113 offset:25600
 v_mul_f32 v10, s37, v10
 s_waitcnt lgkmcnt(7)
 v_mfma_f32_16x16x32_bf16 v[72:75], v[48:51], a[8:11], v[72:75]
 v_mul_f32 v11, s37, v11
 v_mfma_f32_16x16x32_bf16 v[80:83], v[48:51], a[40:43], v[80:83]
 v_mul_f32 v12, s37, v12
 v_mfma_f32_16x16x32_bf16 v[88:91], v[48:51], a[72:75], v[88:91]
 ds_read_b128 v[48:51], v113 offset:26624
 v_mul_f32 v13, s37, v13
 s_waitcnt lgkmcnt(7)
 v_mfma_f32_16x16x32_bf16 v[72:75], v[52:55], a[12:15], v[72:75]
 v_mul_f32 v14, s37, v14
 v_mfma_f32_16x16x32_bf16 v[80:83], v[52:55], a[44:47], v[80:83]
 v_mul_f32 v15, s37, v15
 v_mfma_f32_16x16x32_bf16 v[88:91], v[52:55], a[76:79], v[88:91]
 ds_read_b128 v[52:55], v113 offset:27648
 v_cvt_pk_bf16_f32 v136, v8, v9
 s_waitcnt lgkmcnt(7)
 v_mfma_f32_16x16x32_bf16 v[72:75], v[56:59], a[16:19], v[72:75]
 v_cvt_pk_bf16_f32 v137, v10, v11
 v_mfma_f32_16x16x32_bf16 v[80:83], v[56:59], a[48:51], v[80:83]
 v_cvt_pk_bf16_f32 v138, v12, v13
 v_mfma_f32_16x16x32_bf16 v[88:91], v[56:59], a[80:83], v[88:91]
 ds_read_b128 v[56:59], v113 offset:28672
 v_cvt_pk_bf16_f32 v139, v14, v15
 s_waitcnt lgkmcnt(7)
 v_mfma_f32_16x16x32_bf16 v[72:75], v[60:63], a[20:23], v[72:75]
 v_mul_f32 v16, s37, v16
 v_mfma_f32_16x16x32_bf16 v[80:83], v[60:63], a[52:55], v[80:83]
 v_mul_f32 v17, s37, v17
 v_mfma_f32_16x16x32_bf16 v[88:91], v[60:63], a[84:87], v[88:91]
 ds_read_b128 v[60:63], v113 offset:29696
 v_mul_f32 v18, s37, v18
 s_waitcnt lgkmcnt(7)
 v_mfma_f32_16x16x32_bf16 v[72:75], v[64:67], a[24:27], v[72:75]
 v_mul_f32 v19, s37, v19
 v_mfma_f32_16x16x32_bf16 v[80:83], v[64:67], a[56:59], v[80:83]
 v_mul_f32 v20, s37, v20
 v_mfma_f32_16x16x32_bf16 v[88:91], v[64:67], a[88:91], v[88:91]
 ds_read_b128 v[64:67], v113 offset:30720
 v_mul_f32 v21, s37, v21
 s_waitcnt lgkmcnt(7)
 v_mfma_f32_16x16x32_bf16 v[72:75], v[68:71], a[28:31], v[72:75]
 v_mul_f32 v22, s37, v22
 v_mfma_f32_16x16x32_bf16 v[80:83], v[68:71], a[60:63], v[80:83]
 v_mul_f32 v23, s37, v23
 v_mfma_f32_16x16x32_bf16 v[88:91], v[68:71], a[92:95], v[88:91]
 ds_read_b128 v[68:71], v113 offset:31744
 v_cvt_pk_bf16_f32 v192, v16, v17
 s_waitcnt lgkmcnt(7)
 v_mfma_f32_16x16x32_bf16 v[76:79], v[40:43], a[0:3], 0
 v_cvt_pk_bf16_f32 v193, v18, v19
 v_mfma_f32_16x16x32_bf16 v[84:87], v[40:43], a[32:35], 0
 v_cvt_pk_bf16_f32 v194, v20, v21
 v_mfma_f32_16x16x32_bf16 v[92:95], v[40:43], a[64:67], 0
 v_cvt_pk_bf16_f32 v195, v22, v23
 s_waitcnt lgkmcnt(6)
 v_mfma_f32_16x16x32_bf16 v[76:79], v[44:47], a[4:7], v[76:79]
 v_mul_f32 v24, s37, v24
 v_mfma_f32_16x16x32_bf16 v[84:87], v[44:47], a[36:39], v[84:87]
 v_mul_f32 v25, s37, v25
 v_mfma_f32_16x16x32_bf16 v[92:95], v[44:47], a[68:71], v[92:95]
 v_mul_f32 v26, s37, v26
 s_waitcnt lgkmcnt(5)
 v_mfma_f32_16x16x32_bf16 v[76:79], v[48:51], a[8:11], v[76:79]
 v_mul_f32 v27, s37, v27
 v_mfma_f32_16x16x32_bf16 v[84:87], v[48:51], a[40:43], v[84:87]
 v_mul_f32 v28, s37, v28
 v_mfma_f32_16x16x32_bf16 v[92:95], v[48:51], a[72:75], v[92:95]
 v_mul_f32 v29, s37, v29
 s_waitcnt lgkmcnt(4)
 v_mfma_f32_16x16x32_bf16 v[76:79], v[52:55], a[12:15], v[76:79]
 v_mul_f32 v30, s37, v30
 v_mfma_f32_16x16x32_bf16 v[84:87], v[52:55], a[44:47], v[84:87]
 v_mul_f32 v31, s37, v31
 v_mfma_f32_16x16x32_bf16 v[92:95], v[52:55], a[76:79], v[92:95]
 v_cvt_pk_bf16_f32 v248, v24, v25
 s_waitcnt lgkmcnt(3)
 v_mfma_f32_16x16x32_bf16 v[76:79], v[56:59], a[16:19], v[76:79]
 v_cvt_pk_bf16_f32 v249, v26, v27
 v_mfma_f32_16x16x32_bf16 v[84:87], v[56:59], a[48:51], v[84:87]
 v_cvt_pk_bf16_f32 v250, v28, v29
 v_mfma_f32_16x16x32_bf16 v[92:95], v[56:59], a[80:83], v[92:95]
 v_cvt_pk_bf16_f32 v251, v30, v31
 s_waitcnt lgkmcnt(2)
 v_mfma_f32_16x16x32_bf16 v[76:79], v[60:63], a[20:23], v[76:79]
 v_mfma_f32_16x16x32_bf16 v[84:87], v[60:63], a[52:55], v[84:87]
 v_mfma_f32_16x16x32_bf16 v[92:95], v[60:63], a[84:87], v[92:95]
 s_waitcnt lgkmcnt(1)
 v_mfma_f32_16x16x32_bf16 v[76:79], v[64:67], a[24:27], v[76:79]
 v_mfma_f32_16x16x32_bf16 v[84:87], v[64:67], a[56:59], v[84:87]
 v_mfma_f32_16x16x32_bf16 v[92:95], v[64:67], a[88:91], v[92:95]
 s_waitcnt lgkmcnt(0)
 v_mfma_f32_16x16x32_bf16 v[76:79], v[68:71], a[28:31], v[76:79]
 v_mfma_f32_16x16x32_bf16 v[84:87], v[68:71], a[60:63], v[84:87]
 v_mfma_f32_16x16x32_bf16 v[92:95], v[68:71], a[92:95], v[92:95]
 v_mul_f32 v72, s37, v72
 v_mul_f32 v73, s37, v73
 v_mul_f32 v74, s37, v74
 v_mul_f32 v75, s37, v75
 v_mul_f32 v76, s37, v76
 v_mul_f32 v77, s37, v77
 v_mul_f32 v78, s37, v78
 v_mul_f32 v79, s37, v79
 v_cvt_pk_bf16_f32 v140, v72, v73
 v_cvt_pk_bf16_f32 v141, v74, v75
 v_cvt_pk_bf16_f32 v142, v76, v77
 v_cvt_pk_bf16_f32 v143, v78, v79
 v_mul_f32 v80, s37, v80
 v_mul_f32 v81, s37, v81
 v_mul_f32 v82, s37, v82
 v_mul_f32 v83, s37, v83
 v_mul_f32 v84, s37, v84
 v_mul_f32 v85, s37, v85
 v_mul_f32 v86, s37, v86
 v_mul_f32 v87, s37, v87
 v_cvt_pk_bf16_f32 v196, v80, v81
 v_cvt_pk_bf16_f32 v197, v82, v83
 v_cvt_pk_bf16_f32 v198, v84, v85
 v_cvt_pk_bf16_f32 v199, v86, v87
 v_mul_f32 v88, s37, v88
 v_mul_f32 v89, s37, v89
 v_mul_f32 v90, s37, v90
 v_mul_f32 v91, s37, v91
 v_mul_f32 v92, s37, v92
 v_mul_f32 v93, s37, v93
 v_mul_f32 v94, s37, v94
 v_mul_f32 v95, s37, v95
 v_cvt_pk_bf16_f32 v252, v88, v89
 v_cvt_pk_bf16_f32 v253, v90, v91
 v_cvt_pk_bf16_f32 v254, v92, v93
 v_cvt_pk_bf16_f32 v255, v94, v95
 s_barrier
AL_done:
 s_and_b32 s42, s46, 15
 s_lshr_b32 s73, s46, 4
 v_mov_b32 v29, 1073741824
 v_mov_b32 v3, v29
 v_mov_b32 v7, v29
 v_mov_b32 v8, v29
 v_mov_b32 v9, v29
 v_mov_b32 v11, v29
 v_mov_b32 v12, v29
 v_mov_b32 v13, v29
 v_mov_b32 v14, v29
 v_mov_b32 v30, v29
 v_lshlrev_b32 v1, 4, v0
 v_lshlrev_b32 v6, 2, v0
 s_mov_b32 s50, 0
 s_and_b32 s55, s40, 1
 s_mov_b32 s62, 0x55555555
 s_mov_b32 s63, 0x55555555
 s_mov_b32 s64, 0xaaaaaaaa
 s_mov_b32 s65, 0xaaaaaaaa
 s_mov_b32 s72, 0x7f817f81
 s_mov_b32 s74, 0x7fff7fff
 v_bfe_u32 v20, v0, 1, 1
 v_mul_u32_u24 v20, 0xaaaa, v20
 v_add_u32 v2, 0x4444, v20
 v_mov_b32 v10, -1
 s_cmp_ge_u32 s46, 30
 s_cbranch_scc1 CP_F
 s_cmp_eq_u32 s73, 1
 s_cbranch_scc1 CP_B
 s_mul_i32 s45, s55, 14336
 s_add_u32 s44, s45, 17825792
 s_add_u32 s45, s45, 32768
 v_and_b32 v25, 7, v0
 v_lshlrev_b32 v25, 2, v25
 s_lshl_b32 s54, s42, 6
 s_add_u32 s54, s54, 2089984
 v_add_u32 v25, s54, v25
 v_add_u32 v27, 2091008, v6
 v_cmp_gt_u32 vcc, 32, v0
 s_nop 1
 v_cndmask_b32 v25, v25, v27, vcc
 s_mov_b32 s69, 2093056
CPa_w:
 buffer_load_dword v26, v25, s[16:19], 0 offen sc1
 buffer_load_dwordx4 v[32:35], v1, s[16:19], s69 offen sc1
 s_waitcnt vmcnt(0)
 v_xor_b32 v27, s34, v26
 v_xor_b32 v32, s34, v32
 v_xor_b32 v33, s34, v33
 v_xor_b32 v34, s34, v34
 v_xor_b32 v35, s34, v35
 v_or3_b32 v27, v27, v32, v33
 v_or3_b32 v27, v27, v34, v35
 v_cmp_lt_u32 vcc, 15, v27
 s_cbranch_vccz CPa_d
 s_sleep 1
 s_max_u32 s68, s68, 1
 s_sub_u32 s68, s68, 1
 s_cmp_lg_u32 s68, 0
 s_cbranch_scc1 CPa_w
CPa_d:
 s_add_u32 s54, s34, s41
 v_cmp_ne_u32 vcc, s54, v26
 s_nop 0
 s_cmp_lg_u32 vcc_lo, 0
 s_cselect_b32 s33, 1, 0
 s_cmp_ge_u32 s40, 2
 s_cbranch_scc1 CP_A1
 s_add_u32 s54, s50, 0
 s_min_u32 s54, s54, 63
 s_mul_i32 s56, s54, 28672
 s_add_u32 s56, s56, s44
 s_and_b32 s54, s54, 1
 s_mul_i32 s58, s54, 32768
 s_add_u32 s58, s58, s45
 s_add_u32 m0, s58, 0
 s_add_u32 s59, s56, 0
 buffer_load_dwordx4 v1, s[16:19], s59 offen offset:0 sc1 lds
 buffer_load_dwordx4 v1, s[16:19], s59 offen offset:1024 sc1 lds
 buffer_load_dwordx4 v1, s[16:19], s59 offen offset:2048 sc1 lds
 buffer_load_dwordx4 v1, s[16:19], s59 offen offset:3072 sc1 lds
 s_add_u32 m0, s58, 4096
 s_add_u32 s59, s56, 4096
 buffer_load_dwordx4 v1, s[16:19], s59 offen offset:0 sc1 lds
 buffer_load_dwordx4 v1, s[16:19], s59 offen offset:1024 sc1 lds
 buffer_load_dwordx4 v1, s[16:19], s59 offen offset:2048 sc1 lds
 buffer_load_dwordx4 v1, s[16:19], s59 offen offset:3072 sc1 lds
 s_add_u32 m0, s58, 8192
 s_add_u32 s59, s56, 8192
 buffer_load_dwordx4 v1, s[16:19], s59 offen offset:0 sc1 lds
 buffer_load_dwordx4 v1, s[16:19], s59 offen offset:1024 sc1 lds
 buffer_load_dwordx4 v1, s[16:19], s59 offen offset:2048 sc1 lds
 buffer_load_dwordx4 v1, s[16:19], s59 offen offset:3072 sc1 lds
 s_add_u32 m0, s58, 12288
 s_add_u32 s59, s56, 12288
 buffer_load_dwordx4 v1, s[16:19], s59 offen offset:0 sc1 lds
 buffer_load_dwordx4 v1, s[16:19], s59 offen offset:1024 sc1 lds
CP_A1:
 s_mul_i32 s54, s42, 401408
 s_add_u32 s54, s54, 2097152
 s_lshr_b32 s55, s40, 1
 s_and_b32 s56, s40, 1
 s_lshl_b32 s57, s55, 3
 s_add_u32 s57, s57, s56
 s_add_u32 s59, s57, 0
 s_mul_i32 s59, s59, 14336
 s_add_u32 s59, s59, s54
 buffer_load_dwordx4 a[0:3], v1, s[16:19], s59 offen offset:0 sc1
 buffer_load_dwordx4 a[4:7], v1, s[16:19], s59 offen offset:1024 sc1
 buffer_load_dwordx4 a[8:11], v1, s[16:19], s59 offen offset:2048 sc1
 buffer_load_dwordx4 a[12:15], v1, s[16:19], s59 offen offset:3072 sc1
 s_add_u32 s59, s59, 4096
 buffer_load_dwordx4 a[16:19], v1, s[16:19], s59 offen offset:0 sc1
 buffer_load_dwordx4 a[20:23], v1, s[16:19], s59 offen offset:1024 sc1
 buffer_load_dwordx4 a[24:27], v1, s[16:19], s59 offen offset:2048 sc1
 buffer_load_dwordx4 a[28:31], v1, s[16:19], s59 offen offset:3072 sc1
 s_add_u32 s59, s59, 4096
 buffer_load_dwordx4 a[32:35], v1, s[16:19], s59 offen offset:0 sc1
 buffer_load_dwordx4 a[36:39], v1, s[16:19], s59 offen offset:1024 sc1
 buffer_load_dwordx4 a[40:43], v1, s[16:19], s59 offen offset:2048 sc1
 buffer_load_dwordx4 a[44:47], v1, s[16:19], s59 offen offset:3072 sc1
 s_add_u32 s59, s59, 4096
 buffer_load_dwordx4 a[48:51], v1, s[16:19], s59 offen offset:0 sc1
 buffer_load_dwordx4 a[52:55], v1, s[16:19], s59 offen offset:1024 sc1
 s_add_u32 s59, s57, 2
 s_mul_i32 s59, s59, 14336
 s_add_u32 s59, s59, s54
 buffer_load_dwordx4 a[56:59], v1, s[16:19], s59 offen offset:0 sc1
 buffer_load_dwordx4 a[60:63], v1, s[16:19], s59 offen offset:1024 sc1
 buffer_load_dwordx4 a[64:67], v1, s[16:19], s59 offen offset:2048 sc1
 buffer_load_dwordx4 a[68:71], v1, s[16:19], s59 offen offset:3072 sc1
 s_add_u32 s59, s59, 4096
 buffer_load_dwordx4 a[72:75], v1, s[16:19], s59 offen offset:0 sc1
 buffer_load_dwordx4 a[76:79], v1, s[16:19], s59 offen offset:1024 sc1
 buffer_load_dwordx4 a[80:83], v1, s[16:19], s59 offen offset:2048 sc1
 buffer_load_dwordx4 a[84:87], v1, s[16:19], s59 offen offset:3072 sc1
 s_add_u32 s59, s59, 4096
 buffer_load_dwordx4 a[88:91], v1, s[16:19], s59 offen offset:0 sc1
 buffer_load_dwordx4 a[92:95], v1, s[16:19], s59 offen offset:1024 sc1
 buffer_load_dwordx4 a[96:99], v1, s[16:19], s59 offen offset:2048 sc1
 buffer_load_dwordx4 a[100:103], v1, s[16:19], s59 offen offset:3072 sc1
 s_add_u32 s59, s59, 4096
 buffer_load_dwordx4 a[104:107], v1, s[16:19], s59 offen offset:0 sc1
 buffer_load_dwordx4 a[108:111], v1, s[16:19], s59 offen offset:1024 sc1
 s_add_u32 s59, s57, 4
 s_mul_i32 s59, s59, 14336
 s_add_u32 s59, s59, s54
 buffer_load_dwordx4 a[112:115], v1, s[16:19], s59 offen offset:0 sc1
 buffer_load_dwordx4 a[116:119], v1, s[16:19], s59 offen offset:1024 sc1
 buffer_load_dwordx4 a[120:123], v1, s[16:19], s59 offen offset:2048 sc1
 buffer_load_dwordx4 a[124:127], v1, s[16:19], s59 offen offset:3072 sc1
 s_add_u32 s59, s59, 4096
 buffer_load_dwordx4 a[128:131], v1, s[16:19], s59 offen offset:0 sc1
 buffer_load_dwordx4 a[132:135], v1, s[16:19], s59 offen offset:1024 sc1
 buffer_load_dwordx4 a[136:139], v1, s[16:19], s59 offen offset:2048 sc1
 buffer_load_dwordx4 a[140:143], v1, s[16:19], s59 offen offset:3072 sc1
 s_add_u32 s59, s59, 4096
 buffer_load_dwordx4 a[144:147], v1, s[16:19], s59 offen offset:0 sc1
 buffer_load_dwordx4 a[148:151], v1, s[16:19], s59 offen offset:1024 sc1
 buffer_load_dwordx4 a[152:155], v1, s[16:19], s59 offen offset:2048 sc1
 buffer_load_dwordx4 a[156:159], v1, s[16:19], s59 offen offset:3072 sc1
 s_add_u32 s59, s59, 4096
 buffer_load_dwordx4 a[160:163], v1, s[16:19], s59 offen offset:0 sc1
 buffer_load_dwordx4 a[164:167], v1, s[16:19], s59 offen offset:1024 sc1
 s_add_u32 s59, s57, 6
 s_mul_i32 s59, s59, 14336
 s_add_u32 s59, s59, s54
 buffer_load_dwordx4 a[168:171], v1, s[16:19], s59 offen offset:0 sc1
 buffer_load_dwordx4 a[172:175], v1, s[16:19], s59 offen offset:1024 sc1
 buffer_load_dwordx4 a[176:179], v1, s[16:19], s59 offen offset:2048 sc1
 buffer_load_dwordx4 a[180:183], v1, s[16:19], s59 offen offset:3072 sc1
 s_add_u32 s59, s59, 4096
 buffer_load_dwordx4 a[184:187], v1, s[16:19], s59 offen offset:0 sc1
 buffer_load_dwordx4 a[188:191], v1, s[16:19], s59 offen offset:1024 sc1
 buffer_load_dwordx4 a[192:195], v1, s[16:19], s59 offen offset:2048 sc1
 buffer_load_dwordx4 a[196:199], v1, s[16:19], s59 offen offset:3072 sc1
 s_add_u32 s59, s59, 4096
 buffer_load_dwordx4 a[200:203], v1, s[16:19], s59 offen offset:0 sc1
 buffer_load_dwordx4 a[204:207], v1, s[16:19], s59 offen offset:1024 sc1
 buffer_load_dwordx4 a[208:211], v1, s[16:19], s59 offen offset:2048 sc1
 buffer_load_dwordx4 a[212:215], v1, s[16:19], s59 offen offset:3072 sc1
 s_add_u32 s59, s59, 4096
 buffer_load_dwordx4 a[216:219], v1, s[16:19], s59 offen offset:0 sc1
 buffer_load_dwordx4 a[220:223], v1, s[16:19], s59 offen offset:1024 sc1
 v_lshlrev_b32 v22, 7, v0
 s_mul_i32 s59, s42, 5120
 s_add_u32 s59, s59, 131072
 s_cmp_eq_u32 s40, 2
 s_cselect_b32 s59, s59, 16384
 buffer_load_dword v60, v22, s[16:19], s59 offen sc1
 v_bfe_u32 v26, v0, 4, 2
 v_lshlrev_b32 v14, 8, v26
 v_bfe_u32 v26, v0, 0, 1
 v_lshl_add_u32 v14, v26, 7, v14
 v_bfe_u32 v26, v0, 3, 1
 v_lshl_add_u32 v14, v26, 6, v14
 v_bfe_u32 v26, v0, 1, 1
 v_lshl_add_u32 v14, v26, 5, v14
 v_bfe_u32 v26, v0, 2, 1
 v_lshl_add_u32 v14, v26, 4, v14
 v_add_u32 v14, 32768, v14
 v_bfe_u32 v26, v0, 2, 2
 v_lshlrev_b32 v3, 6, v26
 v_bfe_u32 v26, v0, 0, 1
 v_lshl_add_u32 v3, v26, 5, v3
 v_bfe_u32 v26, v0, 4, 2
 v_lshl_add_u32 v3, v26, 3, v3
 v_bfe_u32 v26, v0, 1, 1
 v_lshl_add_u32 v3, v26, 2, v3
 v_bfe_u32 v26, v0, 4, 2
 v_lshlrev_b32 v12, 8, v26
 v_bfe_u32 v26, v0, 0, 4
 v_lshl_add_u32 v12, v26, 3, v12
 s_lshl_b32 s54, s56, 3
 v_xor_b32 v13, s54, v6
 v_and_b32 v26, 2, v0
 v_cmp_eq_u32 vcc, 0, v26
 v_mov_b32 v27, 0xff800000
 s_nop 0
 v_cndmask_b32 v11, v27, 0, vcc
 v_bfe_u32 v26, v0, 3, 1
 v_lshlrev_b32 v7, 8, v26
 v_bfe_u32 v26, v0, 4, 2
 v_lshl_add_u32 v7, v26, 6, v7
 v_bfe_u32 v26, v0, 2, 1
 v_lshl_add_u32 v7, v26, 5, v7
 v_bfe_u32 v26, v0, 0, 2
 v_lshl_add_u32 v7, v26, 2, v7
 s_lshl_b32 s54, s42, 9
 s_lshl_b32 s55, s56, 4
 s_add_u32 s54, s54, s55
 s_add_u32 s54, s54, 8192
 v_add_u32 v7, s54, v7
 v_bfe_u32 v26, v0, 2, 2
 v_lshlrev_b32 v28, 7, v26
 v_bfe_u32 v26, v0, 4, 2
 v_lshl_add_u32 v28, v26, 5, v28
 s_lshr_b32 s54, s42, 2
 s_lshl_b32 s54, s54, 9
 s_and_b32 s55, s42, 1
 s_lshl_b32 s55, s55, 4
 s_add_u32 s54, s54, s55
 s_and_b32 s55, s42, 2
 s_lshl_b32 s55, s55, 1
 s_add_u32 s54, s54, s55
 s_lshl_b32 s55, s56, 3
 s_add_u32 s54, s54, s55
 s_add_u32 s54, s54, 16384
 v_add_u32 v28, s54, v28
 v_and_b32 v26, 3, v0
 v_cmp_eq_u32 vcc, 0, v26
 s_nop 1
 v_cndmask_b32 v8, v29, v28, vcc
 v_mov_b32 v9, 0
 s_mov_b32 s66, 0x44800000
 s_mul_i32 s47, s42, 28672
 s_mul_i32 s54, s56, 14336
 s_add_u32 s47, s47, s54
 s_add_u32 s47, s47, 44040192
 s_cmp_lt_u32 s40, 2
 s_cbranch_scc1 CP_A2
 v_lshlrev_b32 v28, 7, v0
 v_cmp_gt_u32 vcc, 56, v0
 s_nop 1
 v_cndmask_b32 v7, v29, v28, vcc
CP_A2:
 s_lshl_b32 s54, s42, 2
 s_add_u32 s54, s54, 16384
 s_branch CP_C2
CP_B:
 s_lshl_b32 s48, s40, 8
 s_lshr_b32 s54, s42, 1
 s_lshl_b32 s54, s54, 3
 s_add_u32 s48, s48, s54
 s_add_u32 s48, s48, 2088960
 s_add_u32 s48, s48, s16
 s_addc_u32 s49, s17, 0
 s_lshl_b32 s43, s42, 1
 s_lshl_b32 s44, s43, 14
 s_lshl_b32 s56, s40, 12
 s_add_u32 s44, s44, s56
 s_add_u32 s44, s44, 44040192
 s_lshl_b32 s47, s43, 12
 s_lshl_b32 s56, s40, 10
 s_add_u32 s47, s47, s56
 s_add_u32 s47, s47, 19922944
 v_mov_b32 v32, -1
 v_mov_b32 v33, -1
 v_mov_b32 v34, -1
 v_mov_b32 v35, -1
 s_add_u32 s70, s47, 7225344
 s_add_u32 s71, s70, 4096
 buffer_store_dwordx4 v[32:35], v1, s[16:19], s70 offen sc1
 buffer_store_dwordx4 v[32:35], v1, s[16:19], s71 offen sc1
 s_mul_i32 s54, s40, 1605632
 s_mul_i32 s56, s43, 14336
 s_add_u32 s54, s54, s56
 s_add_u32 s54, s54, 8519680
 s_add_u32 s43, s43, s55
 s_mul_i32 s58, s40, 12288
 s_add_u32 s58, s58, 32768
 v_add_u32 v7, s58, v1
CPb0_w:
 s_load_dwordx2 s[80:81], s[48:49], 0 glc
 s_waitcnt lgkmcnt(0)
 s_xor_b32 s80, s80, s34
 s_xor_b32 s81, s81, s34
 s_or_b32 s80, s80, s81
 s_cmp_lt_u32 s80, 16
 s_cbranch_scc1 CPb0_d
 s_sleep 8
 s_max_u32 s68, s68, 1
 s_sub_u32 s68, s68, 1
 s_cmp_lg_u32 s68, 0
 s_cbranch_scc1 CPb0_w
CPb0_d:
 s_add_u32 s59, s54, 0
 s_add_u32 m0, s58, 0
 s_nop 0
 buffer_load_dwordx4 v1, s[16:19], s59 offen offset:0 sc1 lds
 buffer_load_dwordx4 v1, s[16:19], s59 offen offset:1024 sc1 lds
 buffer_load_dwordx4 v1, s[16:19], s59 offen offset:2048 sc1 lds
 buffer_load_dwordx4 v1, s[16:19], s59 offen offset:3072 sc1 lds
 s_add_u32 s59, s59, 4096
 s_add_u32 m0, s58, 4096
 s_nop 0
 buffer_load_dwordx4 v1, s[16:19], s59 offen offset:0 sc1 lds
 buffer_load_dwordx4 v1, s[16:19], s59 offen offset:1024 sc1 lds
 buffer_load_dwordx4 v1, s[16:19], s59 offen offset:2048 sc1 lds
 buffer_load_dwordx4 v1, s[16:19], s59 offen offset:3072 sc1 lds
 s_add_u32 s59, s59, 4096
 s_add_u32 m0, s58, 8192
 s_nop 0
 buffer_load_dwordx4 v1, s[16:19], s59 offen offset:0 sc1 lds
 buffer_load_dwordx4 v1, s[16:19], s59 offen offset:1024 sc1 lds
 buffer_load_dwordx4 v1, s[16:19], s59 offen offset:2048 sc1 lds
 buffer_load_dwordx4 v1, s[16:19], s59 offen offset:3072 sc1 lds
 s_add_u32 s59, s59, 4096
 buffer_load_dwordx4 a[0:3], v1, s[16:19], s59 offen offset:0 sc1
 buffer_load_dwordx4 a[4:7], v1, s[16:19], s59 offen offset:1024 sc1
 s_add_u32 s59, s54, 14336
 buffer_load_dwordx4 a[176:179], v1, s[16:19], s59 offen offset:0 sc1
 buffer_load_dwordx4 a[180:183], v1, s[16:19], s59 offen offset:1024 sc1
 buffer_load_dwordx4 a[184:187], v1, s[16:19], s59 offen offset:2048 sc1
 buffer_load_dwordx4 a[188:191], v1, s[16:19], s59 offen offset:3072 sc1
 s_add_u32 s59, s59, 4096
 buffer_load_dwordx4 a[192:195], v1, s[16:19], s59 offen offset:0 sc1
 buffer_load_dwordx4 a[196:199], v1, s[16:19], s59 offen offset:1024 sc1
 buffer_load_dwordx4 a[200:203], v1, s[16:19], s59 offen offset:2048 sc1
 buffer_load_dwordx4 a[204:207], v1, s[16:19], s59 offen offset:3072 sc1
 s_add_u32 s59, s59, 4096
 buffer_load_dwordx4 a[208:211], v1, s[16:19], s59 offen offset:0 sc1
 buffer_load_dwordx4 a[212:215], v1, s[16:19], s59 offen offset:1024 sc1
 buffer_load_dwordx4 a[216:219], v1, s[16:19], s59 offen offset:2048 sc1
 buffer_load_dwordx4 a[220:223], v1, s[16:19], s59 offen offset:3072 sc1
 s_add_u32 s59, s59, 4096
 buffer_load_dwordx4 a[224:227], v1, s[16:19], s59 offen offset:0 sc1
 buffer_load_dwordx4 a[228:231], v1, s[16:19], s59 offen offset:1024 sc1
CPb1_w:
 s_load_dwordx2 s[80:81], s[48:49], 64 glc
 s_waitcnt lgkmcnt(0)
 s_xor_b32 s80, s80, s34
 s_xor_b32 s81, s81, s34
 s_or_b32 s80, s80, s81
 s_cmp_lt_u32 s80, 16
 s_cbranch_scc1 CPb1_d
 s_sleep 8
 s_max_u32 s68, s68, 1
 s_sub_u32 s68, s68, 1
 s_cmp_lg_u32 s68, 0
 s_cbranch_scc1 CPb1_w
CPb1_d:
 s_add_u32 s59, s54, 401408
 buffer_load_dwordx4 a[8:11], v1, s[16:19], s59 offen offset:0 sc1
 buffer_load_dwordx4 a[12:15], v1, s[16:19], s59 offen offset:1024 sc1
 buffer_load_dwordx4 a[16:19], v1, s[16:19], s59 offen offset:2048 sc1
 buffer_load_dwordx4 a[20:23], v1, s[16:19], s59 offen offset:3072 sc1
 s_add_u32 s59, s59, 4096
 buffer_load_dwordx4 a[24:27], v1, s[16:19], s59 offen offset:0 sc1
 buffer_load_dwordx4 a[28:31], v1, s[16:19], s59 offen offset:1024 sc1
 buffer_load_dwordx4 a[32:35], v1, s[16:19], s59 offen offset:2048 sc1
 buffer_load_dwordx4 a[36:39], v1, s[16:19], s59 offen offset:3072 sc1
 s_add_u32 s59, s59, 4096
 buffer_load_dwordx4 a[40:43], v1, s[16:19], s59 offen offset:0 sc1
 buffer_load_dwordx4 a[44:47], v1, s[16:19], s59 offen offset:1024 sc1
 buffer_load_dwordx4 a[48:51], v1, s[16:19], s59 offen offset:2048 sc1
 buffer_load_dwordx4 a[52:55], v1, s[16:19], s59 offen offset:3072 sc1
 s_add_u32 s59, s59, 4096
 buffer_load_dwordx4 a[56:59], v1, s[16:19], s59 offen offset:0 sc1
 buffer_load_dwordx4 a[60:63], v1, s[16:19], s59 offen offset:1024 sc1
 s_add_u32 s59, s54, 415744
 buffer_load_dwordx4 a[232:235], v1, s[16:19], s59 offen offset:0 sc1
 buffer_load_dwordx4 a[236:239], v1, s[16:19], s59 offen offset:1024 sc1
 buffer_load_dwordx4 a[240:243], v1, s[16:19], s59 offen offset:2048 sc1
 buffer_load_dwordx4 a[244:247], v1, s[16:19], s59 offen offset:3072 sc1
 s_add_u32 s59, s59, 4096
 buffer_load_dwordx4 a[248:251], v1, s[16:19], s59 offen offset:0 sc1
 buffer_load_dwordx4 a[252:255], v1, s[16:19], s59 offen offset:1024 sc1
 buffer_load_dwordx4 v[112:115], v1, s[16:19], s59 offen offset:2048 sc1
 buffer_load_dwordx4 v[116:119], v1, s[16:19], s59 offen offset:3072 sc1
 s_add_u32 s59, s59, 4096
 buffer_load_dwordx4 v[120:123], v1, s[16:19], s59 offen offset:0 sc1
 buffer_load_dwordx4 v[124:127], v1, s[16:19], s59 offen offset:1024 sc1
 buffer_load_dwordx4 v[128:131], v1, s[16:19], s59 offen offset:2048 sc1
 buffer_load_dwordx4 v[132:135], v1, s[16:19], s59 offen offset:3072 sc1
 s_add_u32 s59, s59, 4096
 buffer_load_dwordx4 v[136:139], v1, s[16:19], s59 offen offset:0 sc1
 buffer_load_dwordx4 v[140:143], v1, s[16:19], s59 offen offset:1024 sc1
CPb2_w:
 s_load_dwordx2 s[80:81], s[48:49], 128 glc
 s_waitcnt lgkmcnt(0)
 s_xor_b32 s80, s80, s34
 s_xor_b32 s81, s81, s34
 s_or_b32 s80, s80, s81
 s_cmp_lt_u32 s80, 16
 s_cbranch_scc1 CPb2_d
 s_sleep 8
 s_max_u32 s68, s68, 1
 s_sub_u32 s68, s68, 1
 s_cmp_lg_u32 s68, 0
 s_cbranch_scc1 CPb2_w
CPb2_d:
 s_add_u32 s59, s54, 802816
 buffer_load_dwordx4 a[64:67], v1, s[16:19], s59 offen offset:0 sc1
 buffer_load_dwordx4 a[68:71], v1, s[16:19], s59 offen offset:1024 sc1
 buffer_load_dwordx4 a[72:75], v1, s[16:19], s59 offen offset:2048 sc1
 buffer_load_dwordx4 a[76:79], v1, s[16:19], s59 offen offset:3072 sc1
 s_add_u32 s59, s59, 4096
 buffer_load_dwordx4 a[80:83], v1, s[16:19], s59 offen offset:0 sc1
 buffer_load_dwordx4 a[84:87], v1, s[16:19], s59 offen offset:1024 sc1
 buffer_load_dwordx4 a[88:91], v1, s[16:19], s59 offen offset:2048 sc1
 buffer_load_dwordx4 a[92:95], v1, s[16:19], s59 offen offset:3072 sc1
 s_add_u32 s59, s59, 4096
 buffer_load_dwordx4 a[96:99], v1, s[16:19], s59 offen offset:0 sc1
 buffer_load_dwordx4 a[100:103], v1, s[16:19], s59 offen offset:1024 sc1
 buffer_load_dwordx4 a[104:107], v1, s[16:19], s59 offen offset:2048 sc1
 buffer_load_dwordx4 a[108:111], v1, s[16:19], s59 offen offset:3072 sc1
 s_add_u32 s59, s59, 4096
 buffer_load_dwordx4 a[112:115], v1, s[16:19], s59 offen offset:0 sc1
 buffer_load_dwordx4 a[116:119], v1, s[16:19], s59 offen offset:1024 sc1
 s_add_u32 s59, s54, 817152
 buffer_load_dwordx4 v[144:147], v1, s[16:19], s59 offen offset:0 sc1
 buffer_load_dwordx4 v[148:151], v1, s[16:19], s59 offen offset:1024 sc1
 buffer_load_dwordx4 v[152:155], v1, s[16:19], s59 offen offset:2048 sc1
 buffer_load_dwordx4 v[156:159], v1, s[16:19], s59 offen offset:3072 sc1
 s_add_u32 s59, s59, 4096
 buffer_load_dwordx4 v[160:163], v1, s[16:19], s59 offen offset:0 sc1
 buffer_load_dwordx4 v[164:167], v1, s[16:19], s59 offen offset:1024 sc1
 buffer_load_dwordx4 v[168:171], v1, s[16:19], s59 offen offset:2048 sc1
 buffer_load_dwordx4 v[172:175], v1, s[16:19], s59 offen offset:3072 sc1
 s_add_u32 s59, s59, 4096
 buffer_load_dwordx4 v[176:179], v1, s[16:19], s59 offen offset:0 sc1
 buffer_load_dwordx4 v[180:183], v1, s[16:19], s59 offen offset:1024 sc1
 buffer_load_dwordx4 v[184:187], v1, s[16:19], s59 offen offset:2048 sc1
 buffer_load_dwordx4 v[188:191], v1, s[16:19], s59 offen offset:3072 sc1
 s_add_u32 s59, s59, 4096
 buffer_load_dwordx4 v[192:195], v1, s[16:19], s59 offen offset:0 sc1
 buffer_load_dwordx4 v[196:199], v1, s[16:19], s59 offen offset:1024 sc1
CPb3_w:
 s_load_dwordx2 s[80:81], s[48:49], 192 glc
 s_waitcnt lgkmcnt(0)
 s_xor_b32 s80, s80, s34
 s_xor_b32 s81, s81, s34
 s_or_b32 s80, s80, s81
 s_cmp_lt_u32 s80, 16
 s_cbranch_scc1 CPb3_d
 s_sleep 8
 s_max_u32 s68, s68, 1
 s_sub_u32 s68, s68, 1
 s_cmp_lg_u32 s68, 0
 s_cbranch_scc1 CPb3_w
CPb3_d:
 s_add_u32 s59, s54, 1204224
 buffer_load_dwordx4 a[120:123], v1, s[16:19], s59 offen offset:0 sc1
 buffer_load_dwordx4 a[124:127], v1, s[16:19], s59 offen offset:1024 sc1
 buffer_load_dwordx4 a[128:131], v1, s[16:19], s59 offen offset:2048 sc1
 buffer_load_dwordx4 a[132:135], v1, s[16:19], s59 offen offset:3072 sc1
 s_add_u32 s59, s59, 4096
 buffer_load_dwordx4 a[136:139], v1, s[16:19], s59 offen offset:0 sc1
 buffer_load_dwordx4 a[140:143], v1, s[16:19], s59 offen offset:1024 sc1
 buffer_load_dwordx4 a[144:147], v1, s[16:19], s59 offen offset:2048 sc1
 buffer_load_dwordx4 a[148:151], v1, s[16:19], s59 offen offset:3072 sc1
 s_add_u32 s59, s59, 4096
 buffer_load_dwordx4 a[152:155], v1, s[16:19], s59 offen offset:0 sc1
 buffer_load_dwordx4 a[156:159], v1, s[16:19], s59 offen offset:1024 sc1
 buffer_load_dwordx4 a[160:163], v1, s[16:19], s59 offen offset:2048 sc1
 buffer_load_dwordx4 a[164:167], v1, s[16:19], s59 offen offset:3072 sc1
 s_add_u32 s59, s59, 4096
 buffer_load_dwordx4 a[168:171], v1, s[16:19], s59 offen offset:0 sc1
 buffer_load_dwordx4 a[172:175], v1, s[16:19], s59 offen offset:1024 sc1
 s_add_u32 s59, s54, 1218560
 buffer_load_dwordx4 v[200:203], v1, s[16:19], s59 offen offset:0 sc1
 buffer_load_dwordx4 v[204:207], v1, s[16:19], s59 offen offset:1024 sc1
 buffer_load_dwordx4 v[208:211], v1, s[16:19], s59 offen offset:2048 sc1
 buffer_load_dwordx4 v[212:215], v1, s[16:19], s59 offen offset:3072 sc1
 s_add_u32 s59, s59, 4096
 buffer_load_dwordx4 v[216:219], v1, s[16:19], s59 offen offset:0 sc1
 buffer_load_dwordx4 v[220:223], v1, s[16:19], s59 offen offset:1024 sc1
 buffer_load_dwordx4 v[224:227], v1, s[16:19], s59 offen offset:2048 sc1
 buffer_load_dwordx4 v[228:231], v1, s[16:19], s59 offen offset:3072 sc1
 s_add_u32 s59, s59, 4096
 buffer_load_dwordx4 v[232:235], v1, s[16:19], s59 offen offset:0 sc1
 buffer_load_dwordx4 v[236:239], v1, s[16:19], s59 offen offset:1024 sc1
 buffer_load_dwordx4 v[240:243], v1, s[16:19], s59 offen offset:2048 sc1
 buffer_load_dwordx4 v[244:247], v1, s[16:19], s59 offen offset:3072 sc1
 s_add_u32 s59, s59, 4096
 buffer_load_dwordx4 v[248:251], v1, s[16:19], s59 offen offset:0 sc1
 buffer_load_dwordx4 v[252:255], v1, s[16:19], s59 offen offset:1024 sc1
 v_bfe_u32 v26, v0, 4, 2
 v_lshlrev_b32 v8, 6, v26
 v_bfe_u32 v26, v0, 0, 2
 v_lshl_add_u32 v8, v26, 4, v8
 v_bfe_u32 v26, v0, 2, 2
 v_lshl_add_u32 v8, v26, 2, v8
 s_lshl_b32 s54, s43, 8
 v_add_u32 v8, s54, v8
 v_lshlrev_b32 v3, 3, v0
 v_lshrrev_b32 v26, 1, v0
 v_mul_u32_u24 v30, 144, v26
 v_add_u32 v30, 20480, v30
 v_and_b32 v26, 1, v0
 v_lshl_add_u32 v30, v26, 4, v30
 v_bfe_u32 v26, v0, 4, 2
 v_lshlrev_b32 v31, 3, v26
 v_bfe_u32 v26, v0, 0, 2
 v_lshl_add_u32 v31, v26, 1, v31
 v_bfe_u32 v26, v0, 3, 1
 v_lshl_add_u32 v31, v26, 0, v31
 v_mul_u32_u24 v6, 144, v31
 v_bfe_u32 v26, v0, 2, 1
 v_lshl_add_u32 v6, v26, 2, v6
 s_lshl_b32 s54, s55, 3
 s_add_u32 s54, s54, 20480
 v_add_u32 v6, s54, v6
 v_bfe_u32 v26, v0, 4, 2
 v_lshlrev_b32 v25, 1, v26
 v_bfe_u32 v26, v0, 0, 1
 v_lshl_add_u32 v25, v26, 0, v25
 v_bfe_u32 v31, v0, 1, 3
 v_mul_u32_u24 v9, 896, v25
 v_and_b32 v26, 7, v31
 v_lshl_add_u32 v9, v26, 2, v9
 s_lshl_b32 s54, s43, 5
 v_add_u32 v9, s54, v9
 v_min_u32 v27, 55, v0
 v_lshlrev_b32 v27, 3, v27
 s_waitcnt vmcnt(0)
 v_and_b32 v25, 31, v0
 v_lshlrev_b32 v25, 2, v25
 s_mov_b32 s69, 2091008
CPxb_w:
 buffer_load_dword v26, v25, s[16:19], s69 offen sc1
 s_waitcnt vmcnt(0)
 v_and_b32 v27, -16, v26
 v_cmp_ne_u32 vcc, s34, v27
 s_cbranch_vccz CPxb_d
 s_sleep 1
 s_max_u32 s68, s68, 1
 s_sub_u32 s68, s68, 1
 s_cmp_lg_u32 s68, 0
 s_cbranch_scc1 CPxb_w
CPxb_d:
 s_add_u32 s54, s34, s41
 v_cmp_ne_u32 vcc, s54, v26
 s_nop 0
 s_cmp_lg_u64 vcc, 0
 s_cselect_b32 s33, 1, 0
 s_mov_b32 s69, 2093056
CPxbn_w:
 buffer_load_dwordx4 v[32:35], v1, s[16:19], s69 offen sc1
 s_waitcnt vmcnt(0)
 v_xor_b32 v32, s34, v32
 v_xor_b32 v33, s34, v33
 v_xor_b32 v34, s34, v34
 v_xor_b32 v35, s34, v35
 v_or3_b32 v32, v32, v33, v34
 v_or_b32 v32, v32, v35
 v_cmp_lt_u32 vcc, 15, v32
 s_cbranch_vccz CPxbn_d
 s_sleep 1
 s_max_u32 s68, s68, 1
 s_sub_u32 s68, s68, 1
 s_cmp_lg_u32 s68, 0
 s_cbranch_scc1 CPxbn_w
CPxbn_d:
 v_min_u32 v27, 55, v0
 v_lshlrev_b32 v27, 3, v27
 s_lshl_b32 s69, 0, 9
 s_add_u32 s69, s69, 8192
CPb_w:
 buffer_load_dwordx2 v[32:33], v27, s[16:19], s69 offen sc1
 s_waitcnt vmcnt(0)
 v_min_u32 v32, v32, v33
 v_cmp_eq_u32 vcc, 0, v32
 s_cbranch_vccz CPb_d
 s_sleep 2
 s_max_u32 s68, s68, 1
 s_sub_u32 s68, s68, 1
 s_cmp_lg_u32 s68, 0
 s_cbranch_scc1 CPb_w
CPb_d:
 s_lshl_b32 s54, s42, 2
 s_cmp_eq_u32 s40, 3
 s_cselect_b32 s54, s54, 4
 s_add_u32 s54, s54, 16640
 s_branch CP_C2
CP_F:
 v_and_b32 v25, 31, v0
 v_lshlrev_b32 v25, 2, v25
 s_mov_b32 s69, 2091008
CPxf_w:
 buffer_load_dword v26, v25, s[16:19], s69 offen sc1
 s_waitcnt vmcnt(0)
 v_and_b32 v27, -16, v26
 v_cmp_ne_u32 vcc, s34, v27
 s_cbranch_vccz CPxf_d
 s_sleep 1
 s_max_u32 s68, s68, 1
 s_sub_u32 s68, s68, 1
 s_cmp_lg_u32 s68, 0
 s_cbranch_scc1 CPxf_w
CPxf_d:
 s_add_u32 s54, s34, s41
 v_cmp_ne_u32 vcc, s54, v26
 s_nop 0
 s_cmp_lg_u64 vcc, 0
 s_cselect_b32 s33, 1, 0
 s_mov_b32 s69, 2093056
CPxfn_w:
 buffer_load_dwordx4 v[32:35], v1, s[16:19], s69 offen sc1
 s_waitcnt vmcnt(0)
 v_xor_b32 v32, s34, v32
 v_xor_b32 v33, s34, v33
 v_xor_b32 v34, s34, v34
 v_xor_b32 v35, s34, v35
 v_or3_b32 v32, v32, v33, v34
 v_or_b32 v32, v32, v35
 v_cmp_lt_u32 vcc, 15, v32
 s_cbranch_vccz CPxfn_d
 s_sleep 1
 s_max_u32 s68, s68, 1
 s_sub_u32 s68, s68, 1
 s_cmp_lg_u32 s68, 0
 s_cbranch_scc1 CPxfn_w
CPxfn_d:
CP_C2:
 v_mov_b32 v27, s54
 v_cmp_eq_u32 vcc, 0, v0
 s_nop 1
 v_cndmask_b32 v4, v29, v27, vcc
 s_cmp_lt_u32 s46, 30
 s_cbranch_scc1 CP_nf
 s_mov_b32 s73, s33
 s_branch CF_start
CP_nf:
 s_cmp_eq_u32 s40, 3
 s_cselect_b32 s54, 13, 17
 v_min_u32 v25, s54, v0
 v_lshlrev_b32 v0, 2, v25
 s_lshl_b32 s54, s73, 2
 s_add_u32 s54, s54, s40
 s_cmp_lg_u32 s33, 0
 s_cbranch_scc1 CP_safe
 s_cmp_lg_u32 s54, 0
 s_cbranch_scc1 CP_nFA0
 s_branch CA0F_start
CP_nFA0:
 s_cmp_lg_u32 s54, 1
 s_cbranch_scc1 CP_nFA1
 s_branch CA1F_start
CP_nFA1:
 s_cmp_lg_u32 s54, 2
 s_cbranch_scc1 CP_nFA2
 s_branch CA2F_start
CP_nFA2:
 s_cmp_lg_u32 s54, 3
 s_cbranch_scc1 CP_nFA3
 s_branch CA3F_start
CP_nFA3:
 s_cmp_lg_u32 s54, 4
 s_cbranch_scc1 CP_nFB0
 s_branch CB0F_start
CP_nFB0:
 s_cmp_lg_u32 s54, 5
 s_cbranch_scc1 CP_nFB1
 s_branch CB1F_start
CP_nFB1:
 s_cmp_lg_u32 s54, 6
 s_cbranch_scc1 CP_nFB2
 s_branch CB2F_start
CP_nFB2:
 s_cmp_lg_u32 s54, 7
 s_cbranch_scc1 CP_nFB3
 s_branch CB3F_start
CP_nFB3:
 s_endpgm
CP_safe:
 s_cmp_lg_u32 s54, 0
 s_cbranch_scc1 CP_nSA0
 s_branch CA0S_start
CP_nSA0:
 s_cmp_lg_u32 s54, 1
 s_cbranch_scc1 CP_nSA1
 s_branch CA1S_start
CP_nSA1:
 s_cmp_lg_u32 s54, 2
 s_cbranch_scc1 CP_nSA2
 s_branch CA2S_start
CP_nSA2:
 s_cmp_lg_u32 s54, 3
 s_cbranch_scc1 CP_nSA3
 s_branch CA3S_start
CP_nSA3:
 s_cmp_lg_u32 s54, 4
 s_cbranch_scc1 CP_nSB0
 s_branch CB0S_start
CP_nSB0:
 s_cmp_lg_u32 s54, 5
 s_cbranch_scc1 CP_nSB1
 s_branch CB1S_start
CP_nSB1:
 s_cmp_lg_u32 s54, 6
 s_cbranch_scc1 CP_nSB2
 s_branch CB2S_start
CP_nSB2:
 s_cmp_lg_u32 s54, 7
 s_cbranch_scc1 CP_nSB3
 s_branch CB3S_start
CP_nSB3:
 s_endpgm
CF_start:
 s_and_b32 s42, s46, 1
 s_lshl_b32 s54, s40, 7
 s_add_u32 s54, s54, 0
 v_add_u32 v27, s54, v0
 v_cmp_gt_u32 vcc, 448, v27
 v_lshlrev_b32 v22, 4, v27
 s_nop 0
 v_cndmask_b32 v22, v29, v22, vcc
 v_mul_u32_u24 v28, 1171, v27
 v_lshrrev_b32 v28, 16, v28
 v_mul_u32_u24 v26, 56, v28
 v_sub_u32 v27, v27, v26
 v_lshrrev_b32 v26, 1, v27
 v_lshlrev_b32 v20, 8, v26
 v_and_b32 v26, 1, v27
 v_lshl_add_u32 v20, v26, 3, v20
 v_lshrrev_b32 v26, 1, v28
 v_lshl_add_u32 v20, v26, 6, v20
 v_and_b32 v26, 1, v28
 v_lshl_add_u32 v20, v26, 4, v20
 v_cndmask_b32 v20, v29, v20, vcc
 s_lshl_b32 s54, s40, 7
 s_add_u32 s54, s54, 64
 v_add_u32 v27, s54, v0
 v_cmp_gt_u32 vcc, 448, v27
 v_lshlrev_b32 v23, 4, v27
 s_nop 0
 v_cndmask_b32 v23, v29, v23, vcc
 v_mul_u32_u24 v28, 1171, v27
 v_lshrrev_b32 v28, 16, v28
 v_mul_u32_u24 v26, 56, v28
 v_sub_u32 v27, v27, v26
 v_lshrrev_b32 v26, 1, v27
 v_lshlrev_b32 v21, 8, v26
 v_and_b32 v26, 1, v27
 v_lshl_add_u32 v21, v26, 3, v21
 v_lshrrev_b32 v26, 1, v28
 v_lshl_add_u32 v21, v26, 6, v21
 v_and_b32 v26, 1, v28
 v_lshl_add_u32 v21, v26, 4, v21
 v_cndmask_b32 v21, v29, v21, vcc
 v_cmp_eq_u32 vcc, 0, v0
 s_nop 1
 v_cndmask_b32 v24, v29, 0, vcc
 v_lshlrev_b32 v25, 7, v0
 v_min_u32 v0, 55, v0
 v_lshlrev_b32 v30, 3, v0
 v_min_u32 v0, 13, v0
 v_lshlrev_b32 v0, 2, v0
 s_mov_b32 s49, -1
 s_lshl_b32 s43, s42, 2
 s_add_u32 s44, s43, 16448
 s_sub_u32 s50, s42, 2
CF_loop:
 s_cmp_lt_i32 s50, 0
 s_cbranch_scc1 CF_pf
 s_mov_b32 s69, 16640
 buffer_load_dword v50, v0, s[16:19], s69 offen sc1
 s_nop 7
 s_nop 7
 s_nop 7
 buffer_load_dword v51, v0, s[16:19], s69 offen sc1
CFm_pl:
 s_waitcnt vmcnt(1)
 v_cmp_gt_u32 vcc, s50, v50
 s_cbranch_vccz CFm_pd
 buffer_load_dword v50, v0, s[16:19], s69 offen sc1
 s_waitcnt vmcnt(1)
 v_cmp_gt_u32 vcc, s50, v51
 s_cbranch_vccz CFm_pd
 buffer_load_dword v51, v0, s[16:19], s69 offen sc1
 s_max_u32 s68, s68, 1
 s_sub_u32 s68, s68, 1
 s_cmp_lg_u32 s68, 0
 s_cbranch_scc1 CFm_pl
CFm_pd:
 s_and_b32 s54, s50, 3
 s_mul_i32 s51, s54, 20480
 s_add_u32 s51, s51, 131072
CF_ld:
 buffer_load_dwordx4 v[40:43], v22, s[16:19], s51 offen sc1
 buffer_load_dwordx4 v[44:47], v23, s[16:19], s51 offen sc1
 buffer_load_dword v32, v20, s[16:19], s51 offen offset:0 sc1
 buffer_load_dword v33, v20, s[16:19], s51 offen offset:32 sc1
 buffer_load_dword v34, v20, s[16:19], s51 offen offset:4 sc1
 buffer_load_dword v35, v20, s[16:19], s51 offen offset:36 sc1
 buffer_load_dword v36, v21, s[16:19], s51 offen offset:0 sc1
 buffer_load_dword v37, v21, s[16:19], s51 offen offset:32 sc1
 buffer_load_dword v38, v21, s[16:19], s51 offen offset:4 sc1
 buffer_load_dword v39, v21, s[16:19], s51 offen offset:36 sc1
 s_waitcnt vmcnt(0)
 v_mov_b32 v53, 0
 v_and_b32 v52, s74, v32
 v_pk_max_u16 v53, v53, v52
 v_and_b32 v52, s74, v33
 v_pk_max_u16 v53, v53, v52
 v_and_b32 v52, s74, v34
 v_pk_max_u16 v53, v53, v52
 v_and_b32 v52, s74, v35
 v_pk_max_u16 v53, v53, v52
 v_and_b32 v52, s74, v36
 v_pk_max_u16 v53, v53, v52
 v_and_b32 v52, s74, v37
 v_pk_max_u16 v53, v53, v52
 v_and_b32 v52, s74, v38
 v_pk_max_u16 v53, v53, v52
 v_and_b32 v52, s74, v39
 v_pk_max_u16 v53, v53, v52
 v_and_b32 v52, s74, v40
 v_pk_max_u16 v53, v53, v52
 v_and_b32 v52, s74, v41
 v_pk_max_u16 v53, v53, v52
 v_and_b32 v52, s74, v42
 v_pk_max_u16 v53, v53, v52
 v_and_b32 v52, s74, v43
 v_pk_max_u16 v53, v53, v52
 v_and_b32 v52, s74, v44
 v_pk_max_u16 v53, v53, v52
 v_and_b32 v52, s74, v45
 v_pk_max_u16 v53, v53, v52
 v_and_b32 v52, s74, v46
 v_pk_max_u16 v53, v53, v52
 v_and_b32 v52, s74, v47
 v_pk_max_u16 v53, v53, v52
 v_lshrrev_b32 v52, 16, v53
 v_and_b32 v53, 0xffff, v53
 v_max_u32 v52, v52, v53
 v_cmp_lt_u32 vcc, 0x7f81, v52
 s_cbranch_vccz CF_pf
 s_max_u32 s68, s68, 1
 s_sub_u32 s68, s68, 1
 s_cmp_lg_u32 s68, 0
 s_cbranch_scc1 CF_ld
CF_pf:
 s_add_u32 s57, s50, 4
 s_min_u32 s57, s57, 63
 s_lshr_b32 s54, s57, 2
 s_cmp_le_i32 s54, s49
 s_cbranch_scc1 CF_ud
 s_mov_b32 s49, s54
 s_lshl_b32 s69, s54, 9
 s_add_u32 s69, s69, 8192
CFu_w:
 buffer_load_dwordx2 v[58:59], v30, s[16:19], s69 offen sc1
 s_waitcnt vmcnt(0)
 v_min_u32 v58, v58, v59
 v_cmp_eq_u32 vcc, 0, v58
 s_cbranch_vccz CFu_d
 s_sleep 2
 s_max_u32 s68, s68, 1
 s_sub_u32 s68, s68, 1
 s_cmp_lg_u32 s68, 0
 s_cbranch_scc1 CFu_w
CFu_d:
CF_ud:
 s_barrier
 s_add_u32 s54, s50, 4
 v_mov_b32 v54, s54
 v_mov_b32 v55, s54
 s_cmp_lg_u32 s40, 0
 s_cbranch_scc1 CF_nf
 s_cmp_lg_u32 s73, 0
 s_cbranch_scc1 CF_fs
 buffer_store_dword v54, v24, s[16:19], s44 offen
 s_branch CF_nf
CF_fs:
 buffer_store_dword v54, v24, s[16:19], s44 offen sc1
CF_nf:
 s_cmp_lt_i32 s50, 0
 s_cbranch_scc1 CF_ne
 s_mul_i32 s47, s50, 7168
 s_add_u32 s48, s47, 671744
 s_add_u32 s47, s47, 212992
 s_lshl_b32 s45, s50, 10
 s_add_u32 s45, s45, 57856
 buffer_store_dwordx4 v[32:35], v22, s[16:19], s47 offen sc1
 buffer_store_dwordx4 v[40:43], v22, s[16:19], s48 offen sc1
 buffer_store_dwordx4 v[36:39], v23, s[16:19], s47 offen sc1
 buffer_store_dwordx4 v[44:47], v23, s[16:19], s48 offen sc1
 s_cmp_lg_u32 s40, 0
 s_cbranch_scc1 CF_ne
 s_mov_b32 s54, 1
 s_atomic_or s54, s[16:17], s45
CF_ne:
 s_mul_i32 s58, s57, 28672
 s_mul_i32 s55, s40, 7168
 s_add_u32 s58, s58, s55
 s_add_u32 s58, s58, 17825792
 buffer_load_dword v56, v25, s[16:19], s58 offen
 s_mul_i32 s59, s57, 458752
 s_add_u32 s59, s59, 44040192
 s_add_u32 s50, s50, 2
 s_cmp_lt_i32 s50, 63
 s_cbranch_scc1 CF_loop
 s_endpgm
.p2align 6
CA0F_start:
 s_mov_b32 s50, 0
 s_mov_b32 s60, 0
 s_mov_b32 s61, -1
 s_mov_b32 s96, 0
 s_mov_b32 s97, 0
 s_mov_b32 s67, 4096
 s_mov_b32 s51, 131072
 s_mov_b32 s52, 151552
 s_mov_b32 s75, 172032
 s_mov_b32 s53, 192512
 s_waitcnt vmcnt(0)
 s_barrier
CA0F_top:
 v_mov_b32 v80, 0
 v_mov_b32 v81, 0
 v_mov_b32 v82, 0
 v_mov_b32 v83, 0
 v_mov_b32 v84, 0
 v_mov_b32 v85, 0
 v_mov_b32 v86, 0
 v_mov_b32 v87, 0
 v_mov_b32 v88, 0
 v_mov_b32 v89, 0
 v_mov_b32 v90, 0
 v_mov_b32 v91, 0
 v_mfma_f32_32x32x16_bf16 v[48:63], v[80:83], v[80:83], 0
 v_mfma_f32_32x32x16_bf16 v[64:79], v[80:83], v[80:83], 0
 s_add_u32 s54, s50, 1
 v_mov_b32 v5, s54
 s_nop 9
 v_mov_b32 v76, v9
 v_mov_b32 v80, v9
 v_mov_b32 v84, v9
 s_waitcnt vmcnt(0)
CA0F_bm:
 s_barrier
 ds_read_b128 v[16:19], v1 offset:12288
 ds_read_b128 v[20:23], v1 offset:13312
 s_waitcnt lgkmcnt(1)
 v_smfmac_f32_16x16x64_bf16 v[48:51], v[16:19], a[0:7], v2
 v_smfmac_f32_16x16x64_bf16 v[52:55], v[16:19], a[56:63], v2
 s_barrier
 ds_read_b128 v[24:27], v1 offset:14336
 ds_read_b128 v[28:31], v1 offset:15360
 v_smfmac_f32_16x16x64_bf16 v[56:59], v[16:19], a[112:119], v2
 ds_read_b128 v[32:35], v1 offset:16384
 s_waitcnt lgkmcnt(3)
 v_smfmac_f32_16x16x64_bf16 v[48:51], v[20:23], a[8:15], v2
 ds_read_b128 v[36:39], v1 offset:17408
 v_smfmac_f32_16x16x64_bf16 v[52:55], v[20:23], a[64:71], v2
 ds_read_b128 v[40:43], v1 offset:18432
CA0F_g2:
 v_smfmac_f32_16x16x64_bf16 v[56:59], v[20:23], a[120:127], v2
 s_waitcnt lgkmcnt(4)
 v_smfmac_f32_16x16x64_bf16 v[48:51], v[24:27], a[16:23], v2
 v_max3_u32 v119, v16, v20, v24
 s_waitcnt lgkmcnt(3)
 v_smfmac_f32_16x16x64_bf16 v[48:51], v[28:31], a[24:31], v2
 s_waitcnt lgkmcnt(2)
 v_smfmac_f32_16x16x64_bf16 v[48:51], v[32:35], a[32:39], v2
 v_max3_u32 v119, v119, v28, v32
 s_waitcnt lgkmcnt(1)
 v_smfmac_f32_16x16x64_bf16 v[48:51], v[36:39], a[40:47], v2
 s_waitcnt lgkmcnt(0)
 v_smfmac_f32_16x16x64_bf16 v[48:51], v[40:43], a[48:55], v2
 v_max3_u32 v119, v119, v36, v40
 v_smfmac_f32_16x16x64_bf16 v[52:55], v[24:27], a[72:79], v2
 v_cmp_eq_u32 vcc, -1, v119
 v_smfmac_f32_16x16x64_bf16 v[52:55], v[28:31], a[80:87], v2
 v_add_f32 v48, v48, v50
 v_add_f32 v49, v49, v51
 v_smfmac_f32_16x16x64_bf16 v[52:55], v[32:35], a[88:95], v2
 s_cbranch_vccnz CA0F_q
CA0F_qc:
 v_smfmac_f32_16x16x64_bf16 v[52:55], v[36:39], a[96:103], v2
 v_cmp_u_f32 vcc, v48, v49
 v_cvt_pk_bf16_f32 v48, v48, v49
 v_smfmac_f32_16x16x64_bf16 v[52:55], v[40:43], a[104:111], v2
 ds_write_b32 v3, v48 offset:5120
 v_smfmac_f32_16x16x64_bf16 v[56:59], v[24:27], a[128:135], v2
 s_cbranch_vccnz CA0F_slow
CA0F_cont:
 v_smfmac_f32_16x16x64_bf16 v[56:59], v[28:31], a[136:143], v2
 v_add_f32 v52, v52, v54
 v_add_f32 v53, v53, v55
 v_smfmac_f32_16x16x64_bf16 v[56:59], v[32:35], a[144:151], v2
 ds_read_b128 v[92:95], v14 offset:0
 v_cvt_pk_bf16_f32 v52, v52, v53
 v_smfmac_f32_16x16x64_bf16 v[56:59], v[36:39], a[152:159], v2
 ds_write_b32 v3, v52 offset:5376
 v_smfmac_f32_16x16x64_bf16 v[56:59], v[40:43], a[160:167], v2
 ds_read_b128 v[48:51], v14 offset:20480
 v_smfmac_f32_16x16x64_bf16 v[60:63], v[16:19], a[168:175], v2
 ds_read_b128 v[52:55], v14 offset:21504
 v_smfmac_f32_16x16x64_bf16 v[60:63], v[20:23], a[176:183], v2
 v_add_f32 v56, v56, v58
 v_smfmac_f32_16x16x64_bf16 v[60:63], v[24:27], a[184:191], v2
 v_add_f32 v57, v57, v59
 v_smfmac_f32_16x16x64_bf16 v[60:63], v[28:31], a[192:199], v2
 v_cvt_pk_bf16_f32 v56, v56, v57
 v_smfmac_f32_16x16x64_bf16 v[60:63], v[32:35], a[200:207], v2
 ds_write_b32 v3, v56 offset:5632
 v_smfmac_f32_16x16x64_bf16 v[60:63], v[36:39], a[208:215], v2
 ds_read_b128 v[56:59], v14 offset:22528
 v_smfmac_f32_16x16x64_bf16 v[60:63], v[40:43], a[216:223], v2
 ds_read_b128 v[96:99], v14 offset:1024
 v_smfmac_f32_16x16x64_bf16 v[64:67], v[16:19], a[224:231], v2
 ds_read_b128 v[100:103], v14 offset:2048
 v_smfmac_f32_16x16x64_bf16 v[64:67], v[20:23], a[232:239], v2
 v_add_f32 v60, v60, v62
 v_smfmac_f32_16x16x64_bf16 v[64:67], v[24:27], a[240:247], v2
 v_add_f32 v61, v61, v63
 v_smfmac_f32_16x16x64_bf16 v[64:67], v[28:31], a[248:255], v2
 v_cvt_pk_bf16_f32 v60, v60, v61
 v_smfmac_f32_16x16x64_bf16 v[64:67], v[32:35], v[120:127], v2
 ds_write_b32 v3, v60 offset:5888
 v_smfmac_f32_16x16x64_bf16 v[64:67], v[36:39], v[128:135], v2
 ds_read_b64_tr_b16 v[116:117], v12 offset:5120
 v_smfmac_f32_16x16x64_bf16 v[64:67], v[40:43], v[136:143], v2
 ds_read_b64_tr_b16 v[118:119], v12 offset:5248
 v_smfmac_f32_16x16x64_bf16 v[68:71], v[16:19], v[144:151], v2
 ds_read_b128 v[104:107], v14 offset:3072
 v_smfmac_f32_16x16x64_bf16 v[68:71], v[20:23], v[152:159], v2
 v_add_f32 v64, v64, v66
 v_smfmac_f32_16x16x64_bf16 v[68:71], v[24:27], v[160:167], v2
 v_add_f32 v65, v65, v67
 v_smfmac_f32_16x16x64_bf16 v[68:71], v[28:31], v[168:175], v2
 v_cvt_pk_bf16_f32 v64, v64, v65
 v_smfmac_f32_16x16x64_bf16 v[68:71], v[32:35], v[176:183], v2
 ds_write_b32 v3, v64 offset:9216
 v_smfmac_f32_16x16x64_bf16 v[68:71], v[36:39], v[184:191], v2
 ds_read_b128 v[60:63], v14 offset:23552
 v_mov_b32_dpp v44, v40 quad_perm:[2,3,0,1] row_mask:0xf bank_mask:0xf
 v_smfmac_f32_16x16x64_bf16 v[68:71], v[40:43], v[192:199], v2
 v_mov_b32_dpp v45, v41 quad_perm:[2,3,0,1] row_mask:0xf bank_mask:0xf
 v_mov_b32_dpp v46, v42 quad_perm:[2,3,0,1] row_mask:0xf bank_mask:0xf
 s_waitcnt lgkmcnt(3)
 v_smfmac_f32_16x16x64_bf16 v[76:79], v[116:119], v[92:99], v2
 ds_read_b128 v[92:95], v14 offset:16384
 v_mov_b32_dpp v47, v43 quad_perm:[2,3,0,1] row_mask:0xf bank_mask:0xf
 s_waitcnt lgkmcnt(3)
 v_smfmac_f32_16x16x64_bf16 v[80:83], v[116:119], v[100:107], v2
 v_add_f32 v68, v68, v70
 v_add_f32 v69, v69, v71
 v_smfmac_f32_16x16x64_bf16 v[84:87], v[116:119], v[16:23], v2
 ds_read_b128 v[96:99], v14 offset:17408
 v_cvt_pk_bf16_f32 v68, v68, v69
 v_smfmac_f32_16x16x64_bf16 v[72:75], v[16:19], v[200:207], v2
 ds_write_b32 v3, v68 offset:10240
 v_add_f32 v77, v77, v79
 v_smfmac_f32_16x16x64_bf16 v[72:75], v[20:23], v[208:215], v2
 ds_read_b128 v[100:103], v14 offset:18432
 v_add_f32 v81, v81, v83
 v_smfmac_f32_16x16x64_bf16 v[72:75], v[24:27], v[216:223], v2
 ds_read_b128 v[104:107], v14 offset:19456
 v_add_f32 v85, v85, v87
 v_smfmac_f32_16x16x64_bf16 v[72:75], v[28:31], v[224:231], v2
 ds_write2st64_b32 v6, v77, v81 offset0:9 offset1:10
 v_smfmac_f32_16x16x64_bf16 v[72:75], v[32:35], v[232:239], v2
 s_waitcnt lgkmcnt(3)
 s_barrier
 ds_read_b64_tr_b16 v[108:109], v12 offset:9216
 v_smfmac_f32_16x16x64_bf16 v[72:75], v[36:39], v[240:247], v2
 ds_read_b64_tr_b16 v[110:111], v12 offset:9344
 v_smfmac_f32_16x16x64_bf16 v[72:75], v[40:43], v[248:255], v2
 ds_write_b32 v13, v85 offset:2816
 ds_read_b64_tr_b16 v[112:113], v12 offset:10240
 ds_read_b64_tr_b16 v[114:115], v12 offset:10368
 ds_read_b128 v[16:19], v14 offset:24576
 ds_read_b128 v[20:23], v14 offset:25600
 s_nop 2
 v_add_f32 v72, v72, v74
 v_add_f32 v73, v73, v75
 v_cvt_pk_bf16_f32 v72, v72, v73
 ds_write_b32 v3, v72 offset:11264
 s_waitcnt lgkmcnt(6)
 v_smfmac_f32_16x16x64_bf16 v[84:87], v[108:111], v[32:39], v2
 ds_read_b128 v[24:27], v14 offset:26624
 v_smfmac_f32_16x16x64_bf16 v[76:79], v[108:111], v[92:99], v2
 ds_read_b128 v[28:31], v14 offset:27648
 v_smfmac_f32_16x16x64_bf16 v[80:83], v[108:111], v[100:107], v2
 s_waitcnt lgkmcnt(2)
 s_barrier
 ds_read_b64_tr_b16 v[116:117], v12 offset:11264
 ds_read_b64_tr_b16 v[118:119], v12 offset:11392
 ds_read2st64_b32 v[64:65], v6 offset0:0 offset1:1
 ds_read2st64_b32 v[66:67], v6 offset0:2 offset1:3
 v_smfmac_f32_16x16x64_bf16 v[88:91], v[112:115], v[32:39], v2
 ds_read2st64_b32 v[68:69], v6 offset0:4 offset1:5
 v_smfmac_f32_16x16x64_bf16 v[76:79], v[112:115], v[48:55], v2
 ds_read2st64_b32 v[70:71], v6 offset0:6 offset1:7
 v_smfmac_f32_16x16x64_bf16 v[80:83], v[112:115], v[56:63], v2
 ds_read_b32 v74, v6 offset:2048
 v_add_f32 v15, v88, v90
 s_waitcnt lgkmcnt(5)
 v_smfmac_f32_16x16x64_bf16 v[84:87], v[116:119], v[40:47], v2
 s_waitcnt lgkmcnt(3)
 v_add_f32 v64, v64, v67
 v_smfmac_f32_16x16x64_bf16 v[76:79], v[116:119], v[16:23], v2
 v_add_f32_dpp v15, v15, v11 quad_perm:[2,3,0,1] row_mask:0xf bank_mask:0xf
 s_waitcnt lgkmcnt(2)
 v_add_f32 v66, v66, v69
 v_smfmac_f32_16x16x64_bf16 v[80:83], v[116:119], v[24:31], v2
 s_waitcnt lgkmcnt(0)
 v_add_f32 v66, v66, v74
 v_add_f32 v64, v64, v70
 v_add_f32 v65, v65, v68
 v_add_f32 v66, v66, v15
 v_add_f32 v65, v65, v71
 v_add_f32 v94, v84, v66
 v_add_f32 v94, v94, v86
 v_add_f32 v92, v76, v64
 v_add_f32 v92, v92, v78
 v_add_f32 v93, v80, v65
 v_add_f32 v93, v93, v82
CA0F_pex:
 v_exp_f32 v100, v94
 v_exp_f32 v98, v92
 v_exp_f32 v99, v93
 v_add_f32 v97, v100, v98
 v_add_f32 v97, v97, v99
 s_nop 1
 v_add_f32_dpp v97, v97, v97 row_ror:8 row_mask:0xf bank_mask:0xf
 s_nop 1
 v_add_f32_dpp v97, v97, v97 row_ror:4 row_mask:0xf bank_mask:0xf
 s_nop 1
 v_add_f32_dpp v97, v97, v97 row_ror:2 row_mask:0xf bank_mask:0xf
 s_nop 1
 v_add_f32_dpp v97, v97, v97 row_ror:1 row_mask:0xf bank_mask:0xf
 v_rcp_f32 v101, v97
 v_subrev_u32 v102, 813694976, v97
 v_cmp_lt_u32 vcc, 503316480, v102
 v_mul_f32 v100, v100, v101
 v_mul_f32 v98, v98, v101
 v_mul_f32 v99, v99, v101
 v_mov_b32_dpp v96, v100 quad_perm:[1,0,3,2] row_mask:0xf bank_mask:0xf
 v_cvt_pk_bf16_f32 v95, v98, v99
 v_cvt_pk_bf16_f32 v96, v100, v96
 s_cbranch_vccnz CA0F_pnan
CA0F_pst:
 buffer_store_dword v95, v7, s[16:19], s51 offen
 buffer_store_dword v96, v8, s[16:19], s51 offen
 v_max3_f32 v97, v94, v92, v93
 s_nop 1
 v_max_f32_dpp v97, v97, v97 row_ror:8 row_mask:0xf bank_mask:0xf
 s_nop 1
 v_max_f32_dpp v97, v97, v97 row_ror:4 row_mask:0xf bank_mask:0xf
 s_nop 1
 v_max_f32_dpp v97, v97, v97 row_ror:2 row_mask:0xf bank_mask:0xf
 s_nop 1
 v_max_f32_dpp v97, v97, v97 row_ror:1 row_mask:0xf bank_mask:0xf
 v_sub_f32 v9, v9, v97
 v_cmp_gt_f32 vcc, s66, abs(v9)
 s_nop 1
 v_cndmask_b32 v9, 0, v9, vcc
 s_barrier
 buffer_store_dword v10, v7, s[16:19], s53 offen
 buffer_store_dword v10, v8, s[16:19], s53 offen
 s_add_u32 s54, s50, 1
 s_min_u32 s54, s54, 63
 s_mul_i32 s56, s54, 28672
 s_add_u32 s56, s56, s44
 s_and_b32 s54, s54, 1
 s_mul_i32 s58, s54, 32768
 s_add_u32 s58, s58, s45
 s_add_u32 m0, s58, 0
 s_add_u32 s59, s56, 0
 buffer_load_dwordx4 v1, s[16:19], s59 offen offset:0 sc1 lds
 buffer_load_dwordx4 v1, s[16:19], s59 offen offset:1024 sc1 lds
 buffer_load_dwordx4 v1, s[16:19], s59 offen offset:2048 sc1 lds
 buffer_load_dwordx4 v1, s[16:19], s59 offen offset:3072 sc1 lds
 s_add_u32 m0, s58, 4096
 s_add_u32 s59, s56, 4096
 buffer_load_dwordx4 v1, s[16:19], s59 offen offset:0 sc1 lds
 buffer_load_dwordx4 v1, s[16:19], s59 offen offset:1024 sc1 lds
 buffer_load_dwordx4 v1, s[16:19], s59 offen offset:2048 sc1 lds
 buffer_load_dwordx4 v1, s[16:19], s59 offen offset:3072 sc1 lds
 s_add_u32 m0, s58, 8192
 s_add_u32 s59, s56, 8192
 buffer_load_dwordx4 v1, s[16:19], s59 offen offset:0 sc1 lds
 buffer_load_dwordx4 v1, s[16:19], s59 offen offset:1024 sc1 lds
 buffer_load_dwordx4 v1, s[16:19], s59 offen offset:2048 sc1 lds
 buffer_load_dwordx4 v1, s[16:19], s59 offen offset:3072 sc1 lds
 s_add_u32 m0, s58, 12288
 s_add_u32 s59, s56, 12288
 buffer_load_dwordx4 v1, s[16:19], s59 offen offset:0 sc1 lds
 buffer_load_dwordx4 v1, s[16:19], s59 offen offset:1024 sc1 lds
 s_add_u32 s50, s50, 1
 s_cmp_eq_u32 s50, 63
 s_cbranch_scc1 CA0F_end
 s_mov_b32 s54, s53
 s_mov_b32 s53, s51
 s_mov_b32 s51, s52
 s_mov_b32 s52, s75
 s_mov_b32 s75, s54
 v_xor_b32 v14, 98304, v14
 s_branch CA0F_top
CA0F_slow:
 s_cmp_eq_u32 s60, s50
 s_cbranch_scc1 CA0F_cont
 s_add_u32 s55, s51, 4096
CA0F_sl:
 buffer_load_dwordx4 v[16:19], v1, s[16:19], s51 offen offset:0 sc1
 buffer_load_dwordx4 v[20:23], v1, s[16:19], s51 offen offset:1024 sc1
 buffer_load_dwordx4 v[24:27], v1, s[16:19], s51 offen offset:2048 sc1
 buffer_load_dwordx4 v[28:31], v1, s[16:19], s51 offen offset:3072 sc1
 buffer_load_dwordx4 v[32:35], v1, s[16:19], s55 offen offset:0 sc1
 buffer_load_dwordx4 v[36:39], v1, s[16:19], s55 offen offset:1024 sc1
 buffer_load_dwordx4 v[40:43], v1, s[16:19], s55 offen offset:2048 sc1
 s_waitcnt vmcnt(0)
 v_mov_b32 v49, 0
 v_and_b32 v48, s74, v16
 v_pk_max_u16 v49, v49, v48
 v_and_b32 v48, s74, v17
 v_pk_max_u16 v49, v49, v48
 v_and_b32 v48, s74, v18
 v_pk_max_u16 v49, v49, v48
 v_and_b32 v48, s74, v19
 v_pk_max_u16 v49, v49, v48
 v_and_b32 v48, s74, v20
 v_pk_max_u16 v49, v49, v48
 v_and_b32 v48, s74, v21
 v_pk_max_u16 v49, v49, v48
 v_and_b32 v48, s74, v22
 v_pk_max_u16 v49, v49, v48
 v_and_b32 v48, s74, v23
 v_pk_max_u16 v49, v49, v48
 v_and_b32 v48, s74, v24
 v_pk_max_u16 v49, v49, v48
 v_and_b32 v48, s74, v25
 v_pk_max_u16 v49, v49, v48
 v_and_b32 v48, s74, v26
 v_pk_max_u16 v49, v49, v48
 v_and_b32 v48, s74, v27
 v_pk_max_u16 v49, v49, v48
 v_and_b32 v48, s74, v28
 v_pk_max_u16 v49, v49, v48
 v_and_b32 v48, s74, v29
 v_pk_max_u16 v49, v49, v48
 v_and_b32 v48, s74, v30
 v_pk_max_u16 v49, v49, v48
 v_and_b32 v48, s74, v31
 v_pk_max_u16 v49, v49, v48
 v_and_b32 v48, s74, v32
 v_pk_max_u16 v49, v49, v48
 v_and_b32 v48, s74, v33
 v_pk_max_u16 v49, v49, v48
 v_and_b32 v48, s74, v34
 v_pk_max_u16 v49, v49, v48
 v_and_b32 v48, s74, v35
 v_pk_max_u16 v49, v49, v48
 v_and_b32 v48, s74, v36
 v_pk_max_u16 v49, v49, v48
 v_and_b32 v48, s74, v37
 v_pk_max_u16 v49, v49, v48
 v_and_b32 v48, s74, v38
 v_pk_max_u16 v49, v49, v48
 v_and_b32 v48, s74, v39
 v_pk_max_u16 v49, v49, v48
 v_and_b32 v48, s74, v40
 v_pk_max_u16 v49, v49, v48
 v_and_b32 v48, s74, v41
 v_pk_max_u16 v49, v49, v48
 v_and_b32 v48, s74, v42
 v_pk_max_u16 v49, v49, v48
 v_and_b32 v48, s74, v43
 v_pk_max_u16 v49, v49, v48
 v_lshrrev_b32 v48, 16, v49
 v_and_b32 v49, 0xffff, v49
 v_max_u32 v48, v48, v49
 v_cmp_lt_u32 vcc, 0x7f81, v48
 s_cbranch_vccz CA0F_sok
 s_max_u32 s68, s68, 1
 s_sub_u32 s68, s68, 1
 s_cmp_lg_u32 s68, 0
 s_cbranch_scc1 CA0F_sl
CA0F_sok:
 s_mov_b32 s60, s50
 s_waitcnt lgkmcnt(0)
 v_mov_b32 v48, 0
 v_mov_b32 v49, 0
 v_mov_b32 v50, 0
 v_mov_b32 v51, 0
 v_mov_b32 v52, 0
 v_mov_b32 v53, 0
 v_mov_b32 v54, 0
 v_mov_b32 v55, 0
 v_mov_b32 v56, 0
 v_mov_b32 v57, 0
 v_mov_b32 v58, 0
 v_mov_b32 v59, 0
 v_mov_b32 v60, 0
 v_mov_b32 v61, 0
 v_mov_b32 v62, 0
 v_mov_b32 v63, 0
 v_mov_b32 v64, 0
 v_mov_b32 v65, 0
 v_mov_b32 v66, 0
 v_mov_b32 v67, 0
 v_mov_b32 v68, 0
 v_mov_b32 v69, 0
 v_mov_b32 v70, 0
 v_mov_b32 v71, 0
 v_mov_b32 v72, 0
 v_mov_b32 v73, 0
 v_mov_b32 v74, 0
 v_mov_b32 v75, 0
 s_branch CA0F_gemm
CA0F_q:
 s_sub_u32 s67, s67, 1
 s_cmp_lt_i32 s67, 0
 s_cbranch_scc1 CA0F_qc
 s_barrier
 v_mov_b32 v48, 0
 v_mov_b32 v49, 0
 v_mov_b32 v50, 0
 v_mov_b32 v51, 0
 v_mov_b32 v52, 0
 v_mov_b32 v53, 0
 v_mov_b32 v54, 0
 v_mov_b32 v55, 0
 v_mov_b32 v56, 0
 v_mov_b32 v57, 0
 v_mov_b32 v58, 0
 v_mov_b32 v59, 0
 s_branch CA0F_bm
CA0F_gemm:
 v_smfmac_f32_16x16x64_bf16 v[48:51], v[16:19], a[0:7], v2
 v_smfmac_f32_16x16x64_bf16 v[52:55], v[16:19], a[56:63], v2
 v_smfmac_f32_16x16x64_bf16 v[56:59], v[16:19], a[112:119], v2
 v_smfmac_f32_16x16x64_bf16 v[48:51], v[20:23], a[8:15], v2
 v_smfmac_f32_16x16x64_bf16 v[52:55], v[20:23], a[64:71], v2
 s_branch CA0F_g2
CA0F_pnan:
 s_cmp_eq_u32 s61, s50
 s_cbranch_scc1 CA0F_pn2
 s_mov_b32 s61, s50
 v_max3_f32 v97, v94, v92, v93
 s_nop 1
 v_max_f32_dpp v97, v97, v97 row_ror:8 row_mask:0xf bank_mask:0xf
 s_nop 1
 v_max_f32_dpp v97, v97, v97 row_ror:4 row_mask:0xf bank_mask:0xf
 s_nop 1
 v_max_f32_dpp v97, v97, v97 row_ror:2 row_mask:0xf bank_mask:0xf
 s_nop 1
 v_max_f32_dpp v97, v97, v97 row_ror:1 row_mask:0xf bank_mask:0xf
 v_sub_f32 v94, v94, v97
 v_sub_f32 v92, v92, v97
 v_sub_f32 v93, v93, v97
 v_sub_f32 v9, v9, v97
 s_branch CA0F_pex
CA0F_pn2:
 v_and_b32 v102, s74, v95
 v_pk_min_u16 v102, v102, s72
 v_bfi_b32 v95, s74, v102, v95
 v_and_b32 v102, s74, v96
 v_pk_min_u16 v102, v102, s72
 v_bfi_b32 v96, s74, v102, v96
 s_branch CA0F_pst
CA0F_end:
 s_endpgm
.p2align 6
CA1F_start:
 s_mov_b32 s50, 0
 s_mov_b32 s60, 0
 s_mov_b32 s61, -1
 s_mov_b32 s96, 0
 s_mov_b32 s97, 0
 s_mov_b32 s67, 4096
 s_mov_b32 s51, 131072
 s_mov_b32 s52, 151552
 s_mov_b32 s75, 172032
 s_mov_b32 s53, 192512
 s_waitcnt vmcnt(0)
 s_barrier
CA1F_top:
 v_mov_b32 v80, 0
 v_mov_b32 v81, 0
 v_mov_b32 v82, 0
 v_mov_b32 v83, 0
 v_mov_b32 v84, 0
 v_mov_b32 v85, 0
 v_mov_b32 v86, 0
 v_mov_b32 v87, 0
 v_mov_b32 v88, 0
 v_mov_b32 v89, 0
 v_mov_b32 v90, 0
 v_mov_b32 v91, 0
 v_mfma_f32_32x32x16_bf16 v[48:63], v[80:83], v[80:83], 0
 v_mfma_f32_32x32x16_bf16 v[64:79], v[80:83], v[80:83], 0
 s_add_u32 s54, s50, 1
 v_mov_b32 v5, s54
 s_nop 9
 v_mov_b32 v77, v9
 v_mov_b32 v81, v9
 v_mov_b32 v85, v9
 s_waitcnt vmcnt(0)
CA1F_bm:
 s_barrier
 ds_read_b128 v[16:19], v1 offset:12288
 ds_read_b128 v[20:23], v1 offset:13312
 s_waitcnt lgkmcnt(1)
 v_smfmac_f32_16x16x64_bf16 v[48:51], v[16:19], a[0:7], v2
 v_smfmac_f32_16x16x64_bf16 v[52:55], v[16:19], a[56:63], v2
 s_barrier
 ds_read_b128 v[24:27], v1 offset:14336
 ds_read_b128 v[28:31], v1 offset:15360
 v_smfmac_f32_16x16x64_bf16 v[56:59], v[16:19], a[112:119], v2
 ds_read_b128 v[32:35], v1 offset:16384
 s_waitcnt lgkmcnt(3)
 v_smfmac_f32_16x16x64_bf16 v[48:51], v[20:23], a[8:15], v2
 ds_read_b128 v[36:39], v1 offset:17408
 v_smfmac_f32_16x16x64_bf16 v[52:55], v[20:23], a[64:71], v2
 ds_read_b128 v[40:43], v1 offset:18432
CA1F_g2:
 v_smfmac_f32_16x16x64_bf16 v[56:59], v[20:23], a[120:127], v2
 s_waitcnt lgkmcnt(4)
 v_smfmac_f32_16x16x64_bf16 v[48:51], v[24:27], a[16:23], v2
 v_max3_u32 v119, v16, v20, v24
 s_waitcnt lgkmcnt(3)
 v_smfmac_f32_16x16x64_bf16 v[48:51], v[28:31], a[24:31], v2
 s_waitcnt lgkmcnt(2)
 v_smfmac_f32_16x16x64_bf16 v[48:51], v[32:35], a[32:39], v2
 v_max3_u32 v119, v119, v28, v32
 s_waitcnt lgkmcnt(1)
 v_smfmac_f32_16x16x64_bf16 v[48:51], v[36:39], a[40:47], v2
 s_waitcnt lgkmcnt(0)
 v_smfmac_f32_16x16x64_bf16 v[48:51], v[40:43], a[48:55], v2
 v_max3_u32 v119, v119, v36, v40
 v_smfmac_f32_16x16x64_bf16 v[52:55], v[24:27], a[72:79], v2
 v_cmp_eq_u32 vcc, -1, v119
 v_smfmac_f32_16x16x64_bf16 v[52:55], v[28:31], a[80:87], v2
 v_add_f32 v48, v48, v50
 v_add_f32 v49, v49, v51
 v_smfmac_f32_16x16x64_bf16 v[52:55], v[32:35], a[88:95], v2
 s_cbranch_vccnz CA1F_q
CA1F_qc:
 v_smfmac_f32_16x16x64_bf16 v[52:55], v[36:39], a[96:103], v2
 v_cmp_u_f32 vcc, v48, v49
 v_cvt_pk_bf16_f32 v48, v48, v49
 v_smfmac_f32_16x16x64_bf16 v[52:55], v[40:43], a[104:111], v2
 ds_write_b32 v3, v48 offset:6144
 v_smfmac_f32_16x16x64_bf16 v[56:59], v[24:27], a[128:135], v2
 s_cbranch_vccnz CA1F_slow
CA1F_cont:
 v_smfmac_f32_16x16x64_bf16 v[56:59], v[28:31], a[136:143], v2
 v_add_f32 v52, v52, v54
 v_add_f32 v53, v53, v55
 v_smfmac_f32_16x16x64_bf16 v[56:59], v[32:35], a[144:151], v2
 ds_read_b128 v[92:95], v14 offset:4096
 v_cvt_pk_bf16_f32 v52, v52, v53
 v_smfmac_f32_16x16x64_bf16 v[56:59], v[36:39], a[152:159], v2
 ds_write_b32 v3, v52 offset:6400
 v_smfmac_f32_16x16x64_bf16 v[56:59], v[40:43], a[160:167], v2
 ds_read_b128 v[48:51], v14 offset:20480
 v_smfmac_f32_16x16x64_bf16 v[60:63], v[16:19], a[168:175], v2
 ds_read_b128 v[52:55], v14 offset:21504
 v_smfmac_f32_16x16x64_bf16 v[60:63], v[20:23], a[176:183], v2
 v_add_f32 v56, v56, v58
 v_smfmac_f32_16x16x64_bf16 v[60:63], v[24:27], a[184:191], v2
 v_add_f32 v57, v57, v59
 v_smfmac_f32_16x16x64_bf16 v[60:63], v[28:31], a[192:199], v2
 v_cvt_pk_bf16_f32 v56, v56, v57
 v_smfmac_f32_16x16x64_bf16 v[60:63], v[32:35], a[200:207], v2
 ds_write_b32 v3, v56 offset:6656
 v_smfmac_f32_16x16x64_bf16 v[60:63], v[36:39], a[208:215], v2
 ds_read_b128 v[56:59], v14 offset:22528
 v_smfmac_f32_16x16x64_bf16 v[60:63], v[40:43], a[216:223], v2
 ds_read_b128 v[96:99], v14 offset:5120
 v_smfmac_f32_16x16x64_bf16 v[64:67], v[16:19], a[224:231], v2
 ds_read_b128 v[100:103], v14 offset:6144
 v_smfmac_f32_16x16x64_bf16 v[64:67], v[20:23], a[232:239], v2
 v_add_f32 v60, v60, v62
 v_smfmac_f32_16x16x64_bf16 v[64:67], v[24:27], a[240:247], v2
 v_add_f32 v61, v61, v63
 v_smfmac_f32_16x16x64_bf16 v[64:67], v[28:31], a[248:255], v2
 v_cvt_pk_bf16_f32 v60, v60, v61
 v_smfmac_f32_16x16x64_bf16 v[64:67], v[32:35], v[120:127], v2
 ds_write_b32 v3, v60 offset:6912
 v_smfmac_f32_16x16x64_bf16 v[64:67], v[36:39], v[128:135], v2
 ds_read_b64_tr_b16 v[116:117], v12 offset:6144
 v_smfmac_f32_16x16x64_bf16 v[64:67], v[40:43], v[136:143], v2
 ds_read_b64_tr_b16 v[118:119], v12 offset:6272
 v_smfmac_f32_16x16x64_bf16 v[68:71], v[16:19], v[144:151], v2
 ds_read_b128 v[104:107], v14 offset:7168
 v_smfmac_f32_16x16x64_bf16 v[68:71], v[20:23], v[152:159], v2
 v_add_f32 v64, v64, v66
 v_smfmac_f32_16x16x64_bf16 v[68:71], v[24:27], v[160:167], v2
 v_add_f32 v65, v65, v67
 v_smfmac_f32_16x16x64_bf16 v[68:71], v[28:31], v[168:175], v2
 v_cvt_pk_bf16_f32 v64, v64, v65
 v_smfmac_f32_16x16x64_bf16 v[68:71], v[32:35], v[176:183], v2
 ds_write_b32 v3, v64 offset:9472
 v_smfmac_f32_16x16x64_bf16 v[68:71], v[36:39], v[184:191], v2
 ds_read_b128 v[60:63], v14 offset:23552
 v_mov_b32_dpp v44, v40 quad_perm:[2,3,0,1] row_mask:0xf bank_mask:0xf
 v_smfmac_f32_16x16x64_bf16 v[68:71], v[40:43], v[192:199], v2
 v_mov_b32_dpp v45, v41 quad_perm:[2,3,0,1] row_mask:0xf bank_mask:0xf
 v_mov_b32_dpp v46, v42 quad_perm:[2,3,0,1] row_mask:0xf bank_mask:0xf
 s_waitcnt lgkmcnt(3)
 v_smfmac_f32_16x16x64_bf16 v[76:79], v[116:119], v[92:99], v2
 ds_read_b128 v[92:95], v14 offset:16384
 v_mov_b32_dpp v47, v43 quad_perm:[2,3,0,1] row_mask:0xf bank_mask:0xf
 s_waitcnt lgkmcnt(3)
 v_smfmac_f32_16x16x64_bf16 v[80:83], v[116:119], v[100:107], v2
 v_add_f32 v68, v68, v70
 v_add_f32 v69, v69, v71
 v_smfmac_f32_16x16x64_bf16 v[88:91], v[116:119], v[16:23], v2
 ds_read_b128 v[96:99], v14 offset:17408
 v_cvt_pk_bf16_f32 v68, v68, v69
 v_smfmac_f32_16x16x64_bf16 v[72:75], v[16:19], v[200:207], v2
 ds_write_b32 v3, v68 offset:10496
 v_add_f32 v76, v76, v78
 v_smfmac_f32_16x16x64_bf16 v[72:75], v[20:23], v[208:215], v2
 ds_read_b128 v[100:103], v14 offset:18432
 v_add_f32 v80, v80, v82
 v_smfmac_f32_16x16x64_bf16 v[72:75], v[24:27], v[216:223], v2
 ds_read_b128 v[104:107], v14 offset:19456
 v_add_f32 v88, v88, v90
 v_smfmac_f32_16x16x64_bf16 v[72:75], v[28:31], v[224:231], v2
 ds_write2st64_b32 v6, v76, v80 offset0:0 offset1:1
 v_smfmac_f32_16x16x64_bf16 v[72:75], v[32:35], v[232:239], v2
 s_waitcnt lgkmcnt(3)
 s_barrier
 ds_read_b64_tr_b16 v[108:109], v12 offset:9216
 v_smfmac_f32_16x16x64_bf16 v[72:75], v[36:39], v[240:247], v2
 ds_read_b64_tr_b16 v[110:111], v12 offset:9344
 v_smfmac_f32_16x16x64_bf16 v[72:75], v[40:43], v[248:255], v2
 ds_write_b32 v13, v88 offset:512
 ds_read_b64_tr_b16 v[112:113], v12 offset:10240
 ds_read_b64_tr_b16 v[114:115], v12 offset:10368
 ds_read_b128 v[16:19], v14 offset:24576
 ds_read_b128 v[20:23], v14 offset:25600
 s_nop 2
 v_add_f32 v72, v72, v74
 v_add_f32 v73, v73, v75
 v_cvt_pk_bf16_f32 v72, v72, v73
 ds_write_b32 v3, v72 offset:11520
 s_waitcnt lgkmcnt(6)
 v_smfmac_f32_16x16x64_bf16 v[84:87], v[108:111], v[32:39], v2
 ds_read_b128 v[24:27], v14 offset:26624
 v_smfmac_f32_16x16x64_bf16 v[76:79], v[108:111], v[92:99], v2
 ds_read_b128 v[28:31], v14 offset:27648
 v_smfmac_f32_16x16x64_bf16 v[80:83], v[108:111], v[100:107], v2
 s_waitcnt lgkmcnt(2)
 s_barrier
 ds_read_b64_tr_b16 v[116:117], v12 offset:11264
 ds_read_b64_tr_b16 v[118:119], v12 offset:11392
 ds_read2st64_b32 v[64:65], v6 offset0:9 offset1:10
 ds_read2st64_b32 v[66:67], v6 offset0:11 offset1:12
 v_smfmac_f32_16x16x64_bf16 v[88:91], v[112:115], v[32:39], v2
 ds_read2st64_b32 v[68:69], v6 offset0:13 offset1:14
 v_smfmac_f32_16x16x64_bf16 v[76:79], v[112:115], v[48:55], v2
 ds_read2st64_b32 v[70:71], v6 offset0:15 offset1:16
 v_smfmac_f32_16x16x64_bf16 v[80:83], v[112:115], v[56:63], v2
 ds_read_b32 v74, v6 offset:4352
 v_add_f32 v15, v89, v91
 s_waitcnt lgkmcnt(5)
 v_smfmac_f32_16x16x64_bf16 v[84:87], v[116:119], v[40:47], v2
 s_waitcnt lgkmcnt(3)
 v_add_f32 v64, v64, v67
 v_smfmac_f32_16x16x64_bf16 v[76:79], v[116:119], v[16:23], v2
 v_add_f32_dpp v15, v15, v11 quad_perm:[2,3,0,1] row_mask:0xf bank_mask:0xf
 s_waitcnt lgkmcnt(2)
 v_add_f32 v66, v66, v69
 v_smfmac_f32_16x16x64_bf16 v[80:83], v[116:119], v[24:31], v2
 s_waitcnt lgkmcnt(0)
 v_add_f32 v66, v66, v74
 v_add_f32 v64, v64, v70
 v_add_f32 v65, v65, v68
 buffer_store_dword v5, v4, s[16:19], 0 offen
 v_add_f32 v66, v66, v15
 v_add_f32 v65, v65, v71
 v_add_f32 v94, v85, v66
 v_add_f32 v94, v94, v87
 v_add_f32 v92, v77, v64
 v_add_f32 v92, v92, v79
 v_add_f32 v93, v81, v65
 v_add_f32 v93, v93, v83
CA1F_pex:
 v_exp_f32 v100, v94
 v_exp_f32 v98, v92
 v_exp_f32 v99, v93
 v_add_f32 v97, v100, v98
 v_add_f32 v97, v97, v99
 s_nop 1
 v_add_f32_dpp v97, v97, v97 row_ror:8 row_mask:0xf bank_mask:0xf
 s_nop 1
 v_add_f32_dpp v97, v97, v97 row_ror:4 row_mask:0xf bank_mask:0xf
 s_nop 1
 v_add_f32_dpp v97, v97, v97 row_ror:2 row_mask:0xf bank_mask:0xf
 s_nop 1
 v_add_f32_dpp v97, v97, v97 row_ror:1 row_mask:0xf bank_mask:0xf
 v_rcp_f32 v101, v97
 v_subrev_u32 v102, 813694976, v97
 v_cmp_lt_u32 vcc, 503316480, v102
 v_mul_f32 v100, v100, v101
 v_mul_f32 v98, v98, v101
 v_mul_f32 v99, v99, v101
 v_mov_b32_dpp v96, v100 quad_perm:[1,0,3,2] row_mask:0xf bank_mask:0xf
 v_cvt_pk_bf16_f32 v95, v98, v99
 v_cvt_pk_bf16_f32 v96, v100, v96
 s_cbranch_vccnz CA1F_pnan
CA1F_pst:
 buffer_store_dword v95, v7, s[16:19], s51 offen
 buffer_store_dword v96, v8, s[16:19], s51 offen
 v_max3_f32 v97, v94, v92, v93
 s_nop 1
 v_max_f32_dpp v97, v97, v97 row_ror:8 row_mask:0xf bank_mask:0xf
 s_nop 1
 v_max_f32_dpp v97, v97, v97 row_ror:4 row_mask:0xf bank_mask:0xf
 s_nop 1
 v_max_f32_dpp v97, v97, v97 row_ror:2 row_mask:0xf bank_mask:0xf
 s_nop 1
 v_max_f32_dpp v97, v97, v97 row_ror:1 row_mask:0xf bank_mask:0xf
 v_sub_f32 v9, v9, v97
 v_cmp_gt_f32 vcc, s66, abs(v9)
 s_nop 1
 v_cndmask_b32 v9, 0, v9, vcc
 s_barrier
 buffer_store_dword v10, v7, s[16:19], s53 offen
 buffer_store_dword v10, v8, s[16:19], s53 offen
 s_add_u32 s54, s50, 1
 s_min_u32 s54, s54, 63
 s_mul_i32 s56, s54, 28672
 s_add_u32 s56, s56, s44
 s_and_b32 s54, s54, 1
 s_mul_i32 s58, s54, 32768
 s_add_u32 s58, s58, s45
 s_add_u32 m0, s58, 0
 s_add_u32 s59, s56, 0
 buffer_load_dwordx4 v1, s[16:19], s59 offen offset:0 sc1 lds
 buffer_load_dwordx4 v1, s[16:19], s59 offen offset:1024 sc1 lds
 buffer_load_dwordx4 v1, s[16:19], s59 offen offset:2048 sc1 lds
 buffer_load_dwordx4 v1, s[16:19], s59 offen offset:3072 sc1 lds
 s_add_u32 m0, s58, 4096
 s_add_u32 s59, s56, 4096
 buffer_load_dwordx4 v1, s[16:19], s59 offen offset:0 sc1 lds
 buffer_load_dwordx4 v1, s[16:19], s59 offen offset:1024 sc1 lds
 buffer_load_dwordx4 v1, s[16:19], s59 offen offset:2048 sc1 lds
 buffer_load_dwordx4 v1, s[16:19], s59 offen offset:3072 sc1 lds
 s_add_u32 m0, s58, 8192
 s_add_u32 s59, s56, 8192
 buffer_load_dwordx4 v1, s[16:19], s59 offen offset:0 sc1 lds
 buffer_load_dwordx4 v1, s[16:19], s59 offen offset:1024 sc1 lds
 buffer_load_dwordx4 v1, s[16:19], s59 offen offset:2048 sc1 lds
 buffer_load_dwordx4 v1, s[16:19], s59 offen offset:3072 sc1 lds
 s_add_u32 m0, s58, 12288
 s_add_u32 s59, s56, 12288
 buffer_load_dwordx4 v1, s[16:19], s59 offen offset:0 sc1 lds
 buffer_load_dwordx4 v1, s[16:19], s59 offen offset:1024 sc1 lds
 s_add_u32 s50, s50, 1
 s_cmp_eq_u32 s50, 63
 s_cbranch_scc1 CA1F_end
 s_mov_b32 s54, s53
 s_mov_b32 s53, s51
 s_mov_b32 s51, s52
 s_mov_b32 s52, s75
 s_mov_b32 s75, s54
 v_xor_b32 v14, 98304, v14
 s_branch CA1F_top
CA1F_slow:
 s_cmp_eq_u32 s60, s50
 s_cbranch_scc1 CA1F_cont
 s_add_u32 s55, s51, 4096
CA1F_sl:
 buffer_load_dwordx4 v[16:19], v1, s[16:19], s51 offen offset:0 sc1
 buffer_load_dwordx4 v[20:23], v1, s[16:19], s51 offen offset:1024 sc1
 buffer_load_dwordx4 v[24:27], v1, s[16:19], s51 offen offset:2048 sc1
 buffer_load_dwordx4 v[28:31], v1, s[16:19], s51 offen offset:3072 sc1
 buffer_load_dwordx4 v[32:35], v1, s[16:19], s55 offen offset:0 sc1
 buffer_load_dwordx4 v[36:39], v1, s[16:19], s55 offen offset:1024 sc1
 buffer_load_dwordx4 v[40:43], v1, s[16:19], s55 offen offset:2048 sc1
 s_waitcnt vmcnt(0)
 v_mov_b32 v49, 0
 v_and_b32 v48, s74, v16
 v_pk_max_u16 v49, v49, v48
 v_and_b32 v48, s74, v17
 v_pk_max_u16 v49, v49, v48
 v_and_b32 v48, s74, v18
 v_pk_max_u16 v49, v49, v48
 v_and_b32 v48, s74, v19
 v_pk_max_u16 v49, v49, v48
 v_and_b32 v48, s74, v20
 v_pk_max_u16 v49, v49, v48
 v_and_b32 v48, s74, v21
 v_pk_max_u16 v49, v49, v48
 v_and_b32 v48, s74, v22
 v_pk_max_u16 v49, v49, v48
 v_and_b32 v48, s74, v23
 v_pk_max_u16 v49, v49, v48
 v_and_b32 v48, s74, v24
 v_pk_max_u16 v49, v49, v48
 v_and_b32 v48, s74, v25
 v_pk_max_u16 v49, v49, v48
 v_and_b32 v48, s74, v26
 v_pk_max_u16 v49, v49, v48
 v_and_b32 v48, s74, v27
 v_pk_max_u16 v49, v49, v48
 v_and_b32 v48, s74, v28
 v_pk_max_u16 v49, v49, v48
 v_and_b32 v48, s74, v29
 v_pk_max_u16 v49, v49, v48
 v_and_b32 v48, s74, v30
 v_pk_max_u16 v49, v49, v48
 v_and_b32 v48, s74, v31
 v_pk_max_u16 v49, v49, v48
 v_and_b32 v48, s74, v32
 v_pk_max_u16 v49, v49, v48
 v_and_b32 v48, s74, v33
 v_pk_max_u16 v49, v49, v48
 v_and_b32 v48, s74, v34
 v_pk_max_u16 v49, v49, v48
 v_and_b32 v48, s74, v35
 v_pk_max_u16 v49, v49, v48
 v_and_b32 v48, s74, v36
 v_pk_max_u16 v49, v49, v48
 v_and_b32 v48, s74, v37
 v_pk_max_u16 v49, v49, v48
 v_and_b32 v48, s74, v38
 v_pk_max_u16 v49, v49, v48
 v_and_b32 v48, s74, v39
 v_pk_max_u16 v49, v49, v48
 v_and_b32 v48, s74, v40
 v_pk_max_u16 v49, v49, v48
 v_and_b32 v48, s74, v41
 v_pk_max_u16 v49, v49, v48
 v_and_b32 v48, s74, v42
 v_pk_max_u16 v49, v49, v48
 v_and_b32 v48, s74, v43
 v_pk_max_u16 v49, v49, v48
 v_lshrrev_b32 v48, 16, v49
 v_and_b32 v49, 0xffff, v49
 v_max_u32 v48, v48, v49
 v_cmp_lt_u32 vcc, 0x7f81, v48
 s_cbranch_vccz CA1F_sok
 s_max_u32 s68, s68, 1
 s_sub_u32 s68, s68, 1
 s_cmp_lg_u32 s68, 0
 s_cbranch_scc1 CA1F_sl
CA1F_sok:
 s_mov_b32 s60, s50
 s_waitcnt lgkmcnt(0)
 v_mov_b32 v48, 0
 v_mov_b32 v49, 0
 v_mov_b32 v50, 0
 v_mov_b32 v51, 0
 v_mov_b32 v52, 0
 v_mov_b32 v53, 0
 v_mov_b32 v54, 0
 v_mov_b32 v55, 0
 v_mov_b32 v56, 0
 v_mov_b32 v57, 0
 v_mov_b32 v58, 0
 v_mov_b32 v59, 0
 v_mov_b32 v60, 0
 v_mov_b32 v61, 0
 v_mov_b32 v62, 0
 v_mov_b32 v63, 0
 v_mov_b32 v64, 0
 v_mov_b32 v65, 0
 v_mov_b32 v66, 0
 v_mov_b32 v67, 0
 v_mov_b32 v68, 0
 v_mov_b32 v69, 0
 v_mov_b32 v70, 0
 v_mov_b32 v71, 0
 v_mov_b32 v72, 0
 v_mov_b32 v73, 0
 v_mov_b32 v74, 0
 v_mov_b32 v75, 0
 s_branch CA1F_gemm
CA1F_q:
 s_sub_u32 s67, s67, 1
 s_cmp_lt_i32 s67, 0
 s_cbranch_scc1 CA1F_qc
 s_barrier
 v_mov_b32 v48, 0
 v_mov_b32 v49, 0
 v_mov_b32 v50, 0
 v_mov_b32 v51, 0
 v_mov_b32 v52, 0
 v_mov_b32 v53, 0
 v_mov_b32 v54, 0
 v_mov_b32 v55, 0
 v_mov_b32 v56, 0
 v_mov_b32 v57, 0
 v_mov_b32 v58, 0
 v_mov_b32 v59, 0
 s_branch CA1F_bm
CA1F_gemm:
 v_smfmac_f32_16x16x64_bf16 v[48:51], v[16:19], a[0:7], v2
 v_smfmac_f32_16x16x64_bf16 v[52:55], v[16:19], a[56:63], v2
 v_smfmac_f32_16x16x64_bf16 v[56:59], v[16:19], a[112:119], v2
 v_smfmac_f32_16x16x64_bf16 v[48:51], v[20:23], a[8:15], v2
 v_smfmac_f32_16x16x64_bf16 v[52:55], v[20:23], a[64:71], v2
 s_branch CA1F_g2
CA1F_pnan:
 s_cmp_eq_u32 s61, s50
 s_cbranch_scc1 CA1F_pn2
 s_mov_b32 s61, s50
 v_max3_f32 v97, v94, v92, v93
 s_nop 1
 v_max_f32_dpp v97, v97, v97 row_ror:8 row_mask:0xf bank_mask:0xf
 s_nop 1
 v_max_f32_dpp v97, v97, v97 row_ror:4 row_mask:0xf bank_mask:0xf
 s_nop 1
 v_max_f32_dpp v97, v97, v97 row_ror:2 row_mask:0xf bank_mask:0xf
 s_nop 1
 v_max_f32_dpp v97, v97, v97 row_ror:1 row_mask:0xf bank_mask:0xf
 v_sub_f32 v94, v94, v97
 v_sub_f32 v92, v92, v97
 v_sub_f32 v93, v93, v97
 v_sub_f32 v9, v9, v97
 s_branch CA1F_pex
CA1F_pn2:
 v_and_b32 v102, s74, v95
 v_pk_min_u16 v102, v102, s72
 v_bfi_b32 v95, s74, v102, v95
 v_and_b32 v102, s74, v96
 v_pk_min_u16 v102, v102, s72
 v_bfi_b32 v96, s74, v102, v96
 s_branch CA1F_pst
CA1F_end:
 s_endpgm
.p2align 6
CA2F_start:
 s_mov_b32 s50, 0
 s_mov_b32 s60, 0
 s_mov_b32 s61, -1
 s_mov_b32 s96, 0
 s_mov_b32 s97, 0
 s_mov_b32 s67, 4096
 s_mov_b32 s51, 131072
 s_mov_b32 s52, 151552
 s_mov_b32 s75, 172032
 s_mov_b32 s53, 192512
 s_waitcnt vmcnt(0)
 s_barrier
CA2F_top:
 v_mov_b32 v80, 0
 v_mov_b32 v81, 0
 v_mov_b32 v82, 0
 v_mov_b32 v83, 0
 v_mov_b32 v84, 0
 v_mov_b32 v85, 0
 v_mov_b32 v86, 0
 v_mov_b32 v87, 0
 v_mov_b32 v88, 0
 v_mov_b32 v89, 0
 v_mov_b32 v90, 0
 v_mov_b32 v91, 0
 v_mfma_f32_32x32x16_bf16 v[48:63], v[80:83], v[80:83], 0
 v_mfma_f32_32x32x16_bf16 v[64:79], v[80:83], v[80:83], 0
 s_add_u32 s54, s50, 1
 v_mov_b32 v5, s54
 s_add_u32 s54, s50, 1
 s_min_u32 s54, s54, 63
 s_mul_i32 s56, s54, 458752
 s_add_u32 s56, s56, s47
 s_cmp_eq_u32 s50, 0
 s_cselect_b32 s56, 1073741824, s56
 s_add_u32 s57, s56, 7168
 s_sub_u32 s58, s56, 7168
 s_sub_u32 s59, s58, 7168
 s_waitcnt vmcnt(0)
CA2F_bm:
 s_barrier
 ds_read_b128 v[16:19], v1 offset:12288
 ds_read_b128 v[20:23], v1 offset:13312
 s_waitcnt lgkmcnt(1)
 v_smfmac_f32_16x16x64_bf16 v[48:51], v[16:19], a[0:7], v2
 v_smfmac_f32_16x16x64_bf16 v[52:55], v[16:19], a[56:63], v2
 s_barrier
 ds_read_b128 v[24:27], v1 offset:14336
 ds_read_b128 v[28:31], v1 offset:15360
 v_smfmac_f32_16x16x64_bf16 v[56:59], v[16:19], a[112:119], v2
 ds_read_b128 v[32:35], v1 offset:16384
 s_waitcnt lgkmcnt(3)
 v_smfmac_f32_16x16x64_bf16 v[48:51], v[20:23], a[8:15], v2
 ds_read_b128 v[36:39], v1 offset:17408
 v_smfmac_f32_16x16x64_bf16 v[52:55], v[20:23], a[64:71], v2
 ds_read_b128 v[40:43], v1 offset:18432
CA2F_g2:
 v_smfmac_f32_16x16x64_bf16 v[56:59], v[20:23], a[120:127], v2
 s_waitcnt lgkmcnt(4)
 v_smfmac_f32_16x16x64_bf16 v[48:51], v[24:27], a[16:23], v2
 v_max3_u32 v119, v16, v20, v24
 s_waitcnt lgkmcnt(3)
 v_smfmac_f32_16x16x64_bf16 v[48:51], v[28:31], a[24:31], v2
 s_waitcnt lgkmcnt(2)
 v_smfmac_f32_16x16x64_bf16 v[48:51], v[32:35], a[32:39], v2
 v_max3_u32 v119, v119, v28, v32
 s_waitcnt lgkmcnt(1)
 v_smfmac_f32_16x16x64_bf16 v[48:51], v[36:39], a[40:47], v2
 s_waitcnt lgkmcnt(0)
 v_smfmac_f32_16x16x64_bf16 v[48:51], v[40:43], a[48:55], v2
 v_max3_u32 v119, v119, v36, v40
 v_smfmac_f32_16x16x64_bf16 v[52:55], v[24:27], a[72:79], v2
 v_cmp_eq_u32 vcc, -1, v119
 v_smfmac_f32_16x16x64_bf16 v[52:55], v[28:31], a[80:87], v2
 v_add_f32 v48, v48, v50
 v_add_f32 v49, v49, v51
 v_smfmac_f32_16x16x64_bf16 v[52:55], v[32:35], a[88:95], v2
 s_cbranch_vccnz CA2F_q
CA2F_qc:
 v_smfmac_f32_16x16x64_bf16 v[52:55], v[36:39], a[96:103], v2
 v_cmp_u_f32 vcc, v48, v49
 v_cvt_pk_bf16_f32 v48, v48, v49
 v_smfmac_f32_16x16x64_bf16 v[52:55], v[40:43], a[104:111], v2
 ds_write_b32 v3, v48 offset:7168
 v_smfmac_f32_16x16x64_bf16 v[56:59], v[24:27], a[128:135], v2
 s_cbranch_vccnz CA2F_slow
CA2F_cont:
 v_smfmac_f32_16x16x64_bf16 v[56:59], v[28:31], a[136:143], v2
 v_add_f32 v52, v52, v54
 v_add_f32 v53, v53, v55
 v_smfmac_f32_16x16x64_bf16 v[56:59], v[32:35], a[144:151], v2
 ds_read_b128 v[92:95], v14 offset:8192
 v_cvt_pk_bf16_f32 v52, v52, v53
 v_smfmac_f32_16x16x64_bf16 v[56:59], v[36:39], a[152:159], v2
 ds_write_b32 v3, v52 offset:7424
 v_smfmac_f32_16x16x64_bf16 v[56:59], v[40:43], a[160:167], v2
 v_smfmac_f32_16x16x64_bf16 v[60:63], v[16:19], a[168:175], v2
 v_smfmac_f32_16x16x64_bf16 v[60:63], v[20:23], a[176:183], v2
 v_add_f32 v56, v56, v58
 v_smfmac_f32_16x16x64_bf16 v[60:63], v[24:27], a[184:191], v2
 v_add_f32 v57, v57, v59
 v_smfmac_f32_16x16x64_bf16 v[60:63], v[28:31], a[192:199], v2
 v_cvt_pk_bf16_f32 v56, v56, v57
 v_smfmac_f32_16x16x64_bf16 v[60:63], v[32:35], a[200:207], v2
 ds_write_b32 v3, v56 offset:7680
 v_smfmac_f32_16x16x64_bf16 v[60:63], v[36:39], a[208:215], v2
 v_smfmac_f32_16x16x64_bf16 v[60:63], v[40:43], a[216:223], v2
 ds_read_b128 v[96:99], v14 offset:9216
 v_smfmac_f32_16x16x64_bf16 v[64:67], v[16:19], a[224:231], v2
 ds_read_b128 v[100:103], v14 offset:10240
 v_smfmac_f32_16x16x64_bf16 v[64:67], v[20:23], a[232:239], v2
 v_add_f32 v60, v60, v62
 v_smfmac_f32_16x16x64_bf16 v[64:67], v[24:27], a[240:247], v2
 v_add_f32 v61, v61, v63
 v_smfmac_f32_16x16x64_bf16 v[64:67], v[28:31], a[248:255], v2
 v_cvt_pk_bf16_f32 v60, v60, v61
 v_smfmac_f32_16x16x64_bf16 v[64:67], v[32:35], v[120:127], v2
 ds_write_b32 v3, v60 offset:7936
 v_smfmac_f32_16x16x64_bf16 v[64:67], v[36:39], v[128:135], v2
 ds_read_b64_tr_b16 v[116:117], v12 offset:7168
 v_smfmac_f32_16x16x64_bf16 v[64:67], v[40:43], v[136:143], v2
 ds_read_b64_tr_b16 v[118:119], v12 offset:7296
 v_smfmac_f32_16x16x64_bf16 v[68:71], v[16:19], v[144:151], v2
 ds_read_b128 v[104:107], v14 offset:11264
 v_smfmac_f32_16x16x64_bf16 v[68:71], v[20:23], v[152:159], v2
 v_add_f32 v64, v64, v66
 v_smfmac_f32_16x16x64_bf16 v[68:71], v[24:27], v[160:167], v2
 v_add_f32 v65, v65, v67
 v_smfmac_f32_16x16x64_bf16 v[68:71], v[28:31], v[168:175], v2
 v_cvt_pk_bf16_f32 v64, v64, v65
 v_smfmac_f32_16x16x64_bf16 v[68:71], v[32:35], v[176:183], v2
 ds_write_b32 v3, v64 offset:9728
 v_smfmac_f32_16x16x64_bf16 v[68:71], v[36:39], v[184:191], v2
 v_smfmac_f32_16x16x64_bf16 v[68:71], v[40:43], v[192:199], v2
 s_waitcnt lgkmcnt(2)
 v_smfmac_f32_16x16x64_bf16 v[76:79], v[116:119], v[92:99], v2
 s_waitcnt lgkmcnt(1)
 v_smfmac_f32_16x16x64_bf16 v[80:83], v[116:119], v[100:107], v2
 v_add_f32 v68, v68, v70
 v_add_f32 v69, v69, v71
 v_smfmac_f32_16x16x64_bf16 v[84:87], v[116:119], v[24:31], v2
 v_cvt_pk_bf16_f32 v68, v68, v69
 v_add_f32 v76, v76, v78
 v_smfmac_f32_16x16x64_bf16 v[72:75], v[16:19], v[200:207], v2
 ds_write_b32 v3, v68 offset:10752
 v_add_f32 v80, v80, v82
 v_smfmac_f32_16x16x64_bf16 v[72:75], v[20:23], v[208:215], v2
 ds_write2st64_b32 v6, v76, v80 offset0:3 offset1:4
 v_add_f32 v77, v77, v79
 v_smfmac_f32_16x16x64_bf16 v[72:75], v[24:27], v[216:223], v2
 v_add_f32 v81, v81, v83
 v_add_f32 v84, v84, v86
 v_smfmac_f32_16x16x64_bf16 v[72:75], v[28:31], v[224:231], v2
 ds_write2st64_b32 v6, v77, v81 offset0:12 offset1:13
 v_add_f32 v85, v85, v87
 v_smfmac_f32_16x16x64_bf16 v[72:75], v[32:35], v[232:239], v2
 s_waitcnt lgkmcnt(2)
 s_barrier
 v_smfmac_f32_16x16x64_bf16 v[72:75], v[36:39], v[240:247], v2
 ds_write2st64_b32 v13, v84, v85 offset0:5 offset1:14
 v_smfmac_f32_16x16x64_bf16 v[72:75], v[40:43], v[248:255], v2
 s_nop 7
 v_add_f32 v72, v72, v74
 v_add_f32 v73, v73, v75
 v_cvt_pk_bf16_f32 v72, v72, v73
 ds_write_b32 v3, v72 offset:11776
 s_waitcnt lgkmcnt(0)
 s_barrier
 s_barrier
 s_add_u32 s50, s50, 1
 s_cmp_eq_u32 s50, 63
 s_cbranch_scc1 CA2F_end
 s_mov_b32 s54, s53
 s_mov_b32 s53, s51
 s_mov_b32 s51, s52
 s_mov_b32 s52, s75
 s_mov_b32 s75, s54
 v_xor_b32 v14, 98304, v14
 s_branch CA2F_top
CA2F_slow:
 s_cmp_eq_u32 s60, s50
 s_cbranch_scc1 CA2F_cont
 s_add_u32 s55, s51, 4096
CA2F_sl:
 buffer_load_dwordx4 v[16:19], v1, s[16:19], s51 offen offset:0 sc1
 buffer_load_dwordx4 v[20:23], v1, s[16:19], s51 offen offset:1024 sc1
 buffer_load_dwordx4 v[24:27], v1, s[16:19], s51 offen offset:2048 sc1
 buffer_load_dwordx4 v[28:31], v1, s[16:19], s51 offen offset:3072 sc1
 buffer_load_dwordx4 v[32:35], v1, s[16:19], s55 offen offset:0 sc1
 buffer_load_dwordx4 v[36:39], v1, s[16:19], s55 offen offset:1024 sc1
 buffer_load_dwordx4 v[40:43], v1, s[16:19], s55 offen offset:2048 sc1
 s_waitcnt vmcnt(0)
 v_mov_b32 v49, 0
 v_and_b32 v48, s74, v16
 v_pk_max_u16 v49, v49, v48
 v_and_b32 v48, s74, v17
 v_pk_max_u16 v49, v49, v48
 v_and_b32 v48, s74, v18
 v_pk_max_u16 v49, v49, v48
 v_and_b32 v48, s74, v19
 v_pk_max_u16 v49, v49, v48
 v_and_b32 v48, s74, v20
 v_pk_max_u16 v49, v49, v48
 v_and_b32 v48, s74, v21
 v_pk_max_u16 v49, v49, v48
 v_and_b32 v48, s74, v22
 v_pk_max_u16 v49, v49, v48
 v_and_b32 v48, s74, v23
 v_pk_max_u16 v49, v49, v48
 v_and_b32 v48, s74, v24
 v_pk_max_u16 v49, v49, v48
 v_and_b32 v48, s74, v25
 v_pk_max_u16 v49, v49, v48
 v_and_b32 v48, s74, v26
 v_pk_max_u16 v49, v49, v48
 v_and_b32 v48, s74, v27
 v_pk_max_u16 v49, v49, v48
 v_and_b32 v48, s74, v28
 v_pk_max_u16 v49, v49, v48
 v_and_b32 v48, s74, v29
 v_pk_max_u16 v49, v49, v48
 v_and_b32 v48, s74, v30
 v_pk_max_u16 v49, v49, v48
 v_and_b32 v48, s74, v31
 v_pk_max_u16 v49, v49, v48
 v_and_b32 v48, s74, v32
 v_pk_max_u16 v49, v49, v48
 v_and_b32 v48, s74, v33
 v_pk_max_u16 v49, v49, v48
 v_and_b32 v48, s74, v34
 v_pk_max_u16 v49, v49, v48
 v_and_b32 v48, s74, v35
 v_pk_max_u16 v49, v49, v48
 v_and_b32 v48, s74, v36
 v_pk_max_u16 v49, v49, v48
 v_and_b32 v48, s74, v37
 v_pk_max_u16 v49, v49, v48
 v_and_b32 v48, s74, v38
 v_pk_max_u16 v49, v49, v48
 v_and_b32 v48, s74, v39
 v_pk_max_u16 v49, v49, v48
 v_and_b32 v48, s74, v40
 v_pk_max_u16 v49, v49, v48
 v_and_b32 v48, s74, v41
 v_pk_max_u16 v49, v49, v48
 v_and_b32 v48, s74, v42
 v_pk_max_u16 v49, v49, v48
 v_and_b32 v48, s74, v43
 v_pk_max_u16 v49, v49, v48
 v_lshrrev_b32 v48, 16, v49
 v_and_b32 v49, 0xffff, v49
 v_max_u32 v48, v48, v49
 v_cmp_lt_u32 vcc, 0x7f81, v48
 s_cbranch_vccz CA2F_sok
 s_max_u32 s68, s68, 1
 s_sub_u32 s68, s68, 1
 s_cmp_lg_u32 s68, 0
 s_cbranch_scc1 CA2F_sl
CA2F_sok:
 s_mov_b32 s60, s50
 s_waitcnt lgkmcnt(0)
 v_mov_b32 v48, 0
 v_mov_b32 v49, 0
 v_mov_b32 v50, 0
 v_mov_b32 v51, 0
 v_mov_b32 v52, 0
 v_mov_b32 v53, 0
 v_mov_b32 v54, 0
 v_mov_b32 v55, 0
 v_mov_b32 v56, 0
 v_mov_b32 v57, 0
 v_mov_b32 v58, 0
 v_mov_b32 v59, 0
 v_mov_b32 v60, 0
 v_mov_b32 v61, 0
 v_mov_b32 v62, 0
 v_mov_b32 v63, 0
 v_mov_b32 v64, 0
 v_mov_b32 v65, 0
 v_mov_b32 v66, 0
 v_mov_b32 v67, 0
 v_mov_b32 v68, 0
 v_mov_b32 v69, 0
 v_mov_b32 v70, 0
 v_mov_b32 v71, 0
 v_mov_b32 v72, 0
 v_mov_b32 v73, 0
 v_mov_b32 v74, 0
 v_mov_b32 v75, 0
 s_branch CA2F_gemm
CA2F_q:
 s_sub_u32 s67, s67, 1
 s_cmp_lt_i32 s67, 0
 s_cbranch_scc1 CA2F_qc
 s_barrier
 v_mov_b32 v48, 0
 v_mov_b32 v49, 0
 v_mov_b32 v50, 0
 v_mov_b32 v51, 0
 v_mov_b32 v52, 0
 v_mov_b32 v53, 0
 v_mov_b32 v54, 0
 v_mov_b32 v55, 0
 v_mov_b32 v56, 0
 v_mov_b32 v57, 0
 v_mov_b32 v58, 0
 v_mov_b32 v59, 0
 s_branch CA2F_bm
CA2F_gemm:
 v_smfmac_f32_16x16x64_bf16 v[48:51], v[16:19], a[0:7], v2
 v_smfmac_f32_16x16x64_bf16 v[52:55], v[16:19], a[56:63], v2
 v_smfmac_f32_16x16x64_bf16 v[56:59], v[16:19], a[112:119], v2
 v_smfmac_f32_16x16x64_bf16 v[48:51], v[20:23], a[8:15], v2
 v_smfmac_f32_16x16x64_bf16 v[52:55], v[20:23], a[64:71], v2
 s_branch CA2F_g2
CA2F_end:
 s_endpgm
.p2align 6
CA3F_start:
 s_mov_b32 s50, 0
 s_mov_b32 s60, 0
 s_mov_b32 s61, -1
 s_mov_b32 s96, 0
 s_mov_b32 s97, 0
 s_mov_b32 s67, 4096
 s_mov_b32 s51, 131072
 s_mov_b32 s52, 151552
 s_mov_b32 s75, 172032
 s_mov_b32 s53, 192512
 s_waitcnt vmcnt(0)
 s_barrier
CA3F_top:
 v_mov_b32 v80, 0
 v_mov_b32 v81, 0
 v_mov_b32 v82, 0
 v_mov_b32 v83, 0
 v_mov_b32 v84, 0
 v_mov_b32 v85, 0
 v_mov_b32 v86, 0
 v_mov_b32 v87, 0
 v_mov_b32 v88, 0
 v_mov_b32 v89, 0
 v_mov_b32 v90, 0
 v_mov_b32 v91, 0
 v_mfma_f32_32x32x16_bf16 v[48:63], v[80:83], v[80:83], 0
 v_mfma_f32_32x32x16_bf16 v[64:79], v[80:83], v[80:83], 0
 s_add_u32 s54, s50, 1
 v_mov_b32 v5, s54
 s_add_u32 s54, s50, 1
 s_min_u32 s54, s54, 63
 s_mul_i32 s56, s54, 458752
 s_add_u32 s56, s56, s47
 s_cmp_eq_u32 s50, 0
 s_cselect_b32 s56, 1073741824, s56
 s_add_u32 s57, s56, 7168
 s_sub_u32 s58, s56, 7168
 s_sub_u32 s59, s58, 7168
 s_mov_b32 s69, 16640
 s_add_u32 s55, s51, 4096
 s_mov_b32 m0, 12288
 buffer_load_dword v108, v0, s[16:19], s69 offen sc1
 s_nop 7
 buffer_load_dword v109, v0, s[16:19], s69 offen sc1
 s_nop 7
 buffer_load_dword v110, v0, s[16:19], s69 offen sc1
 s_nop 7
 buffer_load_dword v111, v0, s[16:19], s69 offen sc1
CA3Ffm_pl:
 s_waitcnt vmcnt(3)
 v_cmp_gt_u32 vcc, s50, v108
 s_cbranch_vccz CA3Ffm_pd
 buffer_load_dword v108, v0, s[16:19], s69 offen sc1
 s_waitcnt vmcnt(3)
 v_cmp_gt_u32 vcc, s50, v109
 s_cbranch_vccz CA3Ffm_pd
 buffer_load_dword v109, v0, s[16:19], s69 offen sc1
 s_waitcnt vmcnt(3)
 v_cmp_gt_u32 vcc, s50, v110
 s_cbranch_vccz CA3Ffm_pd
 buffer_load_dword v110, v0, s[16:19], s69 offen sc1
 s_waitcnt vmcnt(3)
 v_cmp_gt_u32 vcc, s50, v111
 s_cbranch_vccz CA3Ffm_pd
 buffer_load_dword v111, v0, s[16:19], s69 offen sc1
 s_max_u32 s68, s68, 1
 s_sub_u32 s68, s68, 1
 s_cmp_lg_u32 s68, 0
 s_cbranch_scc1 CA3Ffm_pl
CA3Ffm_pd:
 buffer_load_dwordx4 v1, s[16:19], s51 offen offset:0 sc1 lds
 buffer_load_dwordx4 v1, s[16:19], s51 offen offset:1024 sc1 lds
 buffer_load_dwordx4 v1, s[16:19], s51 offen offset:2048 sc1 lds
 buffer_load_dwordx4 v1, s[16:19], s51 offen offset:3072 sc1 lds
 s_mov_b32 m0, 16384
 s_nop 0
 buffer_load_dwordx4 v1, s[16:19], s55 offen offset:0 sc1 lds
 buffer_load_dwordx4 v1, s[16:19], s55 offen offset:1024 sc1 lds
 buffer_load_dwordx4 v1, s[16:19], s55 offen offset:2048 sc1 lds
 buffer_load_dword v15, v7, s[16:19], s56 offen sc1
 buffer_load_dword v15, v7, s[16:19], s57 offen sc1
 buffer_load_dword v15, v7, s[16:19], s58 offen sc1
 buffer_load_dword v15, v7, s[16:19], s59 offen sc1
 s_waitcnt vmcnt(9)
CA3F_bm:
 s_barrier
 ds_read_b128 v[16:19], v1 offset:12288
 ds_read_b128 v[20:23], v1 offset:13312
 s_waitcnt lgkmcnt(1)
 v_smfmac_f32_16x16x64_bf16 v[48:51], v[16:19], a[0:7], v2
 v_smfmac_f32_16x16x64_bf16 v[52:55], v[16:19], a[56:63], v2
 s_waitcnt vmcnt(4)
 s_barrier
 ds_read_b128 v[24:27], v1 offset:14336
 ds_read_b128 v[28:31], v1 offset:15360
 v_smfmac_f32_16x16x64_bf16 v[56:59], v[16:19], a[112:119], v2
 ds_read_b128 v[32:35], v1 offset:16384
 s_waitcnt lgkmcnt(3)
 v_smfmac_f32_16x16x64_bf16 v[48:51], v[20:23], a[8:15], v2
 ds_read_b128 v[36:39], v1 offset:17408
 v_smfmac_f32_16x16x64_bf16 v[52:55], v[20:23], a[64:71], v2
 ds_read_b128 v[40:43], v1 offset:18432
CA3F_g2:
 v_smfmac_f32_16x16x64_bf16 v[56:59], v[20:23], a[120:127], v2
 s_waitcnt lgkmcnt(4)
 v_smfmac_f32_16x16x64_bf16 v[48:51], v[24:27], a[16:23], v2
 v_max3_u32 v119, v16, v20, v24
 s_waitcnt lgkmcnt(3)
 v_smfmac_f32_16x16x64_bf16 v[48:51], v[28:31], a[24:31], v2
 s_waitcnt lgkmcnt(2)
 v_smfmac_f32_16x16x64_bf16 v[48:51], v[32:35], a[32:39], v2
 v_max3_u32 v119, v119, v28, v32
 s_waitcnt lgkmcnt(1)
 v_smfmac_f32_16x16x64_bf16 v[48:51], v[36:39], a[40:47], v2
 s_waitcnt lgkmcnt(0)
 v_smfmac_f32_16x16x64_bf16 v[48:51], v[40:43], a[48:55], v2
 v_max3_u32 v119, v119, v36, v40
 v_smfmac_f32_16x16x64_bf16 v[52:55], v[24:27], a[72:79], v2
 v_cmp_eq_u32 vcc, -1, v119
 v_smfmac_f32_16x16x64_bf16 v[52:55], v[28:31], a[80:87], v2
 v_add_f32 v48, v48, v50
 v_add_f32 v49, v49, v51
 v_smfmac_f32_16x16x64_bf16 v[52:55], v[32:35], a[88:95], v2
 s_cbranch_vccnz CA3F_q
CA3F_qc:
 v_smfmac_f32_16x16x64_bf16 v[52:55], v[36:39], a[96:103], v2
 v_cmp_u_f32 vcc, v48, v49
 v_cvt_pk_bf16_f32 v48, v48, v49
 v_smfmac_f32_16x16x64_bf16 v[52:55], v[40:43], a[104:111], v2
 ds_write_b32 v3, v48 offset:8192
 v_smfmac_f32_16x16x64_bf16 v[56:59], v[24:27], a[128:135], v2
 s_cbranch_vccnz CA3F_slow
CA3F_cont:
 v_smfmac_f32_16x16x64_bf16 v[56:59], v[28:31], a[136:143], v2
 v_add_f32 v52, v52, v54
 v_add_f32 v53, v53, v55
 v_smfmac_f32_16x16x64_bf16 v[56:59], v[32:35], a[144:151], v2
 ds_read_b128 v[92:95], v14 offset:12288
 v_cvt_pk_bf16_f32 v52, v52, v53
 v_smfmac_f32_16x16x64_bf16 v[56:59], v[36:39], a[152:159], v2
 ds_write_b32 v3, v52 offset:8448
 v_smfmac_f32_16x16x64_bf16 v[56:59], v[40:43], a[160:167], v2
 v_smfmac_f32_16x16x64_bf16 v[60:63], v[16:19], a[168:175], v2
 v_smfmac_f32_16x16x64_bf16 v[60:63], v[20:23], a[176:183], v2
 v_add_f32 v56, v56, v58
 v_smfmac_f32_16x16x64_bf16 v[60:63], v[24:27], a[184:191], v2
 v_add_f32 v57, v57, v59
 v_smfmac_f32_16x16x64_bf16 v[60:63], v[28:31], a[192:199], v2
 v_cvt_pk_bf16_f32 v56, v56, v57
 v_smfmac_f32_16x16x64_bf16 v[60:63], v[32:35], a[200:207], v2
 ds_write_b32 v3, v56 offset:8704
 v_smfmac_f32_16x16x64_bf16 v[60:63], v[36:39], a[208:215], v2
 v_smfmac_f32_16x16x64_bf16 v[60:63], v[40:43], a[216:223], v2
 ds_read_b128 v[96:99], v14 offset:13312
 v_smfmac_f32_16x16x64_bf16 v[64:67], v[16:19], a[224:231], v2
 ds_read_b128 v[100:103], v14 offset:14336
 v_smfmac_f32_16x16x64_bf16 v[64:67], v[20:23], a[232:239], v2
 v_add_f32 v60, v60, v62
 v_smfmac_f32_16x16x64_bf16 v[64:67], v[24:27], a[240:247], v2
 v_add_f32 v61, v61, v63
 v_smfmac_f32_16x16x64_bf16 v[64:67], v[28:31], a[248:255], v2
 v_cvt_pk_bf16_f32 v60, v60, v61
 v_smfmac_f32_16x16x64_bf16 v[64:67], v[32:35], v[120:127], v2
 ds_write_b32 v3, v60 offset:8960
 v_smfmac_f32_16x16x64_bf16 v[64:67], v[36:39], v[128:135], v2
 ds_read_b64_tr_b16 v[116:117], v12 offset:8192
 v_smfmac_f32_16x16x64_bf16 v[64:67], v[40:43], v[136:143], v2
 ds_read_b64_tr_b16 v[118:119], v12 offset:8320
 v_smfmac_f32_16x16x64_bf16 v[68:71], v[16:19], v[144:151], v2
 ds_read_b128 v[104:107], v14 offset:15360
 v_smfmac_f32_16x16x64_bf16 v[68:71], v[20:23], v[152:159], v2
 v_add_f32 v64, v64, v66
 v_smfmac_f32_16x16x64_bf16 v[68:71], v[24:27], v[160:167], v2
 v_add_f32 v65, v65, v67
 v_smfmac_f32_16x16x64_bf16 v[68:71], v[28:31], v[168:175], v2
 v_cvt_pk_bf16_f32 v64, v64, v65
 v_smfmac_f32_16x16x64_bf16 v[68:71], v[32:35], v[176:183], v2
 ds_write_b32 v3, v64 offset:9984
 v_smfmac_f32_16x16x64_bf16 v[68:71], v[36:39], v[184:191], v2
 v_smfmac_f32_16x16x64_bf16 v[68:71], v[40:43], v[192:199], v2
 s_waitcnt lgkmcnt(2)
 v_smfmac_f32_16x16x64_bf16 v[76:79], v[116:119], v[92:99], v2
 s_waitcnt lgkmcnt(1)
 v_smfmac_f32_16x16x64_bf16 v[80:83], v[116:119], v[100:107], v2
 v_add_f32 v68, v68, v70
 v_add_f32 v69, v69, v71
 v_smfmac_f32_16x16x64_bf16 v[88:91], v[116:119], v[24:31], v2
 v_cvt_pk_bf16_f32 v68, v68, v69
 v_add_f32 v76, v76, v78
 v_smfmac_f32_16x16x64_bf16 v[72:75], v[16:19], v[200:207], v2
 ds_write_b32 v3, v68 offset:11008
 v_add_f32 v80, v80, v82
 v_smfmac_f32_16x16x64_bf16 v[72:75], v[20:23], v[208:215], v2
 ds_write2st64_b32 v6, v76, v80 offset0:6 offset1:7
 v_add_f32 v77, v77, v79
 v_smfmac_f32_16x16x64_bf16 v[72:75], v[24:27], v[216:223], v2
 v_add_f32 v81, v81, v83
 v_add_f32 v88, v88, v90
 v_smfmac_f32_16x16x64_bf16 v[72:75], v[28:31], v[224:231], v2
 ds_write2st64_b32 v6, v77, v81 offset0:15 offset1:16
 v_add_f32 v89, v89, v91
 v_smfmac_f32_16x16x64_bf16 v[72:75], v[32:35], v[232:239], v2
 s_waitcnt lgkmcnt(2)
 s_barrier
 v_smfmac_f32_16x16x64_bf16 v[72:75], v[36:39], v[240:247], v2
 ds_write2st64_b32 v13, v88, v89 offset0:8 offset1:17
 v_smfmac_f32_16x16x64_bf16 v[72:75], v[40:43], v[248:255], v2
 s_nop 7
 v_add_f32 v72, v72, v74
 v_add_f32 v73, v73, v75
 v_cvt_pk_bf16_f32 v72, v72, v73
 ds_write_b32 v3, v72 offset:12032
 s_waitcnt lgkmcnt(0)
 s_barrier
 s_barrier
 s_add_u32 s50, s50, 1
 s_cmp_eq_u32 s50, 63
 s_cbranch_scc1 CA3F_end
 s_mov_b32 s54, s53
 s_mov_b32 s53, s51
 s_mov_b32 s51, s52
 s_mov_b32 s52, s75
 s_mov_b32 s75, s54
 v_xor_b32 v14, 98304, v14
 s_branch CA3F_top
CA3F_slow:
 s_cmp_eq_u32 s60, s50
 s_cbranch_scc1 CA3F_cont
 s_add_u32 s55, s51, 4096
CA3F_sl:
 buffer_load_dwordx4 v[16:19], v1, s[16:19], s51 offen offset:0 sc1
 buffer_load_dwordx4 v[20:23], v1, s[16:19], s51 offen offset:1024 sc1
 buffer_load_dwordx4 v[24:27], v1, s[16:19], s51 offen offset:2048 sc1
 buffer_load_dwordx4 v[28:31], v1, s[16:19], s51 offen offset:3072 sc1
 buffer_load_dwordx4 v[32:35], v1, s[16:19], s55 offen offset:0 sc1
 buffer_load_dwordx4 v[36:39], v1, s[16:19], s55 offen offset:1024 sc1
 buffer_load_dwordx4 v[40:43], v1, s[16:19], s55 offen offset:2048 sc1
 s_waitcnt vmcnt(0)
 v_mov_b32 v49, 0
 v_and_b32 v48, s74, v16
 v_pk_max_u16 v49, v49, v48
 v_and_b32 v48, s74, v17
 v_pk_max_u16 v49, v49, v48
 v_and_b32 v48, s74, v18
 v_pk_max_u16 v49, v49, v48
 v_and_b32 v48, s74, v19
 v_pk_max_u16 v49, v49, v48
 v_and_b32 v48, s74, v20
 v_pk_max_u16 v49, v49, v48
 v_and_b32 v48, s74, v21
 v_pk_max_u16 v49, v49, v48
 v_and_b32 v48, s74, v22
 v_pk_max_u16 v49, v49, v48
 v_and_b32 v48, s74, v23
 v_pk_max_u16 v49, v49, v48
 v_and_b32 v48, s74, v24
 v_pk_max_u16 v49, v49, v48
 v_and_b32 v48, s74, v25
 v_pk_max_u16 v49, v49, v48
 v_and_b32 v48, s74, v26
 v_pk_max_u16 v49, v49, v48
 v_and_b32 v48, s74, v27
 v_pk_max_u16 v49, v49, v48
 v_and_b32 v48, s74, v28
 v_pk_max_u16 v49, v49, v48
 v_and_b32 v48, s74, v29
 v_pk_max_u16 v49, v49, v48
 v_and_b32 v48, s74, v30
 v_pk_max_u16 v49, v49, v48
 v_and_b32 v48, s74, v31
 v_pk_max_u16 v49, v49, v48
 v_and_b32 v48, s74, v32
 v_pk_max_u16 v49, v49, v48
 v_and_b32 v48, s74, v33
 v_pk_max_u16 v49, v49, v48
 v_and_b32 v48, s74, v34
 v_pk_max_u16 v49, v49, v48
 v_and_b32 v48, s74, v35
 v_pk_max_u16 v49, v49, v48
 v_and_b32 v48, s74, v36
 v_pk_max_u16 v49, v49, v48
 v_and_b32 v48, s74, v37
 v_pk_max_u16 v49, v49, v48
 v_and_b32 v48, s74, v38
 v_pk_max_u16 v49, v49, v48
 v_and_b32 v48, s74, v39
 v_pk_max_u16 v49, v49, v48
 v_and_b32 v48, s74, v40
 v_pk_max_u16 v49, v49, v48
 v_and_b32 v48, s74, v41
 v_pk_max_u16 v49, v49, v48
 v_and_b32 v48, s74, v42
 v_pk_max_u16 v49, v49, v48
 v_and_b32 v48, s74, v43
 v_pk_max_u16 v49, v49, v48
 v_lshrrev_b32 v48, 16, v49
 v_and_b32 v49, 0xffff, v49
 v_max_u32 v48, v48, v49
 v_cmp_lt_u32 vcc, 0x7f81, v48
 s_cbranch_vccz CA3F_sok
 s_max_u32 s68, s68, 1
 s_sub_u32 s68, s68, 1
 s_cmp_lg_u32 s68, 0
 s_cbranch_scc1 CA3F_sl
CA3F_sok:
 s_mov_b32 s60, s50
 s_waitcnt lgkmcnt(0)
 v_mov_b32 v48, 0
 v_mov_b32 v49, 0
 v_mov_b32 v50, 0
 v_mov_b32 v51, 0
 v_mov_b32 v52, 0
 v_mov_b32 v53, 0
 v_mov_b32 v54, 0
 v_mov_b32 v55, 0
 v_mov_b32 v56, 0
 v_mov_b32 v57, 0
 v_mov_b32 v58, 0
 v_mov_b32 v59, 0
 v_mov_b32 v60, 0
 v_mov_b32 v61, 0
 v_mov_b32 v62, 0
 v_mov_b32 v63, 0
 v_mov_b32 v64, 0
 v_mov_b32 v65, 0
 v_mov_b32 v66, 0
 v_mov_b32 v67, 0
 v_mov_b32 v68, 0
 v_mov_b32 v69, 0
 v_mov_b32 v70, 0
 v_mov_b32 v71, 0
 v_mov_b32 v72, 0
 v_mov_b32 v73, 0
 v_mov_b32 v74, 0
 v_mov_b32 v75, 0
 s_branch CA3F_gemm
CA3F_q:
 s_sub_u32 s67, s67, 1
 s_cmp_lt_i32 s67, 0
 s_cbranch_scc1 CA3F_qc
 s_barrier
 s_mov_b32 m0, 12288
 s_nop 0
 buffer_load_dwordx4 v1, s[16:19], s51 offen offset:0 sc1 lds
 buffer_load_dwordx4 v1, s[16:19], s51 offen offset:1024 sc1 lds
 buffer_load_dwordx4 v1, s[16:19], s51 offen offset:2048 sc1 lds
 buffer_load_dwordx4 v1, s[16:19], s51 offen offset:3072 sc1 lds
 s_mov_b32 m0, 16384
 s_nop 0
 buffer_load_dwordx4 v1, s[16:19], s55 offen offset:0 sc1 lds
 buffer_load_dwordx4 v1, s[16:19], s55 offen offset:1024 sc1 lds
 buffer_load_dwordx4 v1, s[16:19], s55 offen offset:2048 sc1 lds
 v_mov_b32 v48, 0
 v_mov_b32 v49, 0
 v_mov_b32 v50, 0
 v_mov_b32 v51, 0
 v_mov_b32 v52, 0
 v_mov_b32 v53, 0
 v_mov_b32 v54, 0
 v_mov_b32 v55, 0
 v_mov_b32 v56, 0
 v_mov_b32 v57, 0
 v_mov_b32 v58, 0
 v_mov_b32 v59, 0
 s_waitcnt vmcnt(0)
 s_branch CA3F_bm
CA3F_gemm:
 v_smfmac_f32_16x16x64_bf16 v[48:51], v[16:19], a[0:7], v2
 v_smfmac_f32_16x16x64_bf16 v[52:55], v[16:19], a[56:63], v2
 v_smfmac_f32_16x16x64_bf16 v[56:59], v[16:19], a[112:119], v2
 v_smfmac_f32_16x16x64_bf16 v[48:51], v[20:23], a[8:15], v2
 v_smfmac_f32_16x16x64_bf16 v[52:55], v[20:23], a[64:71], v2
 s_branch CA3F_g2
CA3F_end:
 s_endpgm
.p2align 6
CB0F_start:
 s_mov_b32 s50, 0
 s_mov_b32 s60, 0
 s_mov_b32 s61, -1
 s_mov_b32 s96, 0
 s_mov_b32 s97, 0
 s_mov_b32 s67, 4096
 s_mov_b32 s51, 131072
 s_mov_b32 s52, 151552
 s_mov_b32 s75, 172032
 s_mov_b32 s53, 192512
 s_waitcnt vmcnt(0)
 s_barrier
CB0F_top:
 ds_read_b128 v[64:67], v7 offset:0
 ds_read_b128 v[68:71], v7 offset:1024
 ds_read_b128 v[72:75], v7 offset:2048
 ds_read_b128 v[76:79], v7 offset:3072
 ds_read_b128 v[80:83], v7 offset:4096
 ds_read_b128 v[84:87], v7 offset:5120
 ds_read_b128 v[88:91], v7 offset:6144
 ds_read_b128 v[92:95], v7 offset:7168
 ds_read_b128 v[96:99], v7 offset:8192
 ds_read_b128 v[100:103], v7 offset:9216
 ds_read_b128 v[104:107], v7 offset:10240
 ds_read_b128 v[108:111], v7 offset:11264
 v_mov_b32 v40, 0
 v_mov_b32 v41, 0
 v_mov_b32 v42, 0
 v_mov_b32 v43, 0
 v_mov_b32 v44, 0
 v_mov_b32 v45, 0
 v_mov_b32 v46, 0
 v_mov_b32 v47, 0
 v_mov_b32 v48, 0
 v_mov_b32 v49, 0
 v_mov_b32 v50, 0
 v_mov_b32 v51, 0
 v_mov_b32 v52, 0
 v_mov_b32 v53, 0
 v_mov_b32 v54, 0
 v_mov_b32 v55, 0
 s_add_u32 s54, s50, 1
 v_mov_b32 v5, s54
 s_mul_i32 s56, s50, 458752
 s_add_u32 s56, s56, s44
 s_add_u32 s57, s56, 16384
 s_waitcnt lgkmcnt(0)
CB0F_bm:
 s_barrier
 ds_read_b128 v[12:15], v1 offset:12288
 ds_read_b128 v[16:19], v1 offset:13312
 ds_read_b128 v[20:23], v1 offset:14336
 ds_read_b128 v[24:27], v1 offset:15360
 ds_read_b128 v[28:31], v1 offset:16384
 ds_read_b128 v[32:35], v1 offset:17408
 ds_read_b128 v[36:39], v1 offset:18432
CB0F_gemm:
 s_waitcnt lgkmcnt(6)
 v_smfmac_f32_16x16x64_bf16 v[40:43], v[12:15], v[64:71], v2
 s_waitcnt lgkmcnt(5)
 v_smfmac_f32_16x16x64_bf16 v[40:43], v[16:19], v[72:79], v2
 s_waitcnt lgkmcnt(4)
 v_smfmac_f32_16x16x64_bf16 v[40:43], v[20:23], v[80:87], v2
 v_max3_u32 v11, v12, v16, v20
 s_waitcnt lgkmcnt(3)
 v_smfmac_f32_16x16x64_bf16 v[40:43], v[24:27], v[88:95], v2
 s_waitcnt lgkmcnt(2)
 v_smfmac_f32_16x16x64_bf16 v[40:43], v[28:31], v[96:103], v2
 v_max3_u32 v11, v11, v24, v28
 s_waitcnt lgkmcnt(1)
 v_smfmac_f32_16x16x64_bf16 v[40:43], v[32:35], v[104:111], v2
 s_waitcnt lgkmcnt(0)
 v_smfmac_f32_16x16x64_bf16 v[40:43], v[36:39], a[0:7], v2
 v_max3_u32 v11, v11, v32, v36
 v_smfmac_f32_16x16x64_bf16 v[44:47], v[12:15], a[8:15], v2
 v_cmp_eq_u32 vcc, -1, v11
 v_smfmac_f32_16x16x64_bf16 v[44:47], v[16:19], a[16:23], v2
 v_smfmac_f32_16x16x64_bf16 v[44:47], v[20:23], a[24:31], v2
 s_cbranch_vccnz CB0F_q
CB0F_qc:
 v_smfmac_f32_16x16x64_bf16 v[44:47], v[24:27], a[32:39], v2
 v_add_f32 v40, v40, v42
 v_smfmac_f32_16x16x64_bf16 v[44:47], v[28:31], a[40:47], v2
 v_add_f32 v41, v41, v43
 v_smfmac_f32_16x16x64_bf16 v[44:47], v[32:35], a[48:55], v2
 v_cmp_u_f32 vcc, v40, v41
 v_smfmac_f32_16x16x64_bf16 v[44:47], v[36:39], a[56:63], v2
 s_nop 0
 v_smfmac_f32_16x16x64_bf16 v[48:51], v[12:15], a[64:71], v2
 s_cbranch_vccnz CB0F_slow
CB0F_cont:
 v_smfmac_f32_16x16x64_bf16 v[48:51], v[16:19], a[72:79], v2
 buffer_load_dwordx4 v[64:67], v1, s[16:19], s56 offen offset:0 sc1
 v_cvt_pk_bf16_f32 v56, v40, v41
 v_smfmac_f32_16x16x64_bf16 v[48:51], v[20:23], a[80:87], v2
 v_mov_b32 v40, 0
 v_mov_b32 v41, 0
 v_smfmac_f32_16x16x64_bf16 v[48:51], v[24:27], a[88:95], v2
 buffer_load_dwordx4 v[68:71], v1, s[16:19], s56 offen offset:1024 sc1
 v_mov_b32 v42, 0
 v_smfmac_f32_16x16x64_bf16 v[48:51], v[28:31], a[96:103], v2
 v_mov_b32 v43, 0
 v_add_f32 v44, v44, v46
 v_smfmac_f32_16x16x64_bf16 v[48:51], v[32:35], a[104:111], v2
 buffer_load_dwordx4 v[80:83], v1, s[16:19], s56 offen offset:2048 sc1
 v_add_f32 v45, v45, v47
 v_smfmac_f32_16x16x64_bf16 v[48:51], v[36:39], a[112:119], v2
 v_cvt_pk_bf16_f32 v57, v44, v45
 v_mov_b32 v44, 0
 v_smfmac_f32_16x16x64_bf16 v[52:55], v[12:15], a[120:127], v2
 buffer_load_dwordx4 v[84:87], v1, s[16:19], s56 offen offset:3072 sc1
 v_mov_b32 v45, 0
 v_smfmac_f32_16x16x64_bf16 v[52:55], v[16:19], a[128:135], v2
 v_mov_b32 v46, 0
 v_mov_b32 v47, 0
 v_smfmac_f32_16x16x64_bf16 v[52:55], v[20:23], a[136:143], v2
 buffer_load_dwordx4 v[72:75], v1, s[16:19], s57 offen offset:0 sc1
 v_add_f32 v48, v48, v50
 v_smfmac_f32_16x16x64_bf16 v[52:55], v[24:27], a[144:151], v2
 v_add_f32 v49, v49, v51
 v_cvt_pk_bf16_f32 v58, v48, v49
 v_smfmac_f32_16x16x64_bf16 v[52:55], v[28:31], a[152:159], v2
 buffer_load_dwordx4 v[76:79], v1, s[16:19], s57 offen offset:1024 sc1
 v_mov_b32 v48, 0
 v_smfmac_f32_16x16x64_bf16 v[52:55], v[32:35], a[160:167], v2
 v_mov_b32 v49, 0
 v_mov_b32 v50, 0
 v_smfmac_f32_16x16x64_bf16 v[52:55], v[36:39], a[168:175], v2
 buffer_load_dwordx4 v[88:91], v1, s[16:19], s57 offen offset:2048 sc1
 v_mov_b32 v51, 0
 v_smfmac_f32_16x16x64_bf16 v[40:43], v[12:15], a[176:183], v2
 v_smfmac_f32_16x16x64_bf16 v[40:43], v[16:19], a[184:191], v2
 buffer_load_dwordx4 v[92:95], v1, s[16:19], s57 offen offset:3072 sc1
 v_add_f32 v52, v52, v54
 v_smfmac_f32_16x16x64_bf16 v[40:43], v[20:23], a[192:199], v2
 v_add_f32 v53, v53, v55
 v_cvt_pk_bf16_f32 v59, v52, v53
 v_smfmac_f32_16x16x64_bf16 v[40:43], v[24:27], a[200:207], v2
 v_mov_b32 v52, 0
 v_mov_b32 v53, 0
 v_smfmac_f32_16x16x64_bf16 v[40:43], v[28:31], a[208:215], v2
 v_mov_b32 v54, 0
 v_mov_b32 v55, 0
 v_smfmac_f32_16x16x64_bf16 v[40:43], v[32:35], a[216:223], v2
 v_smfmac_f32_16x16x64_bf16 v[40:43], v[36:39], a[224:231], v2
 v_smfmac_f32_16x16x64_bf16 v[44:47], v[12:15], a[232:239], v2
 v_smfmac_f32_16x16x64_bf16 v[44:47], v[16:19], a[240:247], v2
 v_add_f32 v40, v40, v42
 v_add_f32 v41, v41, v43
 v_smfmac_f32_16x16x64_bf16 v[44:47], v[20:23], a[248:255], v2
 v_cvt_pk_bf16_f32 v60, v40, v41
 v_smfmac_f32_16x16x64_bf16 v[44:47], v[24:27], v[112:119], v2
 v_smfmac_f32_16x16x64_bf16 v[44:47], v[28:31], v[120:127], v2
 v_smfmac_f32_16x16x64_bf16 v[44:47], v[32:35], v[128:135], v2
 v_smfmac_f32_16x16x64_bf16 v[44:47], v[36:39], v[136:143], v2
 s_nop 7
 v_add_f32 v44, v44, v46
 v_add_f32 v45, v45, v47
 v_cvt_pk_bf16_f32 v61, v44, v45
 s_cmp_eq_u32 s50, 63
 s_cbranch_scc1 CB0F_fin
 s_add_u32 s77, s51, 8192
 s_add_u32 s79, s51, 16384
 v_mov_b32 v40, 0
 v_mov_b32 v41, 0
 v_mov_b32 v42, 0
 v_mov_b32 v43, 0
 v_mov_b32 v44, 0
 v_mov_b32 v45, 0
 v_mov_b32 v46, 0
 v_mov_b32 v47, 0
 s_add_u32 s54, s50, 1
 s_mov_b32 s69, 16384
 buffer_load_dword v106, v0, s[16:19], s69 offen sc1
 s_nop 7
 buffer_load_dword v107, v0, s[16:19], s69 offen sc1
 s_nop 7
 buffer_load_dword v108, v0, s[16:19], s69 offen sc1
 s_nop 7
 buffer_load_dword v109, v0, s[16:19], s69 offen sc1
CB0Ffp_pl:
 s_waitcnt vmcnt(3)
 v_cmp_gt_u32 vcc, s54, v106
 s_cbranch_vccz CB0Ffp_pd
 buffer_load_dword v106, v0, s[16:19], s69 offen sc1
 s_waitcnt vmcnt(3)
 v_cmp_gt_u32 vcc, s54, v107
 s_cbranch_vccz CB0Ffp_pd
 buffer_load_dword v107, v0, s[16:19], s69 offen sc1
 s_waitcnt vmcnt(3)
 v_cmp_gt_u32 vcc, s54, v108
 s_cbranch_vccz CB0Ffp_pd
 buffer_load_dword v108, v0, s[16:19], s69 offen sc1
 s_waitcnt vmcnt(3)
 v_cmp_gt_u32 vcc, s54, v109
 s_cbranch_vccz CB0Ffp_pd
 buffer_load_dword v109, v0, s[16:19], s69 offen sc1
 s_max_u32 s68, s68, 1
 s_sub_u32 s68, s68, 1
 s_cmp_lg_u32 s68, 0
 s_cbranch_scc1 CB0Ffp_pl
CB0Ffp_pd:
 s_barrier
 v_smfmac_f32_16x16x64_bf16 v[48:51], v[12:15], v[144:151], v2
 v_smfmac_f32_16x16x64_bf16 v[48:51], v[16:19], v[152:159], v2
 v_smfmac_f32_16x16x64_bf16 v[48:51], v[20:23], v[160:167], v2
 v_smfmac_f32_16x16x64_bf16 v[48:51], v[24:27], v[168:175], v2
 v_smfmac_f32_16x16x64_bf16 v[48:51], v[28:31], v[176:183], v2
 v_smfmac_f32_16x16x64_bf16 v[48:51], v[32:35], v[184:191], v2
 v_smfmac_f32_16x16x64_bf16 v[48:51], v[36:39], v[192:199], v2
 buffer_load_dwordx4 v[96:99], v1, s[16:19], s77 offen offset:0 sc1
 v_smfmac_f32_16x16x64_bf16 v[52:55], v[12:15], v[200:207], v2
 buffer_load_dwordx4 v[100:103], v1, s[16:19], s77 offen offset:1024 sc1
 v_smfmac_f32_16x16x64_bf16 v[52:55], v[16:19], v[208:215], v2
 buffer_load_dwordx2 v[104:105], v3, s[16:19], s79 offen sc1
 v_smfmac_f32_16x16x64_bf16 v[52:55], v[20:23], v[216:223], v2
 v_add_f32 v48, v48, v50
 v_smfmac_f32_16x16x64_bf16 v[52:55], v[24:27], v[224:231], v2
 v_add_f32 v49, v49, v51
 v_smfmac_f32_16x16x64_bf16 v[52:55], v[28:31], v[232:239], v2
 v_cvt_pk_bf16_f32 v62, v48, v49
 v_smfmac_f32_16x16x64_bf16 v[52:55], v[32:35], v[240:247], v2
 v_smfmac_f32_16x16x64_bf16 v[52:55], v[36:39], v[248:255], v2
 s_nop 7
 v_add_f32 v48, v52, v54
 v_add_f32 v49, v53, v55
 v_cvt_pk_bf16_f32 v63, v48, v49
CB0F_pgo:
 s_waitcnt vmcnt(2)
 v_smfmac_f32_16x16x64_bf16 v[40:43], v[96:99], v[64:71], v2
 v_max3_u32 v11, v96, v97, v98
 v_smfmac_f32_16x16x64_bf16 v[44:47], v[96:99], v[72:79], v2
 v_max_u32 v11, v11, v99
 s_waitcnt vmcnt(1)
 v_smfmac_f32_16x16x64_bf16 v[40:43], v[100:103], v[80:87], v2
 v_max3_u32 v11, v11, v100, v101
 v_smfmac_f32_16x16x64_bf16 v[44:47], v[100:103], v[88:95], v2
 v_max3_u32 v11, v11, v102, v103
 s_waitcnt vmcnt(0)
 v_max3_u32 v11, v11, v104, v105
 v_smfmac_f32_16x16x32_bf16 v[40:43], v[104:105], v[56:59], v2
 v_cmp_eq_u32 vcc, -1, v11
 v_smfmac_f32_16x16x32_bf16 v[44:47], v[104:105], v[60:63], v2
 s_barrier
 ds_read_b128 v[12:15], v1 offset:21504
 ds_read_b128 v[16:19], v1 offset:22528
 ds_read_b128 v[20:23], v1 offset:23552
CB0F_pck:
 s_cbranch_vccnz CB0F_pre
CB0F_pvok:
 s_mov_b64 vcc, s[62:63]
 v_pk_add_f32 v[40:41], v[40:41], v[42:43]
 s_nop 0
 v_pk_add_f32 v[42:43], v[44:45], v[46:47]
 s_waitcnt lgkmcnt(2)
 v_pk_add_f32 v[40:41], v[40:41], v[12:13]
 v_pk_add_f32 v[42:43], v[42:43], v[14:15]
 s_waitcnt lgkmcnt(1)
 v_pk_add_f32 v[40:41], v[40:41], v[16:17]
 v_pk_add_f32 v[42:43], v[42:43], v[18:19]
 s_waitcnt lgkmcnt(0)
 v_pk_add_f32 v[40:41], v[40:41], v[20:21]
 v_pk_add_f32 v[42:43], v[42:43], v[22:23]
 s_nop 0
 v_cndmask_b32_dpp v48, v41, v40, vcc quad_perm:[0,0,2,2] row_mask:0xf bank_mask:0xf
 v_cndmask_b32_dpp v50, v43, v42, vcc quad_perm:[0,0,2,2] row_mask:0xf bank_mask:0xf
 s_mov_b64 vcc, s[64:65]
 v_cndmask_b32_dpp v49, v40, v41, vcc quad_perm:[1,1,3,3] row_mask:0xf bank_mask:0xf
 v_cndmask_b32_dpp v51, v42, v43, vcc quad_perm:[1,1,3,3] row_mask:0xf bank_mask:0xf
 v_cvt_pk_bf16_f32 v48, v48, v49
 buffer_store_dword v48, v8, s[16:19], s52 offen offset:0
 v_cvt_pk_bf16_f32 v50, v50, v51
 buffer_store_dword v50, v8, s[16:19], s52 offen offset:256
 v_add_f32 v40, v40, v42
 v_add_f32 v41, v41, v43
 v_cmp_u_f32 vcc, v40, v41
 s_cbranch_vccnz CB0F_pycanon
CB0F_pydone:
 s_cmp_lg_u32 s50, 62
 s_cbranch_scc1 CB0F_nl
 s_mov_b32 s76, 664576
 buffer_store_dword v48, v9, s[16:19], s76 offen offset:0 sc1
 buffer_store_dword v50, v9, s[16:19], s76 offen offset:32 sc1
CB0F_nl:
 buffer_store_dword v10, v8, s[16:19], s75 offen offset:0
 buffer_store_dword v10, v8, s[16:19], s75 offen offset:256
 s_add_u32 s50, s50, 1
 s_mov_b32 s54, s53
 s_mov_b32 s53, s51
 s_mov_b32 s51, s52
 s_mov_b32 s52, s75
 s_mov_b32 s75, s54
 s_branch CB0F_top
CB0F_slow:
 s_cmp_eq_u32 s60, s50
 s_cbranch_scc1 CB0F_cont
 s_add_u32 s55, s51, 4096
CB0F_sl:
 buffer_load_dwordx4 v[12:15], v1, s[16:19], s51 offen offset:0 sc1
 buffer_load_dwordx4 v[16:19], v1, s[16:19], s51 offen offset:1024 sc1
 buffer_load_dwordx4 v[20:23], v1, s[16:19], s51 offen offset:2048 sc1
 buffer_load_dwordx4 v[24:27], v1, s[16:19], s51 offen offset:3072 sc1
 buffer_load_dwordx4 v[28:31], v1, s[16:19], s55 offen offset:0 sc1
 buffer_load_dwordx4 v[32:35], v1, s[16:19], s55 offen offset:1024 sc1
 buffer_load_dwordx4 v[36:39], v1, s[16:19], s55 offen offset:2048 sc1
 s_waitcnt vmcnt(0)
 v_mov_b32 v41, 0
 v_and_b32 v40, s74, v12
 v_pk_max_u16 v41, v41, v40
 v_and_b32 v40, s74, v13
 v_pk_max_u16 v41, v41, v40
 v_and_b32 v40, s74, v14
 v_pk_max_u16 v41, v41, v40
 v_and_b32 v40, s74, v15
 v_pk_max_u16 v41, v41, v40
 v_and_b32 v40, s74, v16
 v_pk_max_u16 v41, v41, v40
 v_and_b32 v40, s74, v17
 v_pk_max_u16 v41, v41, v40
 v_and_b32 v40, s74, v18
 v_pk_max_u16 v41, v41, v40
 v_and_b32 v40, s74, v19
 v_pk_max_u16 v41, v41, v40
 v_and_b32 v40, s74, v20
 v_pk_max_u16 v41, v41, v40
 v_and_b32 v40, s74, v21
 v_pk_max_u16 v41, v41, v40
 v_and_b32 v40, s74, v22
 v_pk_max_u16 v41, v41, v40
 v_and_b32 v40, s74, v23
 v_pk_max_u16 v41, v41, v40
 v_and_b32 v40, s74, v24
 v_pk_max_u16 v41, v41, v40
 v_and_b32 v40, s74, v25
 v_pk_max_u16 v41, v41, v40
 v_and_b32 v40, s74, v26
 v_pk_max_u16 v41, v41, v40
 v_and_b32 v40, s74, v27
 v_pk_max_u16 v41, v41, v40
 v_and_b32 v40, s74, v28
 v_pk_max_u16 v41, v41, v40
 v_and_b32 v40, s74, v29
 v_pk_max_u16 v41, v41, v40
 v_and_b32 v40, s74, v30
 v_pk_max_u16 v41, v41, v40
 v_and_b32 v40, s74, v31
 v_pk_max_u16 v41, v41, v40
 v_and_b32 v40, s74, v32
 v_pk_max_u16 v41, v41, v40
 v_and_b32 v40, s74, v33
 v_pk_max_u16 v41, v41, v40
 v_and_b32 v40, s74, v34
 v_pk_max_u16 v41, v41, v40
 v_and_b32 v40, s74, v35
 v_pk_max_u16 v41, v41, v40
 v_and_b32 v40, s74, v36
 v_pk_max_u16 v41, v41, v40
 v_and_b32 v40, s74, v37
 v_pk_max_u16 v41, v41, v40
 v_and_b32 v40, s74, v38
 v_pk_max_u16 v41, v41, v40
 v_and_b32 v40, s74, v39
 v_pk_max_u16 v41, v41, v40
 v_lshrrev_b32 v40, 16, v41
 v_and_b32 v41, 0xffff, v41
 v_max_u32 v40, v40, v41
 v_cmp_lt_u32 vcc, 0x7f81, v40
 s_cbranch_vccz CB0F_sok
 s_max_u32 s68, s68, 1
 s_sub_u32 s68, s68, 1
 s_cmp_lg_u32 s68, 0
 s_cbranch_scc1 CB0F_sl
CB0F_sok:
 s_mov_b32 s60, s50
 s_waitcnt lgkmcnt(0)
 v_mov_b32 v40, 0
 v_mov_b32 v41, 0
 v_mov_b32 v42, 0
 v_mov_b32 v43, 0
 v_mov_b32 v44, 0
 v_mov_b32 v45, 0
 v_mov_b32 v46, 0
 v_mov_b32 v47, 0
 v_mov_b32 v48, 0
 v_mov_b32 v49, 0
 v_mov_b32 v50, 0
 v_mov_b32 v51, 0
 v_mov_b32 v52, 0
 v_mov_b32 v53, 0
 v_mov_b32 v54, 0
 v_mov_b32 v55, 0
 s_branch CB0F_gemm
CB0F_q:
 s_sub_u32 s67, s67, 1
 s_cmp_lt_i32 s67, 0
 s_cbranch_scc1 CB0F_qc
 s_barrier
 v_mov_b32 v40, 0
 v_mov_b32 v41, 0
 v_mov_b32 v42, 0
 v_mov_b32 v43, 0
 v_mov_b32 v44, 0
 v_mov_b32 v45, 0
 v_mov_b32 v46, 0
 v_mov_b32 v47, 0
 v_mov_b32 v48, 0
 v_mov_b32 v49, 0
 v_mov_b32 v50, 0
 v_mov_b32 v51, 0
 s_branch CB0F_bm
CB0F_fin:
 s_add_u32 s70, s47, 7225344
 s_add_u32 s71, s70, 4096
 s_cmp_eq_u32 s42, 0
 s_cselect_b32 s54, 3, 1
 s_mov_b32 s55, 121856
 s_atomic_add s54, s[16:17], s55
 v_smfmac_f32_16x16x64_bf16 v[48:51], v[12:15], v[144:151], v2
 v_smfmac_f32_16x16x64_bf16 v[48:51], v[16:19], v[152:159], v2
 v_smfmac_f32_16x16x64_bf16 v[48:51], v[20:23], v[160:167], v2
 v_smfmac_f32_16x16x64_bf16 v[48:51], v[24:27], v[168:175], v2
 v_smfmac_f32_16x16x64_bf16 v[48:51], v[28:31], v[176:183], v2
 v_smfmac_f32_16x16x64_bf16 v[48:51], v[32:35], v[184:191], v2
 v_smfmac_f32_16x16x64_bf16 v[48:51], v[36:39], v[192:199], v2
 s_nop 7
 v_add_f32 v48, v48, v50
 v_add_f32 v49, v49, v51
 v_cvt_pk_bf16_f32 v62, v48, v49
 v_smfmac_f32_16x16x64_bf16 v[52:55], v[12:15], v[200:207], v2
 v_smfmac_f32_16x16x64_bf16 v[52:55], v[16:19], v[208:215], v2
 v_smfmac_f32_16x16x64_bf16 v[52:55], v[20:23], v[216:223], v2
 v_smfmac_f32_16x16x64_bf16 v[52:55], v[24:27], v[224:231], v2
 v_smfmac_f32_16x16x64_bf16 v[52:55], v[28:31], v[232:239], v2
 v_smfmac_f32_16x16x64_bf16 v[52:55], v[32:35], v[240:247], v2
 v_smfmac_f32_16x16x64_bf16 v[52:55], v[36:39], v[248:255], v2
 s_nop 7
 v_add_f32 v52, v52, v54
 v_add_f32 v53, v53, v55
 v_cvt_pk_bf16_f32 v63, v52, v53
 v_min_u32 v56, -2, v56
 v_min_u32 v57, -2, v57
 v_min_u32 v58, -2, v58
 v_min_u32 v59, -2, v59
 v_min_u32 v60, -2, v60
 v_min_u32 v61, -2, v61
 v_min_u32 v62, -2, v62
 v_min_u32 v63, -2, v63
 buffer_store_dwordx4 v[56:59], v1, s[16:19], s70 offen sc1
 buffer_store_dwordx4 v[60:63], v1, s[16:19], s71 offen sc1
 s_branch CB0F_end
CB0F_pre:
 s_max_u32 s68, s68, 1
 s_sub_u32 s68, s68, 1
 s_cmp_lg_u32 s68, 0
 s_cbranch_scc0 CB0F_pvok
 s_mov_b32 s61, s50
 buffer_load_dwordx4 v[96:99], v1, s[16:19], s77 offen offset:0 sc1
 buffer_load_dwordx4 v[100:103], v1, s[16:19], s77 offen offset:1024 sc1
 buffer_load_dwordx2 v[104:105], v3, s[16:19], s79 offen sc1
 s_nop 7
 v_mov_b32 v40, 0
 v_mov_b32 v41, 0
 v_mov_b32 v42, 0
 v_mov_b32 v43, 0
 v_mov_b32 v44, 0
 v_mov_b32 v45, 0
 v_mov_b32 v46, 0
 v_mov_b32 v47, 0
 s_waitcnt vmcnt(2)
 v_smfmac_f32_16x16x64_bf16 v[40:43], v[96:99], v[64:71], v2
 v_max3_u32 v11, v96, v97, v98
 v_smfmac_f32_16x16x64_bf16 v[44:47], v[96:99], v[72:79], v2
 v_max_u32 v11, v11, v99
 s_waitcnt vmcnt(1)
 v_smfmac_f32_16x16x64_bf16 v[40:43], v[100:103], v[80:87], v2
 v_max3_u32 v11, v11, v100, v101
 v_smfmac_f32_16x16x64_bf16 v[44:47], v[100:103], v[88:95], v2
 v_max3_u32 v11, v11, v102, v103
 s_waitcnt vmcnt(0)
 v_max3_u32 v11, v11, v104, v105
 v_smfmac_f32_16x16x32_bf16 v[40:43], v[104:105], v[56:59], v2
 v_cmp_eq_u32 vcc, -1, v11
 v_smfmac_f32_16x16x32_bf16 v[44:47], v[104:105], v[60:63], v2
 s_nop 7
 s_branch CB0F_pck
CB0F_pycanon:
 v_and_b32 v49, s74, v48
 v_pk_min_u16 v49, v49, s72
 v_bfi_b32 v48, s74, v49, v48
 v_and_b32 v49, s74, v50
 v_pk_min_u16 v49, v49, s72
 v_bfi_b32 v50, s74, v49, v50
 buffer_store_dword v50, v8, s[16:19], s52 offen offset:256
 buffer_store_dword v48, v8, s[16:19], s52 offen
 s_branch CB0F_pydone
CB0F_end:
 s_endpgm
.p2align 6
CB1F_start:
 s_mov_b32 s50, 0
 s_mov_b32 s60, 0
 s_mov_b32 s61, -1
 s_mov_b32 s96, 0
 s_mov_b32 s97, 0
 s_mov_b32 s67, 4096
 s_mov_b32 s51, 131072
 s_mov_b32 s52, 151552
 s_mov_b32 s75, 172032
 s_mov_b32 s53, 192512
 s_waitcnt vmcnt(0)
 s_barrier
CB1F_top:
 ds_read_b128 v[64:67], v7 offset:0
 ds_read_b128 v[68:71], v7 offset:1024
 ds_read_b128 v[72:75], v7 offset:2048
 ds_read_b128 v[76:79], v7 offset:3072
 ds_read_b128 v[80:83], v7 offset:4096
 ds_read_b128 v[84:87], v7 offset:5120
 ds_read_b128 v[88:91], v7 offset:6144
 ds_read_b128 v[92:95], v7 offset:7168
 ds_read_b128 v[96:99], v7 offset:8192
 ds_read_b128 v[100:103], v7 offset:9216
 ds_read_b128 v[104:107], v7 offset:10240
 ds_read_b128 v[108:111], v7 offset:11264
 v_mov_b32 v40, 0
 v_mov_b32 v41, 0
 v_mov_b32 v42, 0
 v_mov_b32 v43, 0
 v_mov_b32 v44, 0
 v_mov_b32 v45, 0
 v_mov_b32 v46, 0
 v_mov_b32 v47, 0
 v_mov_b32 v48, 0
 v_mov_b32 v49, 0
 v_mov_b32 v50, 0
 v_mov_b32 v51, 0
 v_mov_b32 v52, 0
 v_mov_b32 v53, 0
 v_mov_b32 v54, 0
 v_mov_b32 v55, 0
 s_add_u32 s54, s50, 1
 v_mov_b32 v5, s54
 s_mul_i32 s56, s50, 458752
 s_add_u32 s56, s56, s44
 s_add_u32 s57, s56, 16384
 s_waitcnt lgkmcnt(0)
CB1F_bm:
 s_barrier
 ds_read_b128 v[12:15], v1 offset:12288
 ds_read_b128 v[16:19], v1 offset:13312
 ds_read_b128 v[20:23], v1 offset:14336
 ds_read_b128 v[24:27], v1 offset:15360
 ds_read_b128 v[28:31], v1 offset:16384
 ds_read_b128 v[32:35], v1 offset:17408
 ds_read_b128 v[36:39], v1 offset:18432
CB1F_gemm:
 s_waitcnt lgkmcnt(6)
 v_smfmac_f32_16x16x64_bf16 v[40:43], v[12:15], v[64:71], v2
 s_waitcnt lgkmcnt(5)
 v_smfmac_f32_16x16x64_bf16 v[40:43], v[16:19], v[72:79], v2
 s_waitcnt lgkmcnt(4)
 v_smfmac_f32_16x16x64_bf16 v[40:43], v[20:23], v[80:87], v2
 v_max3_u32 v11, v12, v16, v20
 s_waitcnt lgkmcnt(3)
 v_smfmac_f32_16x16x64_bf16 v[40:43], v[24:27], v[88:95], v2
 s_waitcnt lgkmcnt(2)
 v_smfmac_f32_16x16x64_bf16 v[40:43], v[28:31], v[96:103], v2
 v_max3_u32 v11, v11, v24, v28
 s_waitcnt lgkmcnt(1)
 v_smfmac_f32_16x16x64_bf16 v[40:43], v[32:35], v[104:111], v2
 s_waitcnt lgkmcnt(0)
 v_smfmac_f32_16x16x64_bf16 v[40:43], v[36:39], a[0:7], v2
 v_max3_u32 v11, v11, v32, v36
 v_smfmac_f32_16x16x64_bf16 v[44:47], v[12:15], a[8:15], v2
 v_cmp_eq_u32 vcc, -1, v11
 v_smfmac_f32_16x16x64_bf16 v[44:47], v[16:19], a[16:23], v2
 v_smfmac_f32_16x16x64_bf16 v[44:47], v[20:23], a[24:31], v2
 s_cbranch_vccnz CB1F_q
CB1F_qc:
 v_smfmac_f32_16x16x64_bf16 v[44:47], v[24:27], a[32:39], v2
 v_add_f32 v40, v40, v42
 v_smfmac_f32_16x16x64_bf16 v[44:47], v[28:31], a[40:47], v2
 v_add_f32 v41, v41, v43
 v_smfmac_f32_16x16x64_bf16 v[44:47], v[32:35], a[48:55], v2
 v_cmp_u_f32 vcc, v40, v41
 v_smfmac_f32_16x16x64_bf16 v[44:47], v[36:39], a[56:63], v2
 s_nop 0
 v_smfmac_f32_16x16x64_bf16 v[48:51], v[12:15], a[64:71], v2
 s_cbranch_vccnz CB1F_slow
CB1F_cont:
 v_smfmac_f32_16x16x64_bf16 v[48:51], v[16:19], a[72:79], v2
 buffer_load_dwordx4 v[64:67], v1, s[16:19], s56 offen offset:0 sc1
 v_cvt_pk_bf16_f32 v56, v40, v41
 v_smfmac_f32_16x16x64_bf16 v[48:51], v[20:23], a[80:87], v2
 v_mov_b32 v40, 0
 v_mov_b32 v41, 0
 v_smfmac_f32_16x16x64_bf16 v[48:51], v[24:27], a[88:95], v2
 buffer_load_dwordx4 v[68:71], v1, s[16:19], s56 offen offset:1024 sc1
 v_mov_b32 v42, 0
 v_smfmac_f32_16x16x64_bf16 v[48:51], v[28:31], a[96:103], v2
 v_mov_b32 v43, 0
 v_add_f32 v44, v44, v46
 v_smfmac_f32_16x16x64_bf16 v[48:51], v[32:35], a[104:111], v2
 buffer_load_dwordx4 v[80:83], v1, s[16:19], s56 offen offset:2048 sc1
 v_add_f32 v45, v45, v47
 v_smfmac_f32_16x16x64_bf16 v[48:51], v[36:39], a[112:119], v2
 v_cvt_pk_bf16_f32 v57, v44, v45
 v_mov_b32 v44, 0
 v_smfmac_f32_16x16x64_bf16 v[52:55], v[12:15], a[120:127], v2
 buffer_load_dwordx4 v[84:87], v1, s[16:19], s56 offen offset:3072 sc1
 v_mov_b32 v45, 0
 v_smfmac_f32_16x16x64_bf16 v[52:55], v[16:19], a[128:135], v2
 v_mov_b32 v46, 0
 v_mov_b32 v47, 0
 v_smfmac_f32_16x16x64_bf16 v[52:55], v[20:23], a[136:143], v2
 buffer_load_dwordx4 v[72:75], v1, s[16:19], s57 offen offset:0 sc1
 v_add_f32 v48, v48, v50
 v_smfmac_f32_16x16x64_bf16 v[52:55], v[24:27], a[144:151], v2
 v_add_f32 v49, v49, v51
 v_cvt_pk_bf16_f32 v58, v48, v49
 v_smfmac_f32_16x16x64_bf16 v[52:55], v[28:31], a[152:159], v2
 buffer_load_dwordx4 v[76:79], v1, s[16:19], s57 offen offset:1024 sc1
 v_mov_b32 v48, 0
 v_smfmac_f32_16x16x64_bf16 v[52:55], v[32:35], a[160:167], v2
 v_mov_b32 v49, 0
 v_mov_b32 v50, 0
 v_smfmac_f32_16x16x64_bf16 v[52:55], v[36:39], a[168:175], v2
 buffer_load_dwordx4 v[88:91], v1, s[16:19], s57 offen offset:2048 sc1
 v_mov_b32 v51, 0
 v_smfmac_f32_16x16x64_bf16 v[40:43], v[12:15], a[176:183], v2
 v_smfmac_f32_16x16x64_bf16 v[40:43], v[16:19], a[184:191], v2
 buffer_load_dwordx4 v[92:95], v1, s[16:19], s57 offen offset:3072 sc1
 v_add_f32 v52, v52, v54
 v_smfmac_f32_16x16x64_bf16 v[40:43], v[20:23], a[192:199], v2
 v_add_f32 v53, v53, v55
 v_cvt_pk_bf16_f32 v59, v52, v53
 v_smfmac_f32_16x16x64_bf16 v[40:43], v[24:27], a[200:207], v2
 v_mov_b32 v52, 0
 v_mov_b32 v53, 0
 v_smfmac_f32_16x16x64_bf16 v[40:43], v[28:31], a[208:215], v2
 v_mov_b32 v54, 0
 v_mov_b32 v55, 0
 v_smfmac_f32_16x16x64_bf16 v[40:43], v[32:35], a[216:223], v2
 v_smfmac_f32_16x16x64_bf16 v[40:43], v[36:39], a[224:231], v2
 v_smfmac_f32_16x16x64_bf16 v[44:47], v[12:15], a[232:239], v2
 v_smfmac_f32_16x16x64_bf16 v[44:47], v[16:19], a[240:247], v2
 v_add_f32 v40, v40, v42
 v_add_f32 v41, v41, v43
 v_smfmac_f32_16x16x64_bf16 v[44:47], v[20:23], a[248:255], v2
 v_cvt_pk_bf16_f32 v60, v40, v41
 v_smfmac_f32_16x16x64_bf16 v[44:47], v[24:27], v[112:119], v2
 v_smfmac_f32_16x16x64_bf16 v[44:47], v[28:31], v[120:127], v2
 v_smfmac_f32_16x16x64_bf16 v[44:47], v[32:35], v[128:135], v2
 v_smfmac_f32_16x16x64_bf16 v[44:47], v[36:39], v[136:143], v2
 s_nop 7
 v_add_f32 v44, v44, v46
 v_add_f32 v45, v45, v47
 v_cvt_pk_bf16_f32 v61, v44, v45
 s_cmp_eq_u32 s50, 63
 s_cbranch_scc1 CB1F_fin
 s_add_u32 s77, s51, 10240
 s_add_u32 s79, s51, 16896
 v_mov_b32 v40, 0
 v_mov_b32 v41, 0
 v_mov_b32 v42, 0
 v_mov_b32 v43, 0
 v_mov_b32 v44, 0
 v_mov_b32 v45, 0
 v_mov_b32 v46, 0
 v_mov_b32 v47, 0
 s_barrier
 buffer_load_dwordx4 v[96:99], v1, s[16:19], s77 offen offset:0 sc1
 v_smfmac_f32_16x16x64_bf16 v[48:51], v[12:15], v[144:151], v2
 buffer_load_dwordx4 v[100:103], v1, s[16:19], s77 offen offset:1024 sc1
 v_smfmac_f32_16x16x64_bf16 v[48:51], v[16:19], v[152:159], v2
 buffer_load_dwordx2 v[104:105], v3, s[16:19], s79 offen sc1
 v_smfmac_f32_16x16x64_bf16 v[48:51], v[20:23], v[160:167], v2
 v_smfmac_f32_16x16x64_bf16 v[48:51], v[24:27], v[168:175], v2
 v_smfmac_f32_16x16x64_bf16 v[48:51], v[28:31], v[176:183], v2
 v_smfmac_f32_16x16x64_bf16 v[48:51], v[32:35], v[184:191], v2
 v_smfmac_f32_16x16x64_bf16 v[48:51], v[36:39], v[192:199], v2
 v_smfmac_f32_16x16x64_bf16 v[52:55], v[12:15], v[200:207], v2
 v_smfmac_f32_16x16x64_bf16 v[52:55], v[16:19], v[208:215], v2
 v_add_f32 v48, v48, v50
 v_smfmac_f32_16x16x64_bf16 v[52:55], v[20:23], v[216:223], v2
 v_add_f32 v49, v49, v51
 v_smfmac_f32_16x16x64_bf16 v[52:55], v[24:27], v[224:231], v2
 v_cvt_pk_bf16_f32 v62, v48, v49
 v_smfmac_f32_16x16x64_bf16 v[52:55], v[28:31], v[232:239], v2
 v_smfmac_f32_16x16x64_bf16 v[52:55], v[32:35], v[240:247], v2
 v_smfmac_f32_16x16x64_bf16 v[52:55], v[36:39], v[248:255], v2
 s_nop 7
 v_add_f32 v48, v52, v54
 v_add_f32 v49, v53, v55
 v_cvt_pk_bf16_f32 v63, v48, v49
CB1F_pgo:
 s_waitcnt vmcnt(2)
 v_smfmac_f32_16x16x64_bf16 v[40:43], v[96:99], v[64:71], v2
 v_max3_u32 v11, v96, v97, v98
 v_smfmac_f32_16x16x64_bf16 v[44:47], v[96:99], v[72:79], v2
 v_max_u32 v11, v11, v99
 s_waitcnt vmcnt(1)
 v_smfmac_f32_16x16x64_bf16 v[40:43], v[100:103], v[80:87], v2
 v_max3_u32 v11, v11, v100, v101
 v_smfmac_f32_16x16x64_bf16 v[44:47], v[100:103], v[88:95], v2
 v_max3_u32 v11, v11, v102, v103
 s_waitcnt vmcnt(0)
 v_max3_u32 v11, v11, v104, v105
 v_smfmac_f32_16x16x32_bf16 v[40:43], v[104:105], v[56:59], v2
 v_cmp_eq_u32 vcc, -1, v11
 v_smfmac_f32_16x16x32_bf16 v[44:47], v[104:105], v[60:63], v2
 s_nop 3
 v_pk_add_f32 v[40:41], v[40:41], v[42:43]
 s_nop 2
 v_pk_add_f32 v[42:43], v[44:45], v[46:47]
 ds_write_b128 v1, v[40:43] offset:21504
 s_cbranch_vccnz CB1F_pre
CB1F_pvok:
 s_waitcnt lgkmcnt(0)
 s_barrier
 s_cmp_lg_u32 s50, 62
 s_cbranch_scc1 CB1F_nu
 s_cmp_lg_u32 s42, 0
 s_cbranch_scc1 CB1F_nu
 s_mov_b32 s54, 1
 s_mov_b32 s55, 122368
 s_atomic_or s54, s[16:17], s55
CB1F_nu:
 s_add_u32 s50, s50, 1
 s_mov_b32 s54, s53
 s_mov_b32 s53, s51
 s_mov_b32 s51, s52
 s_mov_b32 s52, s75
 s_mov_b32 s75, s54
 s_branch CB1F_top
CB1F_slow:
 s_cmp_eq_u32 s60, s50
 s_cbranch_scc1 CB1F_cont
 s_add_u32 s55, s51, 4096
CB1F_sl:
 buffer_load_dwordx4 v[12:15], v1, s[16:19], s51 offen offset:0 sc1
 buffer_load_dwordx4 v[16:19], v1, s[16:19], s51 offen offset:1024 sc1
 buffer_load_dwordx4 v[20:23], v1, s[16:19], s51 offen offset:2048 sc1
 buffer_load_dwordx4 v[24:27], v1, s[16:19], s51 offen offset:3072 sc1
 buffer_load_dwordx4 v[28:31], v1, s[16:19], s55 offen offset:0 sc1
 buffer_load_dwordx4 v[32:35], v1, s[16:19], s55 offen offset:1024 sc1
 buffer_load_dwordx4 v[36:39], v1, s[16:19], s55 offen offset:2048 sc1
 s_waitcnt vmcnt(0)
 v_mov_b32 v41, 0
 v_and_b32 v40, s74, v12
 v_pk_max_u16 v41, v41, v40
 v_and_b32 v40, s74, v13
 v_pk_max_u16 v41, v41, v40
 v_and_b32 v40, s74, v14
 v_pk_max_u16 v41, v41, v40
 v_and_b32 v40, s74, v15
 v_pk_max_u16 v41, v41, v40
 v_and_b32 v40, s74, v16
 v_pk_max_u16 v41, v41, v40
 v_and_b32 v40, s74, v17
 v_pk_max_u16 v41, v41, v40
 v_and_b32 v40, s74, v18
 v_pk_max_u16 v41, v41, v40
 v_and_b32 v40, s74, v19
 v_pk_max_u16 v41, v41, v40
 v_and_b32 v40, s74, v20
 v_pk_max_u16 v41, v41, v40
 v_and_b32 v40, s74, v21
 v_pk_max_u16 v41, v41, v40
 v_and_b32 v40, s74, v22
 v_pk_max_u16 v41, v41, v40
 v_and_b32 v40, s74, v23
 v_pk_max_u16 v41, v41, v40
 v_and_b32 v40, s74, v24
 v_pk_max_u16 v41, v41, v40
 v_and_b32 v40, s74, v25
 v_pk_max_u16 v41, v41, v40
 v_and_b32 v40, s74, v26
 v_pk_max_u16 v41, v41, v40
 v_and_b32 v40, s74, v27
 v_pk_max_u16 v41, v41, v40
 v_and_b32 v40, s74, v28
 v_pk_max_u16 v41, v41, v40
 v_and_b32 v40, s74, v29
 v_pk_max_u16 v41, v41, v40
 v_and_b32 v40, s74, v30
 v_pk_max_u16 v41, v41, v40
 v_and_b32 v40, s74, v31
 v_pk_max_u16 v41, v41, v40
 v_and_b32 v40, s74, v32
 v_pk_max_u16 v41, v41, v40
 v_and_b32 v40, s74, v33
 v_pk_max_u16 v41, v41, v40
 v_and_b32 v40, s74, v34
 v_pk_max_u16 v41, v41, v40
 v_and_b32 v40, s74, v35
 v_pk_max_u16 v41, v41, v40
 v_and_b32 v40, s74, v36
 v_pk_max_u16 v41, v41, v40
 v_and_b32 v40, s74, v37
 v_pk_max_u16 v41, v41, v40
 v_and_b32 v40, s74, v38
 v_pk_max_u16 v41, v41, v40
 v_and_b32 v40, s74, v39
 v_pk_max_u16 v41, v41, v40
 v_lshrrev_b32 v40, 16, v41
 v_and_b32 v41, 0xffff, v41
 v_max_u32 v40, v40, v41
 v_cmp_lt_u32 vcc, 0x7f81, v40
 s_cbranch_vccz CB1F_sok
 s_max_u32 s68, s68, 1
 s_sub_u32 s68, s68, 1
 s_cmp_lg_u32 s68, 0
 s_cbranch_scc1 CB1F_sl
CB1F_sok:
 s_mov_b32 s60, s50
 s_waitcnt lgkmcnt(0)
 v_mov_b32 v40, 0
 v_mov_b32 v41, 0
 v_mov_b32 v42, 0
 v_mov_b32 v43, 0
 v_mov_b32 v44, 0
 v_mov_b32 v45, 0
 v_mov_b32 v46, 0
 v_mov_b32 v47, 0
 v_mov_b32 v48, 0
 v_mov_b32 v49, 0
 v_mov_b32 v50, 0
 v_mov_b32 v51, 0
 v_mov_b32 v52, 0
 v_mov_b32 v53, 0
 v_mov_b32 v54, 0
 v_mov_b32 v55, 0
 s_branch CB1F_gemm
CB1F_q:
 s_sub_u32 s67, s67, 1
 s_cmp_lt_i32 s67, 0
 s_cbranch_scc1 CB1F_qc
 s_barrier
 v_mov_b32 v40, 0
 v_mov_b32 v41, 0
 v_mov_b32 v42, 0
 v_mov_b32 v43, 0
 v_mov_b32 v44, 0
 v_mov_b32 v45, 0
 v_mov_b32 v46, 0
 v_mov_b32 v47, 0
 v_mov_b32 v48, 0
 v_mov_b32 v49, 0
 v_mov_b32 v50, 0
 v_mov_b32 v51, 0
 s_branch CB1F_bm
CB1F_fin:
 s_add_u32 s70, s47, 7225344
 s_add_u32 s71, s70, 4096
 v_smfmac_f32_16x16x64_bf16 v[48:51], v[12:15], v[144:151], v2
 v_smfmac_f32_16x16x64_bf16 v[48:51], v[16:19], v[152:159], v2
 v_smfmac_f32_16x16x64_bf16 v[48:51], v[20:23], v[160:167], v2
 v_smfmac_f32_16x16x64_bf16 v[48:51], v[24:27], v[168:175], v2
 v_smfmac_f32_16x16x64_bf16 v[48:51], v[28:31], v[176:183], v2
 v_smfmac_f32_16x16x64_bf16 v[48:51], v[32:35], v[184:191], v2
 v_smfmac_f32_16x16x64_bf16 v[48:51], v[36:39], v[192:199], v2
 s_nop 7
 v_add_f32 v48, v48, v50
 v_add_f32 v49, v49, v51
 v_cvt_pk_bf16_f32 v62, v48, v49
 v_smfmac_f32_16x16x64_bf16 v[52:55], v[12:15], v[200:207], v2
 v_smfmac_f32_16x16x64_bf16 v[52:55], v[16:19], v[208:215], v2
 v_smfmac_f32_16x16x64_bf16 v[52:55], v[20:23], v[216:223], v2
 v_smfmac_f32_16x16x64_bf16 v[52:55], v[24:27], v[224:231], v2
 v_smfmac_f32_16x16x64_bf16 v[52:55], v[28:31], v[232:239], v2
 v_smfmac_f32_16x16x64_bf16 v[52:55], v[32:35], v[240:247], v2
 v_smfmac_f32_16x16x64_bf16 v[52:55], v[36:39], v[248:255], v2
 s_nop 7
 v_add_f32 v52, v52, v54
 v_add_f32 v53, v53, v55
 v_cvt_pk_bf16_f32 v63, v52, v53
 v_min_u32 v56, -2, v56
 v_min_u32 v57, -2, v57
 v_min_u32 v58, -2, v58
 v_min_u32 v59, -2, v59
 v_min_u32 v60, -2, v60
 v_min_u32 v61, -2, v61
 v_min_u32 v62, -2, v62
 v_min_u32 v63, -2, v63
 buffer_store_dwordx4 v[56:59], v1, s[16:19], s70 offen sc1
 buffer_store_dwordx4 v[60:63], v1, s[16:19], s71 offen sc1
 s_branch CB1F_end
CB1F_pre:
 s_max_u32 s68, s68, 1
 s_sub_u32 s68, s68, 1
 s_cmp_lg_u32 s68, 0
 s_cbranch_scc0 CB1F_pvok
 s_mov_b32 s61, s50
 buffer_load_dwordx4 v[96:99], v1, s[16:19], s77 offen offset:0 sc1
 buffer_load_dwordx4 v[100:103], v1, s[16:19], s77 offen offset:1024 sc1
 buffer_load_dwordx2 v[104:105], v3, s[16:19], s79 offen sc1
 s_nop 7
 v_mov_b32 v40, 0
 v_mov_b32 v41, 0
 v_mov_b32 v42, 0
 v_mov_b32 v43, 0
 v_mov_b32 v44, 0
 v_mov_b32 v45, 0
 v_mov_b32 v46, 0
 v_mov_b32 v47, 0
 s_branch CB1F_pgo
CB1F_end:
 s_endpgm
.p2align 6
CB2F_start:
 s_mov_b32 s50, 0
 s_mov_b32 s60, 0
 s_mov_b32 s61, -1
 s_mov_b32 s96, 0
 s_mov_b32 s97, 0
 s_mov_b32 s67, 4096
 s_mov_b32 s51, 131072
 s_mov_b32 s52, 151552
 s_mov_b32 s75, 172032
 s_mov_b32 s53, 192512
 s_waitcnt vmcnt(0)
 s_barrier
CB2F_top:
 ds_read_b128 v[64:67], v7 offset:0
 ds_read_b128 v[68:71], v7 offset:1024
 ds_read_b128 v[72:75], v7 offset:2048
 ds_read_b128 v[76:79], v7 offset:3072
 ds_read_b128 v[80:83], v7 offset:4096
 ds_read_b128 v[84:87], v7 offset:5120
 ds_read_b128 v[88:91], v7 offset:6144
 ds_read_b128 v[92:95], v7 offset:7168
 ds_read_b128 v[96:99], v7 offset:8192
 ds_read_b128 v[100:103], v7 offset:9216
 ds_read_b128 v[104:107], v7 offset:10240
 ds_read_b128 v[108:111], v7 offset:11264
 v_mov_b32 v40, 0
 v_mov_b32 v41, 0
 v_mov_b32 v42, 0
 v_mov_b32 v43, 0
 v_mov_b32 v44, 0
 v_mov_b32 v45, 0
 v_mov_b32 v46, 0
 v_mov_b32 v47, 0
 v_mov_b32 v48, 0
 v_mov_b32 v49, 0
 v_mov_b32 v50, 0
 v_mov_b32 v51, 0
 v_mov_b32 v52, 0
 v_mov_b32 v53, 0
 v_mov_b32 v54, 0
 v_mov_b32 v55, 0
 s_add_u32 s54, s50, 1
 v_mov_b32 v5, s54
 s_mul_i32 s56, s50, 458752
 s_add_u32 s56, s56, s44
 s_add_u32 s57, s56, 16384
 s_waitcnt lgkmcnt(0)
CB2F_bm:
 s_barrier
 ds_read_b128 v[12:15], v1 offset:12288
 ds_read_b128 v[16:19], v1 offset:13312
 ds_read_b128 v[20:23], v1 offset:14336
 ds_read_b128 v[24:27], v1 offset:15360
 ds_read_b128 v[28:31], v1 offset:16384
 ds_read_b128 v[32:35], v1 offset:17408
 ds_read_b128 v[36:39], v1 offset:18432
CB2F_gemm:
 s_waitcnt lgkmcnt(6)
 v_smfmac_f32_16x16x64_bf16 v[40:43], v[12:15], v[64:71], v2
 s_waitcnt lgkmcnt(5)
 v_smfmac_f32_16x16x64_bf16 v[40:43], v[16:19], v[72:79], v2
 s_waitcnt lgkmcnt(4)
 v_smfmac_f32_16x16x64_bf16 v[40:43], v[20:23], v[80:87], v2
 v_max3_u32 v11, v12, v16, v20
 s_waitcnt lgkmcnt(3)
 v_smfmac_f32_16x16x64_bf16 v[40:43], v[24:27], v[88:95], v2
 s_waitcnt lgkmcnt(2)
 v_smfmac_f32_16x16x64_bf16 v[40:43], v[28:31], v[96:103], v2
 v_max3_u32 v11, v11, v24, v28
 s_waitcnt lgkmcnt(1)
 v_smfmac_f32_16x16x64_bf16 v[40:43], v[32:35], v[104:111], v2
 s_waitcnt lgkmcnt(0)
 v_smfmac_f32_16x16x64_bf16 v[40:43], v[36:39], a[0:7], v2
 v_max3_u32 v11, v11, v32, v36
 v_smfmac_f32_16x16x64_bf16 v[44:47], v[12:15], a[8:15], v2
 v_cmp_eq_u32 vcc, -1, v11
 v_smfmac_f32_16x16x64_bf16 v[44:47], v[16:19], a[16:23], v2
 v_smfmac_f32_16x16x64_bf16 v[44:47], v[20:23], a[24:31], v2
 s_cbranch_vccnz CB2F_q
CB2F_qc:
 v_smfmac_f32_16x16x64_bf16 v[44:47], v[24:27], a[32:39], v2
 v_add_f32 v40, v40, v42
 v_smfmac_f32_16x16x64_bf16 v[44:47], v[28:31], a[40:47], v2
 v_add_f32 v41, v41, v43
 v_smfmac_f32_16x16x64_bf16 v[44:47], v[32:35], a[48:55], v2
 v_cmp_u_f32 vcc, v40, v41
 v_smfmac_f32_16x16x64_bf16 v[44:47], v[36:39], a[56:63], v2
 s_nop 0
 v_smfmac_f32_16x16x64_bf16 v[48:51], v[12:15], a[64:71], v2
 s_cbranch_vccnz CB2F_slow
CB2F_cont:
 v_smfmac_f32_16x16x64_bf16 v[48:51], v[16:19], a[72:79], v2
 buffer_load_dwordx4 v[64:67], v1, s[16:19], s56 offen offset:0 sc1
 v_cvt_pk_bf16_f32 v56, v40, v41
 v_smfmac_f32_16x16x64_bf16 v[48:51], v[20:23], a[80:87], v2
 v_mov_b32 v40, 0
 v_mov_b32 v41, 0
 v_smfmac_f32_16x16x64_bf16 v[48:51], v[24:27], a[88:95], v2
 buffer_load_dwordx4 v[68:71], v1, s[16:19], s56 offen offset:1024 sc1
 v_mov_b32 v42, 0
 v_smfmac_f32_16x16x64_bf16 v[48:51], v[28:31], a[96:103], v2
 v_mov_b32 v43, 0
 v_add_f32 v44, v44, v46
 v_smfmac_f32_16x16x64_bf16 v[48:51], v[32:35], a[104:111], v2
 buffer_load_dwordx4 v[80:83], v1, s[16:19], s56 offen offset:2048 sc1
 v_add_f32 v45, v45, v47
 v_smfmac_f32_16x16x64_bf16 v[48:51], v[36:39], a[112:119], v2
 v_cvt_pk_bf16_f32 v57, v44, v45
 v_mov_b32 v44, 0
 v_smfmac_f32_16x16x64_bf16 v[52:55], v[12:15], a[120:127], v2
 buffer_load_dwordx4 v[84:87], v1, s[16:19], s56 offen offset:3072 sc1
 v_mov_b32 v45, 0
 v_smfmac_f32_16x16x64_bf16 v[52:55], v[16:19], a[128:135], v2
 v_mov_b32 v46, 0
 v_mov_b32 v47, 0
 v_smfmac_f32_16x16x64_bf16 v[52:55], v[20:23], a[136:143], v2
 buffer_load_dwordx4 v[72:75], v1, s[16:19], s57 offen offset:0 sc1
 v_add_f32 v48, v48, v50
 v_smfmac_f32_16x16x64_bf16 v[52:55], v[24:27], a[144:151], v2
 v_add_f32 v49, v49, v51
 v_cvt_pk_bf16_f32 v58, v48, v49
 v_smfmac_f32_16x16x64_bf16 v[52:55], v[28:31], a[152:159], v2
 buffer_load_dwordx4 v[76:79], v1, s[16:19], s57 offen offset:1024 sc1
 v_mov_b32 v48, 0
 v_smfmac_f32_16x16x64_bf16 v[52:55], v[32:35], a[160:167], v2
 v_mov_b32 v49, 0
 v_mov_b32 v50, 0
 v_smfmac_f32_16x16x64_bf16 v[52:55], v[36:39], a[168:175], v2
 buffer_load_dwordx4 v[88:91], v1, s[16:19], s57 offen offset:2048 sc1
 v_mov_b32 v51, 0
 v_smfmac_f32_16x16x64_bf16 v[40:43], v[12:15], a[176:183], v2
 v_smfmac_f32_16x16x64_bf16 v[40:43], v[16:19], a[184:191], v2
 buffer_load_dwordx4 v[92:95], v1, s[16:19], s57 offen offset:3072 sc1
 v_add_f32 v52, v52, v54
 v_smfmac_f32_16x16x64_bf16 v[40:43], v[20:23], a[192:199], v2
 v_add_f32 v53, v53, v55
 v_cvt_pk_bf16_f32 v59, v52, v53
 v_smfmac_f32_16x16x64_bf16 v[40:43], v[24:27], a[200:207], v2
 v_mov_b32 v52, 0
 v_mov_b32 v53, 0
 v_smfmac_f32_16x16x64_bf16 v[40:43], v[28:31], a[208:215], v2
 v_mov_b32 v54, 0
 v_mov_b32 v55, 0
 v_smfmac_f32_16x16x64_bf16 v[40:43], v[32:35], a[216:223], v2
 v_smfmac_f32_16x16x64_bf16 v[40:43], v[36:39], a[224:231], v2
 v_smfmac_f32_16x16x64_bf16 v[44:47], v[12:15], a[232:239], v2
 v_smfmac_f32_16x16x64_bf16 v[44:47], v[16:19], a[240:247], v2
 v_add_f32 v40, v40, v42
 v_add_f32 v41, v41, v43
 v_smfmac_f32_16x16x64_bf16 v[44:47], v[20:23], a[248:255], v2
 v_cvt_pk_bf16_f32 v60, v40, v41
 v_smfmac_f32_16x16x64_bf16 v[44:47], v[24:27], v[112:119], v2
 v_smfmac_f32_16x16x64_bf16 v[44:47], v[28:31], v[120:127], v2
 v_smfmac_f32_16x16x64_bf16 v[44:47], v[32:35], v[128:135], v2
 v_smfmac_f32_16x16x64_bf16 v[44:47], v[36:39], v[136:143], v2
 s_nop 7
 v_add_f32 v44, v44, v46
 v_add_f32 v45, v45, v47
 v_cvt_pk_bf16_f32 v61, v44, v45
 s_cmp_eq_u32 s50, 63
 s_cbranch_scc1 CB2F_fin
 s_add_u32 s77, s51, 12288
 s_add_u32 s79, s51, 17408
 v_mov_b32 v40, 0
 v_mov_b32 v41, 0
 v_mov_b32 v42, 0
 v_mov_b32 v43, 0
 v_mov_b32 v44, 0
 v_mov_b32 v45, 0
 v_mov_b32 v46, 0
 v_mov_b32 v47, 0
 s_barrier
 buffer_load_dwordx4 v[96:99], v1, s[16:19], s77 offen offset:0 sc1
 v_smfmac_f32_16x16x64_bf16 v[48:51], v[12:15], v[144:151], v2
 buffer_load_dwordx4 v[100:103], v1, s[16:19], s77 offen offset:1024 sc1
 v_smfmac_f32_16x16x64_bf16 v[48:51], v[16:19], v[152:159], v2
 buffer_load_dwordx2 v[104:105], v3, s[16:19], s79 offen sc1
 v_smfmac_f32_16x16x64_bf16 v[48:51], v[20:23], v[160:167], v2
 v_smfmac_f32_16x16x64_bf16 v[48:51], v[24:27], v[168:175], v2
 v_smfmac_f32_16x16x64_bf16 v[48:51], v[28:31], v[176:183], v2
 v_smfmac_f32_16x16x64_bf16 v[48:51], v[32:35], v[184:191], v2
 v_smfmac_f32_16x16x64_bf16 v[48:51], v[36:39], v[192:199], v2
 v_smfmac_f32_16x16x64_bf16 v[52:55], v[12:15], v[200:207], v2
 v_smfmac_f32_16x16x64_bf16 v[52:55], v[16:19], v[208:215], v2
 v_add_f32 v48, v48, v50
 v_smfmac_f32_16x16x64_bf16 v[52:55], v[20:23], v[216:223], v2
 v_add_f32 v49, v49, v51
 v_smfmac_f32_16x16x64_bf16 v[52:55], v[24:27], v[224:231], v2
 v_cvt_pk_bf16_f32 v62, v48, v49
 v_smfmac_f32_16x16x64_bf16 v[52:55], v[28:31], v[232:239], v2
 v_smfmac_f32_16x16x64_bf16 v[52:55], v[32:35], v[240:247], v2
 v_smfmac_f32_16x16x64_bf16 v[52:55], v[36:39], v[248:255], v2
 s_nop 7
 v_add_f32 v48, v52, v54
 v_add_f32 v49, v53, v55
 v_cvt_pk_bf16_f32 v63, v48, v49
CB2F_pgo:
 s_waitcnt vmcnt(2)
 v_smfmac_f32_16x16x64_bf16 v[40:43], v[96:99], v[64:71], v2
 v_max3_u32 v11, v96, v97, v98
 v_smfmac_f32_16x16x64_bf16 v[44:47], v[96:99], v[72:79], v2
 v_max_u32 v11, v11, v99
 s_waitcnt vmcnt(1)
 v_smfmac_f32_16x16x64_bf16 v[40:43], v[100:103], v[80:87], v2
 v_max3_u32 v11, v11, v100, v101
 v_smfmac_f32_16x16x64_bf16 v[44:47], v[100:103], v[88:95], v2
 v_max3_u32 v11, v11, v102, v103
 s_waitcnt vmcnt(0)
 v_max3_u32 v11, v11, v104, v105
 v_smfmac_f32_16x16x32_bf16 v[40:43], v[104:105], v[56:59], v2
 v_cmp_eq_u32 vcc, -1, v11
 v_smfmac_f32_16x16x32_bf16 v[44:47], v[104:105], v[60:63], v2
 s_nop 3
 v_pk_add_f32 v[40:41], v[40:41], v[42:43]
 s_nop 2
 v_pk_add_f32 v[42:43], v[44:45], v[46:47]
 ds_write_b128 v1, v[40:43] offset:22528
 s_cbranch_vccnz CB2F_pre
CB2F_pvok:
 s_waitcnt lgkmcnt(0)
 s_barrier
 s_add_u32 s50, s50, 1
 s_mov_b32 s54, s53
 s_mov_b32 s53, s51
 s_mov_b32 s51, s52
 s_mov_b32 s52, s75
 s_mov_b32 s75, s54
 s_branch CB2F_top
CB2F_slow:
 s_cmp_eq_u32 s60, s50
 s_cbranch_scc1 CB2F_cont
 s_add_u32 s55, s51, 4096
CB2F_sl:
 buffer_load_dwordx4 v[12:15], v1, s[16:19], s51 offen offset:0 sc1
 buffer_load_dwordx4 v[16:19], v1, s[16:19], s51 offen offset:1024 sc1
 buffer_load_dwordx4 v[20:23], v1, s[16:19], s51 offen offset:2048 sc1
 buffer_load_dwordx4 v[24:27], v1, s[16:19], s51 offen offset:3072 sc1
 buffer_load_dwordx4 v[28:31], v1, s[16:19], s55 offen offset:0 sc1
 buffer_load_dwordx4 v[32:35], v1, s[16:19], s55 offen offset:1024 sc1
 buffer_load_dwordx4 v[36:39], v1, s[16:19], s55 offen offset:2048 sc1
 s_waitcnt vmcnt(0)
 v_mov_b32 v41, 0
 v_and_b32 v40, s74, v12
 v_pk_max_u16 v41, v41, v40
 v_and_b32 v40, s74, v13
 v_pk_max_u16 v41, v41, v40
 v_and_b32 v40, s74, v14
 v_pk_max_u16 v41, v41, v40
 v_and_b32 v40, s74, v15
 v_pk_max_u16 v41, v41, v40
 v_and_b32 v40, s74, v16
 v_pk_max_u16 v41, v41, v40
 v_and_b32 v40, s74, v17
 v_pk_max_u16 v41, v41, v40
 v_and_b32 v40, s74, v18
 v_pk_max_u16 v41, v41, v40
 v_and_b32 v40, s74, v19
 v_pk_max_u16 v41, v41, v40
 v_and_b32 v40, s74, v20
 v_pk_max_u16 v41, v41, v40
 v_and_b32 v40, s74, v21
 v_pk_max_u16 v41, v41, v40
 v_and_b32 v40, s74, v22
 v_pk_max_u16 v41, v41, v40
 v_and_b32 v40, s74, v23
 v_pk_max_u16 v41, v41, v40
 v_and_b32 v40, s74, v24
 v_pk_max_u16 v41, v41, v40
 v_and_b32 v40, s74, v25
 v_pk_max_u16 v41, v41, v40
 v_and_b32 v40, s74, v26
 v_pk_max_u16 v41, v41, v40
 v_and_b32 v40, s74, v27
 v_pk_max_u16 v41, v41, v40
 v_and_b32 v40, s74, v28
 v_pk_max_u16 v41, v41, v40
 v_and_b32 v40, s74, v29
 v_pk_max_u16 v41, v41, v40
 v_and_b32 v40, s74, v30
 v_pk_max_u16 v41, v41, v40
 v_and_b32 v40, s74, v31
 v_pk_max_u16 v41, v41, v40
 v_and_b32 v40, s74, v32
 v_pk_max_u16 v41, v41, v40
 v_and_b32 v40, s74, v33
 v_pk_max_u16 v41, v41, v40
 v_and_b32 v40, s74, v34
 v_pk_max_u16 v41, v41, v40
 v_and_b32 v40, s74, v35
 v_pk_max_u16 v41, v41, v40
 v_and_b32 v40, s74, v36
 v_pk_max_u16 v41, v41, v40
 v_and_b32 v40, s74, v37
 v_pk_max_u16 v41, v41, v40
 v_and_b32 v40, s74, v38
 v_pk_max_u16 v41, v41, v40
 v_and_b32 v40, s74, v39
 v_pk_max_u16 v41, v41, v40
 v_lshrrev_b32 v40, 16, v41
 v_and_b32 v41, 0xffff, v41
 v_max_u32 v40, v40, v41
 v_cmp_lt_u32 vcc, 0x7f81, v40
 s_cbranch_vccz CB2F_sok
 s_max_u32 s68, s68, 1
 s_sub_u32 s68, s68, 1
 s_cmp_lg_u32 s68, 0
 s_cbranch_scc1 CB2F_sl
CB2F_sok:
 s_mov_b32 s60, s50
 s_waitcnt lgkmcnt(0)
 v_mov_b32 v40, 0
 v_mov_b32 v41, 0
 v_mov_b32 v42, 0
 v_mov_b32 v43, 0
 v_mov_b32 v44, 0
 v_mov_b32 v45, 0
 v_mov_b32 v46, 0
 v_mov_b32 v47, 0
 v_mov_b32 v48, 0
 v_mov_b32 v49, 0
 v_mov_b32 v50, 0
 v_mov_b32 v51, 0
 v_mov_b32 v52, 0
 v_mov_b32 v53, 0
 v_mov_b32 v54, 0
 v_mov_b32 v55, 0
 s_branch CB2F_gemm
CB2F_q:
 s_sub_u32 s67, s67, 1
 s_cmp_lt_i32 s67, 0
 s_cbranch_scc1 CB2F_qc
 s_barrier
 v_mov_b32 v40, 0
 v_mov_b32 v41, 0
 v_mov_b32 v42, 0
 v_mov_b32 v43, 0
 v_mov_b32 v44, 0
 v_mov_b32 v45, 0
 v_mov_b32 v46, 0
 v_mov_b32 v47, 0
 v_mov_b32 v48, 0
 v_mov_b32 v49, 0
 v_mov_b32 v50, 0
 v_mov_b32 v51, 0
 s_branch CB2F_bm
CB2F_fin:
 s_add_u32 s70, s47, 7225344
 s_add_u32 s71, s70, 4096
 v_smfmac_f32_16x16x64_bf16 v[48:51], v[12:15], v[144:151], v2
 v_smfmac_f32_16x16x64_bf16 v[48:51], v[16:19], v[152:159], v2
 v_smfmac_f32_16x16x64_bf16 v[48:51], v[20:23], v[160:167], v2
 v_smfmac_f32_16x16x64_bf16 v[48:51], v[24:27], v[168:175], v2
 v_smfmac_f32_16x16x64_bf16 v[48:51], v[28:31], v[176:183], v2
 v_smfmac_f32_16x16x64_bf16 v[48:51], v[32:35], v[184:191], v2
 v_smfmac_f32_16x16x64_bf16 v[48:51], v[36:39], v[192:199], v2
 s_nop 7
 v_add_f32 v48, v48, v50
 v_add_f32 v49, v49, v51
 v_cvt_pk_bf16_f32 v62, v48, v49
 v_smfmac_f32_16x16x64_bf16 v[52:55], v[12:15], v[200:207], v2
 v_smfmac_f32_16x16x64_bf16 v[52:55], v[16:19], v[208:215], v2
 v_smfmac_f32_16x16x64_bf16 v[52:55], v[20:23], v[216:223], v2
 v_smfmac_f32_16x16x64_bf16 v[52:55], v[24:27], v[224:231], v2
 v_smfmac_f32_16x16x64_bf16 v[52:55], v[28:31], v[232:239], v2
 v_smfmac_f32_16x16x64_bf16 v[52:55], v[32:35], v[240:247], v2
 v_smfmac_f32_16x16x64_bf16 v[52:55], v[36:39], v[248:255], v2
 s_nop 7
 v_add_f32 v52, v52, v54
 v_add_f32 v53, v53, v55
 v_cvt_pk_bf16_f32 v63, v52, v53
 v_min_u32 v56, -2, v56
 v_min_u32 v57, -2, v57
 v_min_u32 v58, -2, v58
 v_min_u32 v59, -2, v59
 v_min_u32 v60, -2, v60
 v_min_u32 v61, -2, v61
 v_min_u32 v62, -2, v62
 v_min_u32 v63, -2, v63
 buffer_store_dwordx4 v[56:59], v1, s[16:19], s70 offen sc1
 buffer_store_dwordx4 v[60:63], v1, s[16:19], s71 offen sc1
 s_branch CB2F_end
CB2F_pre:
 s_max_u32 s68, s68, 1
 s_sub_u32 s68, s68, 1
 s_cmp_lg_u32 s68, 0
 s_cbranch_scc0 CB2F_pvok
 s_mov_b32 s61, s50
 buffer_load_dwordx4 v[96:99], v1, s[16:19], s77 offen offset:0 sc1
 buffer_load_dwordx4 v[100:103], v1, s[16:19], s77 offen offset:1024 sc1
 buffer_load_dwordx2 v[104:105], v3, s[16:19], s79 offen sc1
 s_nop 7
 v_mov_b32 v40, 0
 v_mov_b32 v41, 0
 v_mov_b32 v42, 0
 v_mov_b32 v43, 0
 v_mov_b32 v44, 0
 v_mov_b32 v45, 0
 v_mov_b32 v46, 0
 v_mov_b32 v47, 0
 s_branch CB2F_pgo
CB2F_end:
 s_endpgm
.p2align 6
CB3F_start:
 s_mov_b32 s50, 0
 s_mov_b32 s60, 0
 s_mov_b32 s61, -1
 s_mov_b32 s96, 0
 s_mov_b32 s97, 0
 s_mov_b32 s67, 4096
 s_mov_b32 s51, 131072
 s_mov_b32 s52, 151552
 s_mov_b32 s75, 172032
 s_mov_b32 s53, 192512
 s_waitcnt vmcnt(0)
 s_barrier
CB3F_top:
 s_mov_b32 s69, 16640
 buffer_load_dword v12, v0, s[16:19], s69 offen sc1
 ds_read_b128 v[64:67], v7 offset:0
 ds_read_b128 v[68:71], v7 offset:1024
 ds_read_b128 v[72:75], v7 offset:2048
 ds_read_b128 v[76:79], v7 offset:3072
 ds_read_b128 v[80:83], v7 offset:4096
 ds_read_b128 v[84:87], v7 offset:5120
 ds_read_b128 v[88:91], v7 offset:6144
 buffer_load_dword v13, v0, s[16:19], s69 offen sc1
 ds_read_b128 v[92:95], v7 offset:7168
 ds_read_b128 v[96:99], v7 offset:8192
 ds_read_b128 v[100:103], v7 offset:9216
 ds_read_b128 v[104:107], v7 offset:10240
 ds_read_b128 v[108:111], v7 offset:11264
 v_mov_b32 v40, 0
 v_mov_b32 v41, 0
 buffer_load_dword v14, v0, s[16:19], s69 offen sc1
 v_mov_b32 v42, 0
 v_mov_b32 v43, 0
 v_mov_b32 v44, 0
 v_mov_b32 v45, 0
 v_mov_b32 v46, 0
 v_mov_b32 v47, 0
 v_mov_b32 v48, 0
 buffer_load_dword v15, v0, s[16:19], s69 offen sc1
 v_mov_b32 v49, 0
 v_mov_b32 v50, 0
 v_mov_b32 v51, 0
 v_mov_b32 v52, 0
 v_mov_b32 v53, 0
 v_mov_b32 v54, 0
 v_mov_b32 v55, 0
 s_add_u32 s54, s50, 1
 v_mov_b32 v5, s54
 s_mul_i32 s56, s50, 458752
 s_add_u32 s56, s56, s44
 s_add_u32 s57, s56, 16384
 s_waitcnt lgkmcnt(0)
 s_mov_b32 s69, 16640
 s_add_u32 s55, s51, 4096
 s_mov_b32 m0, 12288
CB3Ffm_pl:
 s_waitcnt vmcnt(3)
 v_cmp_gt_u32 vcc, s50, v12
 s_cbranch_vccz CB3Ffm_pd
 buffer_load_dword v12, v0, s[16:19], s69 offen sc1
 s_waitcnt vmcnt(3)
 v_cmp_gt_u32 vcc, s50, v13
 s_cbranch_vccz CB3Ffm_pd
 buffer_load_dword v13, v0, s[16:19], s69 offen sc1
 s_waitcnt vmcnt(3)
 v_cmp_gt_u32 vcc, s50, v14
 s_cbranch_vccz CB3Ffm_pd
 buffer_load_dword v14, v0, s[16:19], s69 offen sc1
 s_waitcnt vmcnt(3)
 v_cmp_gt_u32 vcc, s50, v15
 s_cbranch_vccz CB3Ffm_pd
 buffer_load_dword v15, v0, s[16:19], s69 offen sc1
 s_max_u32 s68, s68, 1
 s_sub_u32 s68, s68, 1
 s_cmp_lg_u32 s68, 0
 s_cbranch_scc1 CB3Ffm_pl
CB3Ffm_pd:
 buffer_load_dwordx4 v1, s[16:19], s51 offen offset:0 sc1 lds
 buffer_load_dwordx4 v1, s[16:19], s51 offen offset:1024 sc1 lds
 buffer_load_dwordx4 v1, s[16:19], s51 offen offset:2048 sc1 lds
 buffer_load_dwordx4 v1, s[16:19], s51 offen offset:3072 sc1 lds
 s_mov_b32 m0, 16384
 s_nop 0
 buffer_load_dwordx4 v1, s[16:19], s55 offen offset:0 sc1 lds
 buffer_load_dwordx4 v1, s[16:19], s55 offen offset:1024 sc1 lds
 buffer_load_dwordx4 v1, s[16:19], s55 offen offset:2048 sc1 lds
 s_waitcnt vmcnt(0)
CB3F_bm:
 s_barrier
 ds_read_b128 v[12:15], v1 offset:12288
 ds_read_b128 v[16:19], v1 offset:13312
 ds_read_b128 v[20:23], v1 offset:14336
 ds_read_b128 v[24:27], v1 offset:15360
 ds_read_b128 v[28:31], v1 offset:16384
 ds_read_b128 v[32:35], v1 offset:17408
 ds_read_b128 v[36:39], v1 offset:18432
CB3F_gemm:
 s_waitcnt lgkmcnt(6)
 v_smfmac_f32_16x16x64_bf16 v[40:43], v[12:15], v[64:71], v2
 s_waitcnt lgkmcnt(5)
 v_smfmac_f32_16x16x64_bf16 v[40:43], v[16:19], v[72:79], v2
 s_waitcnt lgkmcnt(4)
 v_smfmac_f32_16x16x64_bf16 v[40:43], v[20:23], v[80:87], v2
 v_max3_u32 v11, v12, v16, v20
 s_waitcnt lgkmcnt(3)
 v_smfmac_f32_16x16x64_bf16 v[40:43], v[24:27], v[88:95], v2
 s_waitcnt lgkmcnt(2)
 v_smfmac_f32_16x16x64_bf16 v[40:43], v[28:31], v[96:103], v2
 v_max3_u32 v11, v11, v24, v28
 s_waitcnt lgkmcnt(1)
 v_smfmac_f32_16x16x64_bf16 v[40:43], v[32:35], v[104:111], v2
 s_waitcnt lgkmcnt(0)
 v_smfmac_f32_16x16x64_bf16 v[40:43], v[36:39], a[0:7], v2
 v_max3_u32 v11, v11, v32, v36
 v_smfmac_f32_16x16x64_bf16 v[44:47], v[12:15], a[8:15], v2
 v_cmp_eq_u32 vcc, -1, v11
 v_smfmac_f32_16x16x64_bf16 v[44:47], v[16:19], a[16:23], v2
 v_smfmac_f32_16x16x64_bf16 v[44:47], v[20:23], a[24:31], v2
 s_cbranch_vccnz CB3F_q
CB3F_qc:
 v_smfmac_f32_16x16x64_bf16 v[44:47], v[24:27], a[32:39], v2
 v_add_f32 v40, v40, v42
 v_smfmac_f32_16x16x64_bf16 v[44:47], v[28:31], a[40:47], v2
 v_add_f32 v41, v41, v43
 v_smfmac_f32_16x16x64_bf16 v[44:47], v[32:35], a[48:55], v2
 v_cmp_u_f32 vcc, v40, v41
 v_smfmac_f32_16x16x64_bf16 v[44:47], v[36:39], a[56:63], v2
 s_nop 0
 v_smfmac_f32_16x16x64_bf16 v[48:51], v[12:15], a[64:71], v2
 s_cbranch_vccnz CB3F_slow
CB3F_cont:
 v_smfmac_f32_16x16x64_bf16 v[48:51], v[16:19], a[72:79], v2
 buffer_load_dwordx4 v[64:67], v1, s[16:19], s56 offen offset:0 sc1
 v_cvt_pk_bf16_f32 v56, v40, v41
 v_smfmac_f32_16x16x64_bf16 v[48:51], v[20:23], a[80:87], v2
 v_mov_b32 v40, 0
 v_mov_b32 v41, 0
 v_smfmac_f32_16x16x64_bf16 v[48:51], v[24:27], a[88:95], v2
 buffer_load_dwordx4 v[68:71], v1, s[16:19], s56 offen offset:1024 sc1
 v_mov_b32 v42, 0
 v_smfmac_f32_16x16x64_bf16 v[48:51], v[28:31], a[96:103], v2
 v_mov_b32 v43, 0
 v_add_f32 v44, v44, v46
 v_smfmac_f32_16x16x64_bf16 v[48:51], v[32:35], a[104:111], v2
 buffer_load_dwordx4 v[80:83], v1, s[16:19], s56 offen offset:2048 sc1
 v_add_f32 v45, v45, v47
 v_smfmac_f32_16x16x64_bf16 v[48:51], v[36:39], a[112:119], v2
 v_cvt_pk_bf16_f32 v57, v44, v45
 v_mov_b32 v44, 0
 v_smfmac_f32_16x16x64_bf16 v[52:55], v[12:15], a[120:127], v2
 buffer_load_dwordx4 v[84:87], v1, s[16:19], s56 offen offset:3072 sc1
 v_mov_b32 v45, 0
 v_smfmac_f32_16x16x64_bf16 v[52:55], v[16:19], a[128:135], v2
 v_mov_b32 v46, 0
 v_mov_b32 v47, 0
 v_smfmac_f32_16x16x64_bf16 v[52:55], v[20:23], a[136:143], v2
 buffer_load_dwordx4 v[72:75], v1, s[16:19], s57 offen offset:0 sc1
 v_add_f32 v48, v48, v50
 v_smfmac_f32_16x16x64_bf16 v[52:55], v[24:27], a[144:151], v2
 v_add_f32 v49, v49, v51
 v_cvt_pk_bf16_f32 v58, v48, v49
 v_smfmac_f32_16x16x64_bf16 v[52:55], v[28:31], a[152:159], v2
 buffer_load_dwordx4 v[76:79], v1, s[16:19], s57 offen offset:1024 sc1
 v_mov_b32 v48, 0
 v_smfmac_f32_16x16x64_bf16 v[52:55], v[32:35], a[160:167], v2
 v_mov_b32 v49, 0
 v_mov_b32 v50, 0
 v_smfmac_f32_16x16x64_bf16 v[52:55], v[36:39], a[168:175], v2
 buffer_load_dwordx4 v[88:91], v1, s[16:19], s57 offen offset:2048 sc1
 v_mov_b32 v51, 0
 v_smfmac_f32_16x16x64_bf16 v[40:43], v[12:15], a[176:183], v2
 v_smfmac_f32_16x16x64_bf16 v[40:43], v[16:19], a[184:191], v2
 buffer_load_dwordx4 v[92:95], v1, s[16:19], s57 offen offset:3072 sc1
 v_add_f32 v52, v52, v54
 v_smfmac_f32_16x16x64_bf16 v[40:43], v[20:23], a[192:199], v2
 v_add_f32 v53, v53, v55
 v_cvt_pk_bf16_f32 v59, v52, v53
 v_smfmac_f32_16x16x64_bf16 v[40:43], v[24:27], a[200:207], v2
 v_mov_b32 v52, 0
 v_mov_b32 v53, 0
 v_smfmac_f32_16x16x64_bf16 v[40:43], v[28:31], a[208:215], v2
 v_mov_b32 v54, 0
 v_mov_b32 v55, 0
 v_smfmac_f32_16x16x64_bf16 v[40:43], v[32:35], a[216:223], v2
 v_smfmac_f32_16x16x64_bf16 v[40:43], v[36:39], a[224:231], v2
 v_smfmac_f32_16x16x64_bf16 v[44:47], v[12:15], a[232:239], v2
 v_smfmac_f32_16x16x64_bf16 v[44:47], v[16:19], a[240:247], v2
 v_add_f32 v40, v40, v42
 v_add_f32 v41, v41, v43
 v_smfmac_f32_16x16x64_bf16 v[44:47], v[20:23], a[248:255], v2
 v_cvt_pk_bf16_f32 v60, v40, v41
 v_smfmac_f32_16x16x64_bf16 v[44:47], v[24:27], v[112:119], v2
 v_smfmac_f32_16x16x64_bf16 v[44:47], v[28:31], v[120:127], v2
 v_smfmac_f32_16x16x64_bf16 v[44:47], v[32:35], v[128:135], v2
 v_smfmac_f32_16x16x64_bf16 v[44:47], v[36:39], v[136:143], v2
 s_nop 7
 v_add_f32 v44, v44, v46
 v_add_f32 v45, v45, v47
 v_cvt_pk_bf16_f32 v61, v44, v45
 s_cmp_eq_u32 s50, 63
 s_cbranch_scc1 CB3F_fin
 s_add_u32 s77, s51, 14336
 s_add_u32 s79, s51, 17920
 v_mov_b32 v40, 0
 v_mov_b32 v41, 0
 v_mov_b32 v42, 0
 v_mov_b32 v43, 0
 v_mov_b32 v44, 0
 v_mov_b32 v45, 0
 v_mov_b32 v46, 0
 v_mov_b32 v47, 0
 s_barrier
 buffer_load_dwordx4 v[96:99], v1, s[16:19], s77 offen offset:0 sc1
 v_smfmac_f32_16x16x64_bf16 v[48:51], v[12:15], v[144:151], v2
 buffer_load_dwordx4 v[100:103], v1, s[16:19], s77 offen offset:1024 sc1
 v_smfmac_f32_16x16x64_bf16 v[48:51], v[16:19], v[152:159], v2
 buffer_load_dwordx2 v[104:105], v3, s[16:19], s79 offen sc1
 v_smfmac_f32_16x16x64_bf16 v[48:51], v[20:23], v[160:167], v2
 v_smfmac_f32_16x16x64_bf16 v[48:51], v[24:27], v[168:175], v2
 v_smfmac_f32_16x16x64_bf16 v[48:51], v[28:31], v[176:183], v2
 v_smfmac_f32_16x16x64_bf16 v[48:51], v[32:35], v[184:191], v2
 v_smfmac_f32_16x16x64_bf16 v[48:51], v[36:39], v[192:199], v2
 v_smfmac_f32_16x16x64_bf16 v[52:55], v[12:15], v[200:207], v2
 v_smfmac_f32_16x16x64_bf16 v[52:55], v[16:19], v[208:215], v2
 v_add_f32 v48, v48, v50
 v_smfmac_f32_16x16x64_bf16 v[52:55], v[20:23], v[216:223], v2
 v_add_f32 v49, v49, v51
 v_smfmac_f32_16x16x64_bf16 v[52:55], v[24:27], v[224:231], v2
 v_cvt_pk_bf16_f32 v62, v48, v49
 v_smfmac_f32_16x16x64_bf16 v[52:55], v[28:31], v[232:239], v2
 v_smfmac_f32_16x16x64_bf16 v[52:55], v[32:35], v[240:247], v2
 v_smfmac_f32_16x16x64_bf16 v[52:55], v[36:39], v[248:255], v2
 s_nop 7
 v_add_f32 v48, v52, v54
 v_add_f32 v49, v53, v55
 v_cvt_pk_bf16_f32 v63, v48, v49
CB3F_pgo:
 s_waitcnt vmcnt(2)
 v_smfmac_f32_16x16x64_bf16 v[40:43], v[96:99], v[64:71], v2
 v_max3_u32 v11, v96, v97, v98
 v_smfmac_f32_16x16x64_bf16 v[44:47], v[96:99], v[72:79], v2
 v_max_u32 v11, v11, v99
 s_waitcnt vmcnt(1)
 v_smfmac_f32_16x16x64_bf16 v[40:43], v[100:103], v[80:87], v2
 v_max3_u32 v11, v11, v100, v101
 v_smfmac_f32_16x16x64_bf16 v[44:47], v[100:103], v[88:95], v2
 v_max3_u32 v11, v11, v102, v103
 s_waitcnt vmcnt(0)
 v_max3_u32 v11, v11, v104, v105
 v_smfmac_f32_16x16x32_bf16 v[40:43], v[104:105], v[56:59], v2
 v_cmp_eq_u32 vcc, -1, v11
 v_smfmac_f32_16x16x32_bf16 v[44:47], v[104:105], v[60:63], v2
 s_nop 3
 v_pk_add_f32 v[40:41], v[40:41], v[42:43]
 s_nop 2
 v_pk_add_f32 v[42:43], v[44:45], v[46:47]
 ds_write_b128 v1, v[40:43] offset:23552
 s_cbranch_vccnz CB3F_pre
CB3F_pvok:
 s_waitcnt lgkmcnt(0)
 s_barrier
 buffer_store_dword v5, v4, s[16:19], 0 offen
 s_add_u32 s50, s50, 1
 s_mov_b32 s54, s53
 s_mov_b32 s53, s51
 s_mov_b32 s51, s52
 s_mov_b32 s52, s75
 s_mov_b32 s75, s54
 s_branch CB3F_top
CB3F_slow:
 s_cmp_eq_u32 s60, s50
 s_cbranch_scc1 CB3F_cont
 s_add_u32 s55, s51, 4096
CB3F_sl:
 buffer_load_dwordx4 v[12:15], v1, s[16:19], s51 offen offset:0 sc1
 buffer_load_dwordx4 v[16:19], v1, s[16:19], s51 offen offset:1024 sc1
 buffer_load_dwordx4 v[20:23], v1, s[16:19], s51 offen offset:2048 sc1
 buffer_load_dwordx4 v[24:27], v1, s[16:19], s51 offen offset:3072 sc1
 buffer_load_dwordx4 v[28:31], v1, s[16:19], s55 offen offset:0 sc1
 buffer_load_dwordx4 v[32:35], v1, s[16:19], s55 offen offset:1024 sc1
 buffer_load_dwordx4 v[36:39], v1, s[16:19], s55 offen offset:2048 sc1
 s_waitcnt vmcnt(0)
 v_mov_b32 v41, 0
 v_and_b32 v40, s74, v12
 v_pk_max_u16 v41, v41, v40
 v_and_b32 v40, s74, v13
 v_pk_max_u16 v41, v41, v40
 v_and_b32 v40, s74, v14
 v_pk_max_u16 v41, v41, v40
 v_and_b32 v40, s74, v15
 v_pk_max_u16 v41, v41, v40
 v_and_b32 v40, s74, v16
 v_pk_max_u16 v41, v41, v40
 v_and_b32 v40, s74, v17
 v_pk_max_u16 v41, v41, v40
 v_and_b32 v40, s74, v18
 v_pk_max_u16 v41, v41, v40
 v_and_b32 v40, s74, v19
 v_pk_max_u16 v41, v41, v40
 v_and_b32 v40, s74, v20
 v_pk_max_u16 v41, v41, v40
 v_and_b32 v40, s74, v21
 v_pk_max_u16 v41, v41, v40
 v_and_b32 v40, s74, v22
 v_pk_max_u16 v41, v41, v40
 v_and_b32 v40, s74, v23
 v_pk_max_u16 v41, v41, v40
 v_and_b32 v40, s74, v24
 v_pk_max_u16 v41, v41, v40
 v_and_b32 v40, s74, v25
 v_pk_max_u16 v41, v41, v40
 v_and_b32 v40, s74, v26
 v_pk_max_u16 v41, v41, v40
 v_and_b32 v40, s74, v27
 v_pk_max_u16 v41, v41, v40
 v_and_b32 v40, s74, v28
 v_pk_max_u16 v41, v41, v40
 v_and_b32 v40, s74, v29
 v_pk_max_u16 v41, v41, v40
 v_and_b32 v40, s74, v30
 v_pk_max_u16 v41, v41, v40
 v_and_b32 v40, s74, v31
 v_pk_max_u16 v41, v41, v40
 v_and_b32 v40, s74, v32
 v_pk_max_u16 v41, v41, v40
 v_and_b32 v40, s74, v33
 v_pk_max_u16 v41, v41, v40
 v_and_b32 v40, s74, v34
 v_pk_max_u16 v41, v41, v40
 v_and_b32 v40, s74, v35
 v_pk_max_u16 v41, v41, v40
 v_and_b32 v40, s74, v36
 v_pk_max_u16 v41, v41, v40
 v_and_b32 v40, s74, v37
 v_pk_max_u16 v41, v41, v40
 v_and_b32 v40, s74, v38
 v_pk_max_u16 v41, v41, v40
 v_and_b32 v40, s74, v39
 v_pk_max_u16 v41, v41, v40
 v_lshrrev_b32 v40, 16, v41
 v_and_b32 v41, 0xffff, v41
 v_max_u32 v40, v40, v41
 v_cmp_lt_u32 vcc, 0x7f81, v40
 s_cbranch_vccz CB3F_sok
 s_max_u32 s68, s68, 1
 s_sub_u32 s68, s68, 1
 s_cmp_lg_u32 s68, 0
 s_cbranch_scc1 CB3F_sl
CB3F_sok:
 s_mov_b32 s60, s50
 s_waitcnt lgkmcnt(0)
 v_mov_b32 v40, 0
 v_mov_b32 v41, 0
 v_mov_b32 v42, 0
 v_mov_b32 v43, 0
 v_mov_b32 v44, 0
 v_mov_b32 v45, 0
 v_mov_b32 v46, 0
 v_mov_b32 v47, 0
 v_mov_b32 v48, 0
 v_mov_b32 v49, 0
 v_mov_b32 v50, 0
 v_mov_b32 v51, 0
 v_mov_b32 v52, 0
 v_mov_b32 v53, 0
 v_mov_b32 v54, 0
 v_mov_b32 v55, 0
 s_branch CB3F_gemm
CB3F_q:
 s_sub_u32 s67, s67, 1
 s_cmp_lt_i32 s67, 0
 s_cbranch_scc1 CB3F_qc
 s_barrier
 s_mov_b32 m0, 12288
 s_nop 0
 buffer_load_dwordx4 v1, s[16:19], s51 offen offset:0 sc1 lds
 buffer_load_dwordx4 v1, s[16:19], s51 offen offset:1024 sc1 lds
 buffer_load_dwordx4 v1, s[16:19], s51 offen offset:2048 sc1 lds
 buffer_load_dwordx4 v1, s[16:19], s51 offen offset:3072 sc1 lds
 s_mov_b32 m0, 16384
 s_nop 0
 buffer_load_dwordx4 v1, s[16:19], s55 offen offset:0 sc1 lds
 buffer_load_dwordx4 v1, s[16:19], s55 offen offset:1024 sc1 lds
 buffer_load_dwordx4 v1, s[16:19], s55 offen offset:2048 sc1 lds
 v_mov_b32 v40, 0
 v_mov_b32 v41, 0
 v_mov_b32 v42, 0
 v_mov_b32 v43, 0
 v_mov_b32 v44, 0
 v_mov_b32 v45, 0
 v_mov_b32 v46, 0
 v_mov_b32 v47, 0
 v_mov_b32 v48, 0
 v_mov_b32 v49, 0
 v_mov_b32 v50, 0
 v_mov_b32 v51, 0
 s_waitcnt vmcnt(0)
 s_branch CB3F_bm
CB3F_fin:
 s_add_u32 s70, s47, 7225344
 s_add_u32 s71, s70, 4096
 v_smfmac_f32_16x16x64_bf16 v[48:51], v[12:15], v[144:151], v2
 v_smfmac_f32_16x16x64_bf16 v[48:51], v[16:19], v[152:159], v2
 v_smfmac_f32_16x16x64_bf16 v[48:51], v[20:23], v[160:167], v2
 v_smfmac_f32_16x16x64_bf16 v[48:51], v[24:27], v[168:175], v2
 v_smfmac_f32_16x16x64_bf16 v[48:51], v[28:31], v[176:183], v2
 v_smfmac_f32_16x16x64_bf16 v[48:51], v[32:35], v[184:191], v2
 v_smfmac_f32_16x16x64_bf16 v[48:51], v[36:39], v[192:199], v2
 s_nop 7
 v_add_f32 v48, v48, v50
 v_add_f32 v49, v49, v51
 v_cvt_pk_bf16_f32 v62, v48, v49
 v_smfmac_f32_16x16x64_bf16 v[52:55], v[12:15], v[200:207], v2
 v_smfmac_f32_16x16x64_bf16 v[52:55], v[16:19], v[208:215], v2
 v_smfmac_f32_16x16x64_bf16 v[52:55], v[20:23], v[216:223], v2
 v_smfmac_f32_16x16x64_bf16 v[52:55], v[24:27], v[224:231], v2
 v_smfmac_f32_16x16x64_bf16 v[52:55], v[28:31], v[232:239], v2
 v_smfmac_f32_16x16x64_bf16 v[52:55], v[32:35], v[240:247], v2
 v_smfmac_f32_16x16x64_bf16 v[52:55], v[36:39], v[248:255], v2
 s_nop 7
 v_add_f32 v52, v52, v54
 v_add_f32 v53, v53, v55
 v_cvt_pk_bf16_f32 v63, v52, v53
 v_min_u32 v56, -2, v56
 v_min_u32 v57, -2, v57
 v_min_u32 v58, -2, v58
 v_min_u32 v59, -2, v59
 v_min_u32 v60, -2, v60
 v_min_u32 v61, -2, v61
 v_min_u32 v62, -2, v62
 v_min_u32 v63, -2, v63
 buffer_store_dwordx4 v[56:59], v1, s[16:19], s70 offen sc1
 buffer_store_dwordx4 v[60:63], v1, s[16:19], s71 offen sc1
 s_branch CB3F_end
CB3F_pre:
 s_max_u32 s68, s68, 1
 s_sub_u32 s68, s68, 1
 s_cmp_lg_u32 s68, 0
 s_cbranch_scc0 CB3F_pvok
 s_mov_b32 s61, s50
 buffer_load_dwordx4 v[96:99], v1, s[16:19], s77 offen offset:0 sc1
 buffer_load_dwordx4 v[100:103], v1, s[16:19], s77 offen offset:1024 sc1
 buffer_load_dwordx2 v[104:105], v3, s[16:19], s79 offen sc1
 s_nop 7
 v_mov_b32 v40, 0
 v_mov_b32 v41, 0
 v_mov_b32 v42, 0
 v_mov_b32 v43, 0
 v_mov_b32 v44, 0
 v_mov_b32 v45, 0
 v_mov_b32 v46, 0
 v_mov_b32 v47, 0
 s_branch CB3F_pgo
CB3F_end:
 s_endpgm
.p2align 6
CA0S_start:
 s_mov_b32 s50, 0
 s_mov_b32 s60, 0
 s_mov_b32 s61, -1
 s_mov_b32 s96, 0
 s_mov_b32 s97, 0
 s_mov_b32 s67, 4096
 s_mov_b32 s51, 131072
 s_mov_b32 s52, 151552
 s_mov_b32 s75, 172032
 s_mov_b32 s53, 192512
 s_waitcnt vmcnt(0)
 s_barrier
CA0S_top:
 v_mov_b32 v80, 0
 v_mov_b32 v81, 0
 v_mov_b32 v82, 0
 v_mov_b32 v83, 0
 v_mov_b32 v84, 0
 v_mov_b32 v85, 0
 v_mov_b32 v86, 0
 v_mov_b32 v87, 0
 v_mov_b32 v88, 0
 v_mov_b32 v89, 0
 v_mov_b32 v90, 0
 v_mov_b32 v91, 0
 v_mfma_f32_32x32x16_bf16 v[48:63], v[80:83], v[80:83], 0
 v_mfma_f32_32x32x16_bf16 v[64:79], v[80:83], v[80:83], 0
 s_add_u32 s54, s50, 1
 v_mov_b32 v5, s54
 s_nop 9
 v_mov_b32 v76, v9
 v_mov_b32 v80, v9
 v_mov_b32 v84, v9
 s_waitcnt vmcnt(0)
CA0S_bm:
 s_barrier
 ds_read_b128 v[16:19], v1 offset:12288
 ds_read_b128 v[20:23], v1 offset:13312
 s_waitcnt lgkmcnt(1)
 v_smfmac_f32_16x16x64_bf16 v[48:51], v[16:19], a[0:7], v2
 v_smfmac_f32_16x16x64_bf16 v[52:55], v[16:19], a[56:63], v2
 s_barrier
 ds_read_b128 v[24:27], v1 offset:14336
 ds_read_b128 v[28:31], v1 offset:15360
 v_smfmac_f32_16x16x64_bf16 v[56:59], v[16:19], a[112:119], v2
 ds_read_b128 v[32:35], v1 offset:16384
 s_waitcnt lgkmcnt(3)
 v_smfmac_f32_16x16x64_bf16 v[48:51], v[20:23], a[8:15], v2
 ds_read_b128 v[36:39], v1 offset:17408
 v_smfmac_f32_16x16x64_bf16 v[52:55], v[20:23], a[64:71], v2
 ds_read_b128 v[40:43], v1 offset:18432
CA0S_g2:
 v_smfmac_f32_16x16x64_bf16 v[56:59], v[20:23], a[120:127], v2
 s_waitcnt lgkmcnt(4)
 v_smfmac_f32_16x16x64_bf16 v[48:51], v[24:27], a[16:23], v2
 v_max3_u32 v119, v16, v20, v24
 s_waitcnt lgkmcnt(3)
 v_smfmac_f32_16x16x64_bf16 v[48:51], v[28:31], a[24:31], v2
 s_waitcnt lgkmcnt(2)
 v_smfmac_f32_16x16x64_bf16 v[48:51], v[32:35], a[32:39], v2
 v_max3_u32 v119, v119, v28, v32
 s_waitcnt lgkmcnt(1)
 v_smfmac_f32_16x16x64_bf16 v[48:51], v[36:39], a[40:47], v2
 s_waitcnt lgkmcnt(0)
 v_smfmac_f32_16x16x64_bf16 v[48:51], v[40:43], a[48:55], v2
 v_max3_u32 v119, v119, v36, v40
 v_smfmac_f32_16x16x64_bf16 v[52:55], v[24:27], a[72:79], v2
 v_cmp_eq_u32 vcc, -1, v119
 v_smfmac_f32_16x16x64_bf16 v[52:55], v[28:31], a[80:87], v2
 v_add_f32 v48, v48, v50
 v_add_f32 v49, v49, v51
 v_smfmac_f32_16x16x64_bf16 v[52:55], v[32:35], a[88:95], v2
 s_cbranch_vccnz CA0S_q
CA0S_qc:
 v_smfmac_f32_16x16x64_bf16 v[52:55], v[36:39], a[96:103], v2
 v_cmp_u_f32 vcc, v48, v49
 v_cvt_pk_bf16_f32 v48, v48, v49
 v_smfmac_f32_16x16x64_bf16 v[52:55], v[40:43], a[104:111], v2
 ds_write_b32 v3, v48 offset:5120
 v_smfmac_f32_16x16x64_bf16 v[56:59], v[24:27], a[128:135], v2
 s_cbranch_vccnz CA0S_slow
CA0S_cont:
 v_smfmac_f32_16x16x64_bf16 v[56:59], v[28:31], a[136:143], v2
 v_add_f32 v52, v52, v54
 v_add_f32 v53, v53, v55
 v_smfmac_f32_16x16x64_bf16 v[56:59], v[32:35], a[144:151], v2
 ds_read_b128 v[92:95], v14 offset:0
 v_cvt_pk_bf16_f32 v52, v52, v53
 v_smfmac_f32_16x16x64_bf16 v[56:59], v[36:39], a[152:159], v2
 ds_write_b32 v3, v52 offset:5376
 v_smfmac_f32_16x16x64_bf16 v[56:59], v[40:43], a[160:167], v2
 ds_read_b128 v[48:51], v14 offset:20480
 v_smfmac_f32_16x16x64_bf16 v[60:63], v[16:19], a[168:175], v2
 ds_read_b128 v[52:55], v14 offset:21504
 v_smfmac_f32_16x16x64_bf16 v[60:63], v[20:23], a[176:183], v2
 v_add_f32 v56, v56, v58
 v_smfmac_f32_16x16x64_bf16 v[60:63], v[24:27], a[184:191], v2
 v_add_f32 v57, v57, v59
 v_smfmac_f32_16x16x64_bf16 v[60:63], v[28:31], a[192:199], v2
 v_cvt_pk_bf16_f32 v56, v56, v57
 v_smfmac_f32_16x16x64_bf16 v[60:63], v[32:35], a[200:207], v2
 ds_write_b32 v3, v56 offset:5632
 v_smfmac_f32_16x16x64_bf16 v[60:63], v[36:39], a[208:215], v2
 ds_read_b128 v[56:59], v14 offset:22528
 v_smfmac_f32_16x16x64_bf16 v[60:63], v[40:43], a[216:223], v2
 ds_read_b128 v[96:99], v14 offset:1024
 v_smfmac_f32_16x16x64_bf16 v[64:67], v[16:19], a[224:231], v2
 ds_read_b128 v[100:103], v14 offset:2048
 v_smfmac_f32_16x16x64_bf16 v[64:67], v[20:23], a[232:239], v2
 v_add_f32 v60, v60, v62
 v_smfmac_f32_16x16x64_bf16 v[64:67], v[24:27], a[240:247], v2
 v_add_f32 v61, v61, v63
 v_smfmac_f32_16x16x64_bf16 v[64:67], v[28:31], a[248:255], v2
 v_cvt_pk_bf16_f32 v60, v60, v61
 v_smfmac_f32_16x16x64_bf16 v[64:67], v[32:35], v[120:127], v2
 ds_write_b32 v3, v60 offset:5888
 v_smfmac_f32_16x16x64_bf16 v[64:67], v[36:39], v[128:135], v2
 ds_read_b64_tr_b16 v[116:117], v12 offset:5120
 v_smfmac_f32_16x16x64_bf16 v[64:67], v[40:43], v[136:143], v2
 ds_read_b64_tr_b16 v[118:119], v12 offset:5248
 v_smfmac_f32_16x16x64_bf16 v[68:71], v[16:19], v[144:151], v2
 ds_read_b128 v[104:107], v14 offset:3072
 v_smfmac_f32_16x16x64_bf16 v[68:71], v[20:23], v[152:159], v2
 v_add_f32 v64, v64, v66
 v_smfmac_f32_16x16x64_bf16 v[68:71], v[24:27], v[160:167], v2
 v_add_f32 v65, v65, v67
 v_smfmac_f32_16x16x64_bf16 v[68:71], v[28:31], v[168:175], v2
 v_cvt_pk_bf16_f32 v64, v64, v65
 v_smfmac_f32_16x16x64_bf16 v[68:71], v[32:35], v[176:183], v2
 ds_write_b32 v3, v64 offset:9216
 v_smfmac_f32_16x16x64_bf16 v[68:71], v[36:39], v[184:191], v2
 ds_read_b128 v[60:63], v14 offset:23552
 v_mov_b32_dpp v44, v40 quad_perm:[2,3,0,1] row_mask:0xf bank_mask:0xf
 v_smfmac_f32_16x16x64_bf16 v[68:71], v[40:43], v[192:199], v2
 v_mov_b32_dpp v45, v41 quad_perm:[2,3,0,1] row_mask:0xf bank_mask:0xf
 v_mov_b32_dpp v46, v42 quad_perm:[2,3,0,1] row_mask:0xf bank_mask:0xf
 s_waitcnt lgkmcnt(3)
 v_smfmac_f32_16x16x64_bf16 v[76:79], v[116:119], v[92:99], v2
 ds_read_b128 v[92:95], v14 offset:16384
 v_mov_b32_dpp v47, v43 quad_perm:[2,3,0,1] row_mask:0xf bank_mask:0xf
 s_waitcnt lgkmcnt(3)
 v_smfmac_f32_16x16x64_bf16 v[80:83], v[116:119], v[100:107], v2
 v_add_f32 v68, v68, v70
 v_add_f32 v69, v69, v71
 v_smfmac_f32_16x16x64_bf16 v[84:87], v[116:119], v[16:23], v2
 ds_read_b128 v[96:99], v14 offset:17408
 v_cvt_pk_bf16_f32 v68, v68, v69
 v_smfmac_f32_16x16x64_bf16 v[72:75], v[16:19], v[200:207], v2
 ds_write_b32 v3, v68 offset:10240
 v_add_f32 v77, v77, v79
 v_smfmac_f32_16x16x64_bf16 v[72:75], v[20:23], v[208:215], v2
 ds_read_b128 v[100:103], v14 offset:18432
 v_add_f32 v81, v81, v83
 v_smfmac_f32_16x16x64_bf16 v[72:75], v[24:27], v[216:223], v2
 ds_read_b128 v[104:107], v14 offset:19456
 v_add_f32 v85, v85, v87
 v_smfmac_f32_16x16x64_bf16 v[72:75], v[28:31], v[224:231], v2
 ds_write2st64_b32 v6, v77, v81 offset0:9 offset1:10
 v_smfmac_f32_16x16x64_bf16 v[72:75], v[32:35], v[232:239], v2
 s_waitcnt lgkmcnt(3)
 s_barrier
 ds_read_b64_tr_b16 v[108:109], v12 offset:9216
 v_smfmac_f32_16x16x64_bf16 v[72:75], v[36:39], v[240:247], v2
 ds_read_b64_tr_b16 v[110:111], v12 offset:9344
 v_smfmac_f32_16x16x64_bf16 v[72:75], v[40:43], v[248:255], v2
 ds_write_b32 v13, v85 offset:2816
 ds_read_b64_tr_b16 v[112:113], v12 offset:10240
 ds_read_b64_tr_b16 v[114:115], v12 offset:10368
 ds_read_b128 v[16:19], v14 offset:24576
 ds_read_b128 v[20:23], v14 offset:25600
 s_nop 2
 v_add_f32 v72, v72, v74
 v_add_f32 v73, v73, v75
 v_cvt_pk_bf16_f32 v72, v72, v73
 ds_write_b32 v3, v72 offset:11264
 s_waitcnt lgkmcnt(6)
 v_smfmac_f32_16x16x64_bf16 v[84:87], v[108:111], v[32:39], v2
 ds_read_b128 v[24:27], v14 offset:26624
 v_smfmac_f32_16x16x64_bf16 v[76:79], v[108:111], v[92:99], v2
 ds_read_b128 v[28:31], v14 offset:27648
 v_smfmac_f32_16x16x64_bf16 v[80:83], v[108:111], v[100:107], v2
 s_waitcnt lgkmcnt(2)
 s_barrier
 ds_read_b64_tr_b16 v[116:117], v12 offset:11264
 ds_read_b64_tr_b16 v[118:119], v12 offset:11392
 ds_read2st64_b32 v[64:65], v6 offset0:0 offset1:1
 ds_read2st64_b32 v[66:67], v6 offset0:2 offset1:3
 v_smfmac_f32_16x16x64_bf16 v[88:91], v[112:115], v[32:39], v2
 ds_read2st64_b32 v[68:69], v6 offset0:4 offset1:5
 v_smfmac_f32_16x16x64_bf16 v[76:79], v[112:115], v[48:55], v2
 ds_read2st64_b32 v[70:71], v6 offset0:6 offset1:7
 v_smfmac_f32_16x16x64_bf16 v[80:83], v[112:115], v[56:63], v2
 ds_read_b32 v74, v6 offset:2048
 v_add_f32 v15, v88, v90
 s_waitcnt lgkmcnt(5)
 v_smfmac_f32_16x16x64_bf16 v[84:87], v[116:119], v[40:47], v2
 s_waitcnt lgkmcnt(3)
 v_add_f32 v64, v64, v67
 v_smfmac_f32_16x16x64_bf16 v[76:79], v[116:119], v[16:23], v2
 v_add_f32_dpp v15, v15, v11 quad_perm:[2,3,0,1] row_mask:0xf bank_mask:0xf
 s_waitcnt lgkmcnt(2)
 v_add_f32 v66, v66, v69
 v_smfmac_f32_16x16x64_bf16 v[80:83], v[116:119], v[24:31], v2
 s_waitcnt lgkmcnt(0)
 v_add_f32 v66, v66, v74
 v_add_f32 v64, v64, v70
 v_add_f32 v65, v65, v68
 v_add_f32 v66, v66, v15
 v_add_f32 v65, v65, v71
 v_add_f32 v94, v84, v66
 v_add_f32 v94, v94, v86
 v_add_f32 v92, v76, v64
 v_add_f32 v92, v92, v78
 v_add_f32 v93, v80, v65
 v_add_f32 v93, v93, v82
CA0S_pex:
 v_exp_f32 v100, v94
 v_exp_f32 v98, v92
 v_exp_f32 v99, v93
 v_add_f32 v97, v100, v98
 v_add_f32 v97, v97, v99
 s_nop 1
 v_add_f32_dpp v97, v97, v97 row_ror:8 row_mask:0xf bank_mask:0xf
 s_nop 1
 v_add_f32_dpp v97, v97, v97 row_ror:4 row_mask:0xf bank_mask:0xf
 s_nop 1
 v_add_f32_dpp v97, v97, v97 row_ror:2 row_mask:0xf bank_mask:0xf
 s_nop 1
 v_add_f32_dpp v97, v97, v97 row_ror:1 row_mask:0xf bank_mask:0xf
 v_rcp_f32 v101, v97
 v_subrev_u32 v102, 813694976, v97
 v_cmp_lt_u32 vcc, 503316480, v102
 v_mul_f32 v100, v100, v101
 v_mul_f32 v98, v98, v101
 v_mul_f32 v99, v99, v101
 v_mov_b32_dpp v96, v100 quad_perm:[1,0,3,2] row_mask:0xf bank_mask:0xf
 v_cvt_pk_bf16_f32 v95, v98, v99
 v_cvt_pk_bf16_f32 v96, v100, v96
 s_cbranch_vccnz CA0S_pnan
CA0S_pst:
 buffer_store_dword v95, v7, s[16:19], s51 offen sc1
 buffer_store_dword v96, v8, s[16:19], s51 offen sc1
 v_max3_f32 v97, v94, v92, v93
 s_nop 1
 v_max_f32_dpp v97, v97, v97 row_ror:8 row_mask:0xf bank_mask:0xf
 s_nop 1
 v_max_f32_dpp v97, v97, v97 row_ror:4 row_mask:0xf bank_mask:0xf
 s_nop 1
 v_max_f32_dpp v97, v97, v97 row_ror:2 row_mask:0xf bank_mask:0xf
 s_nop 1
 v_max_f32_dpp v97, v97, v97 row_ror:1 row_mask:0xf bank_mask:0xf
 v_sub_f32 v9, v9, v97
 v_cmp_gt_f32 vcc, s66, abs(v9)
 s_nop 1
 v_cndmask_b32 v9, 0, v9, vcc
 s_barrier
 buffer_store_dword v10, v7, s[16:19], s53 offen sc1
 buffer_store_dword v10, v8, s[16:19], s53 offen sc1
 s_add_u32 s54, s50, 1
 s_min_u32 s54, s54, 63
 s_mul_i32 s56, s54, 28672
 s_add_u32 s56, s56, s44
 s_and_b32 s54, s54, 1
 s_mul_i32 s58, s54, 32768
 s_add_u32 s58, s58, s45
 s_add_u32 m0, s58, 0
 s_add_u32 s59, s56, 0
 buffer_load_dwordx4 v1, s[16:19], s59 offen offset:0 sc1 lds
 buffer_load_dwordx4 v1, s[16:19], s59 offen offset:1024 sc1 lds
 buffer_load_dwordx4 v1, s[16:19], s59 offen offset:2048 sc1 lds
 buffer_load_dwordx4 v1, s[16:19], s59 offen offset:3072 sc1 lds
 s_add_u32 m0, s58, 4096
 s_add_u32 s59, s56, 4096
 buffer_load_dwordx4 v1, s[16:19], s59 offen offset:0 sc1 lds
 buffer_load_dwordx4 v1, s[16:19], s59 offen offset:1024 sc1 lds
 buffer_load_dwordx4 v1, s[16:19], s59 offen offset:2048 sc1 lds
 buffer_load_dwordx4 v1, s[16:19], s59 offen offset:3072 sc1 lds
 s_add_u32 m0, s58, 8192
 s_add_u32 s59, s56, 8192
 buffer_load_dwordx4 v1, s[16:19], s59 offen offset:0 sc1 lds
 buffer_load_dwordx4 v1, s[16:19], s59 offen offset:1024 sc1 lds
 buffer_load_dwordx4 v1, s[16:19], s59 offen offset:2048 sc1 lds
 buffer_load_dwordx4 v1, s[16:19], s59 offen offset:3072 sc1 lds
 s_add_u32 m0, s58, 12288
 s_add_u32 s59, s56, 12288
 buffer_load_dwordx4 v1, s[16:19], s59 offen offset:0 sc1 lds
 buffer_load_dwordx4 v1, s[16:19], s59 offen offset:1024 sc1 lds
 s_add_u32 s50, s50, 1
 s_cmp_eq_u32 s50, 63
 s_cbranch_scc1 CA0S_end
 s_mov_b32 s54, s53
 s_mov_b32 s53, s51
 s_mov_b32 s51, s52
 s_mov_b32 s52, s75
 s_mov_b32 s75, s54
 v_xor_b32 v14, 98304, v14
 s_branch CA0S_top
CA0S_slow:
 s_cmp_eq_u32 s60, s50
 s_cbranch_scc1 CA0S_cont
 s_add_u32 s55, s51, 4096
CA0S_sl:
 buffer_load_dwordx4 v[16:19], v1, s[16:19], s51 offen offset:0 sc1
 buffer_load_dwordx4 v[20:23], v1, s[16:19], s51 offen offset:1024 sc1
 buffer_load_dwordx4 v[24:27], v1, s[16:19], s51 offen offset:2048 sc1
 buffer_load_dwordx4 v[28:31], v1, s[16:19], s51 offen offset:3072 sc1
 buffer_load_dwordx4 v[32:35], v1, s[16:19], s55 offen offset:0 sc1
 buffer_load_dwordx4 v[36:39], v1, s[16:19], s55 offen offset:1024 sc1
 buffer_load_dwordx4 v[40:43], v1, s[16:19], s55 offen offset:2048 sc1
 s_waitcnt vmcnt(0)
 v_mov_b32 v49, 0
 v_and_b32 v48, s74, v16
 v_pk_max_u16 v49, v49, v48
 v_and_b32 v48, s74, v17
 v_pk_max_u16 v49, v49, v48
 v_and_b32 v48, s74, v18
 v_pk_max_u16 v49, v49, v48
 v_and_b32 v48, s74, v19
 v_pk_max_u16 v49, v49, v48
 v_and_b32 v48, s74, v20
 v_pk_max_u16 v49, v49, v48
 v_and_b32 v48, s74, v21
 v_pk_max_u16 v49, v49, v48
 v_and_b32 v48, s74, v22
 v_pk_max_u16 v49, v49, v48
 v_and_b32 v48, s74, v23
 v_pk_max_u16 v49, v49, v48
 v_and_b32 v48, s74, v24
 v_pk_max_u16 v49, v49, v48
 v_and_b32 v48, s74, v25
 v_pk_max_u16 v49, v49, v48
 v_and_b32 v48, s74, v26
 v_pk_max_u16 v49, v49, v48
 v_and_b32 v48, s74, v27
 v_pk_max_u16 v49, v49, v48
 v_and_b32 v48, s74, v28
 v_pk_max_u16 v49, v49, v48
 v_and_b32 v48, s74, v29
 v_pk_max_u16 v49, v49, v48
 v_and_b32 v48, s74, v30
 v_pk_max_u16 v49, v49, v48
 v_and_b32 v48, s74, v31
 v_pk_max_u16 v49, v49, v48
 v_and_b32 v48, s74, v32
 v_pk_max_u16 v49, v49, v48
 v_and_b32 v48, s74, v33
 v_pk_max_u16 v49, v49, v48
 v_and_b32 v48, s74, v34
 v_pk_max_u16 v49, v49, v48
 v_and_b32 v48, s74, v35
 v_pk_max_u16 v49, v49, v48
 v_and_b32 v48, s74, v36
 v_pk_max_u16 v49, v49, v48
 v_and_b32 v48, s74, v37
 v_pk_max_u16 v49, v49, v48
 v_and_b32 v48, s74, v38
 v_pk_max_u16 v49, v49, v48
 v_and_b32 v48, s74, v39
 v_pk_max_u16 v49, v49, v48
 v_and_b32 v48, s74, v40
 v_pk_max_u16 v49, v49, v48
 v_and_b32 v48, s74, v41
 v_pk_max_u16 v49, v49, v48
 v_and_b32 v48, s74, v42
 v_pk_max_u16 v49, v49, v48
 v_and_b32 v48, s74, v43
 v_pk_max_u16 v49, v49, v48
 v_lshrrev_b32 v48, 16, v49
 v_and_b32 v49, 0xffff, v49
 v_max_u32 v48, v48, v49
 v_cmp_lt_u32 vcc, 0x7f81, v48
 s_cbranch_vccz CA0S_sok
 s_max_u32 s68, s68, 1
 s_sub_u32 s68, s68, 1
 s_cmp_lg_u32 s68, 0
 s_cbranch_scc1 CA0S_sl
CA0S_sok:
 s_mov_b32 s60, s50
 s_waitcnt lgkmcnt(0)
 v_mov_b32 v48, 0
 v_mov_b32 v49, 0
 v_mov_b32 v50, 0
 v_mov_b32 v51, 0
 v_mov_b32 v52, 0
 v_mov_b32 v53, 0
 v_mov_b32 v54, 0
 v_mov_b32 v55, 0
 v_mov_b32 v56, 0
 v_mov_b32 v57, 0
 v_mov_b32 v58, 0
 v_mov_b32 v59, 0
 v_mov_b32 v60, 0
 v_mov_b32 v61, 0
 v_mov_b32 v62, 0
 v_mov_b32 v63, 0
 v_mov_b32 v64, 0
 v_mov_b32 v65, 0
 v_mov_b32 v66, 0
 v_mov_b32 v67, 0
 v_mov_b32 v68, 0
 v_mov_b32 v69, 0
 v_mov_b32 v70, 0
 v_mov_b32 v71, 0
 v_mov_b32 v72, 0
 v_mov_b32 v73, 0
 v_mov_b32 v74, 0
 v_mov_b32 v75, 0
 s_branch CA0S_gemm
CA0S_q:
 s_sub_u32 s67, s67, 1
 s_cmp_lt_i32 s67, 0
 s_cbranch_scc1 CA0S_qc
 s_barrier
 v_mov_b32 v48, 0
 v_mov_b32 v49, 0
 v_mov_b32 v50, 0
 v_mov_b32 v51, 0
 v_mov_b32 v52, 0
 v_mov_b32 v53, 0
 v_mov_b32 v54, 0
 v_mov_b32 v55, 0
 v_mov_b32 v56, 0
 v_mov_b32 v57, 0
 v_mov_b32 v58, 0
 v_mov_b32 v59, 0
 s_branch CA0S_bm
CA0S_gemm:
 v_smfmac_f32_16x16x64_bf16 v[48:51], v[16:19], a[0:7], v2
 v_smfmac_f32_16x16x64_bf16 v[52:55], v[16:19], a[56:63], v2
 v_smfmac_f32_16x16x64_bf16 v[56:59], v[16:19], a[112:119], v2
 v_smfmac_f32_16x16x64_bf16 v[48:51], v[20:23], a[8:15], v2
 v_smfmac_f32_16x16x64_bf16 v[52:55], v[20:23], a[64:71], v2
 s_branch CA0S_g2
CA0S_pnan:
 s_cmp_eq_u32 s61, s50
 s_cbranch_scc1 CA0S_pn2
 s_mov_b32 s61, s50
 v_max3_f32 v97, v94, v92, v93
 s_nop 1
 v_max_f32_dpp v97, v97, v97 row_ror:8 row_mask:0xf bank_mask:0xf
 s_nop 1
 v_max_f32_dpp v97, v97, v97 row_ror:4 row_mask:0xf bank_mask:0xf
 s_nop 1
 v_max_f32_dpp v97, v97, v97 row_ror:2 row_mask:0xf bank_mask:0xf
 s_nop 1
 v_max_f32_dpp v97, v97, v97 row_ror:1 row_mask:0xf bank_mask:0xf
 v_sub_f32 v94, v94, v97
 v_sub_f32 v92, v92, v97
 v_sub_f32 v93, v93, v97
 v_sub_f32 v9, v9, v97
 s_branch CA0S_pex
CA0S_pn2:
 v_and_b32 v102, s74, v95
 v_pk_min_u16 v102, v102, s72
 v_bfi_b32 v95, s74, v102, v95
 v_and_b32 v102, s74, v96
 v_pk_min_u16 v102, v102, s72
 v_bfi_b32 v96, s74, v102, v96
 s_branch CA0S_pst
CA0S_end:
 s_endpgm
.p2align 6
CA1S_start:
 s_mov_b32 s50, 0
 s_mov_b32 s60, 0
 s_mov_b32 s61, -1
 s_mov_b32 s96, 0
 s_mov_b32 s97, 0
 s_mov_b32 s67, 4096
 s_mov_b32 s51, 131072
 s_mov_b32 s52, 151552
 s_mov_b32 s75, 172032
 s_mov_b32 s53, 192512
 s_waitcnt vmcnt(0)
 s_barrier
CA1S_top:
 v_mov_b32 v80, 0
 v_mov_b32 v81, 0
 v_mov_b32 v82, 0
 v_mov_b32 v83, 0
 v_mov_b32 v84, 0
 v_mov_b32 v85, 0
 v_mov_b32 v86, 0
 v_mov_b32 v87, 0
 v_mov_b32 v88, 0
 v_mov_b32 v89, 0
 v_mov_b32 v90, 0
 v_mov_b32 v91, 0
 v_mfma_f32_32x32x16_bf16 v[48:63], v[80:83], v[80:83], 0
 v_mfma_f32_32x32x16_bf16 v[64:79], v[80:83], v[80:83], 0
 s_add_u32 s54, s50, 1
 v_mov_b32 v5, s54
 s_nop 9
 v_mov_b32 v77, v9
 v_mov_b32 v81, v9
 v_mov_b32 v85, v9
 s_waitcnt vmcnt(0)
CA1S_bm:
 s_barrier
 ds_read_b128 v[16:19], v1 offset:12288
 ds_read_b128 v[20:23], v1 offset:13312
 s_waitcnt lgkmcnt(1)
 v_smfmac_f32_16x16x64_bf16 v[48:51], v[16:19], a[0:7], v2
 v_smfmac_f32_16x16x64_bf16 v[52:55], v[16:19], a[56:63], v2
 s_barrier
 ds_read_b128 v[24:27], v1 offset:14336
 ds_read_b128 v[28:31], v1 offset:15360
 v_smfmac_f32_16x16x64_bf16 v[56:59], v[16:19], a[112:119], v2
 ds_read_b128 v[32:35], v1 offset:16384
 s_waitcnt lgkmcnt(3)
 v_smfmac_f32_16x16x64_bf16 v[48:51], v[20:23], a[8:15], v2
 ds_read_b128 v[36:39], v1 offset:17408
 v_smfmac_f32_16x16x64_bf16 v[52:55], v[20:23], a[64:71], v2
 ds_read_b128 v[40:43], v1 offset:18432
CA1S_g2:
 v_smfmac_f32_16x16x64_bf16 v[56:59], v[20:23], a[120:127], v2
 s_waitcnt lgkmcnt(4)
 v_smfmac_f32_16x16x64_bf16 v[48:51], v[24:27], a[16:23], v2
 v_max3_u32 v119, v16, v20, v24
 s_waitcnt lgkmcnt(3)
 v_smfmac_f32_16x16x64_bf16 v[48:51], v[28:31], a[24:31], v2
 s_waitcnt lgkmcnt(2)
 v_smfmac_f32_16x16x64_bf16 v[48:51], v[32:35], a[32:39], v2
 v_max3_u32 v119, v119, v28, v32
 s_waitcnt lgkmcnt(1)
 v_smfmac_f32_16x16x64_bf16 v[48:51], v[36:39], a[40:47], v2
 s_waitcnt lgkmcnt(0)
 v_smfmac_f32_16x16x64_bf16 v[48:51], v[40:43], a[48:55], v2
 v_max3_u32 v119, v119, v36, v40
 v_smfmac_f32_16x16x64_bf16 v[52:55], v[24:27], a[72:79], v2
 v_cmp_eq_u32 vcc, -1, v119
 v_smfmac_f32_16x16x64_bf16 v[52:55], v[28:31], a[80:87], v2
 v_add_f32 v48, v48, v50
 v_add_f32 v49, v49, v51
 v_smfmac_f32_16x16x64_bf16 v[52:55], v[32:35], a[88:95], v2
 s_cbranch_vccnz CA1S_q
CA1S_qc:
 v_smfmac_f32_16x16x64_bf16 v[52:55], v[36:39], a[96:103], v2
 v_cmp_u_f32 vcc, v48, v49
 v_cvt_pk_bf16_f32 v48, v48, v49
 v_smfmac_f32_16x16x64_bf16 v[52:55], v[40:43], a[104:111], v2
 ds_write_b32 v3, v48 offset:6144
 v_smfmac_f32_16x16x64_bf16 v[56:59], v[24:27], a[128:135], v2
 s_cbranch_vccnz CA1S_slow
CA1S_cont:
 v_smfmac_f32_16x16x64_bf16 v[56:59], v[28:31], a[136:143], v2
 v_add_f32 v52, v52, v54
 v_add_f32 v53, v53, v55
 v_smfmac_f32_16x16x64_bf16 v[56:59], v[32:35], a[144:151], v2
 ds_read_b128 v[92:95], v14 offset:4096
 v_cvt_pk_bf16_f32 v52, v52, v53
 v_smfmac_f32_16x16x64_bf16 v[56:59], v[36:39], a[152:159], v2
 ds_write_b32 v3, v52 offset:6400
 v_smfmac_f32_16x16x64_bf16 v[56:59], v[40:43], a[160:167], v2
 ds_read_b128 v[48:51], v14 offset:20480
 v_smfmac_f32_16x16x64_bf16 v[60:63], v[16:19], a[168:175], v2
 ds_read_b128 v[52:55], v14 offset:21504
 v_smfmac_f32_16x16x64_bf16 v[60:63], v[20:23], a[176:183], v2
 v_add_f32 v56, v56, v58
 v_smfmac_f32_16x16x64_bf16 v[60:63], v[24:27], a[184:191], v2
 v_add_f32 v57, v57, v59
 v_smfmac_f32_16x16x64_bf16 v[60:63], v[28:31], a[192:199], v2
 v_cvt_pk_bf16_f32 v56, v56, v57
 v_smfmac_f32_16x16x64_bf16 v[60:63], v[32:35], a[200:207], v2
 ds_write_b32 v3, v56 offset:6656
 v_smfmac_f32_16x16x64_bf16 v[60:63], v[36:39], a[208:215], v2
 ds_read_b128 v[56:59], v14 offset:22528
 v_smfmac_f32_16x16x64_bf16 v[60:63], v[40:43], a[216:223], v2
 ds_read_b128 v[96:99], v14 offset:5120
 v_smfmac_f32_16x16x64_bf16 v[64:67], v[16:19], a[224:231], v2
 ds_read_b128 v[100:103], v14 offset:6144
 v_smfmac_f32_16x16x64_bf16 v[64:67], v[20:23], a[232:239], v2
 v_add_f32 v60, v60, v62
 v_smfmac_f32_16x16x64_bf16 v[64:67], v[24:27], a[240:247], v2
 v_add_f32 v61, v61, v63
 v_smfmac_f32_16x16x64_bf16 v[64:67], v[28:31], a[248:255], v2
 v_cvt_pk_bf16_f32 v60, v60, v61
 v_smfmac_f32_16x16x64_bf16 v[64:67], v[32:35], v[120:127], v2
 ds_write_b32 v3, v60 offset:6912
 v_smfmac_f32_16x16x64_bf16 v[64:67], v[36:39], v[128:135], v2
 ds_read_b64_tr_b16 v[116:117], v12 offset:6144
 v_smfmac_f32_16x16x64_bf16 v[64:67], v[40:43], v[136:143], v2
 ds_read_b64_tr_b16 v[118:119], v12 offset:6272
 v_smfmac_f32_16x16x64_bf16 v[68:71], v[16:19], v[144:151], v2
 ds_read_b128 v[104:107], v14 offset:7168
 v_smfmac_f32_16x16x64_bf16 v[68:71], v[20:23], v[152:159], v2
 v_add_f32 v64, v64, v66
 v_smfmac_f32_16x16x64_bf16 v[68:71], v[24:27], v[160:167], v2
 v_add_f32 v65, v65, v67
 v_smfmac_f32_16x16x64_bf16 v[68:71], v[28:31], v[168:175], v2
 v_cvt_pk_bf16_f32 v64, v64, v65
 v_smfmac_f32_16x16x64_bf16 v[68:71], v[32:35], v[176:183], v2
 ds_write_b32 v3, v64 offset:9472
 v_smfmac_f32_16x16x64_bf16 v[68:71], v[36:39], v[184:191], v2
 ds_read_b128 v[60:63], v14 offset:23552
 v_mov_b32_dpp v44, v40 quad_perm:[2,3,0,1] row_mask:0xf bank_mask:0xf
 v_smfmac_f32_16x16x64_bf16 v[68:71], v[40:43], v[192:199], v2
 v_mov_b32_dpp v45, v41 quad_perm:[2,3,0,1] row_mask:0xf bank_mask:0xf
 v_mov_b32_dpp v46, v42 quad_perm:[2,3,0,1] row_mask:0xf bank_mask:0xf
 s_waitcnt lgkmcnt(3)
 v_smfmac_f32_16x16x64_bf16 v[76:79], v[116:119], v[92:99], v2
 ds_read_b128 v[92:95], v14 offset:16384
 v_mov_b32_dpp v47, v43 quad_perm:[2,3,0,1] row_mask:0xf bank_mask:0xf
 s_waitcnt lgkmcnt(3)
 v_smfmac_f32_16x16x64_bf16 v[80:83], v[116:119], v[100:107], v2
 v_add_f32 v68, v68, v70
 v_add_f32 v69, v69, v71
 v_smfmac_f32_16x16x64_bf16 v[88:91], v[116:119], v[16:23], v2
 ds_read_b128 v[96:99], v14 offset:17408
 v_cvt_pk_bf16_f32 v68, v68, v69
 v_smfmac_f32_16x16x64_bf16 v[72:75], v[16:19], v[200:207], v2
 ds_write_b32 v3, v68 offset:10496
 v_add_f32 v76, v76, v78
 v_smfmac_f32_16x16x64_bf16 v[72:75], v[20:23], v[208:215], v2
 ds_read_b128 v[100:103], v14 offset:18432
 v_add_f32 v80, v80, v82
 v_smfmac_f32_16x16x64_bf16 v[72:75], v[24:27], v[216:223], v2
 ds_read_b128 v[104:107], v14 offset:19456
 v_add_f32 v88, v88, v90
 v_smfmac_f32_16x16x64_bf16 v[72:75], v[28:31], v[224:231], v2
 ds_write2st64_b32 v6, v76, v80 offset0:0 offset1:1
 v_smfmac_f32_16x16x64_bf16 v[72:75], v[32:35], v[232:239], v2
 s_waitcnt lgkmcnt(3)
 s_barrier
 ds_read_b64_tr_b16 v[108:109], v12 offset:9216
 v_smfmac_f32_16x16x64_bf16 v[72:75], v[36:39], v[240:247], v2
 ds_read_b64_tr_b16 v[110:111], v12 offset:9344
 v_smfmac_f32_16x16x64_bf16 v[72:75], v[40:43], v[248:255], v2
 ds_write_b32 v13, v88 offset:512
 ds_read_b64_tr_b16 v[112:113], v12 offset:10240
 ds_read_b64_tr_b16 v[114:115], v12 offset:10368
 ds_read_b128 v[16:19], v14 offset:24576
 ds_read_b128 v[20:23], v14 offset:25600
 s_nop 2
 v_add_f32 v72, v72, v74
 v_add_f32 v73, v73, v75
 v_cvt_pk_bf16_f32 v72, v72, v73
 ds_write_b32 v3, v72 offset:11520
 s_waitcnt lgkmcnt(6)
 v_smfmac_f32_16x16x64_bf16 v[84:87], v[108:111], v[32:39], v2
 ds_read_b128 v[24:27], v14 offset:26624
 v_smfmac_f32_16x16x64_bf16 v[76:79], v[108:111], v[92:99], v2
 ds_read_b128 v[28:31], v14 offset:27648
 v_smfmac_f32_16x16x64_bf16 v[80:83], v[108:111], v[100:107], v2
 s_waitcnt lgkmcnt(2)
 s_barrier
 ds_read_b64_tr_b16 v[116:117], v12 offset:11264
 ds_read_b64_tr_b16 v[118:119], v12 offset:11392
 ds_read2st64_b32 v[64:65], v6 offset0:9 offset1:10
 ds_read2st64_b32 v[66:67], v6 offset0:11 offset1:12
 v_smfmac_f32_16x16x64_bf16 v[88:91], v[112:115], v[32:39], v2
 ds_read2st64_b32 v[68:69], v6 offset0:13 offset1:14
 v_smfmac_f32_16x16x64_bf16 v[76:79], v[112:115], v[48:55], v2
 ds_read2st64_b32 v[70:71], v6 offset0:15 offset1:16
 v_smfmac_f32_16x16x64_bf16 v[80:83], v[112:115], v[56:63], v2
 ds_read_b32 v74, v6 offset:4352
 v_add_f32 v15, v89, v91
 s_waitcnt lgkmcnt(5)
 v_smfmac_f32_16x16x64_bf16 v[84:87], v[116:119], v[40:47], v2
 s_waitcnt lgkmcnt(3)
 v_add_f32 v64, v64, v67
 v_smfmac_f32_16x16x64_bf16 v[76:79], v[116:119], v[16:23], v2
 v_add_f32_dpp v15, v15, v11 quad_perm:[2,3,0,1] row_mask:0xf bank_mask:0xf
 s_waitcnt lgkmcnt(2)
 v_add_f32 v66, v66, v69
 v_smfmac_f32_16x16x64_bf16 v[80:83], v[116:119], v[24:31], v2
 s_waitcnt lgkmcnt(0)
 v_add_f32 v66, v66, v74
 v_add_f32 v64, v64, v70
 v_add_f32 v65, v65, v68
 buffer_store_dword v5, v4, s[16:19], 0 offen sc1
 v_add_f32 v66, v66, v15
 v_add_f32 v65, v65, v71
 v_add_f32 v94, v85, v66
 v_add_f32 v94, v94, v87
 v_add_f32 v92, v77, v64
 v_add_f32 v92, v92, v79
 v_add_f32 v93, v81, v65
 v_add_f32 v93, v93, v83
CA1S_pex:
 v_exp_f32 v100, v94
 v_exp_f32 v98, v92
 v_exp_f32 v99, v93
 v_add_f32 v97, v100, v98
 v_add_f32 v97, v97, v99
 s_nop 1
 v_add_f32_dpp v97, v97, v97 row_ror:8 row_mask:0xf bank_mask:0xf
 s_nop 1
 v_add_f32_dpp v97, v97, v97 row_ror:4 row_mask:0xf bank_mask:0xf
 s_nop 1
 v_add_f32_dpp v97, v97, v97 row_ror:2 row_mask:0xf bank_mask:0xf
 s_nop 1
 v_add_f32_dpp v97, v97, v97 row_ror:1 row_mask:0xf bank_mask:0xf
 v_rcp_f32 v101, v97
 v_subrev_u32 v102, 813694976, v97
 v_cmp_lt_u32 vcc, 503316480, v102
 v_mul_f32 v100, v100, v101
 v_mul_f32 v98, v98, v101
 v_mul_f32 v99, v99, v101
 v_mov_b32_dpp v96, v100 quad_perm:[1,0,3,2] row_mask:0xf bank_mask:0xf
 v_cvt_pk_bf16_f32 v95, v98, v99
 v_cvt_pk_bf16_f32 v96, v100, v96
 s_cbranch_vccnz CA1S_pnan
CA1S_pst:
 buffer_store_dword v95, v7, s[16:19], s51 offen sc1
 buffer_store_dword v96, v8, s[16:19], s51 offen sc1
 v_max3_f32 v97, v94, v92, v93
 s_nop 1
 v_max_f32_dpp v97, v97, v97 row_ror:8 row_mask:0xf bank_mask:0xf
 s_nop 1
 v_max_f32_dpp v97, v97, v97 row_ror:4 row_mask:0xf bank_mask:0xf
 s_nop 1
 v_max_f32_dpp v97, v97, v97 row_ror:2 row_mask:0xf bank_mask:0xf
 s_nop 1
 v_max_f32_dpp v97, v97, v97 row_ror:1 row_mask:0xf bank_mask:0xf
 v_sub_f32 v9, v9, v97
 v_cmp_gt_f32 vcc, s66, abs(v9)
 s_nop 1
 v_cndmask_b32 v9, 0, v9, vcc
 s_barrier
 buffer_store_dword v10, v7, s[16:19], s53 offen sc1
 buffer_store_dword v10, v8, s[16:19], s53 offen sc1
 s_add_u32 s54, s50, 1
 s_min_u32 s54, s54, 63
 s_mul_i32 s56, s54, 28672
 s_add_u32 s56, s56, s44
 s_and_b32 s54, s54, 1
 s_mul_i32 s58, s54, 32768
 s_add_u32 s58, s58, s45
 s_add_u32 m0, s58, 0
 s_add_u32 s59, s56, 0
 buffer_load_dwordx4 v1, s[16:19], s59 offen offset:0 sc1 lds
 buffer_load_dwordx4 v1, s[16:19], s59 offen offset:1024 sc1 lds
 buffer_load_dwordx4 v1, s[16:19], s59 offen offset:2048 sc1 lds
 buffer_load_dwordx4 v1, s[16:19], s59 offen offset:3072 sc1 lds
 s_add_u32 m0, s58, 4096
 s_add_u32 s59, s56, 4096
 buffer_load_dwordx4 v1, s[16:19], s59 offen offset:0 sc1 lds
 buffer_load_dwordx4 v1, s[16:19], s59 offen offset:1024 sc1 lds
 buffer_load_dwordx4 v1, s[16:19], s59 offen offset:2048 sc1 lds
 buffer_load_dwordx4 v1, s[16:19], s59 offen offset:3072 sc1 lds
 s_add_u32 m0, s58, 8192
 s_add_u32 s59, s56, 8192
 buffer_load_dwordx4 v1, s[16:19], s59 offen offset:0 sc1 lds
 buffer_load_dwordx4 v1, s[16:19], s59 offen offset:1024 sc1 lds
 buffer_load_dwordx4 v1, s[16:19], s59 offen offset:2048 sc1 lds
 buffer_load_dwordx4 v1, s[16:19], s59 offen offset:3072 sc1 lds
 s_add_u32 m0, s58, 12288
 s_add_u32 s59, s56, 12288
 buffer_load_dwordx4 v1, s[16:19], s59 offen offset:0 sc1 lds
 buffer_load_dwordx4 v1, s[16:19], s59 offen offset:1024 sc1 lds
 s_add_u32 s50, s50, 1
 s_cmp_eq_u32 s50, 63
 s_cbranch_scc1 CA1S_end
 s_mov_b32 s54, s53
 s_mov_b32 s53, s51
 s_mov_b32 s51, s52
 s_mov_b32 s52, s75
 s_mov_b32 s75, s54
 v_xor_b32 v14, 98304, v14
 s_branch CA1S_top
CA1S_slow:
 s_cmp_eq_u32 s60, s50
 s_cbranch_scc1 CA1S_cont
 s_add_u32 s55, s51, 4096
CA1S_sl:
 buffer_load_dwordx4 v[16:19], v1, s[16:19], s51 offen offset:0 sc1
 buffer_load_dwordx4 v[20:23], v1, s[16:19], s51 offen offset:1024 sc1
 buffer_load_dwordx4 v[24:27], v1, s[16:19], s51 offen offset:2048 sc1
 buffer_load_dwordx4 v[28:31], v1, s[16:19], s51 offen offset:3072 sc1
 buffer_load_dwordx4 v[32:35], v1, s[16:19], s55 offen offset:0 sc1
 buffer_load_dwordx4 v[36:39], v1, s[16:19], s55 offen offset:1024 sc1
 buffer_load_dwordx4 v[40:43], v1, s[16:19], s55 offen offset:2048 sc1
 s_waitcnt vmcnt(0)
 v_mov_b32 v49, 0
 v_and_b32 v48, s74, v16
 v_pk_max_u16 v49, v49, v48
 v_and_b32 v48, s74, v17
 v_pk_max_u16 v49, v49, v48
 v_and_b32 v48, s74, v18
 v_pk_max_u16 v49, v49, v48
 v_and_b32 v48, s74, v19
 v_pk_max_u16 v49, v49, v48
 v_and_b32 v48, s74, v20
 v_pk_max_u16 v49, v49, v48
 v_and_b32 v48, s74, v21
 v_pk_max_u16 v49, v49, v48
 v_and_b32 v48, s74, v22
 v_pk_max_u16 v49, v49, v48
 v_and_b32 v48, s74, v23
 v_pk_max_u16 v49, v49, v48
 v_and_b32 v48, s74, v24
 v_pk_max_u16 v49, v49, v48
 v_and_b32 v48, s74, v25
 v_pk_max_u16 v49, v49, v48
 v_and_b32 v48, s74, v26
 v_pk_max_u16 v49, v49, v48
 v_and_b32 v48, s74, v27
 v_pk_max_u16 v49, v49, v48
 v_and_b32 v48, s74, v28
 v_pk_max_u16 v49, v49, v48
 v_and_b32 v48, s74, v29
 v_pk_max_u16 v49, v49, v48
 v_and_b32 v48, s74, v30
 v_pk_max_u16 v49, v49, v48
 v_and_b32 v48, s74, v31
 v_pk_max_u16 v49, v49, v48
 v_and_b32 v48, s74, v32
 v_pk_max_u16 v49, v49, v48
 v_and_b32 v48, s74, v33
 v_pk_max_u16 v49, v49, v48
 v_and_b32 v48, s74, v34
 v_pk_max_u16 v49, v49, v48
 v_and_b32 v48, s74, v35
 v_pk_max_u16 v49, v49, v48
 v_and_b32 v48, s74, v36
 v_pk_max_u16 v49, v49, v48
 v_and_b32 v48, s74, v37
 v_pk_max_u16 v49, v49, v48
 v_and_b32 v48, s74, v38
 v_pk_max_u16 v49, v49, v48
 v_and_b32 v48, s74, v39
 v_pk_max_u16 v49, v49, v48
 v_and_b32 v48, s74, v40
 v_pk_max_u16 v49, v49, v48
 v_and_b32 v48, s74, v41
 v_pk_max_u16 v49, v49, v48
 v_and_b32 v48, s74, v42
 v_pk_max_u16 v49, v49, v48
 v_and_b32 v48, s74, v43
 v_pk_max_u16 v49, v49, v48
 v_lshrrev_b32 v48, 16, v49
 v_and_b32 v49, 0xffff, v49
 v_max_u32 v48, v48, v49
 v_cmp_lt_u32 vcc, 0x7f81, v48
 s_cbranch_vccz CA1S_sok
 s_max_u32 s68, s68, 1
 s_sub_u32 s68, s68, 1
 s_cmp_lg_u32 s68, 0
 s_cbranch_scc1 CA1S_sl
CA1S_sok:
 s_mov_b32 s60, s50
 s_waitcnt lgkmcnt(0)
 v_mov_b32 v48, 0
 v_mov_b32 v49, 0
 v_mov_b32 v50, 0
 v_mov_b32 v51, 0
 v_mov_b32 v52, 0
 v_mov_b32 v53, 0
 v_mov_b32 v54, 0
 v_mov_b32 v55, 0
 v_mov_b32 v56, 0
 v_mov_b32 v57, 0
 v_mov_b32 v58, 0
 v_mov_b32 v59, 0
 v_mov_b32 v60, 0
 v_mov_b32 v61, 0
 v_mov_b32 v62, 0
 v_mov_b32 v63, 0
 v_mov_b32 v64, 0
 v_mov_b32 v65, 0
 v_mov_b32 v66, 0
 v_mov_b32 v67, 0
 v_mov_b32 v68, 0
 v_mov_b32 v69, 0
 v_mov_b32 v70, 0
 v_mov_b32 v71, 0
 v_mov_b32 v72, 0
 v_mov_b32 v73, 0
 v_mov_b32 v74, 0
 v_mov_b32 v75, 0
 s_branch CA1S_gemm
CA1S_q:
 s_sub_u32 s67, s67, 1
 s_cmp_lt_i32 s67, 0
 s_cbranch_scc1 CA1S_qc
 s_barrier
 v_mov_b32 v48, 0
 v_mov_b32 v49, 0
 v_mov_b32 v50, 0
 v_mov_b32 v51, 0
 v_mov_b32 v52, 0
 v_mov_b32 v53, 0
 v_mov_b32 v54, 0
 v_mov_b32 v55, 0
 v_mov_b32 v56, 0
 v_mov_b32 v57, 0
 v_mov_b32 v58, 0
 v_mov_b32 v59, 0
 s_branch CA1S_bm
CA1S_gemm:
 v_smfmac_f32_16x16x64_bf16 v[48:51], v[16:19], a[0:7], v2
 v_smfmac_f32_16x16x64_bf16 v[52:55], v[16:19], a[56:63], v2
 v_smfmac_f32_16x16x64_bf16 v[56:59], v[16:19], a[112:119], v2
 v_smfmac_f32_16x16x64_bf16 v[48:51], v[20:23], a[8:15], v2
 v_smfmac_f32_16x16x64_bf16 v[52:55], v[20:23], a[64:71], v2
 s_branch CA1S_g2
CA1S_pnan:
 s_cmp_eq_u32 s61, s50
 s_cbranch_scc1 CA1S_pn2
 s_mov_b32 s61, s50
 v_max3_f32 v97, v94, v92, v93
 s_nop 1
 v_max_f32_dpp v97, v97, v97 row_ror:8 row_mask:0xf bank_mask:0xf
 s_nop 1
 v_max_f32_dpp v97, v97, v97 row_ror:4 row_mask:0xf bank_mask:0xf
 s_nop 1
 v_max_f32_dpp v97, v97, v97 row_ror:2 row_mask:0xf bank_mask:0xf
 s_nop 1
 v_max_f32_dpp v97, v97, v97 row_ror:1 row_mask:0xf bank_mask:0xf
 v_sub_f32 v94, v94, v97
 v_sub_f32 v92, v92, v97
 v_sub_f32 v93, v93, v97
 v_sub_f32 v9, v9, v97
 s_branch CA1S_pex
CA1S_pn2:
 v_and_b32 v102, s74, v95
 v_pk_min_u16 v102, v102, s72
 v_bfi_b32 v95, s74, v102, v95
 v_and_b32 v102, s74, v96
 v_pk_min_u16 v102, v102, s72
 v_bfi_b32 v96, s74, v102, v96
 s_branch CA1S_pst
CA1S_end:
 s_endpgm
.p2align 6
CA2S_start:
 s_mov_b32 s50, 0
 s_mov_b32 s60, 0
 s_mov_b32 s61, -1
 s_mov_b32 s96, 0
 s_mov_b32 s97, 0
 s_mov_b32 s67, 4096
 s_mov_b32 s51, 131072
 s_mov_b32 s52, 151552
 s_mov_b32 s75, 172032
 s_mov_b32 s53, 192512
 s_waitcnt vmcnt(0)
 s_barrier
CA2S_top:
 v_mov_b32 v80, 0
 v_mov_b32 v81, 0
 v_mov_b32 v82, 0
 v_mov_b32 v83, 0
 v_mov_b32 v84, 0
 v_mov_b32 v85, 0
 v_mov_b32 v86, 0
 v_mov_b32 v87, 0
 v_mov_b32 v88, 0
 v_mov_b32 v89, 0
 v_mov_b32 v90, 0
 v_mov_b32 v91, 0
 v_mfma_f32_32x32x16_bf16 v[48:63], v[80:83], v[80:83], 0
 v_mfma_f32_32x32x16_bf16 v[64:79], v[80:83], v[80:83], 0
 s_add_u32 s54, s50, 1
 v_mov_b32 v5, s54
 s_add_u32 s54, s50, 1
 s_min_u32 s54, s54, 63
 s_mul_i32 s56, s54, 458752
 s_add_u32 s56, s56, s47
 s_cmp_eq_u32 s50, 0
 s_cselect_b32 s56, 1073741824, s56
 s_add_u32 s57, s56, 7168
 s_sub_u32 s58, s56, 7168
 s_sub_u32 s59, s58, 7168
 s_waitcnt vmcnt(0)
CA2S_bm:
 s_barrier
 ds_read_b128 v[16:19], v1 offset:12288
 ds_read_b128 v[20:23], v1 offset:13312
 s_waitcnt lgkmcnt(1)
 v_smfmac_f32_16x16x64_bf16 v[48:51], v[16:19], a[0:7], v2
 v_smfmac_f32_16x16x64_bf16 v[52:55], v[16:19], a[56:63], v2
 s_barrier
 ds_read_b128 v[24:27], v1 offset:14336
 ds_read_b128 v[28:31], v1 offset:15360
 v_smfmac_f32_16x16x64_bf16 v[56:59], v[16:19], a[112:119], v2
 ds_read_b128 v[32:35], v1 offset:16384
 s_waitcnt lgkmcnt(3)
 v_smfmac_f32_16x16x64_bf16 v[48:51], v[20:23], a[8:15], v2
 ds_read_b128 v[36:39], v1 offset:17408
 v_smfmac_f32_16x16x64_bf16 v[52:55], v[20:23], a[64:71], v2
 ds_read_b128 v[40:43], v1 offset:18432
CA2S_g2:
 v_smfmac_f32_16x16x64_bf16 v[56:59], v[20:23], a[120:127], v2
 s_waitcnt lgkmcnt(4)
 v_smfmac_f32_16x16x64_bf16 v[48:51], v[24:27], a[16:23], v2
 v_max3_u32 v119, v16, v20, v24
 s_waitcnt lgkmcnt(3)
 v_smfmac_f32_16x16x64_bf16 v[48:51], v[28:31], a[24:31], v2
 s_waitcnt lgkmcnt(2)
 v_smfmac_f32_16x16x64_bf16 v[48:51], v[32:35], a[32:39], v2
 v_max3_u32 v119, v119, v28, v32
 s_waitcnt lgkmcnt(1)
 v_smfmac_f32_16x16x64_bf16 v[48:51], v[36:39], a[40:47], v2
 s_waitcnt lgkmcnt(0)
 v_smfmac_f32_16x16x64_bf16 v[48:51], v[40:43], a[48:55], v2
 v_max3_u32 v119, v119, v36, v40
 v_smfmac_f32_16x16x64_bf16 v[52:55], v[24:27], a[72:79], v2
 v_cmp_eq_u32 vcc, -1, v119
 v_smfmac_f32_16x16x64_bf16 v[52:55], v[28:31], a[80:87], v2
 v_add_f32 v48, v48, v50
 v_add_f32 v49, v49, v51
 v_smfmac_f32_16x16x64_bf16 v[52:55], v[32:35], a[88:95], v2
 s_cbranch_vccnz CA2S_q
CA2S_qc:
 v_smfmac_f32_16x16x64_bf16 v[52:55], v[36:39], a[96:103], v2
 v_cmp_u_f32 vcc, v48, v49
 v_cvt_pk_bf16_f32 v48, v48, v49
 v_smfmac_f32_16x16x64_bf16 v[52:55], v[40:43], a[104:111], v2
 ds_write_b32 v3, v48 offset:7168
 v_smfmac_f32_16x16x64_bf16 v[56:59], v[24:27], a[128:135], v2
 s_cbranch_vccnz CA2S_slow
CA2S_cont:
 v_smfmac_f32_16x16x64_bf16 v[56:59], v[28:31], a[136:143], v2
 v_add_f32 v52, v52, v54
 v_add_f32 v53, v53, v55
 v_smfmac_f32_16x16x64_bf16 v[56:59], v[32:35], a[144:151], v2
 ds_read_b128 v[92:95], v14 offset:8192
 v_cvt_pk_bf16_f32 v52, v52, v53
 v_smfmac_f32_16x16x64_bf16 v[56:59], v[36:39], a[152:159], v2
 ds_write_b32 v3, v52 offset:7424
 v_smfmac_f32_16x16x64_bf16 v[56:59], v[40:43], a[160:167], v2
 v_smfmac_f32_16x16x64_bf16 v[60:63], v[16:19], a[168:175], v2
 v_smfmac_f32_16x16x64_bf16 v[60:63], v[20:23], a[176:183], v2
 v_add_f32 v56, v56, v58
 v_smfmac_f32_16x16x64_bf16 v[60:63], v[24:27], a[184:191], v2
 v_add_f32 v57, v57, v59
 v_smfmac_f32_16x16x64_bf16 v[60:63], v[28:31], a[192:199], v2
 v_cvt_pk_bf16_f32 v56, v56, v57
 v_smfmac_f32_16x16x64_bf16 v[60:63], v[32:35], a[200:207], v2
 ds_write_b32 v3, v56 offset:7680
 v_smfmac_f32_16x16x64_bf16 v[60:63], v[36:39], a[208:215], v2
 v_smfmac_f32_16x16x64_bf16 v[60:63], v[40:43], a[216:223], v2
 ds_read_b128 v[96:99], v14 offset:9216
 v_smfmac_f32_16x16x64_bf16 v[64:67], v[16:19], a[224:231], v2
 ds_read_b128 v[100:103], v14 offset:10240
 v_smfmac_f32_16x16x64_bf16 v[64:67], v[20:23], a[232:239], v2
 v_add_f32 v60, v60, v62
 v_smfmac_f32_16x16x64_bf16 v[64:67], v[24:27], a[240:247], v2
 v_add_f32 v61, v61, v63
 v_smfmac_f32_16x16x64_bf16 v[64:67], v[28:31], a[248:255], v2
 v_cvt_pk_bf16_f32 v60, v60, v61
 v_smfmac_f32_16x16x64_bf16 v[64:67], v[32:35], v[120:127], v2
 ds_write_b32 v3, v60 offset:7936
 v_smfmac_f32_16x16x64_bf16 v[64:67], v[36:39], v[128:135], v2
 ds_read_b64_tr_b16 v[116:117], v12 offset:7168
 v_smfmac_f32_16x16x64_bf16 v[64:67], v[40:43], v[136:143], v2
 ds_read_b64_tr_b16 v[118:119], v12 offset:7296
 v_smfmac_f32_16x16x64_bf16 v[68:71], v[16:19], v[144:151], v2
 ds_read_b128 v[104:107], v14 offset:11264
 v_smfmac_f32_16x16x64_bf16 v[68:71], v[20:23], v[152:159], v2
 v_add_f32 v64, v64, v66
 v_smfmac_f32_16x16x64_bf16 v[68:71], v[24:27], v[160:167], v2
 v_add_f32 v65, v65, v67
 v_smfmac_f32_16x16x64_bf16 v[68:71], v[28:31], v[168:175], v2
 v_cvt_pk_bf16_f32 v64, v64, v65
 v_smfmac_f32_16x16x64_bf16 v[68:71], v[32:35], v[176:183], v2
 ds_write_b32 v3, v64 offset:9728
 v_smfmac_f32_16x16x64_bf16 v[68:71], v[36:39], v[184:191], v2
 v_smfmac_f32_16x16x64_bf16 v[68:71], v[40:43], v[192:199], v2
 s_waitcnt lgkmcnt(2)
 v_smfmac_f32_16x16x64_bf16 v[76:79], v[116:119], v[92:99], v2
 s_waitcnt lgkmcnt(1)
 v_smfmac_f32_16x16x64_bf16 v[80:83], v[116:119], v[100:107], v2
 v_add_f32 v68, v68, v70
 v_add_f32 v69, v69, v71
 v_smfmac_f32_16x16x64_bf16 v[84:87], v[116:119], v[24:31], v2
 v_cvt_pk_bf16_f32 v68, v68, v69
 v_add_f32 v76, v76, v78
 v_smfmac_f32_16x16x64_bf16 v[72:75], v[16:19], v[200:207], v2
 ds_write_b32 v3, v68 offset:10752
 v_add_f32 v80, v80, v82
 v_smfmac_f32_16x16x64_bf16 v[72:75], v[20:23], v[208:215], v2
 ds_write2st64_b32 v6, v76, v80 offset0:3 offset1:4
 v_add_f32 v77, v77, v79
 v_smfmac_f32_16x16x64_bf16 v[72:75], v[24:27], v[216:223], v2
 v_add_f32 v81, v81, v83
 v_add_f32 v84, v84, v86
 v_smfmac_f32_16x16x64_bf16 v[72:75], v[28:31], v[224:231], v2
 ds_write2st64_b32 v6, v77, v81 offset0:12 offset1:13
 v_add_f32 v85, v85, v87
 v_smfmac_f32_16x16x64_bf16 v[72:75], v[32:35], v[232:239], v2
 s_waitcnt lgkmcnt(2)
 s_barrier
 v_smfmac_f32_16x16x64_bf16 v[72:75], v[36:39], v[240:247], v2
 ds_write2st64_b32 v13, v84, v85 offset0:5 offset1:14
 v_smfmac_f32_16x16x64_bf16 v[72:75], v[40:43], v[248:255], v2
 s_nop 7
 v_add_f32 v72, v72, v74
 v_add_f32 v73, v73, v75
 v_cvt_pk_bf16_f32 v72, v72, v73
 ds_write_b32 v3, v72 offset:11776
 s_waitcnt lgkmcnt(0)
 s_barrier
 s_barrier
 s_add_u32 s50, s50, 1
 s_cmp_eq_u32 s50, 63
 s_cbranch_scc1 CA2S_end
 s_mov_b32 s54, s53
 s_mov_b32 s53, s51
 s_mov_b32 s51, s52
 s_mov_b32 s52, s75
 s_mov_b32 s75, s54
 v_xor_b32 v14, 98304, v14
 s_branch CA2S_top
CA2S_slow:
 s_cmp_eq_u32 s60, s50
 s_cbranch_scc1 CA2S_cont
 s_add_u32 s55, s51, 4096
CA2S_sl:
 buffer_load_dwordx4 v[16:19], v1, s[16:19], s51 offen offset:0 sc1
 buffer_load_dwordx4 v[20:23], v1, s[16:19], s51 offen offset:1024 sc1
 buffer_load_dwordx4 v[24:27], v1, s[16:19], s51 offen offset:2048 sc1
 buffer_load_dwordx4 v[28:31], v1, s[16:19], s51 offen offset:3072 sc1
 buffer_load_dwordx4 v[32:35], v1, s[16:19], s55 offen offset:0 sc1
 buffer_load_dwordx4 v[36:39], v1, s[16:19], s55 offen offset:1024 sc1
 buffer_load_dwordx4 v[40:43], v1, s[16:19], s55 offen offset:2048 sc1
 s_waitcnt vmcnt(0)
 v_mov_b32 v49, 0
 v_and_b32 v48, s74, v16
 v_pk_max_u16 v49, v49, v48
 v_and_b32 v48, s74, v17
 v_pk_max_u16 v49, v49, v48
 v_and_b32 v48, s74, v18
 v_pk_max_u16 v49, v49, v48
 v_and_b32 v48, s74, v19
 v_pk_max_u16 v49, v49, v48
 v_and_b32 v48, s74, v20
 v_pk_max_u16 v49, v49, v48
 v_and_b32 v48, s74, v21
 v_pk_max_u16 v49, v49, v48
 v_and_b32 v48, s74, v22
 v_pk_max_u16 v49, v49, v48
 v_and_b32 v48, s74, v23
 v_pk_max_u16 v49, v49, v48
 v_and_b32 v48, s74, v24
 v_pk_max_u16 v49, v49, v48
 v_and_b32 v48, s74, v25
 v_pk_max_u16 v49, v49, v48
 v_and_b32 v48, s74, v26
 v_pk_max_u16 v49, v49, v48
 v_and_b32 v48, s74, v27
 v_pk_max_u16 v49, v49, v48
 v_and_b32 v48, s74, v28
 v_pk_max_u16 v49, v49, v48
 v_and_b32 v48, s74, v29
 v_pk_max_u16 v49, v49, v48
 v_and_b32 v48, s74, v30
 v_pk_max_u16 v49, v49, v48
 v_and_b32 v48, s74, v31
 v_pk_max_u16 v49, v49, v48
 v_and_b32 v48, s74, v32
 v_pk_max_u16 v49, v49, v48
 v_and_b32 v48, s74, v33
 v_pk_max_u16 v49, v49, v48
 v_and_b32 v48, s74, v34
 v_pk_max_u16 v49, v49, v48
 v_and_b32 v48, s74, v35
 v_pk_max_u16 v49, v49, v48
 v_and_b32 v48, s74, v36
 v_pk_max_u16 v49, v49, v48
 v_and_b32 v48, s74, v37
 v_pk_max_u16 v49, v49, v48
 v_and_b32 v48, s74, v38
 v_pk_max_u16 v49, v49, v48
 v_and_b32 v48, s74, v39
 v_pk_max_u16 v49, v49, v48
 v_and_b32 v48, s74, v40
 v_pk_max_u16 v49, v49, v48
 v_and_b32 v48, s74, v41
 v_pk_max_u16 v49, v49, v48
 v_and_b32 v48, s74, v42
 v_pk_max_u16 v49, v49, v48
 v_and_b32 v48, s74, v43
 v_pk_max_u16 v49, v49, v48
 v_lshrrev_b32 v48, 16, v49
 v_and_b32 v49, 0xffff, v49
 v_max_u32 v48, v48, v49
 v_cmp_lt_u32 vcc, 0x7f81, v48
 s_cbranch_vccz CA2S_sok
 s_max_u32 s68, s68, 1
 s_sub_u32 s68, s68, 1
 s_cmp_lg_u32 s68, 0
 s_cbranch_scc1 CA2S_sl
CA2S_sok:
 s_mov_b32 s60, s50
 s_waitcnt lgkmcnt(0)
 v_mov_b32 v48, 0
 v_mov_b32 v49, 0
 v_mov_b32 v50, 0
 v_mov_b32 v51, 0
 v_mov_b32 v52, 0
 v_mov_b32 v53, 0
 v_mov_b32 v54, 0
 v_mov_b32 v55, 0
 v_mov_b32 v56, 0
 v_mov_b32 v57, 0
 v_mov_b32 v58, 0
 v_mov_b32 v59, 0
 v_mov_b32 v60, 0
 v_mov_b32 v61, 0
 v_mov_b32 v62, 0
 v_mov_b32 v63, 0
 v_mov_b32 v64, 0
 v_mov_b32 v65, 0
 v_mov_b32 v66, 0
 v_mov_b32 v67, 0
 v_mov_b32 v68, 0
 v_mov_b32 v69, 0
 v_mov_b32 v70, 0
 v_mov_b32 v71, 0
 v_mov_b32 v72, 0
 v_mov_b32 v73, 0
 v_mov_b32 v74, 0
 v_mov_b32 v75, 0
 s_branch CA2S_gemm
CA2S_q:
 s_sub_u32 s67, s67, 1
 s_cmp_lt_i32 s67, 0
 s_cbranch_scc1 CA2S_qc
 s_barrier
 v_mov_b32 v48, 0
 v_mov_b32 v49, 0
 v_mov_b32 v50, 0
 v_mov_b32 v51, 0
 v_mov_b32 v52, 0
 v_mov_b32 v53, 0
 v_mov_b32 v54, 0
 v_mov_b32 v55, 0
 v_mov_b32 v56, 0
 v_mov_b32 v57, 0
 v_mov_b32 v58, 0
 v_mov_b32 v59, 0
 s_branch CA2S_bm
CA2S_gemm:
 v_smfmac_f32_16x16x64_bf16 v[48:51], v[16:19], a[0:7], v2
 v_smfmac_f32_16x16x64_bf16 v[52:55], v[16:19], a[56:63], v2
 v_smfmac_f32_16x16x64_bf16 v[56:59], v[16:19], a[112:119], v2
 v_smfmac_f32_16x16x64_bf16 v[48:51], v[20:23], a[8:15], v2
 v_smfmac_f32_16x16x64_bf16 v[52:55], v[20:23], a[64:71], v2
 s_branch CA2S_g2
CA2S_end:
 s_endpgm
.p2align 6
CA3S_start:
 s_mov_b32 s50, 0
 s_mov_b32 s60, 0
 s_mov_b32 s61, -1
 s_mov_b32 s96, 0
 s_mov_b32 s97, 0
 s_mov_b32 s67, 4096
 s_mov_b32 s51, 131072
 s_mov_b32 s52, 151552
 s_mov_b32 s75, 172032
 s_mov_b32 s53, 192512
 s_waitcnt vmcnt(0)
 s_barrier
CA3S_top:
 v_mov_b32 v80, 0
 v_mov_b32 v81, 0
 v_mov_b32 v82, 0
 v_mov_b32 v83, 0
 v_mov_b32 v84, 0
 v_mov_b32 v85, 0
 v_mov_b32 v86, 0
 v_mov_b32 v87, 0
 v_mov_b32 v88, 0
 v_mov_b32 v89, 0
 v_mov_b32 v90, 0
 v_mov_b32 v91, 0
 v_mfma_f32_32x32x16_bf16 v[48:63], v[80:83], v[80:83], 0
 v_mfma_f32_32x32x16_bf16 v[64:79], v[80:83], v[80:83], 0
 s_add_u32 s54, s50, 1
 v_mov_b32 v5, s54
 s_add_u32 s54, s50, 1
 s_min_u32 s54, s54, 63
 s_mul_i32 s56, s54, 458752
 s_add_u32 s56, s56, s47
 s_cmp_eq_u32 s50, 0
 s_cselect_b32 s56, 1073741824, s56
 s_add_u32 s57, s56, 7168
 s_sub_u32 s58, s56, 7168
 s_sub_u32 s59, s58, 7168
 s_mov_b32 s69, 16640
 s_add_u32 s55, s51, 4096
 s_mov_b32 m0, 12288
 buffer_load_dword v108, v0, s[16:19], s69 offen sc1
 s_nop 7
 buffer_load_dword v109, v0, s[16:19], s69 offen sc1
 s_nop 7
 buffer_load_dword v110, v0, s[16:19], s69 offen sc1
 s_nop 7
 buffer_load_dword v111, v0, s[16:19], s69 offen sc1
CA3Sfm_pl:
 s_waitcnt vmcnt(3)
 v_cmp_gt_u32 vcc, s50, v108
 s_cbranch_vccz CA3Sfm_pd
 buffer_load_dword v108, v0, s[16:19], s69 offen sc1
 s_waitcnt vmcnt(3)
 v_cmp_gt_u32 vcc, s50, v109
 s_cbranch_vccz CA3Sfm_pd
 buffer_load_dword v109, v0, s[16:19], s69 offen sc1
 s_waitcnt vmcnt(3)
 v_cmp_gt_u32 vcc, s50, v110
 s_cbranch_vccz CA3Sfm_pd
 buffer_load_dword v110, v0, s[16:19], s69 offen sc1
 s_waitcnt vmcnt(3)
 v_cmp_gt_u32 vcc, s50, v111
 s_cbranch_vccz CA3Sfm_pd
 buffer_load_dword v111, v0, s[16:19], s69 offen sc1
 s_max_u32 s68, s68, 1
 s_sub_u32 s68, s68, 1
 s_cmp_lg_u32 s68, 0
 s_cbranch_scc1 CA3Sfm_pl
CA3Sfm_pd:
 buffer_load_dwordx4 v1, s[16:19], s51 offen offset:0 sc1 lds
 buffer_load_dwordx4 v1, s[16:19], s51 offen offset:1024 sc1 lds
 buffer_load_dwordx4 v1, s[16:19], s51 offen offset:2048 sc1 lds
 buffer_load_dwordx4 v1, s[16:19], s51 offen offset:3072 sc1 lds
 s_mov_b32 m0, 16384
 s_nop 0
 buffer_load_dwordx4 v1, s[16:19], s55 offen offset:0 sc1 lds
 buffer_load_dwordx4 v1, s[16:19], s55 offen offset:1024 sc1 lds
 buffer_load_dwordx4 v1, s[16:19], s55 offen offset:2048 sc1 lds
 buffer_load_dword v15, v7, s[16:19], s56 offen sc1
 buffer_load_dword v15, v7, s[16:19], s57 offen sc1
 buffer_load_dword v15, v7, s[16:19], s58 offen sc1
 buffer_load_dword v15, v7, s[16:19], s59 offen sc1
 s_waitcnt vmcnt(9)
CA3S_bm:
 s_barrier
 ds_read_b128 v[16:19], v1 offset:12288
 ds_read_b128 v[20:23], v1 offset:13312
 s_waitcnt lgkmcnt(1)
 v_smfmac_f32_16x16x64_bf16 v[48:51], v[16:19], a[0:7], v2
 v_smfmac_f32_16x16x64_bf16 v[52:55], v[16:19], a[56:63], v2
 s_waitcnt vmcnt(4)
 s_barrier
 ds_read_b128 v[24:27], v1 offset:14336
 ds_read_b128 v[28:31], v1 offset:15360
 v_smfmac_f32_16x16x64_bf16 v[56:59], v[16:19], a[112:119], v2
 ds_read_b128 v[32:35], v1 offset:16384
 s_waitcnt lgkmcnt(3)
 v_smfmac_f32_16x16x64_bf16 v[48:51], v[20:23], a[8:15], v2
 ds_read_b128 v[36:39], v1 offset:17408
 v_smfmac_f32_16x16x64_bf16 v[52:55], v[20:23], a[64:71], v2
 ds_read_b128 v[40:43], v1 offset:18432
CA3S_g2:
 v_smfmac_f32_16x16x64_bf16 v[56:59], v[20:23], a[120:127], v2
 s_waitcnt lgkmcnt(4)
 v_smfmac_f32_16x16x64_bf16 v[48:51], v[24:27], a[16:23], v2
 v_max3_u32 v119, v16, v20, v24
 s_waitcnt lgkmcnt(3)
 v_smfmac_f32_16x16x64_bf16 v[48:51], v[28:31], a[24:31], v2
 s_waitcnt lgkmcnt(2)
 v_smfmac_f32_16x16x64_bf16 v[48:51], v[32:35], a[32:39], v2
 v_max3_u32 v119, v119, v28, v32
 s_waitcnt lgkmcnt(1)
 v_smfmac_f32_16x16x64_bf16 v[48:51], v[36:39], a[40:47], v2
 s_waitcnt lgkmcnt(0)
 v_smfmac_f32_16x16x64_bf16 v[48:51], v[40:43], a[48:55], v2
 v_max3_u32 v119, v119, v36, v40
 v_smfmac_f32_16x16x64_bf16 v[52:55], v[24:27], a[72:79], v2
 v_cmp_eq_u32 vcc, -1, v119
 v_smfmac_f32_16x16x64_bf16 v[52:55], v[28:31], a[80:87], v2
 v_add_f32 v48, v48, v50
 v_add_f32 v49, v49, v51
 v_smfmac_f32_16x16x64_bf16 v[52:55], v[32:35], a[88:95], v2
 s_cbranch_vccnz CA3S_q
CA3S_qc:
 v_smfmac_f32_16x16x64_bf16 v[52:55], v[36:39], a[96:103], v2
 v_cmp_u_f32 vcc, v48, v49
 v_cvt_pk_bf16_f32 v48, v48, v49
 v_smfmac_f32_16x16x64_bf16 v[52:55], v[40:43], a[104:111], v2
 ds_write_b32 v3, v48 offset:8192
 v_smfmac_f32_16x16x64_bf16 v[56:59], v[24:27], a[128:135], v2
 s_cbranch_vccnz CA3S_slow
CA3S_cont:
 v_smfmac_f32_16x16x64_bf16 v[56:59], v[28:31], a[136:143], v2
 v_add_f32 v52, v52, v54
 v_add_f32 v53, v53, v55
 v_smfmac_f32_16x16x64_bf16 v[56:59], v[32:35], a[144:151], v2
 ds_read_b128 v[92:95], v14 offset:12288
 v_cvt_pk_bf16_f32 v52, v52, v53
 v_smfmac_f32_16x16x64_bf16 v[56:59], v[36:39], a[152:159], v2
 ds_write_b32 v3, v52 offset:8448
 v_smfmac_f32_16x16x64_bf16 v[56:59], v[40:43], a[160:167], v2
 v_smfmac_f32_16x16x64_bf16 v[60:63], v[16:19], a[168:175], v2
 v_smfmac_f32_16x16x64_bf16 v[60:63], v[20:23], a[176:183], v2
 v_add_f32 v56, v56, v58
 v_smfmac_f32_16x16x64_bf16 v[60:63], v[24:27], a[184:191], v2
 v_add_f32 v57, v57, v59
 v_smfmac_f32_16x16x64_bf16 v[60:63], v[28:31], a[192:199], v2
 v_cvt_pk_bf16_f32 v56, v56, v57
 v_smfmac_f32_16x16x64_bf16 v[60:63], v[32:35], a[200:207], v2
 ds_write_b32 v3, v56 offset:8704
 v_smfmac_f32_16x16x64_bf16 v[60:63], v[36:39], a[208:215], v2
 v_smfmac_f32_16x16x64_bf16 v[60:63], v[40:43], a[216:223], v2
 ds_read_b128 v[96:99], v14 offset:13312
 v_smfmac_f32_16x16x64_bf16 v[64:67], v[16:19], a[224:231], v2
 ds_read_b128 v[100:103], v14 offset:14336
 v_smfmac_f32_16x16x64_bf16 v[64:67], v[20:23], a[232:239], v2
 v_add_f32 v60, v60, v62
 v_smfmac_f32_16x16x64_bf16 v[64:67], v[24:27], a[240:247], v2
 v_add_f32 v61, v61, v63
 v_smfmac_f32_16x16x64_bf16 v[64:67], v[28:31], a[248:255], v2
 v_cvt_pk_bf16_f32 v60, v60, v61
 v_smfmac_f32_16x16x64_bf16 v[64:67], v[32:35], v[120:127], v2
 ds_write_b32 v3, v60 offset:8960
 v_smfmac_f32_16x16x64_bf16 v[64:67], v[36:39], v[128:135], v2
 ds_read_b64_tr_b16 v[116:117], v12 offset:8192
 v_smfmac_f32_16x16x64_bf16 v[64:67], v[40:43], v[136:143], v2
 ds_read_b64_tr_b16 v[118:119], v12 offset:8320
 v_smfmac_f32_16x16x64_bf16 v[68:71], v[16:19], v[144:151], v2
 ds_read_b128 v[104:107], v14 offset:15360
 v_smfmac_f32_16x16x64_bf16 v[68:71], v[20:23], v[152:159], v2
 v_add_f32 v64, v64, v66
 v_smfmac_f32_16x16x64_bf16 v[68:71], v[24:27], v[160:167], v2
 v_add_f32 v65, v65, v67
 v_smfmac_f32_16x16x64_bf16 v[68:71], v[28:31], v[168:175], v2
 v_cvt_pk_bf16_f32 v64, v64, v65
 v_smfmac_f32_16x16x64_bf16 v[68:71], v[32:35], v[176:183], v2
 ds_write_b32 v3, v64 offset:9984
 v_smfmac_f32_16x16x64_bf16 v[68:71], v[36:39], v[184:191], v2
 v_smfmac_f32_16x16x64_bf16 v[68:71], v[40:43], v[192:199], v2
 s_waitcnt lgkmcnt(2)
 v_smfmac_f32_16x16x64_bf16 v[76:79], v[116:119], v[92:99], v2
 s_waitcnt lgkmcnt(1)
 v_smfmac_f32_16x16x64_bf16 v[80:83], v[116:119], v[100:107], v2
 v_add_f32 v68, v68, v70
 v_add_f32 v69, v69, v71
 v_smfmac_f32_16x16x64_bf16 v[88:91], v[116:119], v[24:31], v2
 v_cvt_pk_bf16_f32 v68, v68, v69
 v_add_f32 v76, v76, v78
 v_smfmac_f32_16x16x64_bf16 v[72:75], v[16:19], v[200:207], v2
 ds_write_b32 v3, v68 offset:11008
 v_add_f32 v80, v80, v82
 v_smfmac_f32_16x16x64_bf16 v[72:75], v[20:23], v[208:215], v2
 ds_write2st64_b32 v6, v76, v80 offset0:6 offset1:7
 v_add_f32 v77, v77, v79
 v_smfmac_f32_16x16x64_bf16 v[72:75], v[24:27], v[216:223], v2
 v_add_f32 v81, v81, v83
 v_add_f32 v88, v88, v90
 v_smfmac_f32_16x16x64_bf16 v[72:75], v[28:31], v[224:231], v2
 ds_write2st64_b32 v6, v77, v81 offset0:15 offset1:16
 v_add_f32 v89, v89, v91
 v_smfmac_f32_16x16x64_bf16 v[72:75], v[32:35], v[232:239], v2
 s_waitcnt lgkmcnt(2)
 s_barrier
 v_smfmac_f32_16x16x64_bf16 v[72:75], v[36:39], v[240:247], v2
 ds_write2st64_b32 v13, v88, v89 offset0:8 offset1:17
 v_smfmac_f32_16x16x64_bf16 v[72:75], v[40:43], v[248:255], v2
 s_nop 7
 v_add_f32 v72, v72, v74
 v_add_f32 v73, v73, v75
 v_cvt_pk_bf16_f32 v72, v72, v73
 ds_write_b32 v3, v72 offset:12032
 s_waitcnt lgkmcnt(0)
 s_barrier
 s_barrier
 s_add_u32 s50, s50, 1
 s_cmp_eq_u32 s50, 63
 s_cbranch_scc1 CA3S_end
 s_mov_b32 s54, s53
 s_mov_b32 s53, s51
 s_mov_b32 s51, s52
 s_mov_b32 s52, s75
 s_mov_b32 s75, s54
 v_xor_b32 v14, 98304, v14
 s_branch CA3S_top
CA3S_slow:
 s_cmp_eq_u32 s60, s50
 s_cbranch_scc1 CA3S_cont
 s_add_u32 s55, s51, 4096
CA3S_sl:
 buffer_load_dwordx4 v[16:19], v1, s[16:19], s51 offen offset:0 sc1
 buffer_load_dwordx4 v[20:23], v1, s[16:19], s51 offen offset:1024 sc1
 buffer_load_dwordx4 v[24:27], v1, s[16:19], s51 offen offset:2048 sc1
 buffer_load_dwordx4 v[28:31], v1, s[16:19], s51 offen offset:3072 sc1
 buffer_load_dwordx4 v[32:35], v1, s[16:19], s55 offen offset:0 sc1
 buffer_load_dwordx4 v[36:39], v1, s[16:19], s55 offen offset:1024 sc1
 buffer_load_dwordx4 v[40:43], v1, s[16:19], s55 offen offset:2048 sc1
 s_waitcnt vmcnt(0)
 v_mov_b32 v49, 0
 v_and_b32 v48, s74, v16
 v_pk_max_u16 v49, v49, v48
 v_and_b32 v48, s74, v17
 v_pk_max_u16 v49, v49, v48
 v_and_b32 v48, s74, v18
 v_pk_max_u16 v49, v49, v48
 v_and_b32 v48, s74, v19
 v_pk_max_u16 v49, v49, v48
 v_and_b32 v48, s74, v20
 v_pk_max_u16 v49, v49, v48
 v_and_b32 v48, s74, v21
 v_pk_max_u16 v49, v49, v48
 v_and_b32 v48, s74, v22
 v_pk_max_u16 v49, v49, v48
 v_and_b32 v48, s74, v23
 v_pk_max_u16 v49, v49, v48
 v_and_b32 v48, s74, v24
 v_pk_max_u16 v49, v49, v48
 v_and_b32 v48, s74, v25
 v_pk_max_u16 v49, v49, v48
 v_and_b32 v48, s74, v26
 v_pk_max_u16 v49, v49, v48
 v_and_b32 v48, s74, v27
 v_pk_max_u16 v49, v49, v48
 v_and_b32 v48, s74, v28
 v_pk_max_u16 v49, v49, v48
 v_and_b32 v48, s74, v29
 v_pk_max_u16 v49, v49, v48
 v_and_b32 v48, s74, v30
 v_pk_max_u16 v49, v49, v48
 v_and_b32 v48, s74, v31
 v_pk_max_u16 v49, v49, v48
 v_and_b32 v48, s74, v32
 v_pk_max_u16 v49, v49, v48
 v_and_b32 v48, s74, v33
 v_pk_max_u16 v49, v49, v48
 v_and_b32 v48, s74, v34
 v_pk_max_u16 v49, v49, v48
 v_and_b32 v48, s74, v35
 v_pk_max_u16 v49, v49, v48
 v_and_b32 v48, s74, v36
 v_pk_max_u16 v49, v49, v48
 v_and_b32 v48, s74, v37
 v_pk_max_u16 v49, v49, v48
 v_and_b32 v48, s74, v38
 v_pk_max_u16 v49, v49, v48
 v_and_b32 v48, s74, v39
 v_pk_max_u16 v49, v49, v48
 v_and_b32 v48, s74, v40
 v_pk_max_u16 v49, v49, v48
 v_and_b32 v48, s74, v41
 v_pk_max_u16 v49, v49, v48
 v_and_b32 v48, s74, v42
 v_pk_max_u16 v49, v49, v48
 v_and_b32 v48, s74, v43
 v_pk_max_u16 v49, v49, v48
 v_lshrrev_b32 v48, 16, v49
 v_and_b32 v49, 0xffff, v49
 v_max_u32 v48, v48, v49
 v_cmp_lt_u32 vcc, 0x7f81, v48
 s_cbranch_vccz CA3S_sok
 s_max_u32 s68, s68, 1
 s_sub_u32 s68, s68, 1
 s_cmp_lg_u32 s68, 0
 s_cbranch_scc1 CA3S_sl
CA3S_sok:
 s_mov_b32 s60, s50
 s_waitcnt lgkmcnt(0)
 v_mov_b32 v48, 0
 v_mov_b32 v49, 0
 v_mov_b32 v50, 0
 v_mov_b32 v51, 0
 v_mov_b32 v52, 0
 v_mov_b32 v53, 0
 v_mov_b32 v54, 0
 v_mov_b32 v55, 0
 v_mov_b32 v56, 0
 v_mov_b32 v57, 0
 v_mov_b32 v58, 0
 v_mov_b32 v59, 0
 v_mov_b32 v60, 0
 v_mov_b32 v61, 0
 v_mov_b32 v62, 0
 v_mov_b32 v63, 0
 v_mov_b32 v64, 0
 v_mov_b32 v65, 0
 v_mov_b32 v66, 0
 v_mov_b32 v67, 0
 v_mov_b32 v68, 0
 v_mov_b32 v69, 0
 v_mov_b32 v70, 0
 v_mov_b32 v71, 0
 v_mov_b32 v72, 0
 v_mov_b32 v73, 0
 v_mov_b32 v74, 0
 v_mov_b32 v75, 0
 s_branch CA3S_gemm
CA3S_q:
 s_sub_u32 s67, s67, 1
 s_cmp_lt_i32 s67, 0
 s_cbranch_scc1 CA3S_qc
 s_barrier
 s_mov_b32 m0, 12288
 s_nop 0
 buffer_load_dwordx4 v1, s[16:19], s51 offen offset:0 sc1 lds
 buffer_load_dwordx4 v1, s[16:19], s51 offen offset:1024 sc1 lds
 buffer_load_dwordx4 v1, s[16:19], s51 offen offset:2048 sc1 lds
 buffer_load_dwordx4 v1, s[16:19], s51 offen offset:3072 sc1 lds
 s_mov_b32 m0, 16384
 s_nop 0
 buffer_load_dwordx4 v1, s[16:19], s55 offen offset:0 sc1 lds
 buffer_load_dwordx4 v1, s[16:19], s55 offen offset:1024 sc1 lds
 buffer_load_dwordx4 v1, s[16:19], s55 offen offset:2048 sc1 lds
 v_mov_b32 v48, 0
 v_mov_b32 v49, 0
 v_mov_b32 v50, 0
 v_mov_b32 v51, 0
 v_mov_b32 v52, 0
 v_mov_b32 v53, 0
 v_mov_b32 v54, 0
 v_mov_b32 v55, 0
 v_mov_b32 v56, 0
 v_mov_b32 v57, 0
 v_mov_b32 v58, 0
 v_mov_b32 v59, 0
 s_waitcnt vmcnt(0)
 s_branch CA3S_bm
CA3S_gemm:
 v_smfmac_f32_16x16x64_bf16 v[48:51], v[16:19], a[0:7], v2
 v_smfmac_f32_16x16x64_bf16 v[52:55], v[16:19], a[56:63], v2
 v_smfmac_f32_16x16x64_bf16 v[56:59], v[16:19], a[112:119], v2
 v_smfmac_f32_16x16x64_bf16 v[48:51], v[20:23], a[8:15], v2
 v_smfmac_f32_16x16x64_bf16 v[52:55], v[20:23], a[64:71], v2
 s_branch CA3S_g2
CA3S_end:
 s_endpgm
.p2align 6
CB0S_start:
 s_mov_b32 s50, 0
 s_mov_b32 s60, 0
 s_mov_b32 s61, -1
 s_mov_b32 s96, 0
 s_mov_b32 s97, 0
 s_mov_b32 s67, 4096
 s_mov_b32 s51, 131072
 s_mov_b32 s52, 151552
 s_mov_b32 s75, 172032
 s_mov_b32 s53, 192512
 s_waitcnt vmcnt(0)
 s_barrier
CB0S_top:
 ds_read_b128 v[64:67], v7 offset:0
 ds_read_b128 v[68:71], v7 offset:1024
 ds_read_b128 v[72:75], v7 offset:2048
 ds_read_b128 v[76:79], v7 offset:3072
 ds_read_b128 v[80:83], v7 offset:4096
 ds_read_b128 v[84:87], v7 offset:5120
 ds_read_b128 v[88:91], v7 offset:6144
 ds_read_b128 v[92:95], v7 offset:7168
 ds_read_b128 v[96:99], v7 offset:8192
 ds_read_b128 v[100:103], v7 offset:9216
 ds_read_b128 v[104:107], v7 offset:10240
 ds_read_b128 v[108:111], v7 offset:11264
 v_mov_b32 v40, 0
 v_mov_b32 v41, 0
 v_mov_b32 v42, 0
 v_mov_b32 v43, 0
 v_mov_b32 v44, 0
 v_mov_b32 v45, 0
 v_mov_b32 v46, 0
 v_mov_b32 v47, 0
 v_mov_b32 v48, 0
 v_mov_b32 v49, 0
 v_mov_b32 v50, 0
 v_mov_b32 v51, 0
 v_mov_b32 v52, 0
 v_mov_b32 v53, 0
 v_mov_b32 v54, 0
 v_mov_b32 v55, 0
 s_add_u32 s54, s50, 1
 v_mov_b32 v5, s54
 s_mul_i32 s56, s50, 458752
 s_add_u32 s56, s56, s44
 s_add_u32 s57, s56, 16384
 s_waitcnt lgkmcnt(0)
CB0S_bm:
 s_barrier
 ds_read_b128 v[12:15], v1 offset:12288
 ds_read_b128 v[16:19], v1 offset:13312
 ds_read_b128 v[20:23], v1 offset:14336
 ds_read_b128 v[24:27], v1 offset:15360
 ds_read_b128 v[28:31], v1 offset:16384
 ds_read_b128 v[32:35], v1 offset:17408
 ds_read_b128 v[36:39], v1 offset:18432
CB0S_gemm:
 s_waitcnt lgkmcnt(6)
 v_smfmac_f32_16x16x64_bf16 v[40:43], v[12:15], v[64:71], v2
 s_waitcnt lgkmcnt(5)
 v_smfmac_f32_16x16x64_bf16 v[40:43], v[16:19], v[72:79], v2
 s_waitcnt lgkmcnt(4)
 v_smfmac_f32_16x16x64_bf16 v[40:43], v[20:23], v[80:87], v2
 v_max3_u32 v11, v12, v16, v20
 s_waitcnt lgkmcnt(3)
 v_smfmac_f32_16x16x64_bf16 v[40:43], v[24:27], v[88:95], v2
 s_waitcnt lgkmcnt(2)
 v_smfmac_f32_16x16x64_bf16 v[40:43], v[28:31], v[96:103], v2
 v_max3_u32 v11, v11, v24, v28
 s_waitcnt lgkmcnt(1)
 v_smfmac_f32_16x16x64_bf16 v[40:43], v[32:35], v[104:111], v2
 s_waitcnt lgkmcnt(0)
 v_smfmac_f32_16x16x64_bf16 v[40:43], v[36:39], a[0:7], v2
 v_max3_u32 v11, v11, v32, v36
 v_smfmac_f32_16x16x64_bf16 v[44:47], v[12:15], a[8:15], v2
 v_cmp_eq_u32 vcc, -1, v11
 v_smfmac_f32_16x16x64_bf16 v[44:47], v[16:19], a[16:23], v2
 v_smfmac_f32_16x16x64_bf16 v[44:47], v[20:23], a[24:31], v2
 s_cbranch_vccnz CB0S_q
CB0S_qc:
 v_smfmac_f32_16x16x64_bf16 v[44:47], v[24:27], a[32:39], v2
 v_add_f32 v40, v40, v42
 v_smfmac_f32_16x16x64_bf16 v[44:47], v[28:31], a[40:47], v2
 v_add_f32 v41, v41, v43
 v_smfmac_f32_16x16x64_bf16 v[44:47], v[32:35], a[48:55], v2
 v_cmp_u_f32 vcc, v40, v41
 v_smfmac_f32_16x16x64_bf16 v[44:47], v[36:39], a[56:63], v2
 s_nop 0
 v_smfmac_f32_16x16x64_bf16 v[48:51], v[12:15], a[64:71], v2
 s_cbranch_vccnz CB0S_slow
CB0S_cont:
 v_smfmac_f32_16x16x64_bf16 v[48:51], v[16:19], a[72:79], v2
 buffer_load_dwordx4 v[64:67], v1, s[16:19], s56 offen offset:0 sc1
 v_cvt_pk_bf16_f32 v56, v40, v41
 v_smfmac_f32_16x16x64_bf16 v[48:51], v[20:23], a[80:87], v2
 v_mov_b32 v40, 0
 v_mov_b32 v41, 0
 v_smfmac_f32_16x16x64_bf16 v[48:51], v[24:27], a[88:95], v2
 buffer_load_dwordx4 v[68:71], v1, s[16:19], s56 offen offset:1024 sc1
 v_mov_b32 v42, 0
 v_smfmac_f32_16x16x64_bf16 v[48:51], v[28:31], a[96:103], v2
 v_mov_b32 v43, 0
 v_add_f32 v44, v44, v46
 v_smfmac_f32_16x16x64_bf16 v[48:51], v[32:35], a[104:111], v2
 buffer_load_dwordx4 v[80:83], v1, s[16:19], s56 offen offset:2048 sc1
 v_add_f32 v45, v45, v47
 v_smfmac_f32_16x16x64_bf16 v[48:51], v[36:39], a[112:119], v2
 v_cvt_pk_bf16_f32 v57, v44, v45
 v_mov_b32 v44, 0
 v_smfmac_f32_16x16x64_bf16 v[52:55], v[12:15], a[120:127], v2
 buffer_load_dwordx4 v[84:87], v1, s[16:19], s56 offen offset:3072 sc1
 v_mov_b32 v45, 0
 v_smfmac_f32_16x16x64_bf16 v[52:55], v[16:19], a[128:135], v2
 v_mov_b32 v46, 0
 v_mov_b32 v47, 0
 v_smfmac_f32_16x16x64_bf16 v[52:55], v[20:23], a[136:143], v2
 buffer_load_dwordx4 v[72:75], v1, s[16:19], s57 offen offset:0 sc1
 v_add_f32 v48, v48, v50
 v_smfmac_f32_16x16x64_bf16 v[52:55], v[24:27], a[144:151], v2
 v_add_f32 v49, v49, v51
 v_cvt_pk_bf16_f32 v58, v48, v49
 v_smfmac_f32_16x16x64_bf16 v[52:55], v[28:31], a[152:159], v2
 buffer_load_dwordx4 v[76:79], v1, s[16:19], s57 offen offset:1024 sc1
 v_mov_b32 v48, 0
 v_smfmac_f32_16x16x64_bf16 v[52:55], v[32:35], a[160:167], v2
 v_mov_b32 v49, 0
 v_mov_b32 v50, 0
 v_smfmac_f32_16x16x64_bf16 v[52:55], v[36:39], a[168:175], v2
 buffer_load_dwordx4 v[88:91], v1, s[16:19], s57 offen offset:2048 sc1
 v_mov_b32 v51, 0
 v_smfmac_f32_16x16x64_bf16 v[40:43], v[12:15], a[176:183], v2
 v_smfmac_f32_16x16x64_bf16 v[40:43], v[16:19], a[184:191], v2
 buffer_load_dwordx4 v[92:95], v1, s[16:19], s57 offen offset:3072 sc1
 v_add_f32 v52, v52, v54
 v_smfmac_f32_16x16x64_bf16 v[40:43], v[20:23], a[192:199], v2
 v_add_f32 v53, v53, v55
 v_cvt_pk_bf16_f32 v59, v52, v53
 v_smfmac_f32_16x16x64_bf16 v[40:43], v[24:27], a[200:207], v2
 v_mov_b32 v52, 0
 v_mov_b32 v53, 0
 v_smfmac_f32_16x16x64_bf16 v[40:43], v[28:31], a[208:215], v2
 v_mov_b32 v54, 0
 v_mov_b32 v55, 0
 v_smfmac_f32_16x16x64_bf16 v[40:43], v[32:35], a[216:223], v2
 v_smfmac_f32_16x16x64_bf16 v[40:43], v[36:39], a[224:231], v2
 v_smfmac_f32_16x16x64_bf16 v[44:47], v[12:15], a[232:239], v2
 v_smfmac_f32_16x16x64_bf16 v[44:47], v[16:19], a[240:247], v2
 v_add_f32 v40, v40, v42
 v_add_f32 v41, v41, v43
 v_smfmac_f32_16x16x64_bf16 v[44:47], v[20:23], a[248:255], v2
 v_cvt_pk_bf16_f32 v60, v40, v41
 v_smfmac_f32_16x16x64_bf16 v[44:47], v[24:27], v[112:119], v2
 v_smfmac_f32_16x16x64_bf16 v[44:47], v[28:31], v[120:127], v2
 v_smfmac_f32_16x16x64_bf16 v[44:47], v[32:35], v[128:135], v2
 v_smfmac_f32_16x16x64_bf16 v[44:47], v[36:39], v[136:143], v2
 s_nop 7
 v_add_f32 v44, v44, v46
 v_add_f32 v45, v45, v47
 v_cvt_pk_bf16_f32 v61, v44, v45
 s_cmp_eq_u32 s50, 63
 s_cbranch_scc1 CB0S_fin
 s_add_u32 s77, s51, 8192
 s_add_u32 s79, s51, 16384
 v_mov_b32 v40, 0
 v_mov_b32 v41, 0
 v_mov_b32 v42, 0
 v_mov_b32 v43, 0
 v_mov_b32 v44, 0
 v_mov_b32 v45, 0
 v_mov_b32 v46, 0
 v_mov_b32 v47, 0
 s_add_u32 s54, s50, 1
 s_mov_b32 s69, 16384
 buffer_load_dword v106, v0, s[16:19], s69 offen sc1
 s_nop 7
 buffer_load_dword v107, v0, s[16:19], s69 offen sc1
 s_nop 7
 buffer_load_dword v108, v0, s[16:19], s69 offen sc1
 s_nop 7
 buffer_load_dword v109, v0, s[16:19], s69 offen sc1
CB0Sfp_pl:
 s_waitcnt vmcnt(3)
 v_cmp_gt_u32 vcc, s54, v106
 s_cbranch_vccz CB0Sfp_pd
 buffer_load_dword v106, v0, s[16:19], s69 offen sc1
 s_waitcnt vmcnt(3)
 v_cmp_gt_u32 vcc, s54, v107
 s_cbranch_vccz CB0Sfp_pd
 buffer_load_dword v107, v0, s[16:19], s69 offen sc1
 s_waitcnt vmcnt(3)
 v_cmp_gt_u32 vcc, s54, v108
 s_cbranch_vccz CB0Sfp_pd
 buffer_load_dword v108, v0, s[16:19], s69 offen sc1
 s_waitcnt vmcnt(3)
 v_cmp_gt_u32 vcc, s54, v109
 s_cbranch_vccz CB0Sfp_pd
 buffer_load_dword v109, v0, s[16:19], s69 offen sc1
 s_max_u32 s68, s68, 1
 s_sub_u32 s68, s68, 1
 s_cmp_lg_u32 s68, 0
 s_cbranch_scc1 CB0Sfp_pl
CB0Sfp_pd:
 s_barrier
 v_smfmac_f32_16x16x64_bf16 v[48:51], v[12:15], v[144:151], v2
 v_smfmac_f32_16x16x64_bf16 v[48:51], v[16:19], v[152:159], v2
 v_smfmac_f32_16x16x64_bf16 v[48:51], v[20:23], v[160:167], v2
 v_smfmac_f32_16x16x64_bf16 v[48:51], v[24:27], v[168:175], v2
 v_smfmac_f32_16x16x64_bf16 v[48:51], v[28:31], v[176:183], v2
 v_smfmac_f32_16x16x64_bf16 v[48:51], v[32:35], v[184:191], v2
 v_smfmac_f32_16x16x64_bf16 v[48:51], v[36:39], v[192:199], v2
 buffer_load_dwordx4 v[96:99], v1, s[16:19], s77 offen offset:0 sc1
 v_smfmac_f32_16x16x64_bf16 v[52:55], v[12:15], v[200:207], v2
 buffer_load_dwordx4 v[100:103], v1, s[16:19], s77 offen offset:1024 sc1
 v_smfmac_f32_16x16x64_bf16 v[52:55], v[16:19], v[208:215], v2
 buffer_load_dwordx2 v[104:105], v3, s[16:19], s79 offen sc1
 v_smfmac_f32_16x16x64_bf16 v[52:55], v[20:23], v[216:223], v2
 v_add_f32 v48, v48, v50
 v_smfmac_f32_16x16x64_bf16 v[52:55], v[24:27], v[224:231], v2
 v_add_f32 v49, v49, v51
 v_smfmac_f32_16x16x64_bf16 v[52:55], v[28:31], v[232:239], v2
 v_cvt_pk_bf16_f32 v62, v48, v49
 v_smfmac_f32_16x16x64_bf16 v[52:55], v[32:35], v[240:247], v2
 v_smfmac_f32_16x16x64_bf16 v[52:55], v[36:39], v[248:255], v2
 s_nop 7
 v_add_f32 v48, v52, v54
 v_add_f32 v49, v53, v55
 v_cvt_pk_bf16_f32 v63, v48, v49
CB0S_pgo:
 s_waitcnt vmcnt(2)
 v_smfmac_f32_16x16x64_bf16 v[40:43], v[96:99], v[64:71], v2
 v_max3_u32 v11, v96, v97, v98
 v_smfmac_f32_16x16x64_bf16 v[44:47], v[96:99], v[72:79], v2
 v_max_u32 v11, v11, v99
 s_waitcnt vmcnt(1)
 v_smfmac_f32_16x16x64_bf16 v[40:43], v[100:103], v[80:87], v2
 v_max3_u32 v11, v11, v100, v101
 v_smfmac_f32_16x16x64_bf16 v[44:47], v[100:103], v[88:95], v2
 v_max3_u32 v11, v11, v102, v103
 s_waitcnt vmcnt(0)
 v_max3_u32 v11, v11, v104, v105
 v_smfmac_f32_16x16x32_bf16 v[40:43], v[104:105], v[56:59], v2
 v_cmp_eq_u32 vcc, -1, v11
 v_smfmac_f32_16x16x32_bf16 v[44:47], v[104:105], v[60:63], v2
 s_barrier
 ds_read_b128 v[12:15], v1 offset:21504
 ds_read_b128 v[16:19], v1 offset:22528
 ds_read_b128 v[20:23], v1 offset:23552
CB0S_pck:
 s_cbranch_vccnz CB0S_pre
CB0S_pvok:
 s_mov_b64 vcc, s[62:63]
 v_pk_add_f32 v[40:41], v[40:41], v[42:43]
 s_nop 0
 v_pk_add_f32 v[42:43], v[44:45], v[46:47]
 s_waitcnt lgkmcnt(2)
 v_pk_add_f32 v[40:41], v[40:41], v[12:13]
 v_pk_add_f32 v[42:43], v[42:43], v[14:15]
 s_waitcnt lgkmcnt(1)
 v_pk_add_f32 v[40:41], v[40:41], v[16:17]
 v_pk_add_f32 v[42:43], v[42:43], v[18:19]
 s_waitcnt lgkmcnt(0)
 v_pk_add_f32 v[40:41], v[40:41], v[20:21]
 v_pk_add_f32 v[42:43], v[42:43], v[22:23]
 s_nop 0
 v_cndmask_b32_dpp v48, v41, v40, vcc quad_perm:[0,0,2,2] row_mask:0xf bank_mask:0xf
 v_cndmask_b32_dpp v50, v43, v42, vcc quad_perm:[0,0,2,2] row_mask:0xf bank_mask:0xf
 s_mov_b64 vcc, s[64:65]
 v_cndmask_b32_dpp v49, v40, v41, vcc quad_perm:[1,1,3,3] row_mask:0xf bank_mask:0xf
 v_cndmask_b32_dpp v51, v42, v43, vcc quad_perm:[1,1,3,3] row_mask:0xf bank_mask:0xf
 v_cvt_pk_bf16_f32 v48, v48, v49
 buffer_store_dword v48, v8, s[16:19], s52 offen offset:0 sc1
 v_cvt_pk_bf16_f32 v50, v50, v51
 buffer_store_dword v50, v8, s[16:19], s52 offen offset:256 sc1
 v_add_f32 v40, v40, v42
 v_add_f32 v41, v41, v43
 v_cmp_u_f32 vcc, v40, v41
 s_cbranch_vccnz CB0S_pycanon
CB0S_pydone:
 s_cmp_lg_u32 s50, 62
 s_cbranch_scc1 CB0S_nl
 s_mov_b32 s76, 664576
 buffer_store_dword v48, v9, s[16:19], s76 offen offset:0 sc1
 buffer_store_dword v50, v9, s[16:19], s76 offen offset:32 sc1
CB0S_nl:
 buffer_store_dword v10, v8, s[16:19], s75 offen offset:0 sc1
 buffer_store_dword v10, v8, s[16:19], s75 offen offset:256 sc1
 s_add_u32 s50, s50, 1
 s_mov_b32 s54, s53
 s_mov_b32 s53, s51
 s_mov_b32 s51, s52
 s_mov_b32 s52, s75
 s_mov_b32 s75, s54
 s_branch CB0S_top
CB0S_slow:
 s_cmp_eq_u32 s60, s50
 s_cbranch_scc1 CB0S_cont
 s_add_u32 s55, s51, 4096
CB0S_sl:
 buffer_load_dwordx4 v[12:15], v1, s[16:19], s51 offen offset:0 sc1
 buffer_load_dwordx4 v[16:19], v1, s[16:19], s51 offen offset:1024 sc1
 buffer_load_dwordx4 v[20:23], v1, s[16:19], s51 offen offset:2048 sc1
 buffer_load_dwordx4 v[24:27], v1, s[16:19], s51 offen offset:3072 sc1
 buffer_load_dwordx4 v[28:31], v1, s[16:19], s55 offen offset:0 sc1
 buffer_load_dwordx4 v[32:35], v1, s[16:19], s55 offen offset:1024 sc1
 buffer_load_dwordx4 v[36:39], v1, s[16:19], s55 offen offset:2048 sc1
 s_waitcnt vmcnt(0)
 v_mov_b32 v41, 0
 v_and_b32 v40, s74, v12
 v_pk_max_u16 v41, v41, v40
 v_and_b32 v40, s74, v13
 v_pk_max_u16 v41, v41, v40
 v_and_b32 v40, s74, v14
 v_pk_max_u16 v41, v41, v40
 v_and_b32 v40, s74, v15
 v_pk_max_u16 v41, v41, v40
 v_and_b32 v40, s74, v16
 v_pk_max_u16 v41, v41, v40
 v_and_b32 v40, s74, v17
 v_pk_max_u16 v41, v41, v40
 v_and_b32 v40, s74, v18
 v_pk_max_u16 v41, v41, v40
 v_and_b32 v40, s74, v19
 v_pk_max_u16 v41, v41, v40
 v_and_b32 v40, s74, v20
 v_pk_max_u16 v41, v41, v40
 v_and_b32 v40, s74, v21
 v_pk_max_u16 v41, v41, v40
 v_and_b32 v40, s74, v22
 v_pk_max_u16 v41, v41, v40
 v_and_b32 v40, s74, v23
 v_pk_max_u16 v41, v41, v40
 v_and_b32 v40, s74, v24
 v_pk_max_u16 v41, v41, v40
 v_and_b32 v40, s74, v25
 v_pk_max_u16 v41, v41, v40
 v_and_b32 v40, s74, v26
 v_pk_max_u16 v41, v41, v40
 v_and_b32 v40, s74, v27
 v_pk_max_u16 v41, v41, v40
 v_and_b32 v40, s74, v28
 v_pk_max_u16 v41, v41, v40
 v_and_b32 v40, s74, v29
 v_pk_max_u16 v41, v41, v40
 v_and_b32 v40, s74, v30
 v_pk_max_u16 v41, v41, v40
 v_and_b32 v40, s74, v31
 v_pk_max_u16 v41, v41, v40
 v_and_b32 v40, s74, v32
 v_pk_max_u16 v41, v41, v40
 v_and_b32 v40, s74, v33
 v_pk_max_u16 v41, v41, v40
 v_and_b32 v40, s74, v34
 v_pk_max_u16 v41, v41, v40
 v_and_b32 v40, s74, v35
 v_pk_max_u16 v41, v41, v40
 v_and_b32 v40, s74, v36
 v_pk_max_u16 v41, v41, v40
 v_and_b32 v40, s74, v37
 v_pk_max_u16 v41, v41, v40
 v_and_b32 v40, s74, v38
 v_pk_max_u16 v41, v41, v40
 v_and_b32 v40, s74, v39
 v_pk_max_u16 v41, v41, v40
 v_lshrrev_b32 v40, 16, v41
 v_and_b32 v41, 0xffff, v41
 v_max_u32 v40, v40, v41
 v_cmp_lt_u32 vcc, 0x7f81, v40
 s_cbranch_vccz CB0S_sok
 s_max_u32 s68, s68, 1
 s_sub_u32 s68, s68, 1
 s_cmp_lg_u32 s68, 0
 s_cbranch_scc1 CB0S_sl
CB0S_sok:
 s_mov_b32 s60, s50
 s_waitcnt lgkmcnt(0)
 v_mov_b32 v40, 0
 v_mov_b32 v41, 0
 v_mov_b32 v42, 0
 v_mov_b32 v43, 0
 v_mov_b32 v44, 0
 v_mov_b32 v45, 0
 v_mov_b32 v46, 0
 v_mov_b32 v47, 0
 v_mov_b32 v48, 0
 v_mov_b32 v49, 0
 v_mov_b32 v50, 0
 v_mov_b32 v51, 0
 v_mov_b32 v52, 0
 v_mov_b32 v53, 0
 v_mov_b32 v54, 0
 v_mov_b32 v55, 0
 s_branch CB0S_gemm
CB0S_q:
 s_sub_u32 s67, s67, 1
 s_cmp_lt_i32 s67, 0
 s_cbranch_scc1 CB0S_qc
 s_barrier
 v_mov_b32 v40, 0
 v_mov_b32 v41, 0
 v_mov_b32 v42, 0
 v_mov_b32 v43, 0
 v_mov_b32 v44, 0
 v_mov_b32 v45, 0
 v_mov_b32 v46, 0
 v_mov_b32 v47, 0
 v_mov_b32 v48, 0
 v_mov_b32 v49, 0
 v_mov_b32 v50, 0
 v_mov_b32 v51, 0
 s_branch CB0S_bm
CB0S_fin:
 s_add_u32 s70, s47, 7225344
 s_add_u32 s71, s70, 4096
 s_cmp_eq_u32 s42, 0
 s_cselect_b32 s54, 3, 1
 s_mov_b32 s55, 121856
 s_atomic_add s54, s[16:17], s55
 v_smfmac_f32_16x16x64_bf16 v[48:51], v[12:15], v[144:151], v2
 v_smfmac_f32_16x16x64_bf16 v[48:51], v[16:19], v[152:159], v2
 v_smfmac_f32_16x16x64_bf16 v[48:51], v[20:23], v[160:167], v2
 v_smfmac_f32_16x16x64_bf16 v[48:51], v[24:27], v[168:175], v2
 v_smfmac_f32_16x16x64_bf16 v[48:51], v[28:31], v[176:183], v2
 v_smfmac_f32_16x16x64_bf16 v[48:51], v[32:35], v[184:191], v2
 v_smfmac_f32_16x16x64_bf16 v[48:51], v[36:39], v[192:199], v2
 s_nop 7
 v_add_f32 v48, v48, v50
 v_add_f32 v49, v49, v51
 v_cvt_pk_bf16_f32 v62, v48, v49
 v_smfmac_f32_16x16x64_bf16 v[52:55], v[12:15], v[200:207], v2
 v_smfmac_f32_16x16x64_bf16 v[52:55], v[16:19], v[208:215], v2
 v_smfmac_f32_16x16x64_bf16 v[52:55], v[20:23], v[216:223], v2
 v_smfmac_f32_16x16x64_bf16 v[52:55], v[24:27], v[224:231], v2
 v_smfmac_f32_16x16x64_bf16 v[52:55], v[28:31], v[232:239], v2
 v_smfmac_f32_16x16x64_bf16 v[52:55], v[32:35], v[240:247], v2
 v_smfmac_f32_16x16x64_bf16 v[52:55], v[36:39], v[248:255], v2
 s_nop 7
 v_add_f32 v52, v52, v54
 v_add_f32 v53, v53, v55
 v_cvt_pk_bf16_f32 v63, v52, v53
 v_min_u32 v56, -2, v56
 v_min_u32 v57, -2, v57
 v_min_u32 v58, -2, v58
 v_min_u32 v59, -2, v59
 v_min_u32 v60, -2, v60
 v_min_u32 v61, -2, v61
 v_min_u32 v62, -2, v62
 v_min_u32 v63, -2, v63
 buffer_store_dwordx4 v[56:59], v1, s[16:19], s70 offen sc1
 buffer_store_dwordx4 v[60:63], v1, s[16:19], s71 offen sc1
 s_branch CB0S_end
CB0S_pre:
 s_max_u32 s68, s68, 1
 s_sub_u32 s68, s68, 1
 s_cmp_lg_u32 s68, 0
 s_cbranch_scc0 CB0S_pvok
 s_mov_b32 s61, s50
 buffer_load_dwordx4 v[96:99], v1, s[16:19], s77 offen offset:0 sc1
 buffer_load_dwordx4 v[100:103], v1, s[16:19], s77 offen offset:1024 sc1
 buffer_load_dwordx2 v[104:105], v3, s[16:19], s79 offen sc1
 s_nop 7
 v_mov_b32 v40, 0
 v_mov_b32 v41, 0
 v_mov_b32 v42, 0
 v_mov_b32 v43, 0
 v_mov_b32 v44, 0
 v_mov_b32 v45, 0
 v_mov_b32 v46, 0
 v_mov_b32 v47, 0
 s_waitcnt vmcnt(2)
 v_smfmac_f32_16x16x64_bf16 v[40:43], v[96:99], v[64:71], v2
 v_max3_u32 v11, v96, v97, v98
 v_smfmac_f32_16x16x64_bf16 v[44:47], v[96:99], v[72:79], v2
 v_max_u32 v11, v11, v99
 s_waitcnt vmcnt(1)
 v_smfmac_f32_16x16x64_bf16 v[40:43], v[100:103], v[80:87], v2
 v_max3_u32 v11, v11, v100, v101
 v_smfmac_f32_16x16x64_bf16 v[44:47], v[100:103], v[88:95], v2
 v_max3_u32 v11, v11, v102, v103
 s_waitcnt vmcnt(0)
 v_max3_u32 v11, v11, v104, v105
 v_smfmac_f32_16x16x32_bf16 v[40:43], v[104:105], v[56:59], v2
 v_cmp_eq_u32 vcc, -1, v11
 v_smfmac_f32_16x16x32_bf16 v[44:47], v[104:105], v[60:63], v2
 s_nop 7
 s_branch CB0S_pck
CB0S_pycanon:
 v_and_b32 v49, s74, v48
 v_pk_min_u16 v49, v49, s72
 v_bfi_b32 v48, s74, v49, v48
 v_and_b32 v49, s74, v50
 v_pk_min_u16 v49, v49, s72
 v_bfi_b32 v50, s74, v49, v50
 buffer_store_dword v50, v8, s[16:19], s52 offen offset:256 sc1
 buffer_store_dword v48, v8, s[16:19], s52 offen sc1
 s_branch CB0S_pydone
CB0S_end:
 s_endpgm
.p2align 6
CB1S_start:
 s_mov_b32 s50, 0
 s_mov_b32 s60, 0
 s_mov_b32 s61, -1
 s_mov_b32 s96, 0
 s_mov_b32 s97, 0
 s_mov_b32 s67, 4096
 s_mov_b32 s51, 131072
 s_mov_b32 s52, 151552
 s_mov_b32 s75, 172032
 s_mov_b32 s53, 192512
 s_waitcnt vmcnt(0)
 s_barrier
CB1S_top:
 ds_read_b128 v[64:67], v7 offset:0
 ds_read_b128 v[68:71], v7 offset:1024
 ds_read_b128 v[72:75], v7 offset:2048
 ds_read_b128 v[76:79], v7 offset:3072
 ds_read_b128 v[80:83], v7 offset:4096
 ds_read_b128 v[84:87], v7 offset:5120
 ds_read_b128 v[88:91], v7 offset:6144
 ds_read_b128 v[92:95], v7 offset:7168
 ds_read_b128 v[96:99], v7 offset:8192
 ds_read_b128 v[100:103], v7 offset:9216
 ds_read_b128 v[104:107], v7 offset:10240
 ds_read_b128 v[108:111], v7 offset:11264
 v_mov_b32 v40, 0
 v_mov_b32 v41, 0
 v_mov_b32 v42, 0
 v_mov_b32 v43, 0
 v_mov_b32 v44, 0
 v_mov_b32 v45, 0
 v_mov_b32 v46, 0
 v_mov_b32 v47, 0
 v_mov_b32 v48, 0
 v_mov_b32 v49, 0
 v_mov_b32 v50, 0
 v_mov_b32 v51, 0
 v_mov_b32 v52, 0
 v_mov_b32 v53, 0
 v_mov_b32 v54, 0
 v_mov_b32 v55, 0
 s_add_u32 s54, s50, 1
 v_mov_b32 v5, s54
 s_mul_i32 s56, s50, 458752
 s_add_u32 s56, s56, s44
 s_add_u32 s57, s56, 16384
 s_waitcnt lgkmcnt(0)
CB1S_bm:
 s_barrier
 ds_read_b128 v[12:15], v1 offset:12288
 ds_read_b128 v[16:19], v1 offset:13312
 ds_read_b128 v[20:23], v1 offset:14336
 ds_read_b128 v[24:27], v1 offset:15360
 ds_read_b128 v[28:31], v1 offset:16384
 ds_read_b128 v[32:35], v1 offset:17408
 ds_read_b128 v[36:39], v1 offset:18432
CB1S_gemm:
 s_waitcnt lgkmcnt(6)
 v_smfmac_f32_16x16x64_bf16 v[40:43], v[12:15], v[64:71], v2
 s_waitcnt lgkmcnt(5)
 v_smfmac_f32_16x16x64_bf16 v[40:43], v[16:19], v[72:79], v2
 s_waitcnt lgkmcnt(4)
 v_smfmac_f32_16x16x64_bf16 v[40:43], v[20:23], v[80:87], v2
 v_max3_u32 v11, v12, v16, v20
 s_waitcnt lgkmcnt(3)
 v_smfmac_f32_16x16x64_bf16 v[40:43], v[24:27], v[88:95], v2
 s_waitcnt lgkmcnt(2)
 v_smfmac_f32_16x16x64_bf16 v[40:43], v[28:31], v[96:103], v2
 v_max3_u32 v11, v11, v24, v28
 s_waitcnt lgkmcnt(1)
 v_smfmac_f32_16x16x64_bf16 v[40:43], v[32:35], v[104:111], v2
 s_waitcnt lgkmcnt(0)
 v_smfmac_f32_16x16x64_bf16 v[40:43], v[36:39], a[0:7], v2
 v_max3_u32 v11, v11, v32, v36
 v_smfmac_f32_16x16x64_bf16 v[44:47], v[12:15], a[8:15], v2
 v_cmp_eq_u32 vcc, -1, v11
 v_smfmac_f32_16x16x64_bf16 v[44:47], v[16:19], a[16:23], v2
 v_smfmac_f32_16x16x64_bf16 v[44:47], v[20:23], a[24:31], v2
 s_cbranch_vccnz CB1S_q
CB1S_qc:
 v_smfmac_f32_16x16x64_bf16 v[44:47], v[24:27], a[32:39], v2
 v_add_f32 v40, v40, v42
 v_smfmac_f32_16x16x64_bf16 v[44:47], v[28:31], a[40:47], v2
 v_add_f32 v41, v41, v43
 v_smfmac_f32_16x16x64_bf16 v[44:47], v[32:35], a[48:55], v2
 v_cmp_u_f32 vcc, v40, v41
 v_smfmac_f32_16x16x64_bf16 v[44:47], v[36:39], a[56:63], v2
 s_nop 0
 v_smfmac_f32_16x16x64_bf16 v[48:51], v[12:15], a[64:71], v2
 s_cbranch_vccnz CB1S_slow
CB1S_cont:
 v_smfmac_f32_16x16x64_bf16 v[48:51], v[16:19], a[72:79], v2
 buffer_load_dwordx4 v[64:67], v1, s[16:19], s56 offen offset:0 sc1
 v_cvt_pk_bf16_f32 v56, v40, v41
 v_smfmac_f32_16x16x64_bf16 v[48:51], v[20:23], a[80:87], v2
 v_mov_b32 v40, 0
 v_mov_b32 v41, 0
 v_smfmac_f32_16x16x64_bf16 v[48:51], v[24:27], a[88:95], v2
 buffer_load_dwordx4 v[68:71], v1, s[16:19], s56 offen offset:1024 sc1
 v_mov_b32 v42, 0
 v_smfmac_f32_16x16x64_bf16 v[48:51], v[28:31], a[96:103], v2
 v_mov_b32 v43, 0
 v_add_f32 v44, v44, v46
 v_smfmac_f32_16x16x64_bf16 v[48:51], v[32:35], a[104:111], v2
 buffer_load_dwordx4 v[80:83], v1, s[16:19], s56 offen offset:2048 sc1
 v_add_f32 v45, v45, v47
 v_smfmac_f32_16x16x64_bf16 v[48:51], v[36:39], a[112:119], v2
 v_cvt_pk_bf16_f32 v57, v44, v45
 v_mov_b32 v44, 0
 v_smfmac_f32_16x16x64_bf16 v[52:55], v[12:15], a[120:127], v2
 buffer_load_dwordx4 v[84:87], v1, s[16:19], s56 offen offset:3072 sc1
 v_mov_b32 v45, 0
 v_smfmac_f32_16x16x64_bf16 v[52:55], v[16:19], a[128:135], v2
 v_mov_b32 v46, 0
 v_mov_b32 v47, 0
 v_smfmac_f32_16x16x64_bf16 v[52:55], v[20:23], a[136:143], v2
 buffer_load_dwordx4 v[72:75], v1, s[16:19], s57 offen offset:0 sc1
 v_add_f32 v48, v48, v50
 v_smfmac_f32_16x16x64_bf16 v[52:55], v[24:27], a[144:151], v2
 v_add_f32 v49, v49, v51
 v_cvt_pk_bf16_f32 v58, v48, v49
 v_smfmac_f32_16x16x64_bf16 v[52:55], v[28:31], a[152:159], v2
 buffer_load_dwordx4 v[76:79], v1, s[16:19], s57 offen offset:1024 sc1
 v_mov_b32 v48, 0
 v_smfmac_f32_16x16x64_bf16 v[52:55], v[32:35], a[160:167], v2
 v_mov_b32 v49, 0
 v_mov_b32 v50, 0
 v_smfmac_f32_16x16x64_bf16 v[52:55], v[36:39], a[168:175], v2
 buffer_load_dwordx4 v[88:91], v1, s[16:19], s57 offen offset:2048 sc1
 v_mov_b32 v51, 0
 v_smfmac_f32_16x16x64_bf16 v[40:43], v[12:15], a[176:183], v2
 v_smfmac_f32_16x16x64_bf16 v[40:43], v[16:19], a[184:191], v2
 buffer_load_dwordx4 v[92:95], v1, s[16:19], s57 offen offset:3072 sc1
 v_add_f32 v52, v52, v54
 v_smfmac_f32_16x16x64_bf16 v[40:43], v[20:23], a[192:199], v2
 v_add_f32 v53, v53, v55
 v_cvt_pk_bf16_f32 v59, v52, v53
 v_smfmac_f32_16x16x64_bf16 v[40:43], v[24:27], a[200:207], v2
 v_mov_b32 v52, 0
 v_mov_b32 v53, 0
 v_smfmac_f32_16x16x64_bf16 v[40:43], v[28:31], a[208:215], v2
 v_mov_b32 v54, 0
 v_mov_b32 v55, 0
 v_smfmac_f32_16x16x64_bf16 v[40:43], v[32:35], a[216:223], v2
 v_smfmac_f32_16x16x64_bf16 v[40:43], v[36:39], a[224:231], v2
 v_smfmac_f32_16x16x64_bf16 v[44:47], v[12:15], a[232:239], v2
 v_smfmac_f32_16x16x64_bf16 v[44:47], v[16:19], a[240:247], v2
 v_add_f32 v40, v40, v42
 v_add_f32 v41, v41, v43
 v_smfmac_f32_16x16x64_bf16 v[44:47], v[20:23], a[248:255], v2
 v_cvt_pk_bf16_f32 v60, v40, v41
 v_smfmac_f32_16x16x64_bf16 v[44:47], v[24:27], v[112:119], v2
 v_smfmac_f32_16x16x64_bf16 v[44:47], v[28:31], v[120:127], v2
 v_smfmac_f32_16x16x64_bf16 v[44:47], v[32:35], v[128:135], v2
 v_smfmac_f32_16x16x64_bf16 v[44:47], v[36:39], v[136:143], v2
 s_nop 7
 v_add_f32 v44, v44, v46
 v_add_f32 v45, v45, v47
 v_cvt_pk_bf16_f32 v61, v44, v45
 s_cmp_eq_u32 s50, 63
 s_cbranch_scc1 CB1S_fin
 s_add_u32 s77, s51, 10240
 s_add_u32 s79, s51, 16896
 v_mov_b32 v40, 0
 v_mov_b32 v41, 0
 v_mov_b32 v42, 0
 v_mov_b32 v43, 0
 v_mov_b32 v44, 0
 v_mov_b32 v45, 0
 v_mov_b32 v46, 0
 v_mov_b32 v47, 0
 s_barrier
 buffer_load_dwordx4 v[96:99], v1, s[16:19], s77 offen offset:0 sc1
 v_smfmac_f32_16x16x64_bf16 v[48:51], v[12:15], v[144:151], v2
 buffer_load_dwordx4 v[100:103], v1, s[16:19], s77 offen offset:1024 sc1
 v_smfmac_f32_16x16x64_bf16 v[48:51], v[16:19], v[152:159], v2
 buffer_load_dwordx2 v[104:105], v3, s[16:19], s79 offen sc1
 v_smfmac_f32_16x16x64_bf16 v[48:51], v[20:23], v[160:167], v2
 v_smfmac_f32_16x16x64_bf16 v[48:51], v[24:27], v[168:175], v2
 v_smfmac_f32_16x16x64_bf16 v[48:51], v[28:31], v[176:183], v2
 v_smfmac_f32_16x16x64_bf16 v[48:51], v[32:35], v[184:191], v2
 v_smfmac_f32_16x16x64_bf16 v[48:51], v[36:39], v[192:199], v2
 v_smfmac_f32_16x16x64_bf16 v[52:55], v[12:15], v[200:207], v2
 v_smfmac_f32_16x16x64_bf16 v[52:55], v[16:19], v[208:215], v2
 v_add_f32 v48, v48, v50
 v_smfmac_f32_16x16x64_bf16 v[52:55], v[20:23], v[216:223], v2
 v_add_f32 v49, v49, v51
 v_smfmac_f32_16x16x64_bf16 v[52:55], v[24:27], v[224:231], v2
 v_cvt_pk_bf16_f32 v62, v48, v49
 v_smfmac_f32_16x16x64_bf16 v[52:55], v[28:31], v[232:239], v2
 v_smfmac_f32_16x16x64_bf16 v[52:55], v[32:35], v[240:247], v2
 v_smfmac_f32_16x16x64_bf16 v[52:55], v[36:39], v[248:255], v2
 s_nop 7
 v_add_f32 v48, v52, v54
 v_add_f32 v49, v53, v55
 v_cvt_pk_bf16_f32 v63, v48, v49
CB1S_pgo:
 s_waitcnt vmcnt(2)
 v_smfmac_f32_16x16x64_bf16 v[40:43], v[96:99], v[64:71], v2
 v_max3_u32 v11, v96, v97, v98
 v_smfmac_f32_16x16x64_bf16 v[44:47], v[96:99], v[72:79], v2
 v_max_u32 v11, v11, v99
 s_waitcnt vmcnt(1)
 v_smfmac_f32_16x16x64_bf16 v[40:43], v[100:103], v[80:87], v2
 v_max3_u32 v11, v11, v100, v101
 v_smfmac_f32_16x16x64_bf16 v[44:47], v[100:103], v[88:95], v2
 v_max3_u32 v11, v11, v102, v103
 s_waitcnt vmcnt(0)
 v_max3_u32 v11, v11, v104, v105
 v_smfmac_f32_16x16x32_bf16 v[40:43], v[104:105], v[56:59], v2
 v_cmp_eq_u32 vcc, -1, v11
 v_smfmac_f32_16x16x32_bf16 v[44:47], v[104:105], v[60:63], v2
 s_nop 3
 v_pk_add_f32 v[40:41], v[40:41], v[42:43]
 s_nop 2
 v_pk_add_f32 v[42:43], v[44:45], v[46:47]
 ds_write_b128 v1, v[40:43] offset:21504
 s_cbranch_vccnz CB1S_pre
CB1S_pvok:
 s_waitcnt lgkmcnt(0)
 s_barrier
 s_cmp_lg_u32 s50, 62
 s_cbranch_scc1 CB1S_nu
 s_cmp_lg_u32 s42, 0
 s_cbranch_scc1 CB1S_nu
 s_mov_b32 s54, 1
 s_mov_b32 s55, 122368
 s_atomic_or s54, s[16:17], s55
CB1S_nu:
 s_add_u32 s50, s50, 1
 s_mov_b32 s54, s53
 s_mov_b32 s53, s51
 s_mov_b32 s51, s52
 s_mov_b32 s52, s75
 s_mov_b32 s75, s54
 s_branch CB1S_top
CB1S_slow:
 s_cmp_eq_u32 s60, s50
 s_cbranch_scc1 CB1S_cont
 s_add_u32 s55, s51, 4096
CB1S_sl:
 buffer_load_dwordx4 v[12:15], v1, s[16:19], s51 offen offset:0 sc1
 buffer_load_dwordx4 v[16:19], v1, s[16:19], s51 offen offset:1024 sc1
 buffer_load_dwordx4 v[20:23], v1, s[16:19], s51 offen offset:2048 sc1
 buffer_load_dwordx4 v[24:27], v1, s[16:19], s51 offen offset:3072 sc1
 buffer_load_dwordx4 v[28:31], v1, s[16:19], s55 offen offset:0 sc1
 buffer_load_dwordx4 v[32:35], v1, s[16:19], s55 offen offset:1024 sc1
 buffer_load_dwordx4 v[36:39], v1, s[16:19], s55 offen offset:2048 sc1
 s_waitcnt vmcnt(0)
 v_mov_b32 v41, 0
 v_and_b32 v40, s74, v12
 v_pk_max_u16 v41, v41, v40
 v_and_b32 v40, s74, v13
 v_pk_max_u16 v41, v41, v40
 v_and_b32 v40, s74, v14
 v_pk_max_u16 v41, v41, v40
 v_and_b32 v40, s74, v15
 v_pk_max_u16 v41, v41, v40
 v_and_b32 v40, s74, v16
 v_pk_max_u16 v41, v41, v40
 v_and_b32 v40, s74, v17
 v_pk_max_u16 v41, v41, v40
 v_and_b32 v40, s74, v18
 v_pk_max_u16 v41, v41, v40
 v_and_b32 v40, s74, v19
 v_pk_max_u16 v41, v41, v40
 v_and_b32 v40, s74, v20
 v_pk_max_u16 v41, v41, v40
 v_and_b32 v40, s74, v21
 v_pk_max_u16 v41, v41, v40
 v_and_b32 v40, s74, v22
 v_pk_max_u16 v41, v41, v40
 v_and_b32 v40, s74, v23
 v_pk_max_u16 v41, v41, v40
 v_and_b32 v40, s74, v24
 v_pk_max_u16 v41, v41, v40
 v_and_b32 v40, s74, v25
 v_pk_max_u16 v41, v41, v40
 v_and_b32 v40, s74, v26
 v_pk_max_u16 v41, v41, v40
 v_and_b32 v40, s74, v27
 v_pk_max_u16 v41, v41, v40
 v_and_b32 v40, s74, v28
 v_pk_max_u16 v41, v41, v40
 v_and_b32 v40, s74, v29
 v_pk_max_u16 v41, v41, v40
 v_and_b32 v40, s74, v30
 v_pk_max_u16 v41, v41, v40
 v_and_b32 v40, s74, v31
 v_pk_max_u16 v41, v41, v40
 v_and_b32 v40, s74, v32
 v_pk_max_u16 v41, v41, v40
 v_and_b32 v40, s74, v33
 v_pk_max_u16 v41, v41, v40
 v_and_b32 v40, s74, v34
 v_pk_max_u16 v41, v41, v40
 v_and_b32 v40, s74, v35
 v_pk_max_u16 v41, v41, v40
 v_and_b32 v40, s74, v36
 v_pk_max_u16 v41, v41, v40
 v_and_b32 v40, s74, v37
 v_pk_max_u16 v41, v41, v40
 v_and_b32 v40, s74, v38
 v_pk_max_u16 v41, v41, v40
 v_and_b32 v40, s74, v39
 v_pk_max_u16 v41, v41, v40
 v_lshrrev_b32 v40, 16, v41
 v_and_b32 v41, 0xffff, v41
 v_max_u32 v40, v40, v41
 v_cmp_lt_u32 vcc, 0x7f81, v40
 s_cbranch_vccz CB1S_sok
 s_max_u32 s68, s68, 1
 s_sub_u32 s68, s68, 1
 s_cmp_lg_u32 s68, 0
 s_cbranch_scc1 CB1S_sl
CB1S_sok:
 s_mov_b32 s60, s50
 s_waitcnt lgkmcnt(0)
 v_mov_b32 v40, 0
 v_mov_b32 v41, 0
 v_mov_b32 v42, 0
 v_mov_b32 v43, 0
 v_mov_b32 v44, 0
 v_mov_b32 v45, 0
 v_mov_b32 v46, 0
 v_mov_b32 v47, 0
 v_mov_b32 v48, 0
 v_mov_b32 v49, 0
 v_mov_b32 v50, 0
 v_mov_b32 v51, 0
 v_mov_b32 v52, 0
 v_mov_b32 v53, 0
 v_mov_b32 v54, 0
 v_mov_b32 v55, 0
 s_branch CB1S_gemm
CB1S_q:
 s_sub_u32 s67, s67, 1
 s_cmp_lt_i32 s67, 0
 s_cbranch_scc1 CB1S_qc
 s_barrier
 v_mov_b32 v40, 0
 v_mov_b32 v41, 0
 v_mov_b32 v42, 0
 v_mov_b32 v43, 0
 v_mov_b32 v44, 0
 v_mov_b32 v45, 0
 v_mov_b32 v46, 0
 v_mov_b32 v47, 0
 v_mov_b32 v48, 0
 v_mov_b32 v49, 0
 v_mov_b32 v50, 0
 v_mov_b32 v51, 0
 s_branch CB1S_bm
CB1S_fin:
 s_add_u32 s70, s47, 7225344
 s_add_u32 s71, s70, 4096
 v_smfmac_f32_16x16x64_bf16 v[48:51], v[12:15], v[144:151], v2
 v_smfmac_f32_16x16x64_bf16 v[48:51], v[16:19], v[152:159], v2
 v_smfmac_f32_16x16x64_bf16 v[48:51], v[20:23], v[160:167], v2
 v_smfmac_f32_16x16x64_bf16 v[48:51], v[24:27], v[168:175], v2
 v_smfmac_f32_16x16x64_bf16 v[48:51], v[28:31], v[176:183], v2
 v_smfmac_f32_16x16x64_bf16 v[48:51], v[32:35], v[184:191], v2
 v_smfmac_f32_16x16x64_bf16 v[48:51], v[36:39], v[192:199], v2
 s_nop 7
 v_add_f32 v48, v48, v50
 v_add_f32 v49, v49, v51
 v_cvt_pk_bf16_f32 v62, v48, v49
 v_smfmac_f32_16x16x64_bf16 v[52:55], v[12:15], v[200:207], v2
 v_smfmac_f32_16x16x64_bf16 v[52:55], v[16:19], v[208:215], v2
 v_smfmac_f32_16x16x64_bf16 v[52:55], v[20:23], v[216:223], v2
 v_smfmac_f32_16x16x64_bf16 v[52:55], v[24:27], v[224:231], v2
 v_smfmac_f32_16x16x64_bf16 v[52:55], v[28:31], v[232:239], v2
 v_smfmac_f32_16x16x64_bf16 v[52:55], v[32:35], v[240:247], v2
 v_smfmac_f32_16x16x64_bf16 v[52:55], v[36:39], v[248:255], v2
 s_nop 7
 v_add_f32 v52, v52, v54
 v_add_f32 v53, v53, v55
 v_cvt_pk_bf16_f32 v63, v52, v53
 v_min_u32 v56, -2, v56
 v_min_u32 v57, -2, v57
 v_min_u32 v58, -2, v58
 v_min_u32 v59, -2, v59
 v_min_u32 v60, -2, v60
 v_min_u32 v61, -2, v61
 v_min_u32 v62, -2, v62
 v_min_u32 v63, -2, v63
 buffer_store_dwordx4 v[56:59], v1, s[16:19], s70 offen sc1
 buffer_store_dwordx4 v[60:63], v1, s[16:19], s71 offen sc1
 s_branch CB1S_end
CB1S_pre:
 s_max_u32 s68, s68, 1
 s_sub_u32 s68, s68, 1
 s_cmp_lg_u32 s68, 0
 s_cbranch_scc0 CB1S_pvok
 s_mov_b32 s61, s50
 buffer_load_dwordx4 v[96:99], v1, s[16:19], s77 offen offset:0 sc1
 buffer_load_dwordx4 v[100:103], v1, s[16:19], s77 offen offset:1024 sc1
 buffer_load_dwordx2 v[104:105], v3, s[16:19], s79 offen sc1
 s_nop 7
 v_mov_b32 v40, 0
 v_mov_b32 v41, 0
 v_mov_b32 v42, 0
 v_mov_b32 v43, 0
 v_mov_b32 v44, 0
 v_mov_b32 v45, 0
 v_mov_b32 v46, 0
 v_mov_b32 v47, 0
 s_branch CB1S_pgo
CB1S_end:
 s_endpgm
.p2align 6
CB2S_start:
 s_mov_b32 s50, 0
 s_mov_b32 s60, 0
 s_mov_b32 s61, -1
 s_mov_b32 s96, 0
 s_mov_b32 s97, 0
 s_mov_b32 s67, 4096
 s_mov_b32 s51, 131072
 s_mov_b32 s52, 151552
 s_mov_b32 s75, 172032
 s_mov_b32 s53, 192512
 s_waitcnt vmcnt(0)
 s_barrier
CB2S_top:
 ds_read_b128 v[64:67], v7 offset:0
 ds_read_b128 v[68:71], v7 offset:1024
 ds_read_b128 v[72:75], v7 offset:2048
 ds_read_b128 v[76:79], v7 offset:3072
 ds_read_b128 v[80:83], v7 offset:4096
 ds_read_b128 v[84:87], v7 offset:5120
 ds_read_b128 v[88:91], v7 offset:6144
 ds_read_b128 v[92:95], v7 offset:7168
 ds_read_b128 v[96:99], v7 offset:8192
 ds_read_b128 v[100:103], v7 offset:9216
 ds_read_b128 v[104:107], v7 offset:10240
 ds_read_b128 v[108:111], v7 offset:11264
 v_mov_b32 v40, 0
 v_mov_b32 v41, 0
 v_mov_b32 v42, 0
 v_mov_b32 v43, 0
 v_mov_b32 v44, 0
 v_mov_b32 v45, 0
 v_mov_b32 v46, 0
 v_mov_b32 v47, 0
 v_mov_b32 v48, 0
 v_mov_b32 v49, 0
 v_mov_b32 v50, 0
 v_mov_b32 v51, 0
 v_mov_b32 v52, 0
 v_mov_b32 v53, 0
 v_mov_b32 v54, 0
 v_mov_b32 v55, 0
 s_add_u32 s54, s50, 1
 v_mov_b32 v5, s54
 s_mul_i32 s56, s50, 458752
 s_add_u32 s56, s56, s44
 s_add_u32 s57, s56, 16384
 s_waitcnt lgkmcnt(0)
CB2S_bm:
 s_barrier
 ds_read_b128 v[12:15], v1 offset:12288
 ds_read_b128 v[16:19], v1 offset:13312
 ds_read_b128 v[20:23], v1 offset:14336
 ds_read_b128 v[24:27], v1 offset:15360
 ds_read_b128 v[28:31], v1 offset:16384
 ds_read_b128 v[32:35], v1 offset:17408
 ds_read_b128 v[36:39], v1 offset:18432
CB2S_gemm:
 s_waitcnt lgkmcnt(6)
 v_smfmac_f32_16x16x64_bf16 v[40:43], v[12:15], v[64:71], v2
 s_waitcnt lgkmcnt(5)
 v_smfmac_f32_16x16x64_bf16 v[40:43], v[16:19], v[72:79], v2
 s_waitcnt lgkmcnt(4)
 v_smfmac_f32_16x16x64_bf16 v[40:43], v[20:23], v[80:87], v2
 v_max3_u32 v11, v12, v16, v20
 s_waitcnt lgkmcnt(3)
 v_smfmac_f32_16x16x64_bf16 v[40:43], v[24:27], v[88:95], v2
 s_waitcnt lgkmcnt(2)
 v_smfmac_f32_16x16x64_bf16 v[40:43], v[28:31], v[96:103], v2
 v_max3_u32 v11, v11, v24, v28
 s_waitcnt lgkmcnt(1)
 v_smfmac_f32_16x16x64_bf16 v[40:43], v[32:35], v[104:111], v2
 s_waitcnt lgkmcnt(0)
 v_smfmac_f32_16x16x64_bf16 v[40:43], v[36:39], a[0:7], v2
 v_max3_u32 v11, v11, v32, v36
 v_smfmac_f32_16x16x64_bf16 v[44:47], v[12:15], a[8:15], v2
 v_cmp_eq_u32 vcc, -1, v11
 v_smfmac_f32_16x16x64_bf16 v[44:47], v[16:19], a[16:23], v2
 v_smfmac_f32_16x16x64_bf16 v[44:47], v[20:23], a[24:31], v2
 s_cbranch_vccnz CB2S_q
CB2S_qc:
 v_smfmac_f32_16x16x64_bf16 v[44:47], v[24:27], a[32:39], v2
 v_add_f32 v40, v40, v42
 v_smfmac_f32_16x16x64_bf16 v[44:47], v[28:31], a[40:47], v2
 v_add_f32 v41, v41, v43
 v_smfmac_f32_16x16x64_bf16 v[44:47], v[32:35], a[48:55], v2
 v_cmp_u_f32 vcc, v40, v41
 v_smfmac_f32_16x16x64_bf16 v[44:47], v[36:39], a[56:63], v2
 s_nop 0
 v_smfmac_f32_16x16x64_bf16 v[48:51], v[12:15], a[64:71], v2
 s_cbranch_vccnz CB2S_slow
CB2S_cont:
 v_smfmac_f32_16x16x64_bf16 v[48:51], v[16:19], a[72:79], v2
 buffer_load_dwordx4 v[64:67], v1, s[16:19], s56 offen offset:0 sc1
 v_cvt_pk_bf16_f32 v56, v40, v41
 v_smfmac_f32_16x16x64_bf16 v[48:51], v[20:23], a[80:87], v2
 v_mov_b32 v40, 0
 v_mov_b32 v41, 0
 v_smfmac_f32_16x16x64_bf16 v[48:51], v[24:27], a[88:95], v2
 buffer_load_dwordx4 v[68:71], v1, s[16:19], s56 offen offset:1024 sc1
 v_mov_b32 v42, 0
 v_smfmac_f32_16x16x64_bf16 v[48:51], v[28:31], a[96:103], v2
 v_mov_b32 v43, 0
 v_add_f32 v44, v44, v46
 v_smfmac_f32_16x16x64_bf16 v[48:51], v[32:35], a[104:111], v2
 buffer_load_dwordx4 v[80:83], v1, s[16:19], s56 offen offset:2048 sc1
 v_add_f32 v45, v45, v47
 v_smfmac_f32_16x16x64_bf16 v[48:51], v[36:39], a[112:119], v2
 v_cvt_pk_bf16_f32 v57, v44, v45
 v_mov_b32 v44, 0
 v_smfmac_f32_16x16x64_bf16 v[52:55], v[12:15], a[120:127], v2
 buffer_load_dwordx4 v[84:87], v1, s[16:19], s56 offen offset:3072 sc1
 v_mov_b32 v45, 0
 v_smfmac_f32_16x16x64_bf16 v[52:55], v[16:19], a[128:135], v2
 v_mov_b32 v46, 0
 v_mov_b32 v47, 0
 v_smfmac_f32_16x16x64_bf16 v[52:55], v[20:23], a[136:143], v2
 buffer_load_dwordx4 v[72:75], v1, s[16:19], s57 offen offset:0 sc1
 v_add_f32 v48, v48, v50
 v_smfmac_f32_16x16x64_bf16 v[52:55], v[24:27], a[144:151], v2
 v_add_f32 v49, v49, v51
 v_cvt_pk_bf16_f32 v58, v48, v49
 v_smfmac_f32_16x16x64_bf16 v[52:55], v[28:31], a[152:159], v2
 buffer_load_dwordx4 v[76:79], v1, s[16:19], s57 offen offset:1024 sc1
 v_mov_b32 v48, 0
 v_smfmac_f32_16x16x64_bf16 v[52:55], v[32:35], a[160:167], v2
 v_mov_b32 v49, 0
 v_mov_b32 v50, 0
 v_smfmac_f32_16x16x64_bf16 v[52:55], v[36:39], a[168:175], v2
 buffer_load_dwordx4 v[88:91], v1, s[16:19], s57 offen offset:2048 sc1
 v_mov_b32 v51, 0
 v_smfmac_f32_16x16x64_bf16 v[40:43], v[12:15], a[176:183], v2
 v_smfmac_f32_16x16x64_bf16 v[40:43], v[16:19], a[184:191], v2
 buffer_load_dwordx4 v[92:95], v1, s[16:19], s57 offen offset:3072 sc1
 v_add_f32 v52, v52, v54
 v_smfmac_f32_16x16x64_bf16 v[40:43], v[20:23], a[192:199], v2
 v_add_f32 v53, v53, v55
 v_cvt_pk_bf16_f32 v59, v52, v53
 v_smfmac_f32_16x16x64_bf16 v[40:43], v[24:27], a[200:207], v2
 v_mov_b32 v52, 0
 v_mov_b32 v53, 0
 v_smfmac_f32_16x16x64_bf16 v[40:43], v[28:31], a[208:215], v2
 v_mov_b32 v54, 0
 v_mov_b32 v55, 0
 v_smfmac_f32_16x16x64_bf16 v[40:43], v[32:35], a[216:223], v2
 v_smfmac_f32_16x16x64_bf16 v[40:43], v[36:39], a[224:231], v2
 v_smfmac_f32_16x16x64_bf16 v[44:47], v[12:15], a[232:239], v2
 v_smfmac_f32_16x16x64_bf16 v[44:47], v[16:19], a[240:247], v2
 v_add_f32 v40, v40, v42
 v_add_f32 v41, v41, v43
 v_smfmac_f32_16x16x64_bf16 v[44:47], v[20:23], a[248:255], v2
 v_cvt_pk_bf16_f32 v60, v40, v41
 v_smfmac_f32_16x16x64_bf16 v[44:47], v[24:27], v[112:119], v2
 v_smfmac_f32_16x16x64_bf16 v[44:47], v[28:31], v[120:127], v2
 v_smfmac_f32_16x16x64_bf16 v[44:47], v[32:35], v[128:135], v2
 v_smfmac_f32_16x16x64_bf16 v[44:47], v[36:39], v[136:143], v2
 s_nop 7
 v_add_f32 v44, v44, v46
 v_add_f32 v45, v45, v47
 v_cvt_pk_bf16_f32 v61, v44, v45
 s_cmp_eq_u32 s50, 63
 s_cbranch_scc1 CB2S_fin
 s_add_u32 s77, s51, 12288
 s_add_u32 s79, s51, 17408
 v_mov_b32 v40, 0
 v_mov_b32 v41, 0
 v_mov_b32 v42, 0
 v_mov_b32 v43, 0
 v_mov_b32 v44, 0
 v_mov_b32 v45, 0
 v_mov_b32 v46, 0
 v_mov_b32 v47, 0
 s_barrier
 buffer_load_dwordx4 v[96:99], v1, s[16:19], s77 offen offset:0 sc1
 v_smfmac_f32_16x16x64_bf16 v[48:51], v[12:15], v[144:151], v2
 buffer_load_dwordx4 v[100:103], v1, s[16:19], s77 offen offset:1024 sc1
 v_smfmac_f32_16x16x64_bf16 v[48:51], v[16:19], v[152:159], v2
 buffer_load_dwordx2 v[104:105], v3, s[16:19], s79 offen sc1
 v_smfmac_f32_16x16x64_bf16 v[48:51], v[20:23], v[160:167], v2
 v_smfmac_f32_16x16x64_bf16 v[48:51], v[24:27], v[168:175], v2
 v_smfmac_f32_16x16x64_bf16 v[48:51], v[28:31], v[176:183], v2
 v_smfmac_f32_16x16x64_bf16 v[48:51], v[32:35], v[184:191], v2
 v_smfmac_f32_16x16x64_bf16 v[48:51], v[36:39], v[192:199], v2
 v_smfmac_f32_16x16x64_bf16 v[52:55], v[12:15], v[200:207], v2
 v_smfmac_f32_16x16x64_bf16 v[52:55], v[16:19], v[208:215], v2
 v_add_f32 v48, v48, v50
 v_smfmac_f32_16x16x64_bf16 v[52:55], v[20:23], v[216:223], v2
 v_add_f32 v49, v49, v51
 v_smfmac_f32_16x16x64_bf16 v[52:55], v[24:27], v[224:231], v2
 v_cvt_pk_bf16_f32 v62, v48, v49
 v_smfmac_f32_16x16x64_bf16 v[52:55], v[28:31], v[232:239], v2
 v_smfmac_f32_16x16x64_bf16 v[52:55], v[32:35], v[240:247], v2
 v_smfmac_f32_16x16x64_bf16 v[52:55], v[36:39], v[248:255], v2
 s_nop 7
 v_add_f32 v48, v52, v54
 v_add_f32 v49, v53, v55
 v_cvt_pk_bf16_f32 v63, v48, v49
CB2S_pgo:
 s_waitcnt vmcnt(2)
 v_smfmac_f32_16x16x64_bf16 v[40:43], v[96:99], v[64:71], v2
 v_max3_u32 v11, v96, v97, v98
 v_smfmac_f32_16x16x64_bf16 v[44:47], v[96:99], v[72:79], v2
 v_max_u32 v11, v11, v99
 s_waitcnt vmcnt(1)
 v_smfmac_f32_16x16x64_bf16 v[40:43], v[100:103], v[80:87], v2
 v_max3_u32 v11, v11, v100, v101
 v_smfmac_f32_16x16x64_bf16 v[44:47], v[100:103], v[88:95], v2
 v_max3_u32 v11, v11, v102, v103
 s_waitcnt vmcnt(0)
 v_max3_u32 v11, v11, v104, v105
 v_smfmac_f32_16x16x32_bf16 v[40:43], v[104:105], v[56:59], v2
 v_cmp_eq_u32 vcc, -1, v11
 v_smfmac_f32_16x16x32_bf16 v[44:47], v[104:105], v[60:63], v2
 s_nop 3
 v_pk_add_f32 v[40:41], v[40:41], v[42:43]
 s_nop 2
 v_pk_add_f32 v[42:43], v[44:45], v[46:47]
 ds_write_b128 v1, v[40:43] offset:22528
 s_cbranch_vccnz CB2S_pre
CB2S_pvok:
 s_waitcnt lgkmcnt(0)
 s_barrier
 s_add_u32 s50, s50, 1
 s_mov_b32 s54, s53
 s_mov_b32 s53, s51
 s_mov_b32 s51, s52
 s_mov_b32 s52, s75
 s_mov_b32 s75, s54
 s_branch CB2S_top
CB2S_slow:
 s_cmp_eq_u32 s60, s50
 s_cbranch_scc1 CB2S_cont
 s_add_u32 s55, s51, 4096
CB2S_sl:
 buffer_load_dwordx4 v[12:15], v1, s[16:19], s51 offen offset:0 sc1
 buffer_load_dwordx4 v[16:19], v1, s[16:19], s51 offen offset:1024 sc1
 buffer_load_dwordx4 v[20:23], v1, s[16:19], s51 offen offset:2048 sc1
 buffer_load_dwordx4 v[24:27], v1, s[16:19], s51 offen offset:3072 sc1
 buffer_load_dwordx4 v[28:31], v1, s[16:19], s55 offen offset:0 sc1
 buffer_load_dwordx4 v[32:35], v1, s[16:19], s55 offen offset:1024 sc1
 buffer_load_dwordx4 v[36:39], v1, s[16:19], s55 offen offset:2048 sc1
 s_waitcnt vmcnt(0)
 v_mov_b32 v41, 0
 v_and_b32 v40, s74, v12
 v_pk_max_u16 v41, v41, v40
 v_and_b32 v40, s74, v13
 v_pk_max_u16 v41, v41, v40
 v_and_b32 v40, s74, v14
 v_pk_max_u16 v41, v41, v40
 v_and_b32 v40, s74, v15
 v_pk_max_u16 v41, v41, v40
 v_and_b32 v40, s74, v16
 v_pk_max_u16 v41, v41, v40
 v_and_b32 v40, s74, v17
 v_pk_max_u16 v41, v41, v40
 v_and_b32 v40, s74, v18
 v_pk_max_u16 v41, v41, v40
 v_and_b32 v40, s74, v19
 v_pk_max_u16 v41, v41, v40
 v_and_b32 v40, s74, v20
 v_pk_max_u16 v41, v41, v40
 v_and_b32 v40, s74, v21
 v_pk_max_u16 v41, v41, v40
 v_and_b32 v40, s74, v22
 v_pk_max_u16 v41, v41, v40
 v_and_b32 v40, s74, v23
 v_pk_max_u16 v41, v41, v40
 v_and_b32 v40, s74, v24
 v_pk_max_u16 v41, v41, v40
 v_and_b32 v40, s74, v25
 v_pk_max_u16 v41, v41, v40
 v_and_b32 v40, s74, v26
 v_pk_max_u16 v41, v41, v40
 v_and_b32 v40, s74, v27
 v_pk_max_u16 v41, v41, v40
 v_and_b32 v40, s74, v28
 v_pk_max_u16 v41, v41, v40
 v_and_b32 v40, s74, v29
 v_pk_max_u16 v41, v41, v40
 v_and_b32 v40, s74, v30
 v_pk_max_u16 v41, v41, v40
 v_and_b32 v40, s74, v31
 v_pk_max_u16 v41, v41, v40
 v_and_b32 v40, s74, v32
 v_pk_max_u16 v41, v41, v40
 v_and_b32 v40, s74, v33
 v_pk_max_u16 v41, v41, v40
 v_and_b32 v40, s74, v34
 v_pk_max_u16 v41, v41, v40
 v_and_b32 v40, s74, v35
 v_pk_max_u16 v41, v41, v40
 v_and_b32 v40, s74, v36
 v_pk_max_u16 v41, v41, v40
 v_and_b32 v40, s74, v37
 v_pk_max_u16 v41, v41, v40
 v_and_b32 v40, s74, v38
 v_pk_max_u16 v41, v41, v40
 v_and_b32 v40, s74, v39
 v_pk_max_u16 v41, v41, v40
 v_lshrrev_b32 v40, 16, v41
 v_and_b32 v41, 0xffff, v41
 v_max_u32 v40, v40, v41
 v_cmp_lt_u32 vcc, 0x7f81, v40
 s_cbranch_vccz CB2S_sok
 s_max_u32 s68, s68, 1
 s_sub_u32 s68, s68, 1
 s_cmp_lg_u32 s68, 0
 s_cbranch_scc1 CB2S_sl
CB2S_sok:
 s_mov_b32 s60, s50
 s_waitcnt lgkmcnt(0)
 v_mov_b32 v40, 0
 v_mov_b32 v41, 0
 v_mov_b32 v42, 0
 v_mov_b32 v43, 0
 v_mov_b32 v44, 0
 v_mov_b32 v45, 0
 v_mov_b32 v46, 0
 v_mov_b32 v47, 0
 v_mov_b32 v48, 0
 v_mov_b32 v49, 0
 v_mov_b32 v50, 0
 v_mov_b32 v51, 0
 v_mov_b32 v52, 0
 v_mov_b32 v53, 0
 v_mov_b32 v54, 0
 v_mov_b32 v55, 0
 s_branch CB2S_gemm
CB2S_q:
 s_sub_u32 s67, s67, 1
 s_cmp_lt_i32 s67, 0
 s_cbranch_scc1 CB2S_qc
 s_barrier
 v_mov_b32 v40, 0
 v_mov_b32 v41, 0
 v_mov_b32 v42, 0
 v_mov_b32 v43, 0
 v_mov_b32 v44, 0
 v_mov_b32 v45, 0
 v_mov_b32 v46, 0
 v_mov_b32 v47, 0
 v_mov_b32 v48, 0
 v_mov_b32 v49, 0
 v_mov_b32 v50, 0
 v_mov_b32 v51, 0
 s_branch CB2S_bm
CB2S_fin:
 s_add_u32 s70, s47, 7225344
 s_add_u32 s71, s70, 4096
 v_smfmac_f32_16x16x64_bf16 v[48:51], v[12:15], v[144:151], v2
 v_smfmac_f32_16x16x64_bf16 v[48:51], v[16:19], v[152:159], v2
 v_smfmac_f32_16x16x64_bf16 v[48:51], v[20:23], v[160:167], v2
 v_smfmac_f32_16x16x64_bf16 v[48:51], v[24:27], v[168:175], v2
 v_smfmac_f32_16x16x64_bf16 v[48:51], v[28:31], v[176:183], v2
 v_smfmac_f32_16x16x64_bf16 v[48:51], v[32:35], v[184:191], v2
 v_smfmac_f32_16x16x64_bf16 v[48:51], v[36:39], v[192:199], v2
 s_nop 7
 v_add_f32 v48, v48, v50
 v_add_f32 v49, v49, v51
 v_cvt_pk_bf16_f32 v62, v48, v49
 v_smfmac_f32_16x16x64_bf16 v[52:55], v[12:15], v[200:207], v2
 v_smfmac_f32_16x16x64_bf16 v[52:55], v[16:19], v[208:215], v2
 v_smfmac_f32_16x16x64_bf16 v[52:55], v[20:23], v[216:223], v2
 v_smfmac_f32_16x16x64_bf16 v[52:55], v[24:27], v[224:231], v2
 v_smfmac_f32_16x16x64_bf16 v[52:55], v[28:31], v[232:239], v2
 v_smfmac_f32_16x16x64_bf16 v[52:55], v[32:35], v[240:247], v2
 v_smfmac_f32_16x16x64_bf16 v[52:55], v[36:39], v[248:255], v2
 s_nop 7
 v_add_f32 v52, v52, v54
 v_add_f32 v53, v53, v55
 v_cvt_pk_bf16_f32 v63, v52, v53
 v_min_u32 v56, -2, v56
 v_min_u32 v57, -2, v57
 v_min_u32 v58, -2, v58
 v_min_u32 v59, -2, v59
 v_min_u32 v60, -2, v60
 v_min_u32 v61, -2, v61
 v_min_u32 v62, -2, v62
 v_min_u32 v63, -2, v63
 buffer_store_dwordx4 v[56:59], v1, s[16:19], s70 offen sc1
 buffer_store_dwordx4 v[60:63], v1, s[16:19], s71 offen sc1
 s_branch CB2S_end
CB2S_pre:
 s_max_u32 s68, s68, 1
 s_sub_u32 s68, s68, 1
 s_cmp_lg_u32 s68, 0
 s_cbranch_scc0 CB2S_pvok
 s_mov_b32 s61, s50
 buffer_load_dwordx4 v[96:99], v1, s[16:19], s77 offen offset:0 sc1
 buffer_load_dwordx4 v[100:103], v1, s[16:19], s77 offen offset:1024 sc1
 buffer_load_dwordx2 v[104:105], v3, s[16:19], s79 offen sc1
 s_nop 7
 v_mov_b32 v40, 0
 v_mov_b32 v41, 0
 v_mov_b32 v42, 0
 v_mov_b32 v43, 0
 v_mov_b32 v44, 0
 v_mov_b32 v45, 0
 v_mov_b32 v46, 0
 v_mov_b32 v47, 0
 s_branch CB2S_pgo
CB2S_end:
 s_endpgm
.p2align 6
CB3S_start:
 s_mov_b32 s50, 0
 s_mov_b32 s60, 0
 s_mov_b32 s61, -1
 s_mov_b32 s96, 0
 s_mov_b32 s97, 0
 s_mov_b32 s67, 4096
 s_mov_b32 s51, 131072
 s_mov_b32 s52, 151552
 s_mov_b32 s75, 172032
 s_mov_b32 s53, 192512
 s_waitcnt vmcnt(0)
 s_barrier
CB3S_top:
 s_mov_b32 s69, 16640
 buffer_load_dword v12, v0, s[16:19], s69 offen sc1
 ds_read_b128 v[64:67], v7 offset:0
 ds_read_b128 v[68:71], v7 offset:1024
 ds_read_b128 v[72:75], v7 offset:2048
 ds_read_b128 v[76:79], v7 offset:3072
 ds_read_b128 v[80:83], v7 offset:4096
 ds_read_b128 v[84:87], v7 offset:5120
 ds_read_b128 v[88:91], v7 offset:6144
 buffer_load_dword v13, v0, s[16:19], s69 offen sc1
 ds_read_b128 v[92:95], v7 offset:7168
 ds_read_b128 v[96:99], v7 offset:8192
 ds_read_b128 v[100:103], v7 offset:9216
 ds_read_b128 v[104:107], v7 offset:10240
 ds_read_b128 v[108:111], v7 offset:11264
 v_mov_b32 v40, 0
 v_mov_b32 v41, 0
 buffer_load_dword v14, v0, s[16:19], s69 offen sc1
 v_mov_b32 v42, 0
 v_mov_b32 v43, 0
 v_mov_b32 v44, 0
 v_mov_b32 v45, 0
 v_mov_b32 v46, 0
 v_mov_b32 v47, 0
 v_mov_b32 v48, 0
 buffer_load_dword v15, v0, s[16:19], s69 offen sc1
 v_mov_b32 v49, 0
 v_mov_b32 v50, 0
 v_mov_b32 v51, 0
 v_mov_b32 v52, 0
 v_mov_b32 v53, 0
 v_mov_b32 v54, 0
 v_mov_b32 v55, 0
 s_add_u32 s54, s50, 1
 v_mov_b32 v5, s54
 s_mul_i32 s56, s50, 458752
 s_add_u32 s56, s56, s44
 s_add_u32 s57, s56, 16384
 s_waitcnt lgkmcnt(0)
 s_mov_b32 s69, 16640
 s_add_u32 s55, s51, 4096
 s_mov_b32 m0, 12288
CB3Sfm_pl:
 s_waitcnt vmcnt(3)
 v_cmp_gt_u32 vcc, s50, v12
 s_cbranch_vccz CB3Sfm_pd
 buffer_load_dword v12, v0, s[16:19], s69 offen sc1
 s_waitcnt vmcnt(3)
 v_cmp_gt_u32 vcc, s50, v13
 s_cbranch_vccz CB3Sfm_pd
 buffer_load_dword v13, v0, s[16:19], s69 offen sc1
 s_waitcnt vmcnt(3)
 v_cmp_gt_u32 vcc, s50, v14
 s_cbranch_vccz CB3Sfm_pd
 buffer_load_dword v14, v0, s[16:19], s69 offen sc1
 s_waitcnt vmcnt(3)
 v_cmp_gt_u32 vcc, s50, v15
 s_cbranch_vccz CB3Sfm_pd
 buffer_load_dword v15, v0, s[16:19], s69 offen sc1
 s_max_u32 s68, s68, 1
 s_sub_u32 s68, s68, 1
 s_cmp_lg_u32 s68, 0
 s_cbranch_scc1 CB3Sfm_pl
CB3Sfm_pd:
 buffer_load_dwordx4 v1, s[16:19], s51 offen offset:0 sc1 lds
 buffer_load_dwordx4 v1, s[16:19], s51 offen offset:1024 sc1 lds
 buffer_load_dwordx4 v1, s[16:19], s51 offen offset:2048 sc1 lds
 buffer_load_dwordx4 v1, s[16:19], s51 offen offset:3072 sc1 lds
 s_mov_b32 m0, 16384
 s_nop 0
 buffer_load_dwordx4 v1, s[16:19], s55 offen offset:0 sc1 lds
 buffer_load_dwordx4 v1, s[16:19], s55 offen offset:1024 sc1 lds
 buffer_load_dwordx4 v1, s[16:19], s55 offen offset:2048 sc1 lds
 s_waitcnt vmcnt(0)
CB3S_bm:
 s_barrier
 ds_read_b128 v[12:15], v1 offset:12288
 ds_read_b128 v[16:19], v1 offset:13312
 ds_read_b128 v[20:23], v1 offset:14336
 ds_read_b128 v[24:27], v1 offset:15360
 ds_read_b128 v[28:31], v1 offset:16384
 ds_read_b128 v[32:35], v1 offset:17408
 ds_read_b128 v[36:39], v1 offset:18432
CB3S_gemm:
 s_waitcnt lgkmcnt(6)
 v_smfmac_f32_16x16x64_bf16 v[40:43], v[12:15], v[64:71], v2
 s_waitcnt lgkmcnt(5)
 v_smfmac_f32_16x16x64_bf16 v[40:43], v[16:19], v[72:79], v2
 s_waitcnt lgkmcnt(4)
 v_smfmac_f32_16x16x64_bf16 v[40:43], v[20:23], v[80:87], v2
 v_max3_u32 v11, v12, v16, v20
 s_waitcnt lgkmcnt(3)
 v_smfmac_f32_16x16x64_bf16 v[40:43], v[24:27], v[88:95], v2
 s_waitcnt lgkmcnt(2)
 v_smfmac_f32_16x16x64_bf16 v[40:43], v[28:31], v[96:103], v2
 v_max3_u32 v11, v11, v24, v28
 s_waitcnt lgkmcnt(1)
 v_smfmac_f32_16x16x64_bf16 v[40:43], v[32:35], v[104:111], v2
 s_waitcnt lgkmcnt(0)
 v_smfmac_f32_16x16x64_bf16 v[40:43], v[36:39], a[0:7], v2
 v_max3_u32 v11, v11, v32, v36
 v_smfmac_f32_16x16x64_bf16 v[44:47], v[12:15], a[8:15], v2
 v_cmp_eq_u32 vcc, -1, v11
 v_smfmac_f32_16x16x64_bf16 v[44:47], v[16:19], a[16:23], v2
 v_smfmac_f32_16x16x64_bf16 v[44:47], v[20:23], a[24:31], v2
 s_cbranch_vccnz CB3S_q
CB3S_qc:
 v_smfmac_f32_16x16x64_bf16 v[44:47], v[24:27], a[32:39], v2
 v_add_f32 v40, v40, v42
 v_smfmac_f32_16x16x64_bf16 v[44:47], v[28:31], a[40:47], v2
 v_add_f32 v41, v41, v43
 v_smfmac_f32_16x16x64_bf16 v[44:47], v[32:35], a[48:55], v2
 v_cmp_u_f32 vcc, v40, v41
 v_smfmac_f32_16x16x64_bf16 v[44:47], v[36:39], a[56:63], v2
 s_nop 0
 v_smfmac_f32_16x16x64_bf16 v[48:51], v[12:15], a[64:71], v2
 s_cbranch_vccnz CB3S_slow
CB3S_cont:
 v_smfmac_f32_16x16x64_bf16 v[48:51], v[16:19], a[72:79], v2
 buffer_load_dwordx4 v[64:67], v1, s[16:19], s56 offen offset:0 sc1
 v_cvt_pk_bf16_f32 v56, v40, v41
 v_smfmac_f32_16x16x64_bf16 v[48:51], v[20:23], a[80:87], v2
 v_mov_b32 v40, 0
 v_mov_b32 v41, 0
 v_smfmac_f32_16x16x64_bf16 v[48:51], v[24:27], a[88:95], v2
 buffer_load_dwordx4 v[68:71], v1, s[16:19], s56 offen offset:1024 sc1
 v_mov_b32 v42, 0
 v_smfmac_f32_16x16x64_bf16 v[48:51], v[28:31], a[96:103], v2
 v_mov_b32 v43, 0
 v_add_f32 v44, v44, v46
 v_smfmac_f32_16x16x64_bf16 v[48:51], v[32:35], a[104:111], v2
 buffer_load_dwordx4 v[80:83], v1, s[16:19], s56 offen offset:2048 sc1
 v_add_f32 v45, v45, v47
 v_smfmac_f32_16x16x64_bf16 v[48:51], v[36:39], a[112:119], v2
 v_cvt_pk_bf16_f32 v57, v44, v45
 v_mov_b32 v44, 0
 v_smfmac_f32_16x16x64_bf16 v[52:55], v[12:15], a[120:127], v2
 buffer_load_dwordx4 v[84:87], v1, s[16:19], s56 offen offset:3072 sc1
 v_mov_b32 v45, 0
 v_smfmac_f32_16x16x64_bf16 v[52:55], v[16:19], a[128:135], v2
 v_mov_b32 v46, 0
 v_mov_b32 v47, 0
 v_smfmac_f32_16x16x64_bf16 v[52:55], v[20:23], a[136:143], v2
 buffer_load_dwordx4 v[72:75], v1, s[16:19], s57 offen offset:0 sc1
 v_add_f32 v48, v48, v50
 v_smfmac_f32_16x16x64_bf16 v[52:55], v[24:27], a[144:151], v2
 v_add_f32 v49, v49, v51
 v_cvt_pk_bf16_f32 v58, v48, v49
 v_smfmac_f32_16x16x64_bf16 v[52:55], v[28:31], a[152:159], v2
 buffer_load_dwordx4 v[76:79], v1, s[16:19], s57 offen offset:1024 sc1
 v_mov_b32 v48, 0
 v_smfmac_f32_16x16x64_bf16 v[52:55], v[32:35], a[160:167], v2
 v_mov_b32 v49, 0
 v_mov_b32 v50, 0
 v_smfmac_f32_16x16x64_bf16 v[52:55], v[36:39], a[168:175], v2
 buffer_load_dwordx4 v[88:91], v1, s[16:19], s57 offen offset:2048 sc1
 v_mov_b32 v51, 0
 v_smfmac_f32_16x16x64_bf16 v[40:43], v[12:15], a[176:183], v2
 v_smfmac_f32_16x16x64_bf16 v[40:43], v[16:19], a[184:191], v2
 buffer_load_dwordx4 v[92:95], v1, s[16:19], s57 offen offset:3072 sc1
 v_add_f32 v52, v52, v54
 v_smfmac_f32_16x16x64_bf16 v[40:43], v[20:23], a[192:199], v2
 v_add_f32 v53, v53, v55
 v_cvt_pk_bf16_f32 v59, v52, v53
 v_smfmac_f32_16x16x64_bf16 v[40:43], v[24:27], a[200:207], v2
 v_mov_b32 v52, 0
 v_mov_b32 v53, 0
 v_smfmac_f32_16x16x64_bf16 v[40:43], v[28:31], a[208:215], v2
 v_mov_b32 v54, 0
 v_mov_b32 v55, 0
 v_smfmac_f32_16x16x64_bf16 v[40:43], v[32:35], a[216:223], v2
 v_smfmac_f32_16x16x64_bf16 v[40:43], v[36:39], a[224:231], v2
 v_smfmac_f32_16x16x64_bf16 v[44:47], v[12:15], a[232:239], v2
 v_smfmac_f32_16x16x64_bf16 v[44:47], v[16:19], a[240:247], v2
 v_add_f32 v40, v40, v42
 v_add_f32 v41, v41, v43
 v_smfmac_f32_16x16x64_bf16 v[44:47], v[20:23], a[248:255], v2
 v_cvt_pk_bf16_f32 v60, v40, v41
 v_smfmac_f32_16x16x64_bf16 v[44:47], v[24:27], v[112:119], v2
 v_smfmac_f32_16x16x64_bf16 v[44:47], v[28:31], v[120:127], v2
 v_smfmac_f32_16x16x64_bf16 v[44:47], v[32:35], v[128:135], v2
 v_smfmac_f32_16x16x64_bf16 v[44:47], v[36:39], v[136:143], v2
 s_nop 7
 v_add_f32 v44, v44, v46
 v_add_f32 v45, v45, v47
 v_cvt_pk_bf16_f32 v61, v44, v45
 s_cmp_eq_u32 s50, 63
 s_cbranch_scc1 CB3S_fin
 s_add_u32 s77, s51, 14336
 s_add_u32 s79, s51, 17920
 v_mov_b32 v40, 0
 v_mov_b32 v41, 0
 v_mov_b32 v42, 0
 v_mov_b32 v43, 0
 v_mov_b32 v44, 0
 v_mov_b32 v45, 0
 v_mov_b32 v46, 0
 v_mov_b32 v47, 0
 s_barrier
 buffer_load_dwordx4 v[96:99], v1, s[16:19], s77 offen offset:0 sc1
 v_smfmac_f32_16x16x64_bf16 v[48:51], v[12:15], v[144:151], v2
 buffer_load_dwordx4 v[100:103], v1, s[16:19], s77 offen offset:1024 sc1
 v_smfmac_f32_16x16x64_bf16 v[48:51], v[16:19], v[152:159], v2
 buffer_load_dwordx2 v[104:105], v3, s[16:19], s79 offen sc1
 v_smfmac_f32_16x16x64_bf16 v[48:51], v[20:23], v[160:167], v2
 v_smfmac_f32_16x16x64_bf16 v[48:51], v[24:27], v[168:175], v2
 v_smfmac_f32_16x16x64_bf16 v[48:51], v[28:31], v[176:183], v2
 v_smfmac_f32_16x16x64_bf16 v[48:51], v[32:35], v[184:191], v2
 v_smfmac_f32_16x16x64_bf16 v[48:51], v[36:39], v[192:199], v2
 v_smfmac_f32_16x16x64_bf16 v[52:55], v[12:15], v[200:207], v2
 v_smfmac_f32_16x16x64_bf16 v[52:55], v[16:19], v[208:215], v2
 v_add_f32 v48, v48, v50
 v_smfmac_f32_16x16x64_bf16 v[52:55], v[20:23], v[216:223], v2
 v_add_f32 v49, v49, v51
 v_smfmac_f32_16x16x64_bf16 v[52:55], v[24:27], v[224:231], v2
 v_cvt_pk_bf16_f32 v62, v48, v49
 v_smfmac_f32_16x16x64_bf16 v[52:55], v[28:31], v[232:239], v2
 v_smfmac_f32_16x16x64_bf16 v[52:55], v[32:35], v[240:247], v2
 v_smfmac_f32_16x16x64_bf16 v[52:55], v[36:39], v[248:255], v2
 s_nop 7
 v_add_f32 v48, v52, v54
 v_add_f32 v49, v53, v55
 v_cvt_pk_bf16_f32 v63, v48, v49
CB3S_pgo:
 s_waitcnt vmcnt(2)
 v_smfmac_f32_16x16x64_bf16 v[40:43], v[96:99], v[64:71], v2
 v_max3_u32 v11, v96, v97, v98
 v_smfmac_f32_16x16x64_bf16 v[44:47], v[96:99], v[72:79], v2
 v_max_u32 v11, v11, v99
 s_waitcnt vmcnt(1)
 v_smfmac_f32_16x16x64_bf16 v[40:43], v[100:103], v[80:87], v2
 v_max3_u32 v11, v11, v100, v101
 v_smfmac_f32_16x16x64_bf16 v[44:47], v[100:103], v[88:95], v2
 v_max3_u32 v11, v11, v102, v103
 s_waitcnt vmcnt(0)
 v_max3_u32 v11, v11, v104, v105
 v_smfmac_f32_16x16x32_bf16 v[40:43], v[104:105], v[56:59], v2
 v_cmp_eq_u32 vcc, -1, v11
 v_smfmac_f32_16x16x32_bf16 v[44:47], v[104:105], v[60:63], v2
 s_nop 3
 v_pk_add_f32 v[40:41], v[40:41], v[42:43]
 s_nop 2
 v_pk_add_f32 v[42:43], v[44:45], v[46:47]
 ds_write_b128 v1, v[40:43] offset:23552
 s_cbranch_vccnz CB3S_pre
CB3S_pvok:
 s_waitcnt lgkmcnt(0)
 s_barrier
 buffer_store_dword v5, v4, s[16:19], 0 offen sc1
 s_add_u32 s50, s50, 1
 s_mov_b32 s54, s53
 s_mov_b32 s53, s51
 s_mov_b32 s51, s52
 s_mov_b32 s52, s75
 s_mov_b32 s75, s54
 s_branch CB3S_top
CB3S_slow:
 s_cmp_eq_u32 s60, s50
 s_cbranch_scc1 CB3S_cont
 s_add_u32 s55, s51, 4096
CB3S_sl:
 buffer_load_dwordx4 v[12:15], v1, s[16:19], s51 offen offset:0 sc1
 buffer_load_dwordx4 v[16:19], v1, s[16:19], s51 offen offset:1024 sc1
 buffer_load_dwordx4 v[20:23], v1, s[16:19], s51 offen offset:2048 sc1
 buffer_load_dwordx4 v[24:27], v1, s[16:19], s51 offen offset:3072 sc1
 buffer_load_dwordx4 v[28:31], v1, s[16:19], s55 offen offset:0 sc1
 buffer_load_dwordx4 v[32:35], v1, s[16:19], s55 offen offset:1024 sc1
 buffer_load_dwordx4 v[36:39], v1, s[16:19], s55 offen offset:2048 sc1
 s_waitcnt vmcnt(0)
 v_mov_b32 v41, 0
 v_and_b32 v40, s74, v12
 v_pk_max_u16 v41, v41, v40
 v_and_b32 v40, s74, v13
 v_pk_max_u16 v41, v41, v40
 v_and_b32 v40, s74, v14
 v_pk_max_u16 v41, v41, v40
 v_and_b32 v40, s74, v15
 v_pk_max_u16 v41, v41, v40
 v_and_b32 v40, s74, v16
 v_pk_max_u16 v41, v41, v40
 v_and_b32 v40, s74, v17
 v_pk_max_u16 v41, v41, v40
 v_and_b32 v40, s74, v18
 v_pk_max_u16 v41, v41, v40
 v_and_b32 v40, s74, v19
 v_pk_max_u16 v41, v41, v40
 v_and_b32 v40, s74, v20
 v_pk_max_u16 v41, v41, v40
 v_and_b32 v40, s74, v21
 v_pk_max_u16 v41, v41, v40
 v_and_b32 v40, s74, v22
 v_pk_max_u16 v41, v41, v40
 v_and_b32 v40, s74, v23
 v_pk_max_u16 v41, v41, v40
 v_and_b32 v40, s74, v24
 v_pk_max_u16 v41, v41, v40
 v_and_b32 v40, s74, v25
 v_pk_max_u16 v41, v41, v40
 v_and_b32 v40, s74, v26
 v_pk_max_u16 v41, v41, v40
 v_and_b32 v40, s74, v27
 v_pk_max_u16 v41, v41, v40
 v_and_b32 v40, s74, v28
 v_pk_max_u16 v41, v41, v40
 v_and_b32 v40, s74, v29
 v_pk_max_u16 v41, v41, v40
 v_and_b32 v40, s74, v30
 v_pk_max_u16 v41, v41, v40
 v_and_b32 v40, s74, v31
 v_pk_max_u16 v41, v41, v40
 v_and_b32 v40, s74, v32
 v_pk_max_u16 v41, v41, v40
 v_and_b32 v40, s74, v33
 v_pk_max_u16 v41, v41, v40
 v_and_b32 v40, s74, v34
 v_pk_max_u16 v41, v41, v40
 v_and_b32 v40, s74, v35
 v_pk_max_u16 v41, v41, v40
 v_and_b32 v40, s74, v36
 v_pk_max_u16 v41, v41, v40
 v_and_b32 v40, s74, v37
 v_pk_max_u16 v41, v41, v40
 v_and_b32 v40, s74, v38
 v_pk_max_u16 v41, v41, v40
 v_and_b32 v40, s74, v39
 v_pk_max_u16 v41, v41, v40
 v_lshrrev_b32 v40, 16, v41
 v_and_b32 v41, 0xffff, v41
 v_max_u32 v40, v40, v41
 v_cmp_lt_u32 vcc, 0x7f81, v40
 s_cbranch_vccz CB3S_sok
 s_max_u32 s68, s68, 1
 s_sub_u32 s68, s68, 1
 s_cmp_lg_u32 s68, 0
 s_cbranch_scc1 CB3S_sl
CB3S_sok:
 s_mov_b32 s60, s50
 s_waitcnt lgkmcnt(0)
 v_mov_b32 v40, 0
 v_mov_b32 v41, 0
 v_mov_b32 v42, 0
 v_mov_b32 v43, 0
 v_mov_b32 v44, 0
 v_mov_b32 v45, 0
 v_mov_b32 v46, 0
 v_mov_b32 v47, 0
 v_mov_b32 v48, 0
 v_mov_b32 v49, 0
 v_mov_b32 v50, 0
 v_mov_b32 v51, 0
 v_mov_b32 v52, 0
 v_mov_b32 v53, 0
 v_mov_b32 v54, 0
 v_mov_b32 v55, 0
 s_branch CB3S_gemm
CB3S_q:
 s_sub_u32 s67, s67, 1
 s_cmp_lt_i32 s67, 0
 s_cbranch_scc1 CB3S_qc
 s_barrier
 s_mov_b32 m0, 12288
 s_nop 0
 buffer_load_dwordx4 v1, s[16:19], s51 offen offset:0 sc1 lds
 buffer_load_dwordx4 v1, s[16:19], s51 offen offset:1024 sc1 lds
 buffer_load_dwordx4 v1, s[16:19], s51 offen offset:2048 sc1 lds
 buffer_load_dwordx4 v1, s[16:19], s51 offen offset:3072 sc1 lds
 s_mov_b32 m0, 16384
 s_nop 0
 buffer_load_dwordx4 v1, s[16:19], s55 offen offset:0 sc1 lds
 buffer_load_dwordx4 v1, s[16:19], s55 offen offset:1024 sc1 lds
 buffer_load_dwordx4 v1, s[16:19], s55 offen offset:2048 sc1 lds
 v_mov_b32 v40, 0
 v_mov_b32 v41, 0
 v_mov_b32 v42, 0
 v_mov_b32 v43, 0
 v_mov_b32 v44, 0
 v_mov_b32 v45, 0
 v_mov_b32 v46, 0
 v_mov_b32 v47, 0
 v_mov_b32 v48, 0
 v_mov_b32 v49, 0
 v_mov_b32 v50, 0
 v_mov_b32 v51, 0
 s_waitcnt vmcnt(0)
 s_branch CB3S_bm
CB3S_fin:
 s_add_u32 s70, s47, 7225344
 s_add_u32 s71, s70, 4096
 v_smfmac_f32_16x16x64_bf16 v[48:51], v[12:15], v[144:151], v2
 v_smfmac_f32_16x16x64_bf16 v[48:51], v[16:19], v[152:159], v2
 v_smfmac_f32_16x16x64_bf16 v[48:51], v[20:23], v[160:167], v2
 v_smfmac_f32_16x16x64_bf16 v[48:51], v[24:27], v[168:175], v2
 v_smfmac_f32_16x16x64_bf16 v[48:51], v[28:31], v[176:183], v2
 v_smfmac_f32_16x16x64_bf16 v[48:51], v[32:35], v[184:191], v2
 v_smfmac_f32_16x16x64_bf16 v[48:51], v[36:39], v[192:199], v2
 s_nop 7
 v_add_f32 v48, v48, v50
 v_add_f32 v49, v49, v51
 v_cvt_pk_bf16_f32 v62, v48, v49
 v_smfmac_f32_16x16x64_bf16 v[52:55], v[12:15], v[200:207], v2
 v_smfmac_f32_16x16x64_bf16 v[52:55], v[16:19], v[208:215], v2
 v_smfmac_f32_16x16x64_bf16 v[52:55], v[20:23], v[216:223], v2
 v_smfmac_f32_16x16x64_bf16 v[52:55], v[24:27], v[224:231], v2
 v_smfmac_f32_16x16x64_bf16 v[52:55], v[28:31], v[232:239], v2
 v_smfmac_f32_16x16x64_bf16 v[52:55], v[32:35], v[240:247], v2
 v_smfmac_f32_16x16x64_bf16 v[52:55], v[36:39], v[248:255], v2
 s_nop 7
 v_add_f32 v52, v52, v54
 v_add_f32 v53, v53, v55
 v_cvt_pk_bf16_f32 v63, v52, v53
 v_min_u32 v56, -2, v56
 v_min_u32 v57, -2, v57
 v_min_u32 v58, -2, v58
 v_min_u32 v59, -2, v59
 v_min_u32 v60, -2, v60
 v_min_u32 v61, -2, v61
 v_min_u32 v62, -2, v62
 v_min_u32 v63, -2, v63
 buffer_store_dwordx4 v[56:59], v1, s[16:19], s70 offen sc1
 buffer_store_dwordx4 v[60:63], v1, s[16:19], s71 offen sc1
 s_branch CB3S_end
CB3S_pre:
 s_max_u32 s68, s68, 1
 s_sub_u32 s68, s68, 1
 s_cmp_lg_u32 s68, 0
 s_cbranch_scc0 CB3S_pvok
 s_mov_b32 s61, s50
 buffer_load_dwordx4 v[96:99], v1, s[16:19], s77 offen offset:0 sc1
 buffer_load_dwordx4 v[100:103], v1, s[16:19], s77 offen offset:1024 sc1
 buffer_load_dwordx2 v[104:105], v3, s[16:19], s79 offen sc1
 s_nop 7
 v_mov_b32 v40, 0
 v_mov_b32 v41, 0
 v_mov_b32 v42, 0
 v_mov_b32 v43, 0
 v_mov_b32 v44, 0
 v_mov_b32 v45, 0
 v_mov_b32 v46, 0
 v_mov_b32 v47, 0
 s_branch CB3S_pgo
CB3S_end:
 s_endpgm
CODE_END:
 s_endpgm
.section .rodata,"a"
.p2align 6
.amdhsa_kernel sequential_preLN__memory_aug_recurrent_mem_tr__mixer_channel_mlp__prompt_kernel
  .amdhsa_next_free_vgpr 512
  .amdhsa_next_free_sgpr 102
  .amdhsa_accum_offset 256
  .amdhsa_group_segment_fixed_size 0
  .amdhsa_kernarg_size 120
  .amdhsa_user_sgpr_count 2
  .amdhsa_user_sgpr_kernarg_segment_ptr 1
  .amdhsa_system_sgpr_workgroup_id_x 1
  .amdhsa_float_denorm_mode_32 3
  .amdhsa_ieee_mode 0
.end_amdhsa_kernel
```
